```python
import torch

def _softmax(x, axis=-1):
    return torch.softmax(x, dim=axis)
def _gelu(x):
    return torch.nn.functional.gelu(x, approximate="tanh")
def _silu(x):
    return torch.nn.functional.silu(x)
def _sigmoid(x):
    return torch.sigmoid(x)
def _layernorm(x, axis=-1, eps=1e-5):
    m = x.mean(dim=axis, keepdim=True)
    v = x.var(dim=axis, keepdim=True, unbiased=False)
    return (x - m) / torch.sqrt(v + eps)
def _scatter_add(tgt, idx, src, axis=0):
    return tgt.clone().index_add_(axis, idx, src)
def _segment_sum(src, seg, n):
    out = torch.zeros((n,) + src.shape[1:], dtype=src.dtype)
    return out.index_add_(0, seg, src)
def _pad(x, pw):
    flat = tuple(v for pair in reversed(pw) for v in pair)
    return torch.nn.functional.pad(x, flat)

kernel_name = 'parallel_sum__linear_attn_block__mixer_s_mlp__prompt'

def setup_inputs():

    _w = (lambda a: (lambda t: t.to(torch.bfloat16) if t.is_floating_point() else t)(torch.as_tensor(a)))
    def _A_setup():
        B, S, D = 1, 2048, 640
        return {
            "x": _w((lambda *s: torch.randn(*s, dtype=torch.bfloat16) * 0.05)(B, S, D)),
            "wqkv": _w((lambda *s: torch.randn(*s, dtype=torch.bfloat16) * 0.2)(D, 3 * D)),
            "wo": _w((lambda *s: torch.randn(*s, dtype=torch.bfloat16) * 0.1)(D, D)),
        }
    _A_in = _A_setup()

    def _B_setup():
        B, S, D, F = 1, 2048, 640, 1536
        return {
            "x":  _w((lambda *s: torch.randn(*s, dtype=torch.bfloat16) * 0.05)(B, S, D)),
            "w1": _w((lambda *s: torch.randn(*s, dtype=torch.bfloat16) * 0.8)(D, D) * (D ** -0.5)),
            "w2": _w((lambda *s: torch.randn(*s, dtype=torch.bfloat16) * 0.8)(D, D) * (D ** -0.5)),
            "w3": _w((lambda *s: torch.randn(*s, dtype=torch.bfloat16) * 0.8)(D, F) * (D ** -0.5)),
            "w4": _w((lambda *s: torch.randn(*s, dtype=torch.bfloat16) * 0.8)(F, D) * (F ** -0.5)),
        }
    _B_in = _B_setup()

    return {
        "A_x": _A_in["x"],
        "A_wqkv": _A_in["wqkv"],
        "A_wo": _A_in["wo"],
        "B_x": _B_in["x"],
        "B_w1": _B_in["w1"],
        "B_w2": _B_in["w2"],
        "B_w3": _B_in["w3"],
        "B_w4": _B_in["w4"],
    }

def reference(A_x, A_wqkv, A_wo, B_x, B_w1, B_w2, B_w3, B_w4):
    def _A_ref(x, wqkv, wo):
        B, S, D = x.shape
        H = 32; Dh = D // H
        qkv = (lambda x, *d: x.permute(*d))((x @ wqkv).reshape(B, S, 3, H, Dh), 2, 0, 3, 1, 4)
        q, k, v = qkv[0], qkv[1], qkv[2]
        phi = lambda t: torch.where(t > 0, t + 1, torch.exp(t)) + 1e-6
        pq, pk = phi(q), phi(k)
        kv = torch.einsum("bhsd,bhse->bhde", pk, v)
        z = torch.einsum("bhsd->bhd", pk)
        num = torch.einsum("bhqd,bhde->bhqe", pq, kv)
        den = torch.einsum("bhqd,bhd->bhq", pq, z)[..., None] + 1e-6
        o = num / den
        return (lambda x, *d: x.permute(*d))(o, 0, 2, 1, 3).reshape(B, S, D) @ wo

    def _B_ref(x, w1, w2, w3, w4):
        B, S, D = x.shape
        h = _gelu(_layernorm(x, axis=-1) @ w1)
        c = D // 4
        g0 = _pad(h[:, :, 0*c:1*c], ((0, 0), (1, 0), (0, 0)))[:, :S, :]
        g1 = _pad(h[:, :, 1*c:2*c], ((0, 0), (0, 1), (0, 0)))[:, 1:, :]
        g2 = _pad(h[:, :, 2*c:3*c], ((0, 0), (2, 0), (0, 0)))[:, :S, :]
        g3 = _pad(h[:, :, 3*c:   ], ((0, 0), (0, 2), (0, 0)))[:, 2:, :]
        hs = torch.concatenate([g0, g1, g2, g3], axis=-1) @ w2
        x1 = x + hs
        h2 = _gelu(_layernorm(x1, axis=-1) @ w3) @ w4
        return x1 + h2

    x = A_x
    xn = _layernorm(x, axis=-1)
    return x + _A_ref(xn, A_wqkv, A_wo) + _B_ref(xn, B_w1, B_w2, B_w3, B_w4)
```

```asm
; @launch grid=(256,1,1) block=(512,1,1) lds=163840
.amdgcn_target "amdgcn-amd-amdhsa--gfx950"
.text
.globl parallel_sum__linear_attn_block__mixer_s_mlp__prompt_kernel
.p2align 8
.type parallel_sum__linear_attn_block__mixer_s_mlp__prompt_kernel,@function
parallel_sum__linear_attn_block__mixer_s_mlp__prompt_kernel:
s_cmp_ge_u32 s2, 256
s_cbranch_scc1 L_end
s_getpc_b64 s[64:65]
L_pc:
s_lshr_b32 s55, s2, 3
s_mul_i32 s50, s55, 3072
v_min_u32 v9, 191, v0
v_lshl_add_u32 v9, v9, 4, s50
v_min_u32 v9, L_codeend-L_pc-16, v9
global_load_dwordx4 a[76:79], v9, s[64:65]
v_and_b32 v1, 63, v0
v_mov_b32 v3, 163328
v_mov_b32 v2, 0
v_lshl_add_u32 v9, v1, 2, v3
ds_write_b32 v9, v2
v_lshrrev_b32 v9, 6, v0
v_lshlrev_b32 v4, 4, v1
v_readfirstlane_b32 s52, v9
s_waitcnt lgkmcnt(0)
s_load_dwordx4 s[88:91], s[0:1], 0
s_load_dwordx8 s[92:99], s[0:1], 32
s_load_dwordx2 s[36:37], s[0:1], 80
s_load_dwordx2 s[12:13], s[0:1], 16
s_load_dwordx2 s[32:33], s[0:1], 64
s_barrier
s_and_b32 s56, s2, 3
s_bfe_u32 s57, s2, 0x10002
s_and_b32 s50, s55, 3
s_lshl2_add_u32 s58, s56, s50
s_lshr_b32 s59, s55, 2
s_lshr_b32 s63, s55, 3
s_and_b32 s61, s55, 7
s_lshl3_add_u32 s62, s57, s61
s_lshl1_add_u32 s48, s56, s57
s_lshl2_add_u32 s60, s48, s63
s_mov_b32 s54, 2000000
s_cmp_eq_u32 s52, 4
s_cbranch_scc1 L_load0
s_cmp_lt_u32 s52, 4
s_cbranch_scc1 L_comp
s_cmp_ge_u32 s52, 6
s_cbranch_scc1 L_job
L_load1:
s_setprio 3
s_lshl3_add_u32 s48, s57, s59
s_add_u32 s48, s48, s58
s_and_b32 s48, s48, 1
s_mul_i32 s48, s48, 10
s_lshr_b32 s64, s48, 1
s_lshl_b32 s65, s64, 7
s_mov_b32 s10, 2457600
s_mov_b32 s11, 0x20000
s_mov_b32 s18, 819200
s_mov_b32 s19, 0x20000
s_cmp_lt_u32 s59, 4
s_cbranch_scc0 L_load23
s_lshl2_add_u32 s67, s57, s59
s_mul_i32 s67, s67, 160
s_mul_i32 s66, s64, 245760
s_add_u32 s66, s66, s67
v_add_u32 v32, 0, v1
v_mul_u32_u24 v29, 3277, v32
v_lshrrev_b32 v29, 16, v29
v_mul_u32_u24 v30, 20, v29
v_sub_u32 v30, v32, v30
v_lshrrev_b32 v32, 2, v29
v_and_b32 v32, 2, v32
v_xor_b32 v30, v30, v32
v_cmp_le_u32 vcc, 10, v30
v_mov_b32 v31, 1120
v_mul_u32_u24 v29, 3840, v29
v_cndmask_b32 v31, 0, v31, vcc
v_lshlrev_b32 v30, 4, v30
v_add3_u32 v24, v29, v30, v31
v_add_u32 v24, 1280, v24
v_add_u32 v32, 64, v1
v_mul_u32_u24 v29, 3277, v32
v_lshrrev_b32 v29, 16, v29
v_mul_u32_u24 v30, 20, v29
v_sub_u32 v30, v32, v30
v_lshrrev_b32 v32, 2, v29
v_and_b32 v32, 2, v32
v_xor_b32 v30, v30, v32
v_cmp_le_u32 vcc, 10, v30
v_mov_b32 v31, 1120
v_mul_u32_u24 v29, 3840, v29
v_cndmask_b32 v31, 0, v31, vcc
v_lshlrev_b32 v30, 4, v30
v_add3_u32 v25, v29, v30, v31
v_add_u32 v25, 256, v25
v_add_u32 v32, 128, v1
v_mul_u32_u24 v29, 3277, v32
v_lshrrev_b32 v29, 16, v29
v_mul_u32_u24 v30, 20, v29
v_sub_u32 v30, v32, v30
v_lshrrev_b32 v32, 2, v29
v_and_b32 v32, 2, v32
v_xor_b32 v30, v30, v32
v_cmp_le_u32 vcc, 10, v30
v_mov_b32 v31, 1120
v_mul_u32_u24 v29, 3840, v29
v_cndmask_b32 v31, 0, v31, vcc
v_lshlrev_b32 v30, 4, v30
v_add3_u32 v26, v29, v30, v31
v_add_u32 v26, 4294966528, v26
v_add_u32 v32, 192, v1
v_mul_u32_u24 v29, 3277, v32
v_lshrrev_b32 v29, 16, v29
v_mul_u32_u24 v30, 20, v29
v_sub_u32 v30, v32, v30
v_lshrrev_b32 v32, 2, v29
v_and_b32 v32, 2, v32
v_xor_b32 v30, v30, v32
v_cmp_le_u32 vcc, 10, v30
v_mov_b32 v31, 1120
v_mul_u32_u24 v29, 3840, v29
v_cndmask_b32 v31, 0, v31, vcc
v_lshlrev_b32 v30, 4, v30
v_add3_u32 v27, v29, v30, v31
v_add_u32 v27, 4294965504, v27
v_add_u32 v32, 256, v1
v_mul_u32_u24 v29, 3277, v32
v_lshrrev_b32 v29, 16, v29
v_mul_u32_u24 v30, 20, v29
v_sub_u32 v30, v32, v30
v_lshrrev_b32 v32, 2, v29
v_and_b32 v32, 2, v32
v_xor_b32 v30, v30, v32
v_cmp_le_u32 vcc, 10, v30
v_mov_b32 v31, 1120
v_mul_u32_u24 v29, 3840, v29
v_cndmask_b32 v31, 0, v31, vcc
v_lshlrev_b32 v30, 4, v30
v_add3_u32 v28, v29, v30, v31
v_add_u32 v28, 1280, v28
s_waitcnt lgkmcnt(0)
s_mov_b64 s[8:9], s[90:91]
s_mov_b32 m0, 90112
s_nop 0
buffer_load_dwordx4 v24, s[8:11], s66 offen offset:0  lds
buffer_load_dwordx4 v25, s[8:11], s66 offen offset:1024  lds
buffer_load_dwordx4 v26, s[8:11], s66 offen offset:2048  lds
buffer_load_dwordx4 v27, s[8:11], s66 offen offset:3072  lds
s_mov_b32 m0, 94208
s_nop 0
buffer_load_dwordx4 v28, s[8:11], s66 offen offset:0  lds
s_mov_b32 m0, 95232
s_add_u32 s48, s66, 61440
buffer_load_dwordx4 v24, s[8:11], s48 offen offset:0  lds
buffer_load_dwordx4 v25, s[8:11], s48 offen offset:1024  lds
buffer_load_dwordx4 v26, s[8:11], s48 offen offset:2048  lds
buffer_load_dwordx4 v27, s[8:11], s48 offen offset:3072  lds
s_mov_b32 m0, 99328
s_nop 0
buffer_load_dwordx4 v28, s[8:11], s48 offen offset:0  lds
s_mov_b32 m0, 100352
s_add_u32 s48, s66, 122880
buffer_load_dwordx4 v24, s[8:11], s48 offen offset:0  lds
buffer_load_dwordx4 v25, s[8:11], s48 offen offset:1024  lds
buffer_load_dwordx4 v26, s[8:11], s48 offen offset:2048  lds
buffer_load_dwordx4 v27, s[8:11], s48 offen offset:3072  lds
s_mov_b32 m0, 104448
s_nop 0
buffer_load_dwordx4 v28, s[8:11], s48 offen offset:0  lds
s_mov_b32 m0, 105472
s_add_u32 s48, s66, 184320
buffer_load_dwordx4 v24, s[8:11], s48 offen offset:0  lds
buffer_load_dwordx4 v25, s[8:11], s48 offen offset:1024  lds
buffer_load_dwordx4 v26, s[8:11], s48 offen offset:2048  lds
buffer_load_dwordx4 v27, s[8:11], s48 offen offset:3072  lds
s_mov_b32 m0, 109568
s_nop 0
buffer_load_dwordx4 v28, s[8:11], s48 offen offset:0  lds
v_cmp_eq_u32 vcc, 0, v1
v_mov_b32 v45, 1073741824
s_nop 0
v_cndmask_b32 v5, v45, v1, vcc
v_lshrrev_b32 v10, 10, v5
v_add_u32 v10, 163332, v10
v_mov_b32 v9, 1
ds_write_b32 v10, v9 offset:64
s_add_u32 s65, s65, 128
s_add_u32 s66, s66, 245760
s_cmpk_eq_u32 s65, 1280
s_cmov_b32 s66, s67
s_cmovk_i32 s65, 0
s_waitcnt vmcnt(16)
s_mov_b32 m0, 126976
s_nop 0
buffer_load_dwordx4 v24, s[8:11], s66 offen offset:0  lds
buffer_load_dwordx4 v25, s[8:11], s66 offen offset:1024  lds
buffer_load_dwordx4 v26, s[8:11], s66 offen offset:2048  lds
buffer_load_dwordx4 v27, s[8:11], s66 offen offset:3072  lds
s_waitcnt vmcnt(19)
s_mov_b32 m0, 131072
s_nop 0
buffer_load_dwordx4 v28, s[8:11], s66 offen offset:0  lds
s_waitcnt vmcnt(16)
s_mov_b32 m0, 132096
s_add_u32 s48, s66, 61440
buffer_load_dwordx4 v24, s[8:11], s48 offen offset:0  lds
buffer_load_dwordx4 v25, s[8:11], s48 offen offset:1024  lds
buffer_load_dwordx4 v26, s[8:11], s48 offen offset:2048  lds
buffer_load_dwordx4 v27, s[8:11], s48 offen offset:3072  lds
s_waitcnt vmcnt(19)
s_mov_b32 m0, 136192
s_nop 0
buffer_load_dwordx4 v28, s[8:11], s48 offen offset:0  lds
s_waitcnt vmcnt(16)
s_mov_b32 m0, 137216
s_add_u32 s48, s66, 122880
buffer_load_dwordx4 v24, s[8:11], s48 offen offset:0  lds
buffer_load_dwordx4 v25, s[8:11], s48 offen offset:1024  lds
buffer_load_dwordx4 v26, s[8:11], s48 offen offset:2048  lds
buffer_load_dwordx4 v27, s[8:11], s48 offen offset:3072  lds
s_waitcnt vmcnt(19)
s_mov_b32 m0, 141312
s_nop 0
buffer_load_dwordx4 v28, s[8:11], s48 offen offset:0  lds
s_waitcnt vmcnt(16)
s_mov_b32 m0, 142336
s_add_u32 s48, s66, 184320
buffer_load_dwordx4 v24, s[8:11], s48 offen offset:0  lds
buffer_load_dwordx4 v25, s[8:11], s48 offen offset:1024  lds
buffer_load_dwordx4 v26, s[8:11], s48 offen offset:2048  lds
buffer_load_dwordx4 v27, s[8:11], s48 offen offset:3072  lds
s_waitcnt vmcnt(19)
v_mov_b32 v9, 1
ds_max_u32 v10, v9
s_mov_b32 m0, 146432
s_nop 0
buffer_load_dwordx4 v28, s[8:11], s48 offen offset:0  lds
s_add_u32 s65, s65, 128
s_add_u32 s66, s66, 245760
s_cmpk_eq_u32 s65, 1280
s_cmov_b32 s66, s67
s_cmovk_i32 s65, 0
s_mov_b32 s38, 29884416
s_mov_b32 s39, 0x20000
s_mov_b32 s26, 1966080
s_mov_b32 s27, 0x20000
s_mov_b32 s6, 2621440
s_mov_b32 s7, 0x20000
s_mov_b64 s[24:25], s[96:97]
s_mov_b64 s[4:5], s[88:89]
v_add_u32 v40, 0, v1
v_mul_u32_u24 v17, 5462, v40
v_lshrrev_b32 v17, 16, v17
v_mul_u32_u24 v41, 12, v17
v_sub_u32 v41, v40, v41
v_mul_u32_u24 v17, 3072, v17
v_lshl_add_u32 v17, v41, 4, v17
v_add_u32 v40, 64, v1
v_mul_u32_u24 v18, 5462, v40
v_lshrrev_b32 v18, 16, v18
v_mul_u32_u24 v41, 12, v18
v_sub_u32 v41, v40, v41
v_mul_u32_u24 v18, 3072, v18
v_lshl_add_u32 v18, v41, 4, v18
v_subrev_u32 v18, 1024, v18
v_add_u32 v40, 128, v1
v_mul_u32_u24 v19, 5462, v40
v_lshrrev_b32 v19, 16, v19
v_mul_u32_u24 v41, 12, v19
v_sub_u32 v41, v40, v41
s_waitcnt vmcnt(16)
s_mov_b32 m0, 16384
s_nop 0
buffer_load_dwordx4 v24, s[8:11], s66 offen offset:0  lds
buffer_load_dwordx4 v25, s[8:11], s66 offen offset:1024  lds
buffer_load_dwordx4 v26, s[8:11], s66 offen offset:2048  lds
buffer_load_dwordx4 v27, s[8:11], s66 offen offset:3072  lds
s_waitcnt vmcnt(19)
s_mov_b32 m0, 20480
s_nop 0
buffer_load_dwordx4 v28, s[8:11], s66 offen offset:0  lds
s_waitcnt vmcnt(16)
s_mov_b32 m0, 21504
s_add_u32 s48, s66, 61440
buffer_load_dwordx4 v24, s[8:11], s48 offen offset:0  lds
buffer_load_dwordx4 v25, s[8:11], s48 offen offset:1024  lds
buffer_load_dwordx4 v26, s[8:11], s48 offen offset:2048  lds
buffer_load_dwordx4 v27, s[8:11], s48 offen offset:3072  lds
s_waitcnt vmcnt(19)
s_mov_b32 m0, 25600
s_nop 0
buffer_load_dwordx4 v28, s[8:11], s48 offen offset:0  lds
s_waitcnt vmcnt(16)
s_mov_b32 m0, 26624
s_add_u32 s48, s66, 122880
buffer_load_dwordx4 v24, s[8:11], s48 offen offset:0  lds
buffer_load_dwordx4 v25, s[8:11], s48 offen offset:1024  lds
buffer_load_dwordx4 v26, s[8:11], s48 offen offset:2048  lds
buffer_load_dwordx4 v27, s[8:11], s48 offen offset:3072  lds
s_waitcnt vmcnt(19)
s_mov_b32 m0, 30720
s_nop 0
buffer_load_dwordx4 v28, s[8:11], s48 offen offset:0  lds
s_waitcnt vmcnt(16)
s_mov_b32 m0, 31744
s_add_u32 s48, s66, 184320
buffer_load_dwordx4 v24, s[8:11], s48 offen offset:0  lds
buffer_load_dwordx4 v25, s[8:11], s48 offen offset:1024  lds
buffer_load_dwordx4 v26, s[8:11], s48 offen offset:2048  lds
buffer_load_dwordx4 v27, s[8:11], s48 offen offset:3072  lds
s_waitcnt vmcnt(19)
v_mov_b32 v9, 2
ds_max_u32 v10, v9
s_mov_b32 m0, 35840
s_nop 0
buffer_load_dwordx4 v28, s[8:11], s48 offen offset:0  lds
s_add_u32 s65, s65, 128
s_add_u32 s66, s66, 245760
s_cmpk_eq_u32 s65, 1280
s_cmov_b32 s66, s67
s_cmovk_i32 s65, 0
v_mul_u32_u24 v19, 3072, v19
v_lshl_add_u32 v19, v41, 4, v19
v_subrev_u32 v19, 2048, v19
v_add_u32 v45, 0, v1
v_mul_u32_u24 v45, 6554, v45
v_lshrrev_b32 v45, 16, v45
v_mul_u32_u24 v45, 1120, v45
v_add_u32 v40, v45, v4
v_add_u32 v45, 64, v1
v_mul_u32_u24 v45, 6554, v45
v_lshrrev_b32 v45, 16, v45
v_mul_u32_u24 v45, 1120, v45
v_add_u32 v41, v45, v4
v_add_u32 v45, 128, v1
v_mul_u32_u24 v45, 6554, v45
v_lshrrev_b32 v45, 16, v45
v_mul_u32_u24 v45, 1120, v45
v_add_u32 v42, v45, v4
v_add_u32 v45, 192, v1
v_mul_u32_u24 v45, 6554, v45
ds_read_b32 v6, v3 offset:8
s_waitcnt lgkmcnt(0)
v_cmp_gt_u32 vcc, 1, v6
s_nop 0
s_cbranch_vccnz W116
B115:
s_waitcnt vmcnt(16)
s_mov_b32 m0, 53248
s_nop 0
buffer_load_dwordx4 v24, s[8:11], s66 offen offset:0  lds
buffer_load_dwordx4 v25, s[8:11], s66 offen offset:1024  lds
buffer_load_dwordx4 v26, s[8:11], s66 offen offset:2048  lds
buffer_load_dwordx4 v27, s[8:11], s66 offen offset:3072  lds
s_waitcnt vmcnt(19)
s_mov_b32 m0, 57344
s_nop 0
buffer_load_dwordx4 v28, s[8:11], s66 offen offset:0  lds
s_waitcnt vmcnt(16)
s_mov_b32 m0, 58368
s_add_u32 s48, s66, 61440
buffer_load_dwordx4 v24, s[8:11], s48 offen offset:0  lds
buffer_load_dwordx4 v25, s[8:11], s48 offen offset:1024  lds
buffer_load_dwordx4 v26, s[8:11], s48 offen offset:2048  lds
buffer_load_dwordx4 v27, s[8:11], s48 offen offset:3072  lds
s_waitcnt vmcnt(19)
s_mov_b32 m0, 62464
s_nop 0
buffer_load_dwordx4 v28, s[8:11], s48 offen offset:0  lds
s_waitcnt vmcnt(16)
s_mov_b32 m0, 63488
s_add_u32 s48, s66, 122880
buffer_load_dwordx4 v24, s[8:11], s48 offen offset:0  lds
buffer_load_dwordx4 v25, s[8:11], s48 offen offset:1024  lds
buffer_load_dwordx4 v26, s[8:11], s48 offen offset:2048  lds
buffer_load_dwordx4 v27, s[8:11], s48 offen offset:3072  lds
s_waitcnt vmcnt(19)
s_mov_b32 m0, 67584
s_nop 0
buffer_load_dwordx4 v28, s[8:11], s48 offen offset:0  lds
s_waitcnt vmcnt(16)
s_mov_b32 m0, 68608
s_add_u32 s48, s66, 184320
buffer_load_dwordx4 v24, s[8:11], s48 offen offset:0  lds
buffer_load_dwordx4 v25, s[8:11], s48 offen offset:1024  lds
buffer_load_dwordx4 v26, s[8:11], s48 offen offset:2048  lds
buffer_load_dwordx4 v27, s[8:11], s48 offen offset:3072  lds
s_waitcnt vmcnt(19)
v_mov_b32 v9, 3
ds_max_u32 v10, v9
s_mov_b32 m0, 72704
s_nop 0
buffer_load_dwordx4 v28, s[8:11], s48 offen offset:0  lds
s_add_u32 s65, s65, 128
s_add_u32 s66, s66, 245760
s_cmpk_eq_u32 s65, 1280
s_cmov_b32 s66, s67
s_cmovk_i32 s65, 0
v_lshrrev_b32 v45, 16, v45
v_mul_u32_u24 v45, 1120, v45
v_add_u32 v43, v45, v4
v_add_u32 v45, 256, v1
v_mul_u32_u24 v45, 6554, v45
v_lshrrev_b32 v45, 16, v45
v_mul_u32_u24 v45, 1120, v45
v_add_u32 v44, v45, v4
v_add_u32 v44, 4096, v44
ds_read_b128 v[12:15], v3 offset:16
s_waitcnt lgkmcnt(0)
v_min3_u32 v12, v12, v13, v14
v_min_u32 v12, v12, v15
v_cmp_gt_u32 vcc, 1, v12
s_nop 0
s_cbranch_vccnz S117
B118:
s_waitcnt vmcnt(16)
s_mov_b32 m0, 90112
s_nop 0
buffer_load_dwordx4 v24, s[8:11], s66 offen offset:0  lds
buffer_load_dwordx4 v25, s[8:11], s66 offen offset:1024  lds
buffer_load_dwordx4 v26, s[8:11], s66 offen offset:2048  lds
buffer_load_dwordx4 v27, s[8:11], s66 offen offset:3072  lds
s_waitcnt vmcnt(19)
s_mov_b32 m0, 94208
s_nop 0
buffer_load_dwordx4 v28, s[8:11], s66 offen offset:0  lds
s_waitcnt vmcnt(16)
s_mov_b32 m0, 95232
s_add_u32 s48, s66, 61440
buffer_load_dwordx4 v24, s[8:11], s48 offen offset:0  lds
buffer_load_dwordx4 v25, s[8:11], s48 offen offset:1024  lds
buffer_load_dwordx4 v26, s[8:11], s48 offen offset:2048  lds
buffer_load_dwordx4 v27, s[8:11], s48 offen offset:3072  lds
s_waitcnt vmcnt(19)
s_mov_b32 m0, 99328
s_nop 0
buffer_load_dwordx4 v28, s[8:11], s48 offen offset:0  lds
s_waitcnt vmcnt(16)
s_mov_b32 m0, 100352
s_add_u32 s48, s66, 122880
buffer_load_dwordx4 v24, s[8:11], s48 offen offset:0  lds
buffer_load_dwordx4 v25, s[8:11], s48 offen offset:1024  lds
buffer_load_dwordx4 v26, s[8:11], s48 offen offset:2048  lds
buffer_load_dwordx4 v27, s[8:11], s48 offen offset:3072  lds
s_waitcnt vmcnt(19)
s_mov_b32 m0, 104448
s_nop 0
buffer_load_dwordx4 v28, s[8:11], s48 offen offset:0  lds
s_waitcnt vmcnt(16)
s_mov_b32 m0, 105472
s_add_u32 s48, s66, 184320
buffer_load_dwordx4 v24, s[8:11], s48 offen offset:0  lds
buffer_load_dwordx4 v25, s[8:11], s48 offen offset:1024  lds
buffer_load_dwordx4 v26, s[8:11], s48 offen offset:2048  lds
buffer_load_dwordx4 v27, s[8:11], s48 offen offset:3072  lds
s_waitcnt vmcnt(19)
v_mov_b32 v9, 4
ds_max_u32 v10, v9
s_mov_b32 m0, 109568
s_nop 0
buffer_load_dwordx4 v28, s[8:11], s48 offen offset:0  lds
s_add_u32 s65, s65, 128
s_add_u32 s66, s66, 245760
s_cmpk_eq_u32 s65, 1280
s_cmov_b32 s66, s67
s_cmovk_i32 s65, 0
ds_read_b128 v[12:15], v3 offset:16
s_waitcnt lgkmcnt(0)
v_min3_u32 v12, v12, v13, v14
v_min_u32 v12, v12, v15
v_cmp_gt_u32 vcc, 2, v12
s_nop 0
s_cbranch_vccnz S120
B121:
s_waitcnt vmcnt(16)
s_mov_b32 m0, 126976
s_nop 0
buffer_load_dwordx4 v24, s[8:11], s66 offen offset:0  lds
buffer_load_dwordx4 v25, s[8:11], s66 offen offset:1024  lds
buffer_load_dwordx4 v26, s[8:11], s66 offen offset:2048  lds
buffer_load_dwordx4 v27, s[8:11], s66 offen offset:3072  lds
s_waitcnt vmcnt(19)
s_mov_b32 m0, 131072
s_nop 0
buffer_load_dwordx4 v28, s[8:11], s66 offen offset:0  lds
s_waitcnt vmcnt(16)
s_mov_b32 m0, 132096
s_add_u32 s48, s66, 61440
buffer_load_dwordx4 v24, s[8:11], s48 offen offset:0  lds
buffer_load_dwordx4 v25, s[8:11], s48 offen offset:1024  lds
buffer_load_dwordx4 v26, s[8:11], s48 offen offset:2048  lds
buffer_load_dwordx4 v27, s[8:11], s48 offen offset:3072  lds
s_waitcnt vmcnt(19)
s_mov_b32 m0, 136192
s_nop 0
buffer_load_dwordx4 v28, s[8:11], s48 offen offset:0  lds
s_waitcnt vmcnt(16)
s_mov_b32 m0, 137216
s_add_u32 s48, s66, 122880
buffer_load_dwordx4 v24, s[8:11], s48 offen offset:0  lds
buffer_load_dwordx4 v25, s[8:11], s48 offen offset:1024  lds
buffer_load_dwordx4 v26, s[8:11], s48 offen offset:2048  lds
buffer_load_dwordx4 v27, s[8:11], s48 offen offset:3072  lds
s_waitcnt vmcnt(19)
s_mov_b32 m0, 141312
s_nop 0
buffer_load_dwordx4 v28, s[8:11], s48 offen offset:0  lds
s_waitcnt vmcnt(16)
s_mov_b32 m0, 142336
s_add_u32 s48, s66, 184320
buffer_load_dwordx4 v24, s[8:11], s48 offen offset:0  lds
buffer_load_dwordx4 v25, s[8:11], s48 offen offset:1024  lds
buffer_load_dwordx4 v26, s[8:11], s48 offen offset:2048  lds
buffer_load_dwordx4 v27, s[8:11], s48 offen offset:3072  lds
s_waitcnt vmcnt(19)
v_mov_b32 v9, 5
ds_max_u32 v10, v9
s_mov_b32 m0, 146432
s_nop 0
buffer_load_dwordx4 v28, s[8:11], s48 offen offset:0  lds
s_add_u32 s65, s65, 128
s_add_u32 s66, s66, 245760
s_cmpk_eq_u32 s65, 1280
s_cmov_b32 s66, s67
s_cmovk_i32 s65, 0
ds_read_b128 v[12:15], v3 offset:16
s_waitcnt lgkmcnt(0)
v_min3_u32 v12, v12, v13, v14
v_min_u32 v12, v12, v15
v_cmp_gt_u32 vcc, 3, v12
s_nop 0
s_cbranch_vccnz S123
B124:
s_waitcnt vmcnt(16)
s_mov_b32 m0, 16384
s_nop 0
buffer_load_dwordx4 v24, s[8:11], s66 offen offset:0  lds
buffer_load_dwordx4 v25, s[8:11], s66 offen offset:1024  lds
buffer_load_dwordx4 v26, s[8:11], s66 offen offset:2048  lds
buffer_load_dwordx4 v27, s[8:11], s66 offen offset:3072  lds
s_waitcnt vmcnt(19)
s_mov_b32 m0, 20480
s_nop 0
buffer_load_dwordx4 v28, s[8:11], s66 offen offset:0  lds
s_waitcnt vmcnt(16)
s_mov_b32 m0, 21504
s_add_u32 s48, s66, 61440
buffer_load_dwordx4 v24, s[8:11], s48 offen offset:0  lds
buffer_load_dwordx4 v25, s[8:11], s48 offen offset:1024  lds
buffer_load_dwordx4 v26, s[8:11], s48 offen offset:2048  lds
buffer_load_dwordx4 v27, s[8:11], s48 offen offset:3072  lds
s_waitcnt vmcnt(19)
s_mov_b32 m0, 25600
s_nop 0
buffer_load_dwordx4 v28, s[8:11], s48 offen offset:0  lds
s_waitcnt vmcnt(16)
s_mov_b32 m0, 26624
s_add_u32 s48, s66, 122880
buffer_load_dwordx4 v24, s[8:11], s48 offen offset:0  lds
buffer_load_dwordx4 v25, s[8:11], s48 offen offset:1024  lds
buffer_load_dwordx4 v26, s[8:11], s48 offen offset:2048  lds
buffer_load_dwordx4 v27, s[8:11], s48 offen offset:3072  lds
s_waitcnt vmcnt(19)
s_mov_b32 m0, 30720
s_nop 0
buffer_load_dwordx4 v28, s[8:11], s48 offen offset:0  lds
s_waitcnt vmcnt(16)
s_mov_b32 m0, 31744
s_add_u32 s48, s66, 184320
buffer_load_dwordx4 v24, s[8:11], s48 offen offset:0  lds
buffer_load_dwordx4 v25, s[8:11], s48 offen offset:1024  lds
buffer_load_dwordx4 v26, s[8:11], s48 offen offset:2048  lds
buffer_load_dwordx4 v27, s[8:11], s48 offen offset:3072  lds
s_waitcnt vmcnt(19)
v_mov_b32 v9, 6
ds_max_u32 v10, v9
s_mov_b32 m0, 35840
s_nop 0
buffer_load_dwordx4 v28, s[8:11], s48 offen offset:0  lds
s_add_u32 s65, s65, 128
s_add_u32 s66, s66, 245760
s_cmpk_eq_u32 s65, 1280
s_cmov_b32 s66, s67
s_cmovk_i32 s65, 0
ds_read_b128 v[12:15], v3 offset:16
s_waitcnt lgkmcnt(0)
v_min3_u32 v12, v12, v13, v14
v_min_u32 v12, v12, v15
v_cmp_gt_u32 vcc, 4, v12
s_nop 0
s_cbranch_vccnz S126
B127:
s_waitcnt vmcnt(16)
s_mov_b32 m0, 53248
s_nop 0
buffer_load_dwordx4 v24, s[8:11], s66 offen offset:0  lds
buffer_load_dwordx4 v25, s[8:11], s66 offen offset:1024  lds
buffer_load_dwordx4 v26, s[8:11], s66 offen offset:2048  lds
buffer_load_dwordx4 v27, s[8:11], s66 offen offset:3072  lds
s_waitcnt vmcnt(19)
s_mov_b32 m0, 57344
s_nop 0
buffer_load_dwordx4 v28, s[8:11], s66 offen offset:0  lds
s_waitcnt vmcnt(16)
s_mov_b32 m0, 58368
s_add_u32 s48, s66, 61440
buffer_load_dwordx4 v24, s[8:11], s48 offen offset:0  lds
buffer_load_dwordx4 v25, s[8:11], s48 offen offset:1024  lds
buffer_load_dwordx4 v26, s[8:11], s48 offen offset:2048  lds
buffer_load_dwordx4 v27, s[8:11], s48 offen offset:3072  lds
s_waitcnt vmcnt(19)
s_mov_b32 m0, 62464
s_nop 0
buffer_load_dwordx4 v28, s[8:11], s48 offen offset:0  lds
s_waitcnt vmcnt(16)
s_mov_b32 m0, 63488
s_add_u32 s48, s66, 122880
buffer_load_dwordx4 v24, s[8:11], s48 offen offset:0  lds
buffer_load_dwordx4 v25, s[8:11], s48 offen offset:1024  lds
buffer_load_dwordx4 v26, s[8:11], s48 offen offset:2048  lds
buffer_load_dwordx4 v27, s[8:11], s48 offen offset:3072  lds
s_waitcnt vmcnt(19)
s_mov_b32 m0, 67584
s_nop 0
buffer_load_dwordx4 v28, s[8:11], s48 offen offset:0  lds
s_waitcnt vmcnt(16)
s_mov_b32 m0, 68608
s_add_u32 s48, s66, 184320
buffer_load_dwordx4 v24, s[8:11], s48 offen offset:0  lds
buffer_load_dwordx4 v25, s[8:11], s48 offen offset:1024  lds
buffer_load_dwordx4 v26, s[8:11], s48 offen offset:2048  lds
buffer_load_dwordx4 v27, s[8:11], s48 offen offset:3072  lds
s_waitcnt vmcnt(19)
v_mov_b32 v9, 7
ds_max_u32 v10, v9
s_mov_b32 m0, 72704
s_nop 0
buffer_load_dwordx4 v28, s[8:11], s48 offen offset:0  lds
s_add_u32 s65, s65, 128
s_add_u32 s66, s66, 245760
s_cmpk_eq_u32 s65, 1280
s_cmov_b32 s66, s67
s_cmovk_i32 s65, 0
ds_read_b128 v[12:15], v3 offset:16
s_waitcnt lgkmcnt(0)
v_min3_u32 v12, v12, v13, v14
v_min_u32 v12, v12, v15
v_cmp_gt_u32 vcc, 5, v12
s_nop 0
s_cbranch_vccnz S129
B130:
s_waitcnt vmcnt(16)
s_mov_b32 m0, 90112
s_nop 0
buffer_load_dwordx4 v24, s[8:11], s66 offen offset:0  lds
buffer_load_dwordx4 v25, s[8:11], s66 offen offset:1024  lds
buffer_load_dwordx4 v26, s[8:11], s66 offen offset:2048  lds
buffer_load_dwordx4 v27, s[8:11], s66 offen offset:3072  lds
s_waitcnt vmcnt(19)
s_mov_b32 m0, 94208
s_nop 0
buffer_load_dwordx4 v28, s[8:11], s66 offen offset:0  lds
s_waitcnt vmcnt(16)
s_mov_b32 m0, 95232
s_add_u32 s48, s66, 61440
buffer_load_dwordx4 v24, s[8:11], s48 offen offset:0  lds
buffer_load_dwordx4 v25, s[8:11], s48 offen offset:1024  lds
buffer_load_dwordx4 v26, s[8:11], s48 offen offset:2048  lds
buffer_load_dwordx4 v27, s[8:11], s48 offen offset:3072  lds
s_waitcnt vmcnt(19)
s_mov_b32 m0, 99328
s_nop 0
buffer_load_dwordx4 v28, s[8:11], s48 offen offset:0  lds
s_waitcnt vmcnt(16)
s_mov_b32 m0, 100352
s_add_u32 s48, s66, 122880
buffer_load_dwordx4 v24, s[8:11], s48 offen offset:0  lds
buffer_load_dwordx4 v25, s[8:11], s48 offen offset:1024  lds
buffer_load_dwordx4 v26, s[8:11], s48 offen offset:2048  lds
buffer_load_dwordx4 v27, s[8:11], s48 offen offset:3072  lds
s_waitcnt vmcnt(19)
s_mov_b32 m0, 104448
s_nop 0
buffer_load_dwordx4 v28, s[8:11], s48 offen offset:0  lds
s_waitcnt vmcnt(16)
s_mov_b32 m0, 105472
s_add_u32 s48, s66, 184320
buffer_load_dwordx4 v24, s[8:11], s48 offen offset:0  lds
buffer_load_dwordx4 v25, s[8:11], s48 offen offset:1024  lds
buffer_load_dwordx4 v26, s[8:11], s48 offen offset:2048  lds
buffer_load_dwordx4 v27, s[8:11], s48 offen offset:3072  lds
s_waitcnt vmcnt(19)
v_mov_b32 v9, 8
ds_max_u32 v10, v9
s_mov_b32 m0, 109568
s_nop 0
buffer_load_dwordx4 v28, s[8:11], s48 offen offset:0  lds
s_add_u32 s65, s65, 128
s_add_u32 s66, s66, 245760
s_cmpk_eq_u32 s65, 1280
s_cmov_b32 s66, s67
s_cmovk_i32 s65, 0
ds_read_b128 v[12:15], v3 offset:16
s_waitcnt lgkmcnt(0)
v_min3_u32 v12, v12, v13, v14
v_min_u32 v12, v12, v15
v_cmp_gt_u32 vcc, 6, v12
s_nop 0
s_cbranch_vccnz S132
B133:
s_waitcnt vmcnt(16)
s_mov_b32 m0, 126976
s_nop 0
buffer_load_dwordx4 v24, s[8:11], s66 offen offset:0  lds
buffer_load_dwordx4 v25, s[8:11], s66 offen offset:1024  lds
buffer_load_dwordx4 v26, s[8:11], s66 offen offset:2048  lds
buffer_load_dwordx4 v27, s[8:11], s66 offen offset:3072  lds
s_waitcnt vmcnt(19)
s_mov_b32 m0, 131072
s_nop 0
buffer_load_dwordx4 v28, s[8:11], s66 offen offset:0  lds
s_waitcnt vmcnt(16)
s_mov_b32 m0, 132096
s_add_u32 s48, s66, 61440
buffer_load_dwordx4 v24, s[8:11], s48 offen offset:0  lds
buffer_load_dwordx4 v25, s[8:11], s48 offen offset:1024  lds
buffer_load_dwordx4 v26, s[8:11], s48 offen offset:2048  lds
buffer_load_dwordx4 v27, s[8:11], s48 offen offset:3072  lds
s_waitcnt vmcnt(19)
s_mov_b32 m0, 136192
s_nop 0
buffer_load_dwordx4 v28, s[8:11], s48 offen offset:0  lds
s_waitcnt vmcnt(16)
s_mov_b32 m0, 137216
s_add_u32 s48, s66, 122880
buffer_load_dwordx4 v24, s[8:11], s48 offen offset:0  lds
buffer_load_dwordx4 v25, s[8:11], s48 offen offset:1024  lds
buffer_load_dwordx4 v26, s[8:11], s48 offen offset:2048  lds
buffer_load_dwordx4 v27, s[8:11], s48 offen offset:3072  lds
s_waitcnt vmcnt(19)
s_mov_b32 m0, 141312
s_nop 0
buffer_load_dwordx4 v28, s[8:11], s48 offen offset:0  lds
s_waitcnt vmcnt(16)
s_mov_b32 m0, 142336
s_add_u32 s48, s66, 184320
buffer_load_dwordx4 v24, s[8:11], s48 offen offset:0  lds
buffer_load_dwordx4 v25, s[8:11], s48 offen offset:1024  lds
buffer_load_dwordx4 v26, s[8:11], s48 offen offset:2048  lds
buffer_load_dwordx4 v27, s[8:11], s48 offen offset:3072  lds
s_waitcnt vmcnt(19)
v_mov_b32 v9, 9
ds_max_u32 v10, v9
s_mov_b32 m0, 146432
s_nop 0
buffer_load_dwordx4 v28, s[8:11], s48 offen offset:0  lds
s_waitcnt vmcnt(12)
s_branch L_loadj
L_load23:
s_lshl1_add_u32 s48, s57, s59
s_cmp_lt_u32 s59, 6
s_cselect_b32 s49, 4, 6
s_movk_i32 s70, 3840
s_cmovk_i32 s70, 1280
s_movk_i32 s71, 1280
s_cmovk_i32 s71, 3840
s_sub_u32 s48, s48, s49
s_mul_i32 s67, s48, 192
s_lshl_b32 s69, s48, 7
s_add_u32 s69, s69, 768
v_add_u32 v27, 0, v1
v_mul_u32_u24 v24, 5462, v27
v_lshrrev_b32 v24, 16, v24
v_mul_u32_u24 v28, 12, v24
v_sub_u32 v28, v27, v28
v_lshrrev_b32 v27, 2, v24
v_and_b32 v27, 2, v27
v_xor_b32 v28, v28, v27
v_mul_u32_u24 v24, s70, v24
v_lshl_add_u32 v24, v28, 4, v24
v_add_u32 v27, 64, v1
v_mul_u32_u24 v25, 5462, v27
v_lshrrev_b32 v25, 16, v25
v_mul_u32_u24 v28, 12, v25
v_sub_u32 v28, v27, v28
v_lshrrev_b32 v27, 2, v25
v_and_b32 v27, 2, v27
v_xor_b32 v28, v28, v27
v_mul_u32_u24 v25, s70, v25
v_lshl_add_u32 v25, v28, 4, v25
v_subrev_u32 v25, 1024, v25
v_add_u32 v27, 128, v1
v_mul_u32_u24 v26, 5462, v27
v_lshrrev_b32 v26, 16, v26
v_mul_u32_u24 v28, 12, v26
v_sub_u32 v28, v27, v28
v_lshrrev_b32 v27, 2, v26
v_and_b32 v27, 2, v27
v_xor_b32 v28, v28, v27
v_mul_u32_u24 v26, s70, v26
v_lshl_add_u32 v26, v28, 4, v26
v_subrev_u32 v26, 2048, v26
v_lshrrev_b32 v11, 3, v1
v_mul_u32_u24 v11, s71, v11
v_lshrrev_b32 v16, 3, v1
v_and_b32 v16, 2, v16
v_xor_b32 v16, v16, v1
v_and_b32 v16, 7, v16
v_lshl_add_u32 v27, v16, 4, v11
s_lshl_b32 s49, s71, 3
s_sub_u32 s49, s49, 1024
v_xor_b32 v28, 64, v27
v_add_u32 v28, s49, v28
s_lshl_b32 s49, s49, 1
v_add_u32 v29, s49, v27
v_add_u32 v30, s49, v28
s_lshl_b32 s72, s70, 4
s_lshl_b32 s73, s71, 5
s_mul_i32 s66, s64, s72
s_lshl2_add_u32 s66, s66, s67
s_mul_i32 s68, s64, s73
s_lshl1_add_u32 s68, s68, s69
s_waitcnt lgkmcnt(0)
s_mov_b64 s[16:17], s[92:93]
s_mov_b64 s[8:9], s[90:91]
s_cmp_lt_u32 s59, 6
s_cselect_b64 s[40:41], s[16:17], s[8:9]
s_cselect_b32 s42, s18, s10
s_mov_b32 s43, 0x20000
s_cselect_b64 s[44:45], s[8:9], s[16:17]
s_cselect_b32 s46, s10, s18
s_mov_b32 s47, 0x20000
s_mov_b32 m0, 90112
s_nop 0
buffer_load_dwordx4 v24, s[40:43], s66 offen offset:0  lds
buffer_load_dwordx4 v25, s[40:43], s66 offen offset:1024  lds
buffer_load_dwordx4 v26, s[40:43], s66 offen offset:2048  lds
s_mov_b32 m0, 93184
s_add_u32 s66, s66, s72
buffer_load_dwordx4 v24, s[40:43], s66 offen offset:0  lds
buffer_load_dwordx4 v25, s[40:43], s66 offen offset:1024  lds
buffer_load_dwordx4 v26, s[40:43], s66 offen offset:2048  lds
s_mov_b32 m0, 96256
s_add_u32 s66, s66, s72
buffer_load_dwordx4 v24, s[40:43], s66 offen offset:0  lds
buffer_load_dwordx4 v25, s[40:43], s66 offen offset:1024  lds
buffer_load_dwordx4 v26, s[40:43], s66 offen offset:2048  lds
s_mov_b32 m0, 99328
s_add_u32 s66, s66, s72
buffer_load_dwordx4 v24, s[40:43], s66 offen offset:0  lds
buffer_load_dwordx4 v25, s[40:43], s66 offen offset:1024  lds
buffer_load_dwordx4 v26, s[40:43], s66 offen offset:2048  lds
s_mov_b32 m0, 102400
s_nop 0
buffer_load_dwordx4 v27, s[44:47], s68 offen offset:0  lds
buffer_load_dwordx4 v28, s[44:47], s68 offen offset:1024  lds
buffer_load_dwordx4 v29, s[44:47], s68 offen offset:2048  lds
buffer_load_dwordx4 v30, s[44:47], s68 offen offset:3072  lds
s_mov_b32 m0, 106496
s_add_u32 s68, s68, s73
buffer_load_dwordx4 v27, s[44:47], s68 offen offset:0  lds
buffer_load_dwordx4 v28, s[44:47], s68 offen offset:1024  lds
buffer_load_dwordx4 v29, s[44:47], s68 offen offset:2048  lds
buffer_load_dwordx4 v30, s[44:47], s68 offen offset:3072  lds
v_cmp_eq_u32 vcc, 0, v1
v_mov_b32 v45, 1073741824
s_nop 0
v_cndmask_b32 v5, v45, v1, vcc
v_lshrrev_b32 v10, 10, v5
v_add_u32 v10, 163332, v10
v_mov_b32 v9, 1
ds_write_b32 v10, v9 offset:64
s_add_u32 s65, s65, 128
s_add_u32 s66, s66, s72
s_add_u32 s68, s68, s73
s_cmpk_eq_u32 s65, 1280
s_cmov_b32 s66, s67
s_cmov_b32 s68, s69
s_cmovk_i32 s65, 0
s_waitcnt vmcnt(17)
s_mov_b32 m0, 126976
s_nop 0
buffer_load_dwordx4 v24, s[40:43], s66 offen offset:0  lds
buffer_load_dwordx4 v25, s[40:43], s66 offen offset:1024  lds
buffer_load_dwordx4 v26, s[40:43], s66 offen offset:2048  lds
s_waitcnt vmcnt(17)
s_mov_b32 m0, 130048
s_add_u32 s66, s66, s72
buffer_load_dwordx4 v24, s[40:43], s66 offen offset:0  lds
buffer_load_dwordx4 v25, s[40:43], s66 offen offset:1024  lds
buffer_load_dwordx4 v26, s[40:43], s66 offen offset:2048  lds
s_waitcnt vmcnt(17)
s_mov_b32 m0, 133120
s_add_u32 s66, s66, s72
buffer_load_dwordx4 v24, s[40:43], s66 offen offset:0  lds
buffer_load_dwordx4 v25, s[40:43], s66 offen offset:1024  lds
buffer_load_dwordx4 v26, s[40:43], s66 offen offset:2048  lds
s_waitcnt vmcnt(17)
s_mov_b32 m0, 136192
s_add_u32 s66, s66, s72
buffer_load_dwordx4 v24, s[40:43], s66 offen offset:0  lds
buffer_load_dwordx4 v25, s[40:43], s66 offen offset:1024  lds
buffer_load_dwordx4 v26, s[40:43], s66 offen offset:2048  lds
s_waitcnt vmcnt(16)
s_mov_b32 m0, 139264
s_nop 0
buffer_load_dwordx4 v27, s[44:47], s68 offen offset:0  lds
buffer_load_dwordx4 v28, s[44:47], s68 offen offset:1024  lds
buffer_load_dwordx4 v29, s[44:47], s68 offen offset:2048  lds
buffer_load_dwordx4 v30, s[44:47], s68 offen offset:3072  lds
s_waitcnt vmcnt(16)
v_mov_b32 v9, 1
ds_max_u32 v10, v9
s_mov_b32 m0, 143360
s_add_u32 s68, s68, s73
buffer_load_dwordx4 v27, s[44:47], s68 offen offset:0  lds
buffer_load_dwordx4 v28, s[44:47], s68 offen offset:1024  lds
buffer_load_dwordx4 v29, s[44:47], s68 offen offset:2048  lds
buffer_load_dwordx4 v30, s[44:47], s68 offen offset:3072  lds
s_add_u32 s65, s65, 128
s_add_u32 s66, s66, s72
s_add_u32 s68, s68, s73
s_cmpk_eq_u32 s65, 1280
s_cmov_b32 s66, s67
s_cmov_b32 s68, s69
s_cmovk_i32 s65, 0
s_mov_b32 s38, 29884416
s_mov_b32 s39, 0x20000
s_mov_b32 s26, 1966080
s_mov_b32 s27, 0x20000
s_mov_b32 s6, 2621440
s_mov_b32 s7, 0x20000
s_mov_b64 s[24:25], s[96:97]
s_mov_b64 s[4:5], s[88:89]
v_add_u32 v40, 0, v1
v_mul_u32_u24 v17, 5462, v40
v_lshrrev_b32 v17, 16, v17
v_mul_u32_u24 v41, 12, v17
v_sub_u32 v41, v40, v41
v_mul_u32_u24 v17, 3072, v17
v_lshl_add_u32 v17, v41, 4, v17
v_add_u32 v40, 64, v1
v_mul_u32_u24 v18, 5462, v40
v_lshrrev_b32 v18, 16, v18
v_mul_u32_u24 v41, 12, v18
v_sub_u32 v41, v40, v41
v_mul_u32_u24 v18, 3072, v18
v_lshl_add_u32 v18, v41, 4, v18
v_subrev_u32 v18, 1024, v18
v_add_u32 v40, 128, v1
v_mul_u32_u24 v19, 5462, v40
v_lshrrev_b32 v19, 16, v19
v_mul_u32_u24 v41, 12, v19
v_sub_u32 v41, v40, v41
s_waitcnt vmcnt(17)
s_mov_b32 m0, 16384
s_nop 0
buffer_load_dwordx4 v24, s[40:43], s66 offen offset:0  lds
buffer_load_dwordx4 v25, s[40:43], s66 offen offset:1024  lds
buffer_load_dwordx4 v26, s[40:43], s66 offen offset:2048  lds
s_waitcnt vmcnt(17)
s_mov_b32 m0, 19456
s_add_u32 s66, s66, s72
buffer_load_dwordx4 v24, s[40:43], s66 offen offset:0  lds
buffer_load_dwordx4 v25, s[40:43], s66 offen offset:1024  lds
buffer_load_dwordx4 v26, s[40:43], s66 offen offset:2048  lds
s_waitcnt vmcnt(17)
s_mov_b32 m0, 22528
s_add_u32 s66, s66, s72
buffer_load_dwordx4 v24, s[40:43], s66 offen offset:0  lds
buffer_load_dwordx4 v25, s[40:43], s66 offen offset:1024  lds
buffer_load_dwordx4 v26, s[40:43], s66 offen offset:2048  lds
s_waitcnt vmcnt(17)
s_mov_b32 m0, 25600
s_add_u32 s66, s66, s72
buffer_load_dwordx4 v24, s[40:43], s66 offen offset:0  lds
buffer_load_dwordx4 v25, s[40:43], s66 offen offset:1024  lds
buffer_load_dwordx4 v26, s[40:43], s66 offen offset:2048  lds
s_waitcnt vmcnt(16)
s_mov_b32 m0, 28672
s_nop 0
buffer_load_dwordx4 v27, s[44:47], s68 offen offset:0  lds
buffer_load_dwordx4 v28, s[44:47], s68 offen offset:1024  lds
buffer_load_dwordx4 v29, s[44:47], s68 offen offset:2048  lds
buffer_load_dwordx4 v30, s[44:47], s68 offen offset:3072  lds
s_waitcnt vmcnt(16)
v_mov_b32 v9, 2
ds_max_u32 v10, v9
s_mov_b32 m0, 32768
s_add_u32 s68, s68, s73
buffer_load_dwordx4 v27, s[44:47], s68 offen offset:0  lds
buffer_load_dwordx4 v28, s[44:47], s68 offen offset:1024  lds
buffer_load_dwordx4 v29, s[44:47], s68 offen offset:2048  lds
buffer_load_dwordx4 v30, s[44:47], s68 offen offset:3072  lds
s_add_u32 s65, s65, 128
s_add_u32 s66, s66, s72
s_add_u32 s68, s68, s73
s_cmpk_eq_u32 s65, 1280
s_cmov_b32 s66, s67
s_cmov_b32 s68, s69
s_cmovk_i32 s65, 0
v_mul_u32_u24 v19, 3072, v19
v_lshl_add_u32 v19, v41, 4, v19
v_subrev_u32 v19, 2048, v19
v_add_u32 v45, 0, v1
v_mul_u32_u24 v45, 6554, v45
v_lshrrev_b32 v45, 16, v45
v_mul_u32_u24 v45, 1120, v45
v_add_u32 v40, v45, v4
v_add_u32 v45, 64, v1
v_mul_u32_u24 v45, 6554, v45
v_lshrrev_b32 v45, 16, v45
v_mul_u32_u24 v45, 1120, v45
v_add_u32 v41, v45, v4
v_add_u32 v45, 128, v1
v_mul_u32_u24 v45, 6554, v45
v_lshrrev_b32 v45, 16, v45
v_mul_u32_u24 v45, 1120, v45
v_add_u32 v42, v45, v4
v_add_u32 v45, 192, v1
v_mul_u32_u24 v45, 6554, v45
ds_read_b32 v6, v3 offset:8
s_waitcnt lgkmcnt(0)
v_cmp_gt_u32 vcc, 1, v6
s_nop 0
s_cbranch_vccnz W137
B136:
s_waitcnt vmcnt(17)
s_mov_b32 m0, 53248
s_nop 0
buffer_load_dwordx4 v24, s[40:43], s66 offen offset:0  lds
buffer_load_dwordx4 v25, s[40:43], s66 offen offset:1024  lds
buffer_load_dwordx4 v26, s[40:43], s66 offen offset:2048  lds
s_waitcnt vmcnt(17)
s_mov_b32 m0, 56320
s_add_u32 s66, s66, s72
buffer_load_dwordx4 v24, s[40:43], s66 offen offset:0  lds
buffer_load_dwordx4 v25, s[40:43], s66 offen offset:1024  lds
buffer_load_dwordx4 v26, s[40:43], s66 offen offset:2048  lds
s_waitcnt vmcnt(17)
s_mov_b32 m0, 59392
s_add_u32 s66, s66, s72
buffer_load_dwordx4 v24, s[40:43], s66 offen offset:0  lds
buffer_load_dwordx4 v25, s[40:43], s66 offen offset:1024  lds
buffer_load_dwordx4 v26, s[40:43], s66 offen offset:2048  lds
s_waitcnt vmcnt(17)
s_mov_b32 m0, 62464
s_add_u32 s66, s66, s72
buffer_load_dwordx4 v24, s[40:43], s66 offen offset:0  lds
buffer_load_dwordx4 v25, s[40:43], s66 offen offset:1024  lds
buffer_load_dwordx4 v26, s[40:43], s66 offen offset:2048  lds
s_waitcnt vmcnt(16)
s_mov_b32 m0, 65536
s_nop 0
buffer_load_dwordx4 v27, s[44:47], s68 offen offset:0  lds
buffer_load_dwordx4 v28, s[44:47], s68 offen offset:1024  lds
buffer_load_dwordx4 v29, s[44:47], s68 offen offset:2048  lds
buffer_load_dwordx4 v30, s[44:47], s68 offen offset:3072  lds
s_waitcnt vmcnt(16)
v_mov_b32 v9, 3
ds_max_u32 v10, v9
s_mov_b32 m0, 69632
s_add_u32 s68, s68, s73
buffer_load_dwordx4 v27, s[44:47], s68 offen offset:0  lds
buffer_load_dwordx4 v28, s[44:47], s68 offen offset:1024  lds
buffer_load_dwordx4 v29, s[44:47], s68 offen offset:2048  lds
buffer_load_dwordx4 v30, s[44:47], s68 offen offset:3072  lds
s_add_u32 s65, s65, 128
s_add_u32 s66, s66, s72
s_add_u32 s68, s68, s73
s_cmpk_eq_u32 s65, 1280
s_cmov_b32 s66, s67
s_cmov_b32 s68, s69
s_cmovk_i32 s65, 0
v_lshrrev_b32 v45, 16, v45
v_mul_u32_u24 v45, 1120, v45
v_add_u32 v43, v45, v4
v_add_u32 v45, 256, v1
v_mul_u32_u24 v45, 6554, v45
v_lshrrev_b32 v45, 16, v45
v_mul_u32_u24 v45, 1120, v45
v_add_u32 v44, v45, v4
v_add_u32 v44, 4096, v44
ds_read_b128 v[12:15], v3 offset:16
s_waitcnt lgkmcnt(0)
v_min3_u32 v12, v12, v13, v14
v_min_u32 v12, v12, v15
v_cmp_gt_u32 vcc, 1, v12
s_nop 0
s_cbranch_vccnz S138
B139:
s_waitcnt vmcnt(17)
s_mov_b32 m0, 90112
s_nop 0
buffer_load_dwordx4 v24, s[40:43], s66 offen offset:0  lds
buffer_load_dwordx4 v25, s[40:43], s66 offen offset:1024  lds
buffer_load_dwordx4 v26, s[40:43], s66 offen offset:2048  lds
s_waitcnt vmcnt(17)
s_mov_b32 m0, 93184
s_add_u32 s66, s66, s72
buffer_load_dwordx4 v24, s[40:43], s66 offen offset:0  lds
buffer_load_dwordx4 v25, s[40:43], s66 offen offset:1024  lds
buffer_load_dwordx4 v26, s[40:43], s66 offen offset:2048  lds
s_waitcnt vmcnt(17)
s_mov_b32 m0, 96256
s_add_u32 s66, s66, s72
buffer_load_dwordx4 v24, s[40:43], s66 offen offset:0  lds
buffer_load_dwordx4 v25, s[40:43], s66 offen offset:1024  lds
buffer_load_dwordx4 v26, s[40:43], s66 offen offset:2048  lds
s_waitcnt vmcnt(17)
s_mov_b32 m0, 99328
s_add_u32 s66, s66, s72
buffer_load_dwordx4 v24, s[40:43], s66 offen offset:0  lds
buffer_load_dwordx4 v25, s[40:43], s66 offen offset:1024  lds
buffer_load_dwordx4 v26, s[40:43], s66 offen offset:2048  lds
s_waitcnt vmcnt(16)
s_mov_b32 m0, 102400
s_nop 0
buffer_load_dwordx4 v27, s[44:47], s68 offen offset:0  lds
buffer_load_dwordx4 v28, s[44:47], s68 offen offset:1024  lds
buffer_load_dwordx4 v29, s[44:47], s68 offen offset:2048  lds
buffer_load_dwordx4 v30, s[44:47], s68 offen offset:3072  lds
s_waitcnt vmcnt(16)
v_mov_b32 v9, 4
ds_max_u32 v10, v9
s_mov_b32 m0, 106496
s_add_u32 s68, s68, s73
buffer_load_dwordx4 v27, s[44:47], s68 offen offset:0  lds
buffer_load_dwordx4 v28, s[44:47], s68 offen offset:1024  lds
buffer_load_dwordx4 v29, s[44:47], s68 offen offset:2048  lds
buffer_load_dwordx4 v30, s[44:47], s68 offen offset:3072  lds
s_add_u32 s65, s65, 128
s_add_u32 s66, s66, s72
s_add_u32 s68, s68, s73
s_cmpk_eq_u32 s65, 1280
s_cmov_b32 s66, s67
s_cmov_b32 s68, s69
s_cmovk_i32 s65, 0
ds_read_b128 v[12:15], v3 offset:16
s_waitcnt lgkmcnt(0)
v_min3_u32 v12, v12, v13, v14
v_min_u32 v12, v12, v15
v_cmp_gt_u32 vcc, 2, v12
s_nop 0
s_cbranch_vccnz S141
B142:
s_waitcnt vmcnt(17)
s_mov_b32 m0, 126976
s_nop 0
buffer_load_dwordx4 v24, s[40:43], s66 offen offset:0  lds
buffer_load_dwordx4 v25, s[40:43], s66 offen offset:1024  lds
buffer_load_dwordx4 v26, s[40:43], s66 offen offset:2048  lds
s_waitcnt vmcnt(17)
s_mov_b32 m0, 130048
s_add_u32 s66, s66, s72
buffer_load_dwordx4 v24, s[40:43], s66 offen offset:0  lds
buffer_load_dwordx4 v25, s[40:43], s66 offen offset:1024  lds
buffer_load_dwordx4 v26, s[40:43], s66 offen offset:2048  lds
s_waitcnt vmcnt(17)
s_mov_b32 m0, 133120
s_add_u32 s66, s66, s72
buffer_load_dwordx4 v24, s[40:43], s66 offen offset:0  lds
buffer_load_dwordx4 v25, s[40:43], s66 offen offset:1024  lds
buffer_load_dwordx4 v26, s[40:43], s66 offen offset:2048  lds
s_waitcnt vmcnt(17)
s_mov_b32 m0, 136192
s_add_u32 s66, s66, s72
buffer_load_dwordx4 v24, s[40:43], s66 offen offset:0  lds
buffer_load_dwordx4 v25, s[40:43], s66 offen offset:1024  lds
buffer_load_dwordx4 v26, s[40:43], s66 offen offset:2048  lds
s_waitcnt vmcnt(16)
s_mov_b32 m0, 139264
s_nop 0
buffer_load_dwordx4 v27, s[44:47], s68 offen offset:0  lds
buffer_load_dwordx4 v28, s[44:47], s68 offen offset:1024  lds
buffer_load_dwordx4 v29, s[44:47], s68 offen offset:2048  lds
buffer_load_dwordx4 v30, s[44:47], s68 offen offset:3072  lds
s_waitcnt vmcnt(16)
v_mov_b32 v9, 5
ds_max_u32 v10, v9
s_mov_b32 m0, 143360
s_add_u32 s68, s68, s73
buffer_load_dwordx4 v27, s[44:47], s68 offen offset:0  lds
buffer_load_dwordx4 v28, s[44:47], s68 offen offset:1024  lds
buffer_load_dwordx4 v29, s[44:47], s68 offen offset:2048  lds
buffer_load_dwordx4 v30, s[44:47], s68 offen offset:3072  lds
s_add_u32 s65, s65, 128
s_add_u32 s66, s66, s72
s_add_u32 s68, s68, s73
s_cmpk_eq_u32 s65, 1280
s_cmov_b32 s66, s67
s_cmov_b32 s68, s69
s_cmovk_i32 s65, 0
ds_read_b128 v[12:15], v3 offset:16
s_waitcnt lgkmcnt(0)
v_min3_u32 v12, v12, v13, v14
v_min_u32 v12, v12, v15
v_cmp_gt_u32 vcc, 3, v12
s_nop 0
s_cbranch_vccnz S144
B145:
s_waitcnt vmcnt(17)
s_mov_b32 m0, 16384
s_nop 0
buffer_load_dwordx4 v24, s[40:43], s66 offen offset:0  lds
buffer_load_dwordx4 v25, s[40:43], s66 offen offset:1024  lds
buffer_load_dwordx4 v26, s[40:43], s66 offen offset:2048  lds
s_waitcnt vmcnt(17)
s_mov_b32 m0, 19456
s_add_u32 s66, s66, s72
buffer_load_dwordx4 v24, s[40:43], s66 offen offset:0  lds
buffer_load_dwordx4 v25, s[40:43], s66 offen offset:1024  lds
buffer_load_dwordx4 v26, s[40:43], s66 offen offset:2048  lds
s_waitcnt vmcnt(17)
s_mov_b32 m0, 22528
s_add_u32 s66, s66, s72
buffer_load_dwordx4 v24, s[40:43], s66 offen offset:0  lds
buffer_load_dwordx4 v25, s[40:43], s66 offen offset:1024  lds
buffer_load_dwordx4 v26, s[40:43], s66 offen offset:2048  lds
s_waitcnt vmcnt(17)
s_mov_b32 m0, 25600
s_add_u32 s66, s66, s72
buffer_load_dwordx4 v24, s[40:43], s66 offen offset:0  lds
buffer_load_dwordx4 v25, s[40:43], s66 offen offset:1024  lds
buffer_load_dwordx4 v26, s[40:43], s66 offen offset:2048  lds
s_waitcnt vmcnt(16)
s_mov_b32 m0, 28672
s_nop 0
buffer_load_dwordx4 v27, s[44:47], s68 offen offset:0  lds
buffer_load_dwordx4 v28, s[44:47], s68 offen offset:1024  lds
buffer_load_dwordx4 v29, s[44:47], s68 offen offset:2048  lds
buffer_load_dwordx4 v30, s[44:47], s68 offen offset:3072  lds
s_waitcnt vmcnt(16)
v_mov_b32 v9, 6
ds_max_u32 v10, v9
s_mov_b32 m0, 32768
s_add_u32 s68, s68, s73
buffer_load_dwordx4 v27, s[44:47], s68 offen offset:0  lds
buffer_load_dwordx4 v28, s[44:47], s68 offen offset:1024  lds
buffer_load_dwordx4 v29, s[44:47], s68 offen offset:2048  lds
buffer_load_dwordx4 v30, s[44:47], s68 offen offset:3072  lds
s_add_u32 s65, s65, 128
s_add_u32 s66, s66, s72
s_add_u32 s68, s68, s73
s_cmpk_eq_u32 s65, 1280
s_cmov_b32 s66, s67
s_cmov_b32 s68, s69
s_cmovk_i32 s65, 0
ds_read_b128 v[12:15], v3 offset:16
s_waitcnt lgkmcnt(0)
v_min3_u32 v12, v12, v13, v14
v_min_u32 v12, v12, v15
v_cmp_gt_u32 vcc, 4, v12
s_nop 0
s_cbranch_vccnz S147
B148:
s_waitcnt vmcnt(17)
s_mov_b32 m0, 53248
s_nop 0
buffer_load_dwordx4 v24, s[40:43], s66 offen offset:0  lds
buffer_load_dwordx4 v25, s[40:43], s66 offen offset:1024  lds
buffer_load_dwordx4 v26, s[40:43], s66 offen offset:2048  lds
s_waitcnt vmcnt(17)
s_mov_b32 m0, 56320
s_add_u32 s66, s66, s72
buffer_load_dwordx4 v24, s[40:43], s66 offen offset:0  lds
buffer_load_dwordx4 v25, s[40:43], s66 offen offset:1024  lds
buffer_load_dwordx4 v26, s[40:43], s66 offen offset:2048  lds
s_waitcnt vmcnt(17)
s_mov_b32 m0, 59392
s_add_u32 s66, s66, s72
buffer_load_dwordx4 v24, s[40:43], s66 offen offset:0  lds
buffer_load_dwordx4 v25, s[40:43], s66 offen offset:1024  lds
buffer_load_dwordx4 v26, s[40:43], s66 offen offset:2048  lds
s_waitcnt vmcnt(17)
s_mov_b32 m0, 62464
s_add_u32 s66, s66, s72
buffer_load_dwordx4 v24, s[40:43], s66 offen offset:0  lds
buffer_load_dwordx4 v25, s[40:43], s66 offen offset:1024  lds
buffer_load_dwordx4 v26, s[40:43], s66 offen offset:2048  lds
s_waitcnt vmcnt(16)
s_mov_b32 m0, 65536
s_nop 0
buffer_load_dwordx4 v27, s[44:47], s68 offen offset:0  lds
buffer_load_dwordx4 v28, s[44:47], s68 offen offset:1024  lds
buffer_load_dwordx4 v29, s[44:47], s68 offen offset:2048  lds
buffer_load_dwordx4 v30, s[44:47], s68 offen offset:3072  lds
s_waitcnt vmcnt(16)
v_mov_b32 v9, 7
ds_max_u32 v10, v9
s_mov_b32 m0, 69632
s_add_u32 s68, s68, s73
buffer_load_dwordx4 v27, s[44:47], s68 offen offset:0  lds
buffer_load_dwordx4 v28, s[44:47], s68 offen offset:1024  lds
buffer_load_dwordx4 v29, s[44:47], s68 offen offset:2048  lds
buffer_load_dwordx4 v30, s[44:47], s68 offen offset:3072  lds
s_add_u32 s65, s65, 128
s_add_u32 s66, s66, s72
s_add_u32 s68, s68, s73
s_cmpk_eq_u32 s65, 1280
s_cmov_b32 s66, s67
s_cmov_b32 s68, s69
s_cmovk_i32 s65, 0
ds_read_b128 v[12:15], v3 offset:16
s_waitcnt lgkmcnt(0)
v_min3_u32 v12, v12, v13, v14
v_min_u32 v12, v12, v15
v_cmp_gt_u32 vcc, 5, v12
s_nop 0
s_cbranch_vccnz S150
B151:
s_waitcnt vmcnt(17)
s_mov_b32 m0, 90112
s_nop 0
buffer_load_dwordx4 v24, s[40:43], s66 offen offset:0  lds
buffer_load_dwordx4 v25, s[40:43], s66 offen offset:1024  lds
buffer_load_dwordx4 v26, s[40:43], s66 offen offset:2048  lds
s_waitcnt vmcnt(17)
s_mov_b32 m0, 93184
s_add_u32 s66, s66, s72
buffer_load_dwordx4 v24, s[40:43], s66 offen offset:0  lds
buffer_load_dwordx4 v25, s[40:43], s66 offen offset:1024  lds
buffer_load_dwordx4 v26, s[40:43], s66 offen offset:2048  lds
s_waitcnt vmcnt(17)
s_mov_b32 m0, 96256
s_add_u32 s66, s66, s72
buffer_load_dwordx4 v24, s[40:43], s66 offen offset:0  lds
buffer_load_dwordx4 v25, s[40:43], s66 offen offset:1024  lds
buffer_load_dwordx4 v26, s[40:43], s66 offen offset:2048  lds
s_waitcnt vmcnt(17)
s_mov_b32 m0, 99328
s_add_u32 s66, s66, s72
buffer_load_dwordx4 v24, s[40:43], s66 offen offset:0  lds
buffer_load_dwordx4 v25, s[40:43], s66 offen offset:1024  lds
buffer_load_dwordx4 v26, s[40:43], s66 offen offset:2048  lds
s_waitcnt vmcnt(16)
s_mov_b32 m0, 102400
s_nop 0
buffer_load_dwordx4 v27, s[44:47], s68 offen offset:0  lds
buffer_load_dwordx4 v28, s[44:47], s68 offen offset:1024  lds
buffer_load_dwordx4 v29, s[44:47], s68 offen offset:2048  lds
buffer_load_dwordx4 v30, s[44:47], s68 offen offset:3072  lds
s_waitcnt vmcnt(16)
v_mov_b32 v9, 8
ds_max_u32 v10, v9
s_mov_b32 m0, 106496
s_add_u32 s68, s68, s73
buffer_load_dwordx4 v27, s[44:47], s68 offen offset:0  lds
buffer_load_dwordx4 v28, s[44:47], s68 offen offset:1024  lds
buffer_load_dwordx4 v29, s[44:47], s68 offen offset:2048  lds
buffer_load_dwordx4 v30, s[44:47], s68 offen offset:3072  lds
s_add_u32 s65, s65, 128
s_add_u32 s66, s66, s72
s_add_u32 s68, s68, s73
s_cmpk_eq_u32 s65, 1280
s_cmov_b32 s66, s67
s_cmov_b32 s68, s69
s_cmovk_i32 s65, 0
ds_read_b128 v[12:15], v3 offset:16
s_waitcnt lgkmcnt(0)
v_min3_u32 v12, v12, v13, v14
v_min_u32 v12, v12, v15
v_cmp_gt_u32 vcc, 6, v12
s_nop 0
s_cbranch_vccnz S153
B154:
s_waitcnt vmcnt(17)
s_mov_b32 m0, 126976
s_nop 0
buffer_load_dwordx4 v24, s[40:43], s66 offen offset:0  lds
buffer_load_dwordx4 v25, s[40:43], s66 offen offset:1024  lds
buffer_load_dwordx4 v26, s[40:43], s66 offen offset:2048  lds
s_waitcnt vmcnt(17)
s_mov_b32 m0, 130048
s_add_u32 s66, s66, s72
buffer_load_dwordx4 v24, s[40:43], s66 offen offset:0  lds
buffer_load_dwordx4 v25, s[40:43], s66 offen offset:1024  lds
buffer_load_dwordx4 v26, s[40:43], s66 offen offset:2048  lds
s_waitcnt vmcnt(17)
s_mov_b32 m0, 133120
s_add_u32 s66, s66, s72
buffer_load_dwordx4 v24, s[40:43], s66 offen offset:0  lds
buffer_load_dwordx4 v25, s[40:43], s66 offen offset:1024  lds
buffer_load_dwordx4 v26, s[40:43], s66 offen offset:2048  lds
s_waitcnt vmcnt(17)
s_mov_b32 m0, 136192
s_add_u32 s66, s66, s72
buffer_load_dwordx4 v24, s[40:43], s66 offen offset:0  lds
buffer_load_dwordx4 v25, s[40:43], s66 offen offset:1024  lds
buffer_load_dwordx4 v26, s[40:43], s66 offen offset:2048  lds
s_waitcnt vmcnt(16)
s_mov_b32 m0, 139264
s_nop 0
buffer_load_dwordx4 v27, s[44:47], s68 offen offset:0  lds
buffer_load_dwordx4 v28, s[44:47], s68 offen offset:1024  lds
buffer_load_dwordx4 v29, s[44:47], s68 offen offset:2048  lds
buffer_load_dwordx4 v30, s[44:47], s68 offen offset:3072  lds
s_waitcnt vmcnt(16)
v_mov_b32 v9, 9
ds_max_u32 v10, v9
s_mov_b32 m0, 143360
s_add_u32 s68, s68, s73
buffer_load_dwordx4 v27, s[44:47], s68 offen offset:0  lds
buffer_load_dwordx4 v28, s[44:47], s68 offen offset:1024  lds
buffer_load_dwordx4 v29, s[44:47], s68 offen offset:2048  lds
buffer_load_dwordx4 v30, s[44:47], s68 offen offset:3072  lds
s_waitcnt vmcnt(12)
L_loadj:
s_mul_i32 s49, s61, 160
s_mul_i32 s75, s60, 81920
s_add_u32 s75, s75, s49
s_lshl1_add_u32 s50, s61, s57
s_mul_i32 s50, s50, 51200
s_and_b32 s49, s60, 3
s_mul_i32 s49, s49, 3
s_lshr_b32 s49, s49, 1
v_add_u32 v45, s50, v4
s_mul_i32 s76, s49, 0
s_add_u32 s76, s76, 18874368
s_lshl1_add_u32 s50, s61, s57
s_mul_i32 s50, s50, 122880
s_and_b32 s49, s60, 3
s_mul_i32 s49, s49, 3
s_lshr_b32 s49, s49, 1
v_add_u32 v46, s50, v4
s_mul_i32 s77, s49, 20480
s_add_u32 s77, s77, 22544384
s_mul_i32 s50, s61, 102400
s_and_b32 s49, s60, 3
v_add_u32 v47, s50, v4
s_mul_i32 s78, s49, 25600
s_add_u32 s78, s78, 7340032
ds_read_b32 v6, v3 offset:32
s_waitcnt lgkmcnt(0)
v_cmp_gt_u32 vcc, 1, v6
s_nop 0
s_cbranch_vccnz W158
B157:
ds_read_b128 v[12:15], v3 offset:16
s_waitcnt lgkmcnt(0)
v_min3_u32 v12, v12, v13, v14
v_min_u32 v12, v12, v15
v_cmp_gt_u32 vcc, 7, v12
s_nop 0
s_cbranch_vccnz S159
B160:
s_waitcnt vmcnt(8)
s_mov_b32 m0, 13312
s_add_u32 s48, s78, 13312
buffer_load_dwordx4 v47, s[36:39], s48 offen offset:0 sc1 lds
buffer_load_dwordx4 v47, s[36:39], s48 offen offset:1024 sc1 lds
buffer_load_dwordx4 v47, s[36:39], s48 offen offset:2048 sc1 lds
buffer_load_dwordx4 v47, s[36:39], s48 offen offset:3072 sc1 lds
s_waitcnt vmcnt(8)
s_mov_b32 m0, 17408
s_add_u32 s48, s78, 17408
buffer_load_dwordx4 v47, s[36:39], s48 offen offset:0 sc1 lds
buffer_load_dwordx4 v47, s[36:39], s48 offen offset:1024 sc1 lds
buffer_load_dwordx4 v47, s[36:39], s48 offen offset:2048 sc1 lds
buffer_load_dwordx4 v47, s[36:39], s48 offen offset:3072 sc1 lds
s_waitcnt vmcnt(8)
v_mov_b32 v9, 10
ds_max_u32 v10, v9
s_mov_b32 m0, 21504
s_add_u32 s48, s78, 21504
buffer_load_dwordx4 v47, s[36:39], s48 offen offset:0 sc1 lds
buffer_load_dwordx4 v47, s[36:39], s48 offen offset:1024 sc1 lds
buffer_load_dwordx4 v47, s[36:39], s48 offen offset:2048 sc1 lds
buffer_load_dwordx4 v47, s[36:39], s48 offen offset:3072 sc1 lds
s_add_u32 s78, s78, 25600
s_cmp_ge_u32 s78, 7442432
s_cmov_b32 s78, 7340032
ds_read_b128 v[12:15], v3 offset:16
s_waitcnt lgkmcnt(0)
v_min3_u32 v12, v12, v13, v14
v_min_u32 v12, v12, v15
v_cmp_gt_u32 vcc, 8, v12
s_nop 0
s_cbranch_vccnz S162
B163:
s_waitcnt vmcnt(8)
s_mov_b32 m0, 38912
s_add_u32 s48, s78, 13312
buffer_load_dwordx4 v47, s[36:39], s48 offen offset:0 sc1 lds
buffer_load_dwordx4 v47, s[36:39], s48 offen offset:1024 sc1 lds
buffer_load_dwordx4 v47, s[36:39], s48 offen offset:2048 sc1 lds
buffer_load_dwordx4 v47, s[36:39], s48 offen offset:3072 sc1 lds
s_waitcnt vmcnt(8)
s_mov_b32 m0, 43008
s_add_u32 s48, s78, 17408
buffer_load_dwordx4 v47, s[36:39], s48 offen offset:0 sc1 lds
buffer_load_dwordx4 v47, s[36:39], s48 offen offset:1024 sc1 lds
buffer_load_dwordx4 v47, s[36:39], s48 offen offset:2048 sc1 lds
buffer_load_dwordx4 v47, s[36:39], s48 offen offset:3072 sc1 lds
s_waitcnt vmcnt(8)
v_mov_b32 v9, 11
ds_max_u32 v10, v9
s_mov_b32 m0, 47104
s_add_u32 s48, s78, 21504
buffer_load_dwordx4 v47, s[36:39], s48 offen offset:0 sc1 lds
buffer_load_dwordx4 v47, s[36:39], s48 offen offset:1024 sc1 lds
buffer_load_dwordx4 v47, s[36:39], s48 offen offset:2048 sc1 lds
buffer_load_dwordx4 v47, s[36:39], s48 offen offset:3072 sc1 lds
s_add_u32 s78, s78, 25600
s_cmp_ge_u32 s78, 7442432
s_cmov_b32 s78, 7340032
ds_read_b128 v[12:15], v3 offset:16
s_waitcnt lgkmcnt(0)
v_min3_u32 v12, v12, v13, v14
v_min_u32 v12, v12, v15
v_cmp_gt_u32 vcc, 9, v12
s_nop 0
s_cbranch_vccnz S165
B166:
s_waitcnt vmcnt(8)
s_mov_b32 m0, 64512
s_add_u32 s48, s78, 13312
buffer_load_dwordx4 v47, s[36:39], s48 offen offset:0 sc1 lds
buffer_load_dwordx4 v47, s[36:39], s48 offen offset:1024 sc1 lds
buffer_load_dwordx4 v47, s[36:39], s48 offen offset:2048 sc1 lds
buffer_load_dwordx4 v47, s[36:39], s48 offen offset:3072 sc1 lds
s_waitcnt vmcnt(8)
s_mov_b32 m0, 68608
s_add_u32 s48, s78, 17408
buffer_load_dwordx4 v47, s[36:39], s48 offen offset:0 sc1 lds
buffer_load_dwordx4 v47, s[36:39], s48 offen offset:1024 sc1 lds
buffer_load_dwordx4 v47, s[36:39], s48 offen offset:2048 sc1 lds
buffer_load_dwordx4 v47, s[36:39], s48 offen offset:3072 sc1 lds
s_waitcnt vmcnt(8)
v_mov_b32 v9, 12
ds_max_u32 v10, v9
s_mov_b32 m0, 72704
s_add_u32 s48, s78, 21504
buffer_load_dwordx4 v47, s[36:39], s48 offen offset:0 sc1 lds
buffer_load_dwordx4 v47, s[36:39], s48 offen offset:1024 sc1 lds
buffer_load_dwordx4 v47, s[36:39], s48 offen offset:2048 sc1 lds
buffer_load_dwordx4 v47, s[36:39], s48 offen offset:3072 sc1 lds
s_add_u32 s78, s78, 25600
s_cmp_ge_u32 s78, 7442432
s_cmov_b32 s78, 7340032
s_waitcnt vmcnt(8)
s_mov_b32 m0, 90112
s_add_u32 s48, s78, 13312
buffer_load_dwordx4 v47, s[36:39], s48 offen offset:0 sc1 lds
buffer_load_dwordx4 v47, s[36:39], s48 offen offset:1024 sc1 lds
buffer_load_dwordx4 v47, s[36:39], s48 offen offset:2048 sc1 lds
buffer_load_dwordx4 v47, s[36:39], s48 offen offset:3072 sc1 lds
s_waitcnt vmcnt(8)
s_mov_b32 m0, 94208
s_add_u32 s48, s78, 17408
buffer_load_dwordx4 v47, s[36:39], s48 offen offset:0 sc1 lds
buffer_load_dwordx4 v47, s[36:39], s48 offen offset:1024 sc1 lds
buffer_load_dwordx4 v47, s[36:39], s48 offen offset:2048 sc1 lds
buffer_load_dwordx4 v47, s[36:39], s48 offen offset:3072 sc1 lds
s_waitcnt vmcnt(8)
v_mov_b32 v9, 13
ds_max_u32 v10, v9
s_mov_b32 m0, 98304
s_add_u32 s48, s78, 21504
buffer_load_dwordx4 v47, s[36:39], s48 offen offset:0 sc1 lds
buffer_load_dwordx4 v47, s[36:39], s48 offen offset:1024 sc1 lds
buffer_load_dwordx4 v47, s[36:39], s48 offen offset:2048 sc1 lds
buffer_load_dwordx4 v47, s[36:39], s48 offen offset:3072 sc1 lds
s_add_u32 s78, s78, 25600
s_cmp_ge_u32 s78, 7442432
s_cmov_b32 s78, 7340032
ds_read_b128 v[12:15], v3 offset:16
s_waitcnt lgkmcnt(0)
v_min3_u32 v12, v12, v13, v14
v_min_u32 v12, v12, v15
v_cmp_gt_u32 vcc, 10, v12
s_nop 0
s_cbranch_vccnz S168
B169:
s_waitcnt vmcnt(8)
s_mov_b32 m0, 156672
s_add_u32 s48, s75, 40960
buffer_load_dwordx4 v40, s[4:7], s48 offen offset:0  lds
buffer_load_dwordx4 v41, s[4:7], s48 offen offset:1024  lds
buffer_load_dwordx4 v42, s[4:7], s48 offen offset:2048  lds
buffer_load_dwordx4 v43, s[4:7], s48 offen offset:3072  lds
s_waitcnt vmcnt(11)
s_mov_b32 m0, 160768
s_nop 0
buffer_load_dwordx4 v44, s[4:7], s48 offen offset:0  lds
s_mul_i32 s75, s62, 192
s_mul_i32 s48, s63, 5
s_lshr_b32 s48, s48, 1
s_mul_i32 s74, s48, 196608
s_add_u32 s74, s74, s75
s_waitcnt vmcnt(5)
v_mov_b32 v9, 14
ds_max_u32 v10, v9
s_waitcnt vmcnt(4)
s_mov_b32 m0, 108544
s_add_u32 s48, s74, 98304
buffer_load_dwordx4 v17, s[24:27], s48 offen offset:0  lds
buffer_load_dwordx4 v18, s[24:27], s48 offen offset:1024  lds
buffer_load_dwordx4 v19, s[24:27], s48 offen offset:2048  lds
s_waitcnt vmcnt(4)
s_mov_b32 m0, 111616
s_add_u32 s48, s74, 147456
buffer_load_dwordx4 v17, s[24:27], s48 offen offset:0  lds
buffer_load_dwordx4 v18, s[24:27], s48 offen offset:1024  lds
buffer_load_dwordx4 v19, s[24:27], s48 offen offset:2048  lds
s_add_u32 s74, s74, 196608
s_cmp_ge_u32 s74, 1966080
s_cmov_b32 s74, s75
s_waitcnt vmcnt(6)
v_mov_b32 v9, 15
ds_max_u32 v10, v9
s_waitcnt vmcnt(4)
s_mov_b32 m0, 120832
s_add_u32 s48, s74, 98304
buffer_load_dwordx4 v17, s[24:27], s48 offen offset:0  lds
buffer_load_dwordx4 v18, s[24:27], s48 offen offset:1024  lds
buffer_load_dwordx4 v19, s[24:27], s48 offen offset:2048  lds
s_waitcnt vmcnt(4)
s_mov_b32 m0, 123904
s_add_u32 s48, s74, 147456
buffer_load_dwordx4 v17, s[24:27], s48 offen offset:0  lds
buffer_load_dwordx4 v18, s[24:27], s48 offen offset:1024  lds
buffer_load_dwordx4 v19, s[24:27], s48 offen offset:2048  lds
s_add_u32 s74, s74, 196608
s_cmp_ge_u32 s74, 1966080
s_cmov_b32 s74, s75
ds_read_b128 v[12:15], v3 offset:16
s_waitcnt lgkmcnt(0)
v_min3_u32 v12, v12, v13, v14
v_min_u32 v12, v12, v15
v_cmp_gt_u32 vcc, 11, v12
s_nop 0
s_cbranch_vccnz S171
B172:
s_waitcnt vmcnt(6)
v_mov_b32 v9, 16
ds_max_u32 v10, v9
s_waitcnt vmcnt(4)
s_mov_b32 m0, 133120
s_add_u32 s48, s74, 98304
buffer_load_dwordx4 v17, s[24:27], s48 offen offset:0  lds
buffer_load_dwordx4 v18, s[24:27], s48 offen offset:1024  lds
buffer_load_dwordx4 v19, s[24:27], s48 offen offset:2048  lds
s_waitcnt vmcnt(4)
s_mov_b32 m0, 136192
s_add_u32 s48, s74, 147456
buffer_load_dwordx4 v17, s[24:27], s48 offen offset:0  lds
buffer_load_dwordx4 v18, s[24:27], s48 offen offset:1024  lds
buffer_load_dwordx4 v19, s[24:27], s48 offen offset:2048  lds
s_add_u32 s74, s74, 196608
s_cmp_ge_u32 s74, 1966080
s_cmov_b32 s74, s75
ds_read_b64 v[6:7], v3 offset:40
s_waitcnt lgkmcnt(0)
v_min_u32 v6, v6, v7
v_cmp_gt_u32 vcc, 1, v6
s_nop 0
s_cbranch_vccnz W176
B175:
s_waitcnt vmcnt(6)
v_mov_b32 v9, 17
ds_max_u32 v10, v9
s_waitcnt vmcnt(4)
s_mov_b32 m0, 145408
s_add_u32 s48, s74, 98304
buffer_load_dwordx4 v17, s[24:27], s48 offen offset:0  lds
buffer_load_dwordx4 v18, s[24:27], s48 offen offset:1024  lds
buffer_load_dwordx4 v19, s[24:27], s48 offen offset:2048  lds
s_waitcnt vmcnt(4)
s_mov_b32 m0, 148480
s_add_u32 s48, s74, 147456
buffer_load_dwordx4 v17, s[24:27], s48 offen offset:0  lds
buffer_load_dwordx4 v18, s[24:27], s48 offen offset:1024  lds
buffer_load_dwordx4 v19, s[24:27], s48 offen offset:2048  lds
s_add_u32 s74, s74, 196608
s_cmp_ge_u32 s74, 1966080
s_cmov_b32 s74, s75
ds_read_b128 v[12:15], v3 offset:16
s_waitcnt lgkmcnt(0)
v_min3_u32 v12, v12, v13, v14
v_min_u32 v12, v12, v15
v_cmp_gt_u32 vcc, 12, v12
s_nop 0
s_cbranch_vccnz S177
B178:
s_waitcnt vmcnt(6)
v_mov_b32 v9, 18
ds_max_u32 v10, v9
s_waitcnt vmcnt(4)
s_mov_b32 m0, 6144
s_add_u32 s48, s74, 98304
buffer_load_dwordx4 v17, s[24:27], s48 offen offset:0  lds
buffer_load_dwordx4 v18, s[24:27], s48 offen offset:1024  lds
buffer_load_dwordx4 v19, s[24:27], s48 offen offset:2048  lds
s_waitcnt vmcnt(4)
s_mov_b32 m0, 9216
s_add_u32 s48, s74, 147456
buffer_load_dwordx4 v17, s[24:27], s48 offen offset:0  lds
buffer_load_dwordx4 v18, s[24:27], s48 offen offset:1024  lds
buffer_load_dwordx4 v19, s[24:27], s48 offen offset:2048  lds
s_add_u32 s74, s74, 196608
s_cmp_ge_u32 s74, 1966080
s_cmov_b32 s74, s75
s_waitcnt vmcnt(6)
v_mov_b32 v9, 19
ds_max_u32 v10, v9
s_waitcnt vmcnt(4)
s_mov_b32 m0, 18432
s_add_u32 s48, s74, 98304
buffer_load_dwordx4 v17, s[24:27], s48 offen offset:0  lds
buffer_load_dwordx4 v18, s[24:27], s48 offen offset:1024  lds
buffer_load_dwordx4 v19, s[24:27], s48 offen offset:2048  lds
s_waitcnt vmcnt(4)
s_mov_b32 m0, 21504
s_add_u32 s48, s74, 147456
buffer_load_dwordx4 v17, s[24:27], s48 offen offset:0  lds
buffer_load_dwordx4 v18, s[24:27], s48 offen offset:1024  lds
buffer_load_dwordx4 v19, s[24:27], s48 offen offset:2048  lds
s_add_u32 s74, s74, 196608
s_cmp_ge_u32 s74, 1966080
s_cmov_b32 s74, s75
s_waitcnt vmcnt(6)
v_mov_b32 v9, 20
ds_max_u32 v10, v9
s_waitcnt vmcnt(4)
s_mov_b32 m0, 30720
s_add_u32 s48, s74, 98304
buffer_load_dwordx4 v17, s[24:27], s48 offen offset:0  lds
buffer_load_dwordx4 v18, s[24:27], s48 offen offset:1024  lds
buffer_load_dwordx4 v19, s[24:27], s48 offen offset:2048  lds
s_waitcnt vmcnt(4)
s_mov_b32 m0, 33792
s_add_u32 s48, s74, 147456
buffer_load_dwordx4 v17, s[24:27], s48 offen offset:0  lds
buffer_load_dwordx4 v18, s[24:27], s48 offen offset:1024  lds
buffer_load_dwordx4 v19, s[24:27], s48 offen offset:2048  lds
s_add_u32 s74, s74, 196608
s_cmp_ge_u32 s74, 1966080
s_cmov_b32 s74, s75
s_waitcnt vmcnt(6)
v_mov_b32 v9, 21
ds_max_u32 v10, v9
s_waitcnt vmcnt(4)
s_mov_b32 m0, 43008
s_add_u32 s48, s74, 98304
buffer_load_dwordx4 v17, s[24:27], s48 offen offset:0  lds
buffer_load_dwordx4 v18, s[24:27], s48 offen offset:1024  lds
buffer_load_dwordx4 v19, s[24:27], s48 offen offset:2048  lds
s_waitcnt vmcnt(4)
s_mov_b32 m0, 46080
s_add_u32 s48, s74, 147456
buffer_load_dwordx4 v17, s[24:27], s48 offen offset:0  lds
buffer_load_dwordx4 v18, s[24:27], s48 offen offset:1024  lds
buffer_load_dwordx4 v19, s[24:27], s48 offen offset:2048  lds
s_add_u32 s74, s74, 196608
s_cmp_ge_u32 s74, 1966080
s_cmov_b32 s74, s75
ds_read_b128 v[12:15], v3 offset:16
s_waitcnt lgkmcnt(0)
v_min3_u32 v12, v12, v13, v14
v_min_u32 v12, v12, v15
v_cmp_gt_u32 vcc, 13, v12
s_nop 0
s_cbranch_vccnz S180
B181:
s_waitcnt vmcnt(6)
v_mov_b32 v9, 22
ds_max_u32 v10, v9
s_waitcnt vmcnt(4)
s_mov_b32 m0, 55296
s_add_u32 s48, s74, 98304
buffer_load_dwordx4 v17, s[24:27], s48 offen offset:0  lds
buffer_load_dwordx4 v18, s[24:27], s48 offen offset:1024  lds
buffer_load_dwordx4 v19, s[24:27], s48 offen offset:2048  lds
s_waitcnt vmcnt(4)
s_mov_b32 m0, 58368
s_add_u32 s48, s74, 147456
buffer_load_dwordx4 v17, s[24:27], s48 offen offset:0  lds
buffer_load_dwordx4 v18, s[24:27], s48 offen offset:1024  lds
buffer_load_dwordx4 v19, s[24:27], s48 offen offset:2048  lds
s_add_u32 s74, s74, 196608
s_cmp_ge_u32 s74, 1966080
s_cmov_b32 s74, s75
s_waitcnt vmcnt(6)
v_mov_b32 v9, 23
ds_max_u32 v10, v9
s_waitcnt vmcnt(4)
s_mov_b32 m0, 67584
s_add_u32 s48, s74, 98304
buffer_load_dwordx4 v17, s[24:27], s48 offen offset:0  lds
buffer_load_dwordx4 v18, s[24:27], s48 offen offset:1024  lds
buffer_load_dwordx4 v19, s[24:27], s48 offen offset:2048  lds
s_waitcnt vmcnt(4)
s_mov_b32 m0, 70656
s_add_u32 s48, s74, 147456
buffer_load_dwordx4 v17, s[24:27], s48 offen offset:0  lds
buffer_load_dwordx4 v18, s[24:27], s48 offen offset:1024  lds
buffer_load_dwordx4 v19, s[24:27], s48 offen offset:2048  lds
s_add_u32 s74, s74, 196608
s_cmp_ge_u32 s74, 1966080
s_cmov_b32 s74, s75
ds_read_b32 v6, v3 offset:32
s_waitcnt lgkmcnt(0)
v_cmp_gt_u32 vcc, 2, v6
s_nop 0
s_cbranch_vccnz W185
B184:
ds_read_b128 v[12:15], v3 offset:16
s_waitcnt lgkmcnt(0)
v_min3_u32 v12, v12, v13, v14
v_min_u32 v12, v12, v15
v_cmp_gt_u32 vcc, 14, v12
s_nop 0
s_cbranch_vccnz S186
B187:
s_waitcnt vmcnt(6)
v_mov_b32 v9, 24
ds_max_u32 v10, v9
s_waitcnt vmcnt(4)
s_mov_b32 m0, 87040
s_add_u32 s48, s77, 5120
buffer_load_dwordx4 v46, s[36:39], s48 offen offset:0 sc1 lds
buffer_load_dwordx4 v46, s[36:39], s48 offen offset:1024 sc1 lds
buffer_load_dwordx4 v46, s[36:39], s48 offen offset:2048 sc1 lds
s_waitcnt vmcnt(5)
s_mov_b32 m0, 90112
s_add_u32 s48, s77, 8192
buffer_load_dwordx4 v46, s[36:39], s48 offen offset:0 sc1 lds
buffer_load_dwordx4 v46, s[36:39], s48 offen offset:1024 sc1 lds
s_add_u32 s77, s77, 10240
s_cmp_ge_u32 s77, 22667264
s_cmov_b32 s77, 22544384
s_waitcnt vmcnt(5)
v_mov_b32 v9, 25
ds_max_u32 v10, v9
s_waitcnt vmcnt(4)
s_mov_b32 m0, 97280
s_add_u32 s48, s77, 5120
buffer_load_dwordx4 v46, s[36:39], s48 offen offset:0 sc1 lds
buffer_load_dwordx4 v46, s[36:39], s48 offen offset:1024 sc1 lds
buffer_load_dwordx4 v46, s[36:39], s48 offen offset:2048 sc1 lds
s_waitcnt vmcnt(5)
s_mov_b32 m0, 100352
s_add_u32 s48, s77, 8192
buffer_load_dwordx4 v46, s[36:39], s48 offen offset:0 sc1 lds
buffer_load_dwordx4 v46, s[36:39], s48 offen offset:1024 sc1 lds
s_add_u32 s77, s77, 10240
s_cmp_ge_u32 s77, 22667264
s_cmov_b32 s77, 22544384
ds_read_b128 v[12:15], v3 offset:16
s_waitcnt lgkmcnt(0)
v_min3_u32 v12, v12, v13, v14
v_min_u32 v12, v12, v15
v_cmp_gt_u32 vcc, 15, v12
s_nop 0
s_cbranch_vccnz S189
B190:
s_mov_b32 m0, 107520
s_add_u32 s48, s77, 5120
buffer_load_dwordx4 v46, s[36:39], s48 offen offset:0 sc1 lds
buffer_load_dwordx4 v46, s[36:39], s48 offen offset:1024 sc1 lds
buffer_load_dwordx4 v46, s[36:39], s48 offen offset:2048 sc1 lds
s_waitcnt vmcnt(8)
v_mov_b32 v9, 26
ds_max_u32 v10, v9
s_mov_b32 m0, 110592
s_add_u32 s48, s77, 8192
buffer_load_dwordx4 v46, s[36:39], s48 offen offset:0 sc1 lds
buffer_load_dwordx4 v46, s[36:39], s48 offen offset:1024 sc1 lds
s_add_u32 s77, s77, 10240
s_cmp_ge_u32 s77, 22667264
s_cmov_b32 s77, 22544384
s_waitcnt vmcnt(7)
s_mov_b32 m0, 117760
s_add_u32 s48, s77, 5120
buffer_load_dwordx4 v46, s[36:39], s48 offen offset:0 sc1 lds
buffer_load_dwordx4 v46, s[36:39], s48 offen offset:1024 sc1 lds
buffer_load_dwordx4 v46, s[36:39], s48 offen offset:2048 sc1 lds
s_waitcnt vmcnt(8)
v_mov_b32 v9, 27
ds_max_u32 v10, v9
s_mov_b32 m0, 120832
s_add_u32 s48, s77, 8192
buffer_load_dwordx4 v46, s[36:39], s48 offen offset:0 sc1 lds
buffer_load_dwordx4 v46, s[36:39], s48 offen offset:1024 sc1 lds
s_add_u32 s77, s77, 10240
s_cmp_ge_u32 s77, 22667264
s_cmov_b32 s77, 22544384
ds_read_b128 v[12:15], v3 offset:16
s_waitcnt lgkmcnt(0)
v_min3_u32 v12, v12, v13, v14
v_min_u32 v12, v12, v15
v_cmp_gt_u32 vcc, 16, v12
s_nop 0
s_cbranch_vccnz S192
B193:
s_waitcnt vmcnt(7)
s_mov_b32 m0, 128000
s_add_u32 s48, s77, 5120
buffer_load_dwordx4 v46, s[36:39], s48 offen offset:0 sc1 lds
buffer_load_dwordx4 v46, s[36:39], s48 offen offset:1024 sc1 lds
buffer_load_dwordx4 v46, s[36:39], s48 offen offset:2048 sc1 lds
s_waitcnt vmcnt(8)
v_mov_b32 v9, 28
ds_max_u32 v10, v9
s_mov_b32 m0, 131072
s_add_u32 s48, s77, 8192
buffer_load_dwordx4 v46, s[36:39], s48 offen offset:0 sc1 lds
buffer_load_dwordx4 v46, s[36:39], s48 offen offset:1024 sc1 lds
s_add_u32 s77, s77, 10240
s_cmp_ge_u32 s77, 22667264
s_cmov_b32 s77, 22544384
s_waitcnt vmcnt(7)
s_mov_b32 m0, 138240
s_add_u32 s48, s77, 5120
buffer_load_dwordx4 v46, s[36:39], s48 offen offset:0 sc1 lds
buffer_load_dwordx4 v46, s[36:39], s48 offen offset:1024 sc1 lds
buffer_load_dwordx4 v46, s[36:39], s48 offen offset:2048 sc1 lds
s_waitcnt vmcnt(8)
v_mov_b32 v9, 29
ds_max_u32 v10, v9
s_mov_b32 m0, 141312
s_add_u32 s48, s77, 8192
buffer_load_dwordx4 v46, s[36:39], s48 offen offset:0 sc1 lds
buffer_load_dwordx4 v46, s[36:39], s48 offen offset:1024 sc1 lds
s_add_u32 s77, s77, 10240
s_cmp_ge_u32 s77, 22667264
s_cmov_b32 s77, 22544384
s_waitcnt vmcnt(7)
s_mov_b32 m0, 148480
s_add_u32 s48, s77, 5120
buffer_load_dwordx4 v46, s[36:39], s48 offen offset:0 sc1 lds
buffer_load_dwordx4 v46, s[36:39], s48 offen offset:1024 sc1 lds
buffer_load_dwordx4 v46, s[36:39], s48 offen offset:2048 sc1 lds
s_waitcnt vmcnt(8)
v_mov_b32 v9, 30
ds_max_u32 v10, v9
s_mov_b32 m0, 151552
s_add_u32 s48, s77, 8192
buffer_load_dwordx4 v46, s[36:39], s48 offen offset:0 sc1 lds
buffer_load_dwordx4 v46, s[36:39], s48 offen offset:1024 sc1 lds
s_add_u32 s77, s77, 10240
s_cmp_ge_u32 s77, 22667264
s_cmov_b32 s77, 22544384
ds_read_b128 v[12:15], v3 offset:16
s_waitcnt lgkmcnt(0)
v_min3_u32 v12, v12, v13, v14
v_min_u32 v12, v12, v15
v_cmp_gt_u32 vcc, 17, v12
s_nop 0
s_cbranch_vccnz S195
B196:
ds_read_b32 v6, v3 offset:56
s_waitcnt lgkmcnt(0)
v_cmp_gt_u32 vcc, 1, v6
s_nop 0
s_cbranch_vccnz W200
B199:
s_mov_b32 m0, 5120
s_add_u32 s48, s76, 5120
buffer_load_dwordx4 v45, s[36:39], s48 offen offset:0 sc1 lds
buffer_load_dwordx4 v45, s[36:39], s48 offen offset:1024 sc1 lds
buffer_load_dwordx4 v45, s[36:39], s48 offen offset:2048 sc1 lds
s_waitcnt vmcnt(12)
s_mov_b32 m0, 8192
s_add_u32 s48, s76, 8192
buffer_load_dwordx4 v45, s[36:39], s48 offen offset:0 sc1 lds
buffer_load_dwordx4 v45, s[36:39], s48 offen offset:1024 sc1 lds
s_add_u32 s76, s76, 10240
s_cmp_ge_u32 s76, 18925568
s_cmov_b32 s76, 18874368
s_waitcnt vmcnt(11)
s_mov_b32 m0, 15360
s_add_u32 s48, s76, 5120
buffer_load_dwordx4 v45, s[36:39], s48 offen offset:0 sc1 lds
buffer_load_dwordx4 v45, s[36:39], s48 offen offset:1024 sc1 lds
buffer_load_dwordx4 v45, s[36:39], s48 offen offset:2048 sc1 lds
s_waitcnt vmcnt(13)
v_mov_b32 v9, 31
ds_max_u32 v10, v9
s_waitcnt vmcnt(12)
s_mov_b32 m0, 18432
s_add_u32 s48, s76, 8192
buffer_load_dwordx4 v45, s[36:39], s48 offen offset:0 sc1 lds
buffer_load_dwordx4 v45, s[36:39], s48 offen offset:1024 sc1 lds
s_add_u32 s76, s76, 10240
s_cmp_ge_u32 s76, 18925568
s_cmov_b32 s76, 18874368
ds_read_b128 v[12:15], v3 offset:16
s_waitcnt lgkmcnt(0)
v_min3_u32 v12, v12, v13, v14
v_min_u32 v12, v12, v15
v_cmp_gt_u32 vcc, 18, v12
s_nop 0
s_cbranch_vccnz S201
B202:
s_waitcnt vmcnt(11)
s_mov_b32 m0, 25600
s_add_u32 s48, s76, 5120
buffer_load_dwordx4 v45, s[36:39], s48 offen offset:0 sc1 lds
buffer_load_dwordx4 v45, s[36:39], s48 offen offset:1024 sc1 lds
buffer_load_dwordx4 v45, s[36:39], s48 offen offset:2048 sc1 lds
s_waitcnt vmcnt(13)
v_mov_b32 v9, 32
ds_max_u32 v10, v9
s_waitcnt vmcnt(12)
s_mov_b32 m0, 28672
s_add_u32 s48, s76, 8192
buffer_load_dwordx4 v45, s[36:39], s48 offen offset:0 sc1 lds
buffer_load_dwordx4 v45, s[36:39], s48 offen offset:1024 sc1 lds
s_add_u32 s76, s76, 10240
s_cmp_ge_u32 s76, 18925568
s_cmov_b32 s76, 18874368
s_waitcnt vmcnt(11)
s_mov_b32 m0, 35840
s_add_u32 s48, s76, 5120
buffer_load_dwordx4 v45, s[36:39], s48 offen offset:0 sc1 lds
buffer_load_dwordx4 v45, s[36:39], s48 offen offset:1024 sc1 lds
buffer_load_dwordx4 v45, s[36:39], s48 offen offset:2048 sc1 lds
s_waitcnt vmcnt(13)
v_mov_b32 v9, 33
ds_max_u32 v10, v9
s_waitcnt vmcnt(12)
s_mov_b32 m0, 38912
s_add_u32 s48, s76, 8192
buffer_load_dwordx4 v45, s[36:39], s48 offen offset:0 sc1 lds
buffer_load_dwordx4 v45, s[36:39], s48 offen offset:1024 sc1 lds
s_add_u32 s76, s76, 10240
s_cmp_ge_u32 s76, 18925568
s_cmov_b32 s76, 18874368
ds_read_b128 v[12:15], v3 offset:16
s_waitcnt lgkmcnt(0)
v_min3_u32 v12, v12, v13, v14
v_min_u32 v12, v12, v15
v_cmp_gt_u32 vcc, 19, v12
s_nop 0
s_cbranch_vccnz S204
B205:
s_waitcnt vmcnt(11)
s_mov_b32 m0, 46080
s_add_u32 s48, s76, 5120
buffer_load_dwordx4 v45, s[36:39], s48 offen offset:0 sc1 lds
buffer_load_dwordx4 v45, s[36:39], s48 offen offset:1024 sc1 lds
buffer_load_dwordx4 v45, s[36:39], s48 offen offset:2048 sc1 lds
s_waitcnt vmcnt(13)
v_mov_b32 v9, 34
ds_max_u32 v10, v9
s_waitcnt vmcnt(12)
s_mov_b32 m0, 49152
s_add_u32 s48, s76, 8192
buffer_load_dwordx4 v45, s[36:39], s48 offen offset:0 sc1 lds
buffer_load_dwordx4 v45, s[36:39], s48 offen offset:1024 sc1 lds
s_add_u32 s76, s76, 10240
s_cmp_ge_u32 s76, 18925568
s_cmov_b32 s76, 18874368
s_waitcnt vmcnt(11)
s_mov_b32 m0, 56320
s_add_u32 s48, s77, 5120
buffer_load_dwordx4 v46, s[36:39], s48 offen offset:0 sc1 lds
buffer_load_dwordx4 v46, s[36:39], s48 offen offset:1024 sc1 lds
buffer_load_dwordx4 v46, s[36:39], s48 offen offset:2048 sc1 lds
s_waitcnt vmcnt(13)
v_mov_b32 v9, 35
ds_max_u32 v10, v9
s_waitcnt vmcnt(12)
s_mov_b32 m0, 59392
s_add_u32 s48, s77, 8192
buffer_load_dwordx4 v46, s[36:39], s48 offen offset:0 sc1 lds
buffer_load_dwordx4 v46, s[36:39], s48 offen offset:1024 sc1 lds
s_add_u32 s77, s77, 10240
s_cmp_ge_u32 s77, 22667264
s_cmov_b32 s77, 22544384
ds_read_b128 v[12:15], v3 offset:16
s_waitcnt lgkmcnt(0)
v_min3_u32 v12, v12, v13, v14
v_min_u32 v12, v12, v15
v_cmp_gt_u32 vcc, 20, v12
s_nop 0
s_cbranch_vccnz S207
B208:
s_waitcnt vmcnt(11)
s_mov_b32 m0, 66560
s_add_u32 s48, s77, 5120
buffer_load_dwordx4 v46, s[36:39], s48 offen offset:0 sc1 lds
buffer_load_dwordx4 v46, s[36:39], s48 offen offset:1024 sc1 lds
buffer_load_dwordx4 v46, s[36:39], s48 offen offset:2048 sc1 lds
s_waitcnt vmcnt(13)
v_mov_b32 v9, 36
ds_max_u32 v10, v9
s_waitcnt vmcnt(12)
s_mov_b32 m0, 69632
s_add_u32 s48, s77, 8192
buffer_load_dwordx4 v46, s[36:39], s48 offen offset:0 sc1 lds
buffer_load_dwordx4 v46, s[36:39], s48 offen offset:1024 sc1 lds
s_add_u32 s77, s77, 10240
s_cmp_ge_u32 s77, 22667264
s_cmov_b32 s77, 22544384
s_waitcnt vmcnt(11)
s_mov_b32 m0, 76800
s_add_u32 s48, s77, 5120
buffer_load_dwordx4 v46, s[36:39], s48 offen offset:0 sc1 lds
buffer_load_dwordx4 v46, s[36:39], s48 offen offset:1024 sc1 lds
buffer_load_dwordx4 v46, s[36:39], s48 offen offset:2048 sc1 lds
s_waitcnt vmcnt(13)
v_mov_b32 v9, 37
ds_max_u32 v10, v9
s_waitcnt vmcnt(12)
s_mov_b32 m0, 79872
s_add_u32 s48, s77, 8192
buffer_load_dwordx4 v46, s[36:39], s48 offen offset:0 sc1 lds
buffer_load_dwordx4 v46, s[36:39], s48 offen offset:1024 sc1 lds
s_add_u32 s77, s77, 10240
s_cmp_ge_u32 s77, 22667264
s_cmov_b32 s77, 22544384
ds_read_b128 v[12:15], v3 offset:16
s_waitcnt lgkmcnt(0)
v_min3_u32 v12, v12, v13, v14
v_min_u32 v12, v12, v15
v_cmp_gt_u32 vcc, 22, v12
s_nop 0
s_cbranch_vccnz S210
B211:
s_waitcnt vmcnt(11)
s_mov_b32 m0, 5120
s_add_u32 s48, s77, 5120
buffer_load_dwordx4 v46, s[36:39], s48 offen offset:0 sc1 lds
buffer_load_dwordx4 v46, s[36:39], s48 offen offset:1024 sc1 lds
buffer_load_dwordx4 v46, s[36:39], s48 offen offset:2048 sc1 lds
s_waitcnt vmcnt(13)
v_mov_b32 v9, 38
ds_max_u32 v10, v9
s_waitcnt vmcnt(12)
s_mov_b32 m0, 8192
s_add_u32 s48, s77, 8192
buffer_load_dwordx4 v46, s[36:39], s48 offen offset:0 sc1 lds
buffer_load_dwordx4 v46, s[36:39], s48 offen offset:1024 sc1 lds
s_add_u32 s77, s77, 10240
s_cmp_ge_u32 s77, 22667264
s_cmov_b32 s77, 22544384
s_waitcnt vmcnt(11)
s_mov_b32 m0, 15360
s_add_u32 s48, s77, 5120
buffer_load_dwordx4 v46, s[36:39], s48 offen offset:0 sc1 lds
buffer_load_dwordx4 v46, s[36:39], s48 offen offset:1024 sc1 lds
buffer_load_dwordx4 v46, s[36:39], s48 offen offset:2048 sc1 lds
s_waitcnt vmcnt(13)
v_mov_b32 v9, 39
ds_max_u32 v10, v9
s_waitcnt vmcnt(12)
s_mov_b32 m0, 18432
s_add_u32 s48, s77, 8192
buffer_load_dwordx4 v46, s[36:39], s48 offen offset:0 sc1 lds
buffer_load_dwordx4 v46, s[36:39], s48 offen offset:1024 sc1 lds
s_add_u32 s77, s77, 10240
s_cmp_ge_u32 s77, 22667264
s_cmov_b32 s77, 22544384
ds_read_b128 v[12:15], v3 offset:16
s_waitcnt lgkmcnt(0)
v_min3_u32 v12, v12, v13, v14
v_min_u32 v12, v12, v15
v_cmp_gt_u32 vcc, 23, v12
s_nop 0
s_cbranch_vccnz S213
B214:
s_waitcnt vmcnt(10)
v_mov_b32 v9, 40
ds_max_u32 v10, v9
s_waitcnt vmcnt(5)
v_mov_b32 v9, 41
ds_max_u32 v10, v9
s_waitcnt vmcnt(0)
v_mov_b32 v9, 42
ds_max_u32 v10, v9
ds_read_b32 v2, v3 offset:76
s_waitcnt lgkmcnt(0)
v_readfirstlane_b32 s53, v2
s_lshl3_add_u32 s49, s60, s61
s_lshl_b32 s50, s49, 7
s_add_u32 s50, s50, 524288
s_mul_i32 s49, s49, 20480
s_add_u32 s49, s49, 24651776
L216:
ds_read_b128 v[12:15], v3 offset:16
s_sleep 2
s_sub_u32 s54, s54, 1
s_cmp_lt_i32 s54, 0
s_cbranch_scc1 L217
s_waitcnt lgkmcnt(0)
v_min3_u32 v12, v12, v13, v14
v_min_u32 v12, v12, v15
v_cmp_gt_u32 vcc, 24, v12
s_nop 0
s_cbranch_vccnz L216
L217:
s_mov_b64 s[80:81], 0
s_atomic_add_x2 s[80:81], s[36:37], s50 glc
s_waitcnt lgkmcnt(0)
s_cmp_lg_u32 s81, s53
s_cbranch_scc1 N218
s_andn2_b32 s51, 4, s80
s_cbranch_scc1 N218
B219:
s_mov_b32 m0, 30720
s_add_u32 s48, s49, 0
buffer_load_dwordx4 v4, s[36:39], s48 offen offset:0 sc1 lds
buffer_load_dwordx4 v4, s[36:39], s48 offen offset:1024 sc1 lds
buffer_load_dwordx4 v4, s[36:39], s48 offen offset:2048 sc1 lds
s_cmp_lg_u32 s81, s53
s_cbranch_scc1 N220
s_andn2_b32 s51, 8, s80
s_cbranch_scc1 N220
B221:
s_mov_b32 m0, 35840
s_add_u32 s48, s49, 5120
buffer_load_dwordx4 v4, s[36:39], s48 offen offset:0 sc1 lds
buffer_load_dwordx4 v4, s[36:39], s48 offen offset:1024 sc1 lds
buffer_load_dwordx4 v4, s[36:39], s48 offen offset:2048 sc1 lds
s_waitcnt vmcnt(0)
v_mov_b32 v9, 43
ds_max_u32 v10, v9
s_waitcnt vmcnt(0) lgkmcnt(0)
s_branch L_fin
L_load0:
s_setprio 3
s_lshl3_add_u32 s48, s57, s59
s_add_u32 s48, s48, s58
s_and_b32 s48, s48, 1
s_mul_i32 s48, s48, 10
s_lshr_b32 s64, s48, 1
s_lshl_b32 s65, s64, 7
s_mul_i32 s48, s58, 163840
v_lshrrev_b32 v16, 3, v1
v_mul_u32_u24 v16, 1280, v16
v_add_u32 v11, s48, v16
v_lshrrev_b32 v16, 4, v1
v_xor_b32 v16, v16, v1
v_and_b32 v16, 7, v16
v_lshlrev_b32 v16, 4, v16
v_add_u32 v17, v11, v16
v_xor_b32 v16, 64, v16
v_add_u32 v16, 9216, v16
v_add_u32 v18, v11, v16
v_add_u32 v19, 18432, v17
v_add_u32 v24, 18432, v18
s_mov_b32 s6, 2621440
s_mov_b32 s7, 0x20000
s_waitcnt lgkmcnt(0)
s_mov_b64 s[4:5], s[88:89]
s_mov_b32 m0, 73728
s_add_u32 s48, s65, 0
buffer_load_dwordx4 v17, s[4:7], s48 offen offset:0  lds
buffer_load_dwordx4 v18, s[4:7], s48 offen offset:1024  lds
buffer_load_dwordx4 v19, s[4:7], s48 offen offset:2048  lds
buffer_load_dwordx4 v24, s[4:7], s48 offen offset:3072  lds
s_mov_b32 m0, 77824
s_add_u32 s48, s65, 40960
buffer_load_dwordx4 v17, s[4:7], s48 offen offset:0  lds
buffer_load_dwordx4 v18, s[4:7], s48 offen offset:1024  lds
buffer_load_dwordx4 v19, s[4:7], s48 offen offset:2048  lds
buffer_load_dwordx4 v24, s[4:7], s48 offen offset:3072  lds
s_mov_b32 m0, 81920
s_add_u32 s48, s65, 81920
buffer_load_dwordx4 v17, s[4:7], s48 offen offset:0  lds
buffer_load_dwordx4 v18, s[4:7], s48 offen offset:1024  lds
buffer_load_dwordx4 v19, s[4:7], s48 offen offset:2048  lds
buffer_load_dwordx4 v24, s[4:7], s48 offen offset:3072  lds
s_mov_b32 m0, 86016
s_add_u32 s48, s65, 122880
buffer_load_dwordx4 v17, s[4:7], s48 offen offset:0  lds
buffer_load_dwordx4 v18, s[4:7], s48 offen offset:1024  lds
buffer_load_dwordx4 v19, s[4:7], s48 offen offset:2048  lds
buffer_load_dwordx4 v24, s[4:7], s48 offen offset:3072  lds
v_cmp_eq_u32 vcc, 0, v1
v_mov_b32 v37, 1073741824
s_nop 0
v_cndmask_b32 v5, v37, v1, vcc
v_lshrrev_b32 v10, 10, v5
v_add_u32 v10, 163328, v10
v_mov_b32 v9, 1
ds_write_b32 v10, v9 offset:64
s_add_u32 s65, s65, 128
s_cmpk_eq_u32 s65, 1280
s_cmovk_i32 s65, 0
s_waitcnt vmcnt(12)
s_mov_b32 m0, 110592
s_add_u32 s48, s65, 0
buffer_load_dwordx4 v17, s[4:7], s48 offen offset:0  lds
buffer_load_dwordx4 v18, s[4:7], s48 offen offset:1024  lds
buffer_load_dwordx4 v19, s[4:7], s48 offen offset:2048  lds
buffer_load_dwordx4 v24, s[4:7], s48 offen offset:3072  lds
s_waitcnt vmcnt(12)
s_mov_b32 m0, 114688
s_add_u32 s48, s65, 40960
buffer_load_dwordx4 v17, s[4:7], s48 offen offset:0  lds
buffer_load_dwordx4 v18, s[4:7], s48 offen offset:1024  lds
buffer_load_dwordx4 v19, s[4:7], s48 offen offset:2048  lds
buffer_load_dwordx4 v24, s[4:7], s48 offen offset:3072  lds
s_waitcnt vmcnt(12)
s_mov_b32 m0, 118784
s_add_u32 s48, s65, 81920
buffer_load_dwordx4 v17, s[4:7], s48 offen offset:0  lds
buffer_load_dwordx4 v18, s[4:7], s48 offen offset:1024  lds
buffer_load_dwordx4 v19, s[4:7], s48 offen offset:2048  lds
buffer_load_dwordx4 v24, s[4:7], s48 offen offset:3072  lds
s_waitcnt vmcnt(12)
v_mov_b32 v9, 1
ds_max_u32 v10, v9
s_mov_b32 m0, 122880
s_add_u32 s48, s65, 122880
buffer_load_dwordx4 v17, s[4:7], s48 offen offset:0  lds
buffer_load_dwordx4 v18, s[4:7], s48 offen offset:1024  lds
buffer_load_dwordx4 v19, s[4:7], s48 offen offset:2048  lds
buffer_load_dwordx4 v24, s[4:7], s48 offen offset:3072  lds
s_add_u32 s65, s65, 128
s_cmpk_eq_u32 s65, 1280
s_cmovk_i32 s65, 0
s_mov_b32 s38, 29884416
s_mov_b32 s39, 0x20000
s_mov_b32 s26, 1966080
s_mov_b32 s27, 0x20000
s_mov_b64 s[24:25], s[96:97]
v_add_u32 v32, 0, v1
v_mul_u32_u24 v25, 5462, v32
v_lshrrev_b32 v25, 16, v25
v_mul_u32_u24 v33, 12, v25
v_sub_u32 v33, v32, v33
v_mul_u32_u24 v25, 3072, v25
v_lshl_add_u32 v25, v33, 4, v25
v_add_u32 v32, 64, v1
v_mul_u32_u24 v26, 5462, v32
v_lshrrev_b32 v26, 16, v26
v_mul_u32_u24 v33, 12, v26
v_sub_u32 v33, v32, v33
v_mul_u32_u24 v26, 3072, v26
v_lshl_add_u32 v26, v33, 4, v26
v_subrev_u32 v26, 1024, v26
v_add_u32 v32, 128, v1
v_mul_u32_u24 v27, 5462, v32
v_lshrrev_b32 v27, 16, v27
v_mul_u32_u24 v33, 12, v27
v_sub_u32 v33, v32, v33
s_waitcnt vmcnt(12)
s_mov_b32 m0, 0
s_add_u32 s48, s65, 0
buffer_load_dwordx4 v17, s[4:7], s48 offen offset:0  lds
buffer_load_dwordx4 v18, s[4:7], s48 offen offset:1024  lds
buffer_load_dwordx4 v19, s[4:7], s48 offen offset:2048  lds
buffer_load_dwordx4 v24, s[4:7], s48 offen offset:3072  lds
s_waitcnt vmcnt(12)
s_mov_b32 m0, 4096
s_add_u32 s48, s65, 40960
buffer_load_dwordx4 v17, s[4:7], s48 offen offset:0  lds
buffer_load_dwordx4 v18, s[4:7], s48 offen offset:1024  lds
buffer_load_dwordx4 v19, s[4:7], s48 offen offset:2048  lds
buffer_load_dwordx4 v24, s[4:7], s48 offen offset:3072  lds
s_waitcnt vmcnt(12)
s_mov_b32 m0, 8192
s_add_u32 s48, s65, 81920
buffer_load_dwordx4 v17, s[4:7], s48 offen offset:0  lds
buffer_load_dwordx4 v18, s[4:7], s48 offen offset:1024  lds
buffer_load_dwordx4 v19, s[4:7], s48 offen offset:2048  lds
buffer_load_dwordx4 v24, s[4:7], s48 offen offset:3072  lds
s_waitcnt vmcnt(12)
v_mov_b32 v9, 2
ds_max_u32 v10, v9
s_mov_b32 m0, 12288
s_add_u32 s48, s65, 122880
buffer_load_dwordx4 v17, s[4:7], s48 offen offset:0  lds
buffer_load_dwordx4 v18, s[4:7], s48 offen offset:1024  lds
buffer_load_dwordx4 v19, s[4:7], s48 offen offset:2048  lds
buffer_load_dwordx4 v24, s[4:7], s48 offen offset:3072  lds
s_add_u32 s65, s65, 128
s_cmpk_eq_u32 s65, 1280
s_cmovk_i32 s65, 0
v_mul_u32_u24 v27, 3072, v27
v_lshl_add_u32 v27, v33, 4, v27
v_subrev_u32 v27, 2048, v27
v_add_u32 v37, 0, v1
v_mul_u32_u24 v37, 6554, v37
v_lshrrev_b32 v37, 16, v37
v_mul_u32_u24 v37, 1120, v37
v_add_u32 v32, v37, v4
v_add_u32 v37, 64, v1
v_mul_u32_u24 v37, 6554, v37
v_lshrrev_b32 v37, 16, v37
v_mul_u32_u24 v37, 1120, v37
v_add_u32 v33, v37, v4
v_add_u32 v37, 128, v1
v_mul_u32_u24 v37, 6554, v37
v_lshrrev_b32 v37, 16, v37
v_mul_u32_u24 v37, 1120, v37
v_add_u32 v34, v37, v4
v_add_u32 v37, 192, v1
v_mul_u32_u24 v37, 6554, v37
ds_read_b32 v6, v3 offset:8
s_waitcnt lgkmcnt(0)
v_cmp_gt_u32 vcc, 1, v6
s_nop 0
s_cbranch_vccnz W224
B223:
s_waitcnt vmcnt(12)
s_mov_b32 m0, 36864
s_add_u32 s48, s65, 0
buffer_load_dwordx4 v17, s[4:7], s48 offen offset:0  lds
buffer_load_dwordx4 v18, s[4:7], s48 offen offset:1024  lds
buffer_load_dwordx4 v19, s[4:7], s48 offen offset:2048  lds
buffer_load_dwordx4 v24, s[4:7], s48 offen offset:3072  lds
s_waitcnt vmcnt(12)
s_mov_b32 m0, 40960
s_add_u32 s48, s65, 40960
buffer_load_dwordx4 v17, s[4:7], s48 offen offset:0  lds
buffer_load_dwordx4 v18, s[4:7], s48 offen offset:1024  lds
buffer_load_dwordx4 v19, s[4:7], s48 offen offset:2048  lds
buffer_load_dwordx4 v24, s[4:7], s48 offen offset:3072  lds
s_waitcnt vmcnt(12)
s_mov_b32 m0, 45056
s_add_u32 s48, s65, 81920
buffer_load_dwordx4 v17, s[4:7], s48 offen offset:0  lds
buffer_load_dwordx4 v18, s[4:7], s48 offen offset:1024  lds
buffer_load_dwordx4 v19, s[4:7], s48 offen offset:2048  lds
buffer_load_dwordx4 v24, s[4:7], s48 offen offset:3072  lds
s_waitcnt vmcnt(12)
v_mov_b32 v9, 3
ds_max_u32 v10, v9
s_mov_b32 m0, 49152
s_add_u32 s48, s65, 122880
buffer_load_dwordx4 v17, s[4:7], s48 offen offset:0  lds
buffer_load_dwordx4 v18, s[4:7], s48 offen offset:1024  lds
buffer_load_dwordx4 v19, s[4:7], s48 offen offset:2048  lds
buffer_load_dwordx4 v24, s[4:7], s48 offen offset:3072  lds
s_add_u32 s65, s65, 128
s_cmpk_eq_u32 s65, 1280
s_cmovk_i32 s65, 0
v_lshrrev_b32 v37, 16, v37
v_mul_u32_u24 v37, 1120, v37
v_add_u32 v35, v37, v4
v_add_u32 v37, 256, v1
v_mul_u32_u24 v37, 6554, v37
v_lshrrev_b32 v37, 16, v37
v_mul_u32_u24 v37, 1120, v37
v_add_u32 v36, v37, v4
v_add_u32 v36, 4096, v36
s_mul_i32 s51, s61, 5
s_lshr_b32 s51, s51, 2
v_lshrrev_b32 v11, 5, v1
v_add_u32 v11, s51, v11
v_and_b32 v16, 31, v1
v_min_u32 v22, 19, v16
v_lshlrev_b32 v22, 2, v22
v_lshl_add_u32 v22, v11, 7, v22
v_add_u32 v22, 53248, v22
v_min_u32 v23, 23, v16
v_lshlrev_b32 v23, 3, v23
v_lshl_add_u32 v23, v11, 8, v23
v_add_u32 v23, 55296, v23
ds_read_b128 v[12:15], v3 offset:16
s_waitcnt lgkmcnt(0)
v_min3_u32 v12, v12, v13, v14
v_min_u32 v12, v12, v15
v_cmp_gt_u32 vcc, 1, v12
s_nop 0
s_cbranch_vccnz S225
B226:
s_waitcnt vmcnt(12)
s_mov_b32 m0, 73728
s_add_u32 s48, s65, 0
buffer_load_dwordx4 v17, s[4:7], s48 offen offset:0  lds
buffer_load_dwordx4 v18, s[4:7], s48 offen offset:1024  lds
buffer_load_dwordx4 v19, s[4:7], s48 offen offset:2048  lds
buffer_load_dwordx4 v24, s[4:7], s48 offen offset:3072  lds
s_waitcnt vmcnt(12)
s_mov_b32 m0, 77824
s_add_u32 s48, s65, 40960
buffer_load_dwordx4 v17, s[4:7], s48 offen offset:0  lds
buffer_load_dwordx4 v18, s[4:7], s48 offen offset:1024  lds
buffer_load_dwordx4 v19, s[4:7], s48 offen offset:2048  lds
buffer_load_dwordx4 v24, s[4:7], s48 offen offset:3072  lds
s_waitcnt vmcnt(12)
s_mov_b32 m0, 81920
s_add_u32 s48, s65, 81920
buffer_load_dwordx4 v17, s[4:7], s48 offen offset:0  lds
buffer_load_dwordx4 v18, s[4:7], s48 offen offset:1024  lds
buffer_load_dwordx4 v19, s[4:7], s48 offen offset:2048  lds
buffer_load_dwordx4 v24, s[4:7], s48 offen offset:3072  lds
s_waitcnt vmcnt(12)
v_mov_b32 v9, 4
ds_max_u32 v10, v9
s_mov_b32 m0, 86016
s_add_u32 s48, s65, 122880
buffer_load_dwordx4 v17, s[4:7], s48 offen offset:0  lds
buffer_load_dwordx4 v18, s[4:7], s48 offen offset:1024  lds
buffer_load_dwordx4 v19, s[4:7], s48 offen offset:2048  lds
buffer_load_dwordx4 v24, s[4:7], s48 offen offset:3072  lds
s_add_u32 s65, s65, 128
s_cmpk_eq_u32 s65, 1280
s_cmovk_i32 s65, 0
ds_read_b128 v[12:15], v3 offset:16
s_waitcnt lgkmcnt(0)
v_min3_u32 v12, v12, v13, v14
v_min_u32 v12, v12, v15
v_cmp_gt_u32 vcc, 2, v12
s_nop 0
s_cbranch_vccnz S228
B229:
s_waitcnt vmcnt(12)
s_mov_b32 m0, 110592
s_add_u32 s48, s65, 0
buffer_load_dwordx4 v17, s[4:7], s48 offen offset:0  lds
buffer_load_dwordx4 v18, s[4:7], s48 offen offset:1024  lds
buffer_load_dwordx4 v19, s[4:7], s48 offen offset:2048  lds
buffer_load_dwordx4 v24, s[4:7], s48 offen offset:3072  lds
s_waitcnt vmcnt(12)
s_mov_b32 m0, 114688
s_add_u32 s48, s65, 40960
buffer_load_dwordx4 v17, s[4:7], s48 offen offset:0  lds
buffer_load_dwordx4 v18, s[4:7], s48 offen offset:1024  lds
buffer_load_dwordx4 v19, s[4:7], s48 offen offset:2048  lds
buffer_load_dwordx4 v24, s[4:7], s48 offen offset:3072  lds
s_waitcnt vmcnt(12)
s_mov_b32 m0, 118784
s_add_u32 s48, s65, 81920
buffer_load_dwordx4 v17, s[4:7], s48 offen offset:0  lds
buffer_load_dwordx4 v18, s[4:7], s48 offen offset:1024  lds
buffer_load_dwordx4 v19, s[4:7], s48 offen offset:2048  lds
buffer_load_dwordx4 v24, s[4:7], s48 offen offset:3072  lds
s_waitcnt vmcnt(12)
v_mov_b32 v9, 5
ds_max_u32 v10, v9
s_mov_b32 m0, 122880
s_add_u32 s48, s65, 122880
buffer_load_dwordx4 v17, s[4:7], s48 offen offset:0  lds
buffer_load_dwordx4 v18, s[4:7], s48 offen offset:1024  lds
buffer_load_dwordx4 v19, s[4:7], s48 offen offset:2048  lds
buffer_load_dwordx4 v24, s[4:7], s48 offen offset:3072  lds
s_add_u32 s65, s65, 128
s_cmpk_eq_u32 s65, 1280
s_cmovk_i32 s65, 0
ds_read_b128 v[12:15], v3 offset:16
s_waitcnt lgkmcnt(0)
v_min3_u32 v12, v12, v13, v14
v_min_u32 v12, v12, v15
v_cmp_gt_u32 vcc, 3, v12
s_nop 0
s_cbranch_vccnz S231
B232:
s_waitcnt vmcnt(12)
s_mov_b32 m0, 0
s_add_u32 s48, s65, 0
buffer_load_dwordx4 v17, s[4:7], s48 offen offset:0  lds
buffer_load_dwordx4 v18, s[4:7], s48 offen offset:1024  lds
buffer_load_dwordx4 v19, s[4:7], s48 offen offset:2048  lds
buffer_load_dwordx4 v24, s[4:7], s48 offen offset:3072  lds
s_waitcnt vmcnt(12)
s_mov_b32 m0, 4096
s_add_u32 s48, s65, 40960
buffer_load_dwordx4 v17, s[4:7], s48 offen offset:0  lds
buffer_load_dwordx4 v18, s[4:7], s48 offen offset:1024  lds
buffer_load_dwordx4 v19, s[4:7], s48 offen offset:2048  lds
buffer_load_dwordx4 v24, s[4:7], s48 offen offset:3072  lds
s_waitcnt vmcnt(12)
s_mov_b32 m0, 8192
s_add_u32 s48, s65, 81920
buffer_load_dwordx4 v17, s[4:7], s48 offen offset:0  lds
buffer_load_dwordx4 v18, s[4:7], s48 offen offset:1024  lds
buffer_load_dwordx4 v19, s[4:7], s48 offen offset:2048  lds
buffer_load_dwordx4 v24, s[4:7], s48 offen offset:3072  lds
s_waitcnt vmcnt(12)
v_mov_b32 v9, 6
ds_max_u32 v10, v9
s_mov_b32 m0, 12288
s_add_u32 s48, s65, 122880
buffer_load_dwordx4 v17, s[4:7], s48 offen offset:0  lds
buffer_load_dwordx4 v18, s[4:7], s48 offen offset:1024  lds
buffer_load_dwordx4 v19, s[4:7], s48 offen offset:2048  lds
buffer_load_dwordx4 v24, s[4:7], s48 offen offset:3072  lds
s_add_u32 s65, s65, 128
s_cmpk_eq_u32 s65, 1280
s_cmovk_i32 s65, 0
ds_read_b128 v[12:15], v3 offset:16
s_waitcnt lgkmcnt(0)
v_min3_u32 v12, v12, v13, v14
v_min_u32 v12, v12, v15
v_cmp_gt_u32 vcc, 4, v12
s_nop 0
s_cbranch_vccnz S234
B235:
s_waitcnt vmcnt(12)
s_mov_b32 m0, 36864
s_add_u32 s48, s65, 0
buffer_load_dwordx4 v17, s[4:7], s48 offen offset:0  lds
buffer_load_dwordx4 v18, s[4:7], s48 offen offset:1024  lds
buffer_load_dwordx4 v19, s[4:7], s48 offen offset:2048  lds
buffer_load_dwordx4 v24, s[4:7], s48 offen offset:3072  lds
s_waitcnt vmcnt(12)
s_mov_b32 m0, 40960
s_add_u32 s48, s65, 40960
buffer_load_dwordx4 v17, s[4:7], s48 offen offset:0  lds
buffer_load_dwordx4 v18, s[4:7], s48 offen offset:1024  lds
buffer_load_dwordx4 v19, s[4:7], s48 offen offset:2048  lds
buffer_load_dwordx4 v24, s[4:7], s48 offen offset:3072  lds
s_waitcnt vmcnt(12)
s_mov_b32 m0, 45056
s_add_u32 s48, s65, 81920
buffer_load_dwordx4 v17, s[4:7], s48 offen offset:0  lds
buffer_load_dwordx4 v18, s[4:7], s48 offen offset:1024  lds
buffer_load_dwordx4 v19, s[4:7], s48 offen offset:2048  lds
buffer_load_dwordx4 v24, s[4:7], s48 offen offset:3072  lds
s_waitcnt vmcnt(12)
v_mov_b32 v9, 7
ds_max_u32 v10, v9
s_mov_b32 m0, 49152
s_add_u32 s48, s65, 122880
buffer_load_dwordx4 v17, s[4:7], s48 offen offset:0  lds
buffer_load_dwordx4 v18, s[4:7], s48 offen offset:1024  lds
buffer_load_dwordx4 v19, s[4:7], s48 offen offset:2048  lds
buffer_load_dwordx4 v24, s[4:7], s48 offen offset:3072  lds
s_add_u32 s65, s65, 128
s_cmpk_eq_u32 s65, 1280
s_cmovk_i32 s65, 0
ds_read_b128 v[12:15], v3 offset:16
s_waitcnt lgkmcnt(0)
v_min3_u32 v12, v12, v13, v14
v_min_u32 v12, v12, v15
v_cmp_gt_u32 vcc, 5, v12
s_nop 0
s_cbranch_vccnz S237
B238:
s_waitcnt vmcnt(12)
s_mov_b32 m0, 73728
s_add_u32 s48, s65, 0
buffer_load_dwordx4 v17, s[4:7], s48 offen offset:0  lds
buffer_load_dwordx4 v18, s[4:7], s48 offen offset:1024  lds
buffer_load_dwordx4 v19, s[4:7], s48 offen offset:2048  lds
buffer_load_dwordx4 v24, s[4:7], s48 offen offset:3072  lds
s_waitcnt vmcnt(12)
s_mov_b32 m0, 77824
s_add_u32 s48, s65, 40960
buffer_load_dwordx4 v17, s[4:7], s48 offen offset:0  lds
buffer_load_dwordx4 v18, s[4:7], s48 offen offset:1024  lds
buffer_load_dwordx4 v19, s[4:7], s48 offen offset:2048  lds
buffer_load_dwordx4 v24, s[4:7], s48 offen offset:3072  lds
s_waitcnt vmcnt(12)
s_mov_b32 m0, 81920
s_add_u32 s48, s65, 81920
buffer_load_dwordx4 v17, s[4:7], s48 offen offset:0  lds
buffer_load_dwordx4 v18, s[4:7], s48 offen offset:1024  lds
buffer_load_dwordx4 v19, s[4:7], s48 offen offset:2048  lds
buffer_load_dwordx4 v24, s[4:7], s48 offen offset:3072  lds
s_waitcnt vmcnt(12)
v_mov_b32 v9, 8
ds_max_u32 v10, v9
s_mov_b32 m0, 86016
s_add_u32 s48, s65, 122880
buffer_load_dwordx4 v17, s[4:7], s48 offen offset:0  lds
buffer_load_dwordx4 v18, s[4:7], s48 offen offset:1024  lds
buffer_load_dwordx4 v19, s[4:7], s48 offen offset:2048  lds
buffer_load_dwordx4 v24, s[4:7], s48 offen offset:3072  lds
s_add_u32 s65, s65, 128
s_cmpk_eq_u32 s65, 1280
s_cmovk_i32 s65, 0
ds_read_b32 v6, v3 offset:36
s_waitcnt lgkmcnt(0)
v_cmp_gt_u32 vcc, 1, v6
s_nop 0
s_cbranch_vccnz W242
B241:
ds_read_b32 v2, v3 offset:76
s_waitcnt lgkmcnt(0)
v_readfirstlane_b32 s53, v2
v_mov_b32 v20, v2
s_mov_b32 exec_lo, 0xfffff
s_mov_b32 exec_hi, 0xfffff
v_mov_b32 v20, 0
buffer_atomic_add v20, v22, s[36:39], 0 offen sc0 sc1
s_mov_b64 exec, -1
ds_read_b128 v[12:15], v3 offset:16
s_waitcnt lgkmcnt(0)
v_min3_u32 v12, v12, v13, v14
v_min_u32 v12, v12, v15
v_cmp_gt_u32 vcc, 6, v12
s_nop 0
s_cbranch_vccnz S243
B244:
s_waitcnt vmcnt(12)
s_mov_b32 m0, 110592
s_add_u32 s48, s65, 0
buffer_load_dwordx4 v17, s[4:7], s48 offen offset:0  lds
buffer_load_dwordx4 v18, s[4:7], s48 offen offset:1024  lds
buffer_load_dwordx4 v19, s[4:7], s48 offen offset:2048  lds
buffer_load_dwordx4 v24, s[4:7], s48 offen offset:3072  lds
s_waitcnt vmcnt(12)
s_mov_b32 m0, 114688
s_add_u32 s48, s65, 40960
buffer_load_dwordx4 v17, s[4:7], s48 offen offset:0  lds
buffer_load_dwordx4 v18, s[4:7], s48 offen offset:1024  lds
buffer_load_dwordx4 v19, s[4:7], s48 offen offset:2048  lds
buffer_load_dwordx4 v24, s[4:7], s48 offen offset:3072  lds
s_waitcnt vmcnt(12)
s_mov_b32 m0, 118784
s_add_u32 s48, s65, 81920
buffer_load_dwordx4 v17, s[4:7], s48 offen offset:0  lds
buffer_load_dwordx4 v18, s[4:7], s48 offen offset:1024  lds
buffer_load_dwordx4 v19, s[4:7], s48 offen offset:2048  lds
buffer_load_dwordx4 v24, s[4:7], s48 offen offset:3072  lds
s_waitcnt vmcnt(13)
v_mov_b32 v9, 9
ds_max_u32 v10, v9
s_waitcnt vmcnt(12)
s_mov_b32 m0, 122880
s_add_u32 s48, s65, 122880
buffer_load_dwordx4 v17, s[4:7], s48 offen offset:0  lds
buffer_load_dwordx4 v18, s[4:7], s48 offen offset:1024  lds
buffer_load_dwordx4 v19, s[4:7], s48 offen offset:2048  lds
buffer_load_dwordx4 v24, s[4:7], s48 offen offset:3072  lds
s_mul_i32 s49, s61, 160
s_mul_i32 s71, s60, 81920
s_add_u32 s71, s71, s49
s_lshl1_add_u32 s50, s61, s57
s_mul_i32 s50, s50, 51200
s_and_b32 s49, s60, 3
s_mul_i32 s49, s49, 3
s_lshr_b32 s49, s49, 1
v_add_u32 v37, s50, v4
s_mul_i32 s72, s49, 0
s_add_u32 s72, s72, 18874368
s_lshl1_add_u32 s50, s61, s57
s_mul_i32 s50, s50, 122880
s_and_b32 s49, s60, 3
s_mul_i32 s49, s49, 3
s_lshr_b32 s49, s49, 1
v_add_u32 v38, s50, v4
s_mul_i32 s73, s49, 20480
s_add_u32 s73, s73, 22544384
s_mul_i32 s50, s61, 102400
s_and_b32 s49, s60, 3
v_add_u32 v39, s50, v4
s_mul_i32 s74, s49, 25600
s_add_u32 s74, s74, 7340032
v_cmp_ne_u32 vcc, s53, v20
s_nop 0
s_cbranch_vccnz R246
B247:
v_mov_b32 v9, 1
ds_write_b32 v10, v9 offset:32
ds_read_b128 v[12:15], v3 offset:16
s_waitcnt lgkmcnt(0)
v_min3_u32 v12, v12, v13, v14
v_min_u32 v12, v12, v15
v_cmp_gt_u32 vcc, 7, v12
s_nop 0
s_cbranch_vccnz S249
B250:
s_waitcnt vmcnt(8)
s_mov_b32 m0, 0
s_add_u32 s48, s74, 0
buffer_load_dwordx4 v39, s[36:39], s48 offen offset:0 sc1 lds
buffer_load_dwordx4 v39, s[36:39], s48 offen offset:1024 sc1 lds
buffer_load_dwordx4 v39, s[36:39], s48 offen offset:2048 sc1 lds
buffer_load_dwordx4 v39, s[36:39], s48 offen offset:3072 sc1 lds
s_waitcnt vmcnt(8)
s_mov_b32 m0, 4096
s_add_u32 s48, s74, 4096
buffer_load_dwordx4 v39, s[36:39], s48 offen offset:0 sc1 lds
buffer_load_dwordx4 v39, s[36:39], s48 offen offset:1024 sc1 lds
buffer_load_dwordx4 v39, s[36:39], s48 offen offset:2048 sc1 lds
buffer_load_dwordx4 v39, s[36:39], s48 offen offset:3072 sc1 lds
s_waitcnt vmcnt(8)
v_mov_b32 v9, 10
ds_max_u32 v10, v9
s_mov_b32 m0, 8192
s_add_u32 s48, s74, 8192
buffer_load_dwordx4 v39, s[36:39], s48 offen offset:0 sc1 lds
buffer_load_dwordx4 v39, s[36:39], s48 offen offset:1024 sc1 lds
buffer_load_dwordx4 v39, s[36:39], s48 offen offset:2048 sc1 lds
buffer_load_dwordx4 v39, s[36:39], s48 offen offset:3072 sc1 lds
s_waitcnt vmcnt(11)
s_mov_b32 m0, 12288
s_add_u32 s48, s74, 12288
buffer_load_dwordx4 v39, s[36:39], s48 offen offset:0 sc1 lds
s_add_u32 s74, s74, 25600
s_cmp_ge_u32 s74, 7442432
s_cmov_b32 s74, 7340032
ds_read_b128 v[12:15], v3 offset:16
s_waitcnt lgkmcnt(0)
v_min3_u32 v12, v12, v13, v14
v_min_u32 v12, v12, v15
v_cmp_gt_u32 vcc, 8, v12
s_nop 0
s_cbranch_vccnz S252
B253:
s_waitcnt vmcnt(8)
s_mov_b32 m0, 25600
s_add_u32 s48, s74, 0
buffer_load_dwordx4 v39, s[36:39], s48 offen offset:0 sc1 lds
buffer_load_dwordx4 v39, s[36:39], s48 offen offset:1024 sc1 lds
buffer_load_dwordx4 v39, s[36:39], s48 offen offset:2048 sc1 lds
buffer_load_dwordx4 v39, s[36:39], s48 offen offset:3072 sc1 lds
s_waitcnt vmcnt(8)
s_mov_b32 m0, 29696
s_add_u32 s48, s74, 4096
buffer_load_dwordx4 v39, s[36:39], s48 offen offset:0 sc1 lds
buffer_load_dwordx4 v39, s[36:39], s48 offen offset:1024 sc1 lds
buffer_load_dwordx4 v39, s[36:39], s48 offen offset:2048 sc1 lds
buffer_load_dwordx4 v39, s[36:39], s48 offen offset:3072 sc1 lds
s_waitcnt vmcnt(8)
v_mov_b32 v9, 11
ds_max_u32 v10, v9
s_mov_b32 m0, 33792
s_add_u32 s48, s74, 8192
buffer_load_dwordx4 v39, s[36:39], s48 offen offset:0 sc1 lds
buffer_load_dwordx4 v39, s[36:39], s48 offen offset:1024 sc1 lds
buffer_load_dwordx4 v39, s[36:39], s48 offen offset:2048 sc1 lds
buffer_load_dwordx4 v39, s[36:39], s48 offen offset:3072 sc1 lds
s_waitcnt vmcnt(11)
s_mov_b32 m0, 37888
s_add_u32 s48, s74, 12288
buffer_load_dwordx4 v39, s[36:39], s48 offen offset:0 sc1 lds
s_add_u32 s74, s74, 25600
s_cmp_ge_u32 s74, 7442432
s_cmov_b32 s74, 7340032
ds_read_b128 v[12:15], v3 offset:16
s_waitcnt lgkmcnt(0)
v_min3_u32 v12, v12, v13, v14
v_min_u32 v12, v12, v15
v_cmp_gt_u32 vcc, 9, v12
s_nop 0
s_cbranch_vccnz S255
B256:
s_waitcnt vmcnt(8)
s_mov_b32 m0, 51200
s_add_u32 s48, s74, 0
buffer_load_dwordx4 v39, s[36:39], s48 offen offset:0 sc1 lds
buffer_load_dwordx4 v39, s[36:39], s48 offen offset:1024 sc1 lds
buffer_load_dwordx4 v39, s[36:39], s48 offen offset:2048 sc1 lds
buffer_load_dwordx4 v39, s[36:39], s48 offen offset:3072 sc1 lds
s_waitcnt vmcnt(8)
s_mov_b32 m0, 55296
s_add_u32 s48, s74, 4096
buffer_load_dwordx4 v39, s[36:39], s48 offen offset:0 sc1 lds
buffer_load_dwordx4 v39, s[36:39], s48 offen offset:1024 sc1 lds
buffer_load_dwordx4 v39, s[36:39], s48 offen offset:2048 sc1 lds
buffer_load_dwordx4 v39, s[36:39], s48 offen offset:3072 sc1 lds
s_waitcnt vmcnt(8)
v_mov_b32 v9, 12
ds_max_u32 v10, v9
s_mov_b32 m0, 59392
s_add_u32 s48, s74, 8192
buffer_load_dwordx4 v39, s[36:39], s48 offen offset:0 sc1 lds
buffer_load_dwordx4 v39, s[36:39], s48 offen offset:1024 sc1 lds
buffer_load_dwordx4 v39, s[36:39], s48 offen offset:2048 sc1 lds
buffer_load_dwordx4 v39, s[36:39], s48 offen offset:3072 sc1 lds
s_waitcnt vmcnt(11)
s_mov_b32 m0, 63488
s_add_u32 s48, s74, 12288
buffer_load_dwordx4 v39, s[36:39], s48 offen offset:0 sc1 lds
s_add_u32 s74, s74, 25600
s_cmp_ge_u32 s74, 7442432
s_cmov_b32 s74, 7340032
s_waitcnt vmcnt(8)
s_mov_b32 m0, 76800
s_add_u32 s48, s74, 0
buffer_load_dwordx4 v39, s[36:39], s48 offen offset:0 sc1 lds
buffer_load_dwordx4 v39, s[36:39], s48 offen offset:1024 sc1 lds
buffer_load_dwordx4 v39, s[36:39], s48 offen offset:2048 sc1 lds
buffer_load_dwordx4 v39, s[36:39], s48 offen offset:3072 sc1 lds
s_waitcnt vmcnt(8)
s_mov_b32 m0, 80896
s_add_u32 s48, s74, 4096
buffer_load_dwordx4 v39, s[36:39], s48 offen offset:0 sc1 lds
buffer_load_dwordx4 v39, s[36:39], s48 offen offset:1024 sc1 lds
buffer_load_dwordx4 v39, s[36:39], s48 offen offset:2048 sc1 lds
buffer_load_dwordx4 v39, s[36:39], s48 offen offset:3072 sc1 lds
s_waitcnt vmcnt(8)
v_mov_b32 v9, 13
ds_max_u32 v10, v9
s_mov_b32 m0, 84992
s_add_u32 s48, s74, 8192
buffer_load_dwordx4 v39, s[36:39], s48 offen offset:0 sc1 lds
buffer_load_dwordx4 v39, s[36:39], s48 offen offset:1024 sc1 lds
buffer_load_dwordx4 v39, s[36:39], s48 offen offset:2048 sc1 lds
buffer_load_dwordx4 v39, s[36:39], s48 offen offset:3072 sc1 lds
s_waitcnt vmcnt(11)
s_mov_b32 m0, 89088
s_add_u32 s48, s74, 12288
buffer_load_dwordx4 v39, s[36:39], s48 offen offset:0 sc1 lds
s_add_u32 s74, s74, 25600
s_cmp_ge_u32 s74, 7442432
s_cmov_b32 s74, 7340032
ds_read_b128 v[12:15], v3 offset:16
s_waitcnt lgkmcnt(0)
v_min3_u32 v12, v12, v13, v14
v_min_u32 v12, v12, v15
v_cmp_gt_u32 vcc, 10, v12
s_nop 0
s_cbranch_vccnz S258
B259:
s_waitcnt vmcnt(8)
s_mov_b32 m0, 151552
s_nop 0
buffer_load_dwordx4 v32, s[4:7], s71 offen offset:0  lds
buffer_load_dwordx4 v33, s[4:7], s71 offen offset:1024  lds
buffer_load_dwordx4 v34, s[4:7], s71 offen offset:2048  lds
buffer_load_dwordx4 v35, s[4:7], s71 offen offset:3072  lds
s_waitcnt vmcnt(11)
s_mov_b32 m0, 155648
s_nop 0
buffer_load_dwordx4 v36, s[4:7], s71 offen offset:0  lds
s_mul_i32 s71, s62, 192
s_mul_i32 s48, s63, 5
s_lshr_b32 s48, s48, 1
s_mul_i32 s70, s48, 196608
s_add_u32 s70, s70, s71
s_waitcnt vmcnt(5)
v_mov_b32 v9, 14
ds_max_u32 v10, v9
s_waitcnt vmcnt(4)
s_mov_b32 m0, 102400
s_add_u32 s48, s70, 0
buffer_load_dwordx4 v25, s[24:27], s48 offen offset:0  lds
buffer_load_dwordx4 v26, s[24:27], s48 offen offset:1024  lds
buffer_load_dwordx4 v27, s[24:27], s48 offen offset:2048  lds
s_waitcnt vmcnt(4)
s_mov_b32 m0, 105472
s_add_u32 s48, s70, 49152
buffer_load_dwordx4 v25, s[24:27], s48 offen offset:0  lds
buffer_load_dwordx4 v26, s[24:27], s48 offen offset:1024  lds
buffer_load_dwordx4 v27, s[24:27], s48 offen offset:2048  lds
s_add_u32 s70, s70, 196608
s_cmp_ge_u32 s70, 1966080
s_cmov_b32 s70, s71
s_waitcnt vmcnt(6)
v_mov_b32 v9, 15
ds_max_u32 v10, v9
s_waitcnt vmcnt(4)
s_mov_b32 m0, 114688
s_add_u32 s48, s70, 0
buffer_load_dwordx4 v25, s[24:27], s48 offen offset:0  lds
buffer_load_dwordx4 v26, s[24:27], s48 offen offset:1024  lds
buffer_load_dwordx4 v27, s[24:27], s48 offen offset:2048  lds
s_waitcnt vmcnt(4)
s_mov_b32 m0, 117760
s_add_u32 s48, s70, 49152
buffer_load_dwordx4 v25, s[24:27], s48 offen offset:0  lds
buffer_load_dwordx4 v26, s[24:27], s48 offen offset:1024  lds
buffer_load_dwordx4 v27, s[24:27], s48 offen offset:2048  lds
s_add_u32 s70, s70, 196608
s_cmp_ge_u32 s70, 1966080
s_cmov_b32 s70, s71
ds_read_b128 v[12:15], v3 offset:16
s_waitcnt lgkmcnt(0)
v_min3_u32 v12, v12, v13, v14
v_min_u32 v12, v12, v15
v_cmp_gt_u32 vcc, 11, v12
s_nop 0
s_cbranch_vccnz S261
B262:
s_waitcnt vmcnt(6)
v_mov_b32 v9, 16
ds_max_u32 v10, v9
s_waitcnt vmcnt(4)
s_mov_b32 m0, 126976
s_add_u32 s48, s70, 0
buffer_load_dwordx4 v25, s[24:27], s48 offen offset:0  lds
buffer_load_dwordx4 v26, s[24:27], s48 offen offset:1024  lds
buffer_load_dwordx4 v27, s[24:27], s48 offen offset:2048  lds
s_waitcnt vmcnt(4)
s_mov_b32 m0, 130048
s_add_u32 s48, s70, 49152
buffer_load_dwordx4 v25, s[24:27], s48 offen offset:0  lds
buffer_load_dwordx4 v26, s[24:27], s48 offen offset:1024  lds
buffer_load_dwordx4 v27, s[24:27], s48 offen offset:2048  lds
s_add_u32 s70, s70, 196608
s_cmp_ge_u32 s70, 1966080
s_cmov_b32 s70, s71
ds_read_b64 v[6:7], v3 offset:40
s_waitcnt lgkmcnt(0)
v_min_u32 v6, v6, v7
v_cmp_gt_u32 vcc, 1, v6
s_nop 0
s_cbranch_vccnz W266
B265:
s_waitcnt vmcnt(6)
v_mov_b32 v9, 17
ds_max_u32 v10, v9
s_waitcnt vmcnt(4)
s_mov_b32 m0, 139264
s_add_u32 s48, s70, 0
buffer_load_dwordx4 v25, s[24:27], s48 offen offset:0  lds
buffer_load_dwordx4 v26, s[24:27], s48 offen offset:1024  lds
buffer_load_dwordx4 v27, s[24:27], s48 offen offset:2048  lds
s_waitcnt vmcnt(4)
s_mov_b32 m0, 142336
s_add_u32 s48, s70, 49152
buffer_load_dwordx4 v25, s[24:27], s48 offen offset:0  lds
buffer_load_dwordx4 v26, s[24:27], s48 offen offset:1024  lds
buffer_load_dwordx4 v27, s[24:27], s48 offen offset:2048  lds
s_add_u32 s70, s70, 196608
s_cmp_ge_u32 s70, 1966080
s_cmov_b32 s70, s71
ds_read_b128 v[12:15], v3 offset:16
s_waitcnt lgkmcnt(0)
v_min3_u32 v12, v12, v13, v14
v_min_u32 v12, v12, v15
v_cmp_gt_u32 vcc, 12, v12
s_nop 0
s_cbranch_vccnz S267
B268:
s_waitcnt vmcnt(6)
v_mov_b32 v9, 18
ds_max_u32 v10, v9
s_waitcnt vmcnt(4)
s_mov_b32 m0, 0
s_add_u32 s48, s70, 0
buffer_load_dwordx4 v25, s[24:27], s48 offen offset:0  lds
buffer_load_dwordx4 v26, s[24:27], s48 offen offset:1024  lds
buffer_load_dwordx4 v27, s[24:27], s48 offen offset:2048  lds
s_waitcnt vmcnt(4)
s_mov_b32 m0, 3072
s_add_u32 s48, s70, 49152
buffer_load_dwordx4 v25, s[24:27], s48 offen offset:0  lds
buffer_load_dwordx4 v26, s[24:27], s48 offen offset:1024  lds
buffer_load_dwordx4 v27, s[24:27], s48 offen offset:2048  lds
s_add_u32 s70, s70, 196608
s_cmp_ge_u32 s70, 1966080
s_cmov_b32 s70, s71
s_waitcnt vmcnt(6)
v_mov_b32 v9, 19
ds_max_u32 v10, v9
s_waitcnt vmcnt(4)
s_mov_b32 m0, 12288
s_add_u32 s48, s70, 0
buffer_load_dwordx4 v25, s[24:27], s48 offen offset:0  lds
buffer_load_dwordx4 v26, s[24:27], s48 offen offset:1024  lds
buffer_load_dwordx4 v27, s[24:27], s48 offen offset:2048  lds
s_waitcnt vmcnt(4)
s_mov_b32 m0, 15360
s_add_u32 s48, s70, 49152
buffer_load_dwordx4 v25, s[24:27], s48 offen offset:0  lds
buffer_load_dwordx4 v26, s[24:27], s48 offen offset:1024  lds
buffer_load_dwordx4 v27, s[24:27], s48 offen offset:2048  lds
s_add_u32 s70, s70, 196608
s_cmp_ge_u32 s70, 1966080
s_cmov_b32 s70, s71
s_waitcnt vmcnt(6)
v_mov_b32 v9, 20
ds_max_u32 v10, v9
s_waitcnt vmcnt(4)
s_mov_b32 m0, 24576
s_add_u32 s48, s70, 0
buffer_load_dwordx4 v25, s[24:27], s48 offen offset:0  lds
buffer_load_dwordx4 v26, s[24:27], s48 offen offset:1024  lds
buffer_load_dwordx4 v27, s[24:27], s48 offen offset:2048  lds
s_waitcnt vmcnt(4)
s_mov_b32 m0, 27648
s_add_u32 s48, s70, 49152
buffer_load_dwordx4 v25, s[24:27], s48 offen offset:0  lds
buffer_load_dwordx4 v26, s[24:27], s48 offen offset:1024  lds
buffer_load_dwordx4 v27, s[24:27], s48 offen offset:2048  lds
s_add_u32 s70, s70, 196608
s_cmp_ge_u32 s70, 1966080
s_cmov_b32 s70, s71
s_waitcnt vmcnt(6)
v_mov_b32 v9, 21
ds_max_u32 v10, v9
s_waitcnt vmcnt(4)
s_mov_b32 m0, 36864
s_add_u32 s48, s70, 0
buffer_load_dwordx4 v25, s[24:27], s48 offen offset:0  lds
buffer_load_dwordx4 v26, s[24:27], s48 offen offset:1024  lds
buffer_load_dwordx4 v27, s[24:27], s48 offen offset:2048  lds
s_waitcnt vmcnt(4)
s_mov_b32 m0, 39936
s_add_u32 s48, s70, 49152
buffer_load_dwordx4 v25, s[24:27], s48 offen offset:0  lds
buffer_load_dwordx4 v26, s[24:27], s48 offen offset:1024  lds
buffer_load_dwordx4 v27, s[24:27], s48 offen offset:2048  lds
s_add_u32 s70, s70, 196608
s_cmp_ge_u32 s70, 1966080
s_cmov_b32 s70, s71
ds_read_b128 v[12:15], v3 offset:16
s_waitcnt lgkmcnt(0)
v_min3_u32 v12, v12, v13, v14
v_min_u32 v12, v12, v15
v_cmp_gt_u32 vcc, 13, v12
s_nop 0
s_cbranch_vccnz S270
B271:
v_mov_b32 v20, v2
v_mov_b32 v21, v2
s_mov_b32 exec_lo, 0xffffff
s_mov_b32 exec_hi, 0xffffff
v_mov_b32 v20, 0
v_mov_b32 v21, 0
buffer_atomic_add_x2 v[20:21], v23, s[36:39], 0 offen sc0 sc1
s_mov_b64 exec, -1
s_waitcnt vmcnt(7)
v_mov_b32 v9, 22
ds_max_u32 v10, v9
s_waitcnt vmcnt(4)
s_mov_b32 m0, 49152
s_add_u32 s48, s70, 0
buffer_load_dwordx4 v25, s[24:27], s48 offen offset:0  lds
buffer_load_dwordx4 v26, s[24:27], s48 offen offset:1024  lds
buffer_load_dwordx4 v27, s[24:27], s48 offen offset:2048  lds
s_waitcnt vmcnt(4)
v_mov_b32 v9, 23
ds_max_u32 v10, v9
s_mov_b32 m0, 52224
s_add_u32 s48, s70, 49152
buffer_load_dwordx4 v25, s[24:27], s48 offen offset:0  lds
buffer_load_dwordx4 v26, s[24:27], s48 offen offset:1024  lds
buffer_load_dwordx4 v27, s[24:27], s48 offen offset:2048  lds
s_add_u32 s70, s70, 196608
s_cmp_ge_u32 s70, 1966080
s_cmov_b32 s70, s71
s_waitcnt vmcnt(4)
s_mov_b32 m0, 61440
s_add_u32 s48, s70, 0
buffer_load_dwordx4 v25, s[24:27], s48 offen offset:0  lds
buffer_load_dwordx4 v26, s[24:27], s48 offen offset:1024  lds
buffer_load_dwordx4 v27, s[24:27], s48 offen offset:2048  lds
s_waitcnt vmcnt(4)
s_mov_b32 m0, 64512
s_add_u32 s48, s70, 49152
buffer_load_dwordx4 v25, s[24:27], s48 offen offset:0  lds
buffer_load_dwordx4 v26, s[24:27], s48 offen offset:1024  lds
buffer_load_dwordx4 v27, s[24:27], s48 offen offset:2048  lds
s_add_u32 s70, s70, 196608
s_cmp_ge_u32 s70, 1966080
s_cmov_b32 s70, s71
v_xor_b32 v40, s53, v20
v_bitop3_b32 v40, v40, v2, v21 bitop3:0xf6
v_cmp_ne_u32 vcc, 0, v40
s_nop 0
s_cbranch_vccnz R273
B274:
v_mov_b32 v9, 2
ds_write_b32 v10, v9 offset:32
ds_read_b128 v[12:15], v3 offset:16
s_waitcnt lgkmcnt(0)
v_min3_u32 v12, v12, v13, v14
v_min_u32 v12, v12, v15
v_cmp_gt_u32 vcc, 14, v12
s_nop 0
s_cbranch_vccnz S276
B277:
s_waitcnt vmcnt(6)
v_mov_b32 v9, 24
ds_max_u32 v10, v9
s_waitcnt vmcnt(4)
s_mov_b32 m0, 81920
s_add_u32 s48, s73, 0
buffer_load_dwordx4 v38, s[36:39], s48 offen offset:0 sc1 lds
buffer_load_dwordx4 v38, s[36:39], s48 offen offset:1024 sc1 lds
buffer_load_dwordx4 v38, s[36:39], s48 offen offset:2048 sc1 lds
s_waitcnt vmcnt(5)
s_mov_b32 m0, 84992
s_add_u32 s48, s73, 3072
buffer_load_dwordx4 v38, s[36:39], s48 offen offset:0 sc1 lds
buffer_load_dwordx4 v38, s[36:39], s48 offen offset:1024 sc1 lds
s_add_u32 s73, s73, 10240
s_cmp_ge_u32 s73, 22667264
s_cmov_b32 s73, 22544384
s_waitcnt vmcnt(5)
v_mov_b32 v9, 25
ds_max_u32 v10, v9
s_waitcnt vmcnt(4)
s_mov_b32 m0, 92160
s_add_u32 s48, s73, 0
buffer_load_dwordx4 v38, s[36:39], s48 offen offset:0 sc1 lds
buffer_load_dwordx4 v38, s[36:39], s48 offen offset:1024 sc1 lds
buffer_load_dwordx4 v38, s[36:39], s48 offen offset:2048 sc1 lds
s_waitcnt vmcnt(5)
s_mov_b32 m0, 95232
s_add_u32 s48, s73, 3072
buffer_load_dwordx4 v38, s[36:39], s48 offen offset:0 sc1 lds
buffer_load_dwordx4 v38, s[36:39], s48 offen offset:1024 sc1 lds
s_add_u32 s73, s73, 10240
s_cmp_ge_u32 s73, 22667264
s_cmov_b32 s73, 22544384
ds_read_b128 v[12:15], v3 offset:16
s_waitcnt lgkmcnt(0)
v_min3_u32 v12, v12, v13, v14
v_min_u32 v12, v12, v15
v_cmp_gt_u32 vcc, 15, v12
s_nop 0
s_cbranch_vccnz S279
B280:
s_mov_b32 m0, 102400
s_add_u32 s48, s73, 0
buffer_load_dwordx4 v38, s[36:39], s48 offen offset:0 sc1 lds
buffer_load_dwordx4 v38, s[36:39], s48 offen offset:1024 sc1 lds
buffer_load_dwordx4 v38, s[36:39], s48 offen offset:2048 sc1 lds
s_waitcnt vmcnt(8)
v_mov_b32 v9, 26
ds_max_u32 v10, v9
s_mov_b32 m0, 105472
s_add_u32 s48, s73, 3072
buffer_load_dwordx4 v38, s[36:39], s48 offen offset:0 sc1 lds
buffer_load_dwordx4 v38, s[36:39], s48 offen offset:1024 sc1 lds
s_add_u32 s73, s73, 10240
s_cmp_ge_u32 s73, 22667264
s_cmov_b32 s73, 22544384
s_waitcnt vmcnt(7)
s_mov_b32 m0, 112640
s_add_u32 s48, s73, 0
buffer_load_dwordx4 v38, s[36:39], s48 offen offset:0 sc1 lds
buffer_load_dwordx4 v38, s[36:39], s48 offen offset:1024 sc1 lds
buffer_load_dwordx4 v38, s[36:39], s48 offen offset:2048 sc1 lds
s_waitcnt vmcnt(8)
v_mov_b32 v9, 27
ds_max_u32 v10, v9
s_mov_b32 m0, 115712
s_add_u32 s48, s73, 3072
buffer_load_dwordx4 v38, s[36:39], s48 offen offset:0 sc1 lds
buffer_load_dwordx4 v38, s[36:39], s48 offen offset:1024 sc1 lds
s_add_u32 s73, s73, 10240
s_cmp_ge_u32 s73, 22667264
s_cmov_b32 s73, 22544384
ds_read_b128 v[12:15], v3 offset:16
s_waitcnt lgkmcnt(0)
v_min3_u32 v12, v12, v13, v14
v_min_u32 v12, v12, v15
v_cmp_gt_u32 vcc, 16, v12
s_nop 0
s_cbranch_vccnz S282
B283:
s_waitcnt vmcnt(7)
s_mov_b32 m0, 122880
s_add_u32 s48, s73, 0
buffer_load_dwordx4 v38, s[36:39], s48 offen offset:0 sc1 lds
buffer_load_dwordx4 v38, s[36:39], s48 offen offset:1024 sc1 lds
buffer_load_dwordx4 v38, s[36:39], s48 offen offset:2048 sc1 lds
s_waitcnt vmcnt(8)
v_mov_b32 v9, 28
ds_max_u32 v10, v9
s_mov_b32 m0, 125952
s_add_u32 s48, s73, 3072
buffer_load_dwordx4 v38, s[36:39], s48 offen offset:0 sc1 lds
buffer_load_dwordx4 v38, s[36:39], s48 offen offset:1024 sc1 lds
s_add_u32 s73, s73, 10240
s_cmp_ge_u32 s73, 22667264
s_cmov_b32 s73, 22544384
s_waitcnt vmcnt(7)
s_mov_b32 m0, 133120
s_add_u32 s48, s73, 0
buffer_load_dwordx4 v38, s[36:39], s48 offen offset:0 sc1 lds
buffer_load_dwordx4 v38, s[36:39], s48 offen offset:1024 sc1 lds
buffer_load_dwordx4 v38, s[36:39], s48 offen offset:2048 sc1 lds
s_waitcnt vmcnt(8)
v_mov_b32 v9, 29
ds_max_u32 v10, v9
s_mov_b32 m0, 136192
s_add_u32 s48, s73, 3072
buffer_load_dwordx4 v38, s[36:39], s48 offen offset:0 sc1 lds
buffer_load_dwordx4 v38, s[36:39], s48 offen offset:1024 sc1 lds
s_add_u32 s73, s73, 10240
s_cmp_ge_u32 s73, 22667264
s_cmov_b32 s73, 22544384
s_waitcnt vmcnt(7)
s_mov_b32 m0, 143360
s_add_u32 s48, s73, 0
buffer_load_dwordx4 v38, s[36:39], s48 offen offset:0 sc1 lds
buffer_load_dwordx4 v38, s[36:39], s48 offen offset:1024 sc1 lds
buffer_load_dwordx4 v38, s[36:39], s48 offen offset:2048 sc1 lds
s_waitcnt vmcnt(8)
v_mov_b32 v9, 30
ds_max_u32 v10, v9
s_mov_b32 m0, 146432
s_add_u32 s48, s73, 3072
buffer_load_dwordx4 v38, s[36:39], s48 offen offset:0 sc1 lds
buffer_load_dwordx4 v38, s[36:39], s48 offen offset:1024 sc1 lds
s_add_u32 s73, s73, 10240
s_cmp_ge_u32 s73, 22667264
s_cmov_b32 s73, 22544384
ds_read_b128 v[12:15], v3 offset:16
s_waitcnt lgkmcnt(0)
v_min3_u32 v12, v12, v13, v14
v_min_u32 v12, v12, v15
v_cmp_gt_u32 vcc, 17, v12
s_nop 0
s_cbranch_vccnz S285
B286:
ds_read_b32 v6, v3 offset:56
s_waitcnt lgkmcnt(0)
v_cmp_gt_u32 vcc, 1, v6
s_nop 0
s_cbranch_vccnz W290
B289:
s_mov_b32 m0, 0
s_add_u32 s48, s72, 0
buffer_load_dwordx4 v37, s[36:39], s48 offen offset:0 sc1 lds
buffer_load_dwordx4 v37, s[36:39], s48 offen offset:1024 sc1 lds
buffer_load_dwordx4 v37, s[36:39], s48 offen offset:2048 sc1 lds
s_waitcnt vmcnt(12)
s_mov_b32 m0, 3072
s_add_u32 s48, s72, 3072
buffer_load_dwordx4 v37, s[36:39], s48 offen offset:0 sc1 lds
buffer_load_dwordx4 v37, s[36:39], s48 offen offset:1024 sc1 lds
s_add_u32 s72, s72, 10240
s_cmp_ge_u32 s72, 18925568
s_cmov_b32 s72, 18874368
s_waitcnt vmcnt(11)
s_mov_b32 m0, 10240
s_add_u32 s48, s72, 0
buffer_load_dwordx4 v37, s[36:39], s48 offen offset:0 sc1 lds
buffer_load_dwordx4 v37, s[36:39], s48 offen offset:1024 sc1 lds
buffer_load_dwordx4 v37, s[36:39], s48 offen offset:2048 sc1 lds
s_waitcnt vmcnt(13)
v_mov_b32 v9, 31
ds_max_u32 v10, v9
s_waitcnt vmcnt(12)
s_mov_b32 m0, 13312
s_add_u32 s48, s72, 3072
buffer_load_dwordx4 v37, s[36:39], s48 offen offset:0 sc1 lds
buffer_load_dwordx4 v37, s[36:39], s48 offen offset:1024 sc1 lds
s_add_u32 s72, s72, 10240
s_cmp_ge_u32 s72, 18925568
s_cmov_b32 s72, 18874368
ds_read_b128 v[12:15], v3 offset:16
s_waitcnt lgkmcnt(0)
v_min3_u32 v12, v12, v13, v14
v_min_u32 v12, v12, v15
v_cmp_gt_u32 vcc, 18, v12
s_nop 0
s_cbranch_vccnz S291
B292:
s_waitcnt vmcnt(11)
s_mov_b32 m0, 20480
s_add_u32 s48, s72, 0
buffer_load_dwordx4 v37, s[36:39], s48 offen offset:0 sc1 lds
buffer_load_dwordx4 v37, s[36:39], s48 offen offset:1024 sc1 lds
buffer_load_dwordx4 v37, s[36:39], s48 offen offset:2048 sc1 lds
s_waitcnt vmcnt(13)
v_mov_b32 v9, 32
ds_max_u32 v10, v9
s_waitcnt vmcnt(12)
s_mov_b32 m0, 23552
s_add_u32 s48, s72, 3072
buffer_load_dwordx4 v37, s[36:39], s48 offen offset:0 sc1 lds
buffer_load_dwordx4 v37, s[36:39], s48 offen offset:1024 sc1 lds
s_add_u32 s72, s72, 10240
s_cmp_ge_u32 s72, 18925568
s_cmov_b32 s72, 18874368
s_waitcnt vmcnt(11)
s_mov_b32 m0, 30720
s_add_u32 s48, s72, 0
buffer_load_dwordx4 v37, s[36:39], s48 offen offset:0 sc1 lds
buffer_load_dwordx4 v37, s[36:39], s48 offen offset:1024 sc1 lds
buffer_load_dwordx4 v37, s[36:39], s48 offen offset:2048 sc1 lds
s_waitcnt vmcnt(13)
v_mov_b32 v9, 33
ds_max_u32 v10, v9
s_waitcnt vmcnt(12)
s_mov_b32 m0, 33792
s_add_u32 s48, s72, 3072
buffer_load_dwordx4 v37, s[36:39], s48 offen offset:0 sc1 lds
buffer_load_dwordx4 v37, s[36:39], s48 offen offset:1024 sc1 lds
s_add_u32 s72, s72, 10240
s_cmp_ge_u32 s72, 18925568
s_cmov_b32 s72, 18874368
ds_read_b128 v[12:15], v3 offset:16
s_waitcnt lgkmcnt(0)
v_min3_u32 v12, v12, v13, v14
v_min_u32 v12, v12, v15
v_cmp_gt_u32 vcc, 19, v12
s_nop 0
s_cbranch_vccnz S294
B295:
s_waitcnt vmcnt(11)
s_mov_b32 m0, 40960
s_add_u32 s48, s72, 0
buffer_load_dwordx4 v37, s[36:39], s48 offen offset:0 sc1 lds
buffer_load_dwordx4 v37, s[36:39], s48 offen offset:1024 sc1 lds
buffer_load_dwordx4 v37, s[36:39], s48 offen offset:2048 sc1 lds
s_waitcnt vmcnt(13)
v_mov_b32 v9, 34
ds_max_u32 v10, v9
s_waitcnt vmcnt(12)
s_mov_b32 m0, 44032
s_add_u32 s48, s72, 3072
buffer_load_dwordx4 v37, s[36:39], s48 offen offset:0 sc1 lds
buffer_load_dwordx4 v37, s[36:39], s48 offen offset:1024 sc1 lds
s_add_u32 s72, s72, 10240
s_cmp_ge_u32 s72, 18925568
s_cmov_b32 s72, 18874368
s_waitcnt vmcnt(11)
s_mov_b32 m0, 51200
s_add_u32 s48, s73, 0
buffer_load_dwordx4 v38, s[36:39], s48 offen offset:0 sc1 lds
buffer_load_dwordx4 v38, s[36:39], s48 offen offset:1024 sc1 lds
buffer_load_dwordx4 v38, s[36:39], s48 offen offset:2048 sc1 lds
s_waitcnt vmcnt(13)
v_mov_b32 v9, 35
ds_max_u32 v10, v9
s_waitcnt vmcnt(12)
s_mov_b32 m0, 54272
s_add_u32 s48, s73, 3072
buffer_load_dwordx4 v38, s[36:39], s48 offen offset:0 sc1 lds
buffer_load_dwordx4 v38, s[36:39], s48 offen offset:1024 sc1 lds
s_add_u32 s73, s73, 10240
s_cmp_ge_u32 s73, 22667264
s_cmov_b32 s73, 22544384
ds_read_b128 v[12:15], v3 offset:16
s_waitcnt lgkmcnt(0)
v_min3_u32 v12, v12, v13, v14
v_min_u32 v12, v12, v15
v_cmp_gt_u32 vcc, 20, v12
s_nop 0
s_cbranch_vccnz S297
B298:
s_waitcnt vmcnt(11)
s_mov_b32 m0, 61440
s_add_u32 s48, s73, 0
buffer_load_dwordx4 v38, s[36:39], s48 offen offset:0 sc1 lds
buffer_load_dwordx4 v38, s[36:39], s48 offen offset:1024 sc1 lds
buffer_load_dwordx4 v38, s[36:39], s48 offen offset:2048 sc1 lds
s_waitcnt vmcnt(13)
v_mov_b32 v9, 36
ds_max_u32 v10, v9
s_waitcnt vmcnt(12)
s_mov_b32 m0, 64512
s_add_u32 s48, s73, 3072
buffer_load_dwordx4 v38, s[36:39], s48 offen offset:0 sc1 lds
buffer_load_dwordx4 v38, s[36:39], s48 offen offset:1024 sc1 lds
s_add_u32 s73, s73, 10240
s_cmp_ge_u32 s73, 22667264
s_cmov_b32 s73, 22544384
s_waitcnt vmcnt(11)
s_mov_b32 m0, 71680
s_add_u32 s48, s73, 0
buffer_load_dwordx4 v38, s[36:39], s48 offen offset:0 sc1 lds
buffer_load_dwordx4 v38, s[36:39], s48 offen offset:1024 sc1 lds
buffer_load_dwordx4 v38, s[36:39], s48 offen offset:2048 sc1 lds
s_waitcnt vmcnt(13)
v_mov_b32 v9, 37
ds_max_u32 v10, v9
s_waitcnt vmcnt(12)
s_mov_b32 m0, 74752
s_add_u32 s48, s73, 3072
buffer_load_dwordx4 v38, s[36:39], s48 offen offset:0 sc1 lds
buffer_load_dwordx4 v38, s[36:39], s48 offen offset:1024 sc1 lds
s_add_u32 s73, s73, 10240
s_cmp_ge_u32 s73, 22667264
s_cmov_b32 s73, 22544384
ds_read_b128 v[12:15], v3 offset:16
s_waitcnt lgkmcnt(0)
v_min3_u32 v12, v12, v13, v14
v_min_u32 v12, v12, v15
v_cmp_gt_u32 vcc, 22, v12
s_nop 0
s_cbranch_vccnz S300
B301:
s_waitcnt vmcnt(11)
s_mov_b32 m0, 0
s_add_u32 s48, s73, 0
buffer_load_dwordx4 v38, s[36:39], s48 offen offset:0 sc1 lds
buffer_load_dwordx4 v38, s[36:39], s48 offen offset:1024 sc1 lds
buffer_load_dwordx4 v38, s[36:39], s48 offen offset:2048 sc1 lds
s_waitcnt vmcnt(13)
v_mov_b32 v9, 38
ds_max_u32 v10, v9
s_waitcnt vmcnt(12)
s_mov_b32 m0, 3072
s_add_u32 s48, s73, 3072
buffer_load_dwordx4 v38, s[36:39], s48 offen offset:0 sc1 lds
buffer_load_dwordx4 v38, s[36:39], s48 offen offset:1024 sc1 lds
s_add_u32 s73, s73, 10240
s_cmp_ge_u32 s73, 22667264
s_cmov_b32 s73, 22544384
s_waitcnt vmcnt(11)
s_mov_b32 m0, 10240
s_add_u32 s48, s73, 0
buffer_load_dwordx4 v38, s[36:39], s48 offen offset:0 sc1 lds
buffer_load_dwordx4 v38, s[36:39], s48 offen offset:1024 sc1 lds
buffer_load_dwordx4 v38, s[36:39], s48 offen offset:2048 sc1 lds
s_waitcnt vmcnt(13)
v_mov_b32 v9, 39
ds_max_u32 v10, v9
s_waitcnt vmcnt(12)
s_mov_b32 m0, 13312
s_add_u32 s48, s73, 3072
buffer_load_dwordx4 v38, s[36:39], s48 offen offset:0 sc1 lds
buffer_load_dwordx4 v38, s[36:39], s48 offen offset:1024 sc1 lds
s_add_u32 s73, s73, 10240
s_cmp_ge_u32 s73, 22667264
s_cmov_b32 s73, 22544384
ds_read_b128 v[12:15], v3 offset:16
s_waitcnt lgkmcnt(0)
v_min3_u32 v12, v12, v13, v14
v_min_u32 v12, v12, v15
v_cmp_gt_u32 vcc, 23, v12
s_nop 0
s_cbranch_vccnz S303
B304:
s_waitcnt vmcnt(10)
v_mov_b32 v9, 40
ds_max_u32 v10, v9
s_waitcnt vmcnt(5)
v_mov_b32 v9, 41
ds_max_u32 v10, v9
s_waitcnt vmcnt(0)
v_mov_b32 v9, 42
ds_max_u32 v10, v9
s_lshl3_add_u32 s49, s60, s61
s_lshl_b32 s50, s49, 7
s_add_u32 s50, s50, 524288
s_mul_i32 s49, s49, 20480
s_add_u32 s49, s49, 24641536
L306:
ds_read_b128 v[12:15], v3 offset:16
s_sleep 2
s_sub_u32 s54, s54, 1
s_cmp_lt_i32 s54, 0
s_cbranch_scc1 L307
s_waitcnt lgkmcnt(0)
v_min3_u32 v12, v12, v13, v14
v_min_u32 v12, v12, v15
v_cmp_gt_u32 vcc, 24, v12
s_nop 0
s_cbranch_vccnz L306
L307:
s_mov_b64 s[76:77], 0
s_atomic_add_x2 s[76:77], s[36:37], s50 glc
s_waitcnt lgkmcnt(0)
s_cmp_lg_u32 s77, s53
s_cbranch_scc1 N308
s_andn2_b32 s51, 1, s76
s_cbranch_scc1 N308
B309:
s_mov_b32 m0, 20480
s_add_u32 s48, s49, 0
buffer_load_dwordx4 v4, s[36:39], s48 offen offset:0 sc1 lds
buffer_load_dwordx4 v4, s[36:39], s48 offen offset:1024 sc1 lds
buffer_load_dwordx4 v4, s[36:39], s48 offen offset:2048 sc1 lds
s_cmp_lg_u32 s77, s53
s_cbranch_scc1 N310
s_andn2_b32 s51, 2, s76
s_cbranch_scc1 N310
B311:
s_mov_b32 m0, 25600
s_add_u32 s48, s49, 5120
buffer_load_dwordx4 v4, s[36:39], s48 offen offset:0 sc1 lds
buffer_load_dwordx4 v4, s[36:39], s48 offen offset:1024 sc1 lds
buffer_load_dwordx4 v4, s[36:39], s48 offen offset:2048 sc1 lds
s_waitcnt vmcnt(0)
v_mov_b32 v9, 43
ds_max_u32 v10, v9
s_waitcnt vmcnt(0) lgkmcnt(0)
s_branch L_fin
L_job:
s_and_b32 s64, s52, 1
v_lshrrev_b32 v9, 3, v1
v_and_b32 v10, 7, v1
s_cmp_eq_u32 s52, 7
s_cbranch_scc1 L_job1
s_sub_u32 s51, 31, s55
s_movk_i32 s65, 10
s_movk_i32 s50, 5
s_cmp_ge_u32 s51, 5
s_cmovk_i32 s65, 15
s_cmp_ge_u32 s51, 10
s_cmovk_i32 s65, -10
s_cmovk_i32 s50, 3
s_cmp_ge_u32 s51, 13
s_cmovk_i32 s65, 17
s_cmp_ge_u32 s51, 16
s_cmovk_i32 s65, -10
s_cmovk_i32 s50, 2
s_cmp_ge_u32 s51, 18
s_cmovk_i32 s65, 18
s_cmp_ge_u32 s51, 20
s_cmovk_i32 s65, 20
s_cmovk_i32 s50, 12
s_mul_i32 s50, s50, s57
s_add_u32 s65, s65, s51
s_add_u32 s65, s65, s50
s_mov_b32 s10, 2457600
s_mov_b32 s11, 0x20000
s_mov_b32 s18, 819200
s_mov_b32 s19, 0x20000
s_mov_b32 s26, 1966080
s_mov_b32 s27, 0x20000
s_mov_b32 s38, 29884416
s_mov_b32 s39, 0x20000
s_cmp_lt_u32 s65, 40
s_movk_i32 s49, 3072
s_cmovk_i32 s49, 1280
s_cselect_b32 s50, 30, 40
s_cmp_lt_u32 s65, 30
s_cmovk_i32 s49, 3840
s_cmovk_i32 s50, 0
s_sub_u32 s48, s65, s50
s_lshl_b32 s48, s48, 7
s_mul_i32 s50, s56, 160
s_mul_i32 s50, s50, s49
s_add_u32 s48, s48, s50
v_mul_lo_u32 v13, v9, s49
v_lshl_add_u32 v13, v10, 4, v13
s_lshl_b32 s50, s49, 3
s_sub_u32 s50, s50, 1024
v_add_u32 v14, s50, v13
v_add_u32 v15, s50, v14
v_add_u32 v36, s50, v15
s_lshl_b32 s49, s49, 5
s_waitcnt lgkmcnt(0)
s_mov_b64 s[16:17], s[92:93]
s_mov_b64 s[24:25], s[96:97]
s_mov_b64 s[8:9], s[90:91]
s_cmp_lt_u32 s65, 40
s_cselect_b64 s[40:41], s[16:17], s[24:25]
s_cselect_b32 s42, s18, s26
s_cmp_lt_u32 s65, 30
s_cselect_b64 s[40:41], s[8:9], s[40:41]
s_cselect_b32 s42, s10, s42
s_mov_b32 s43, 0x20000
s_mov_b32 m0, 36864
s_nop 0
buffer_load_dwordx4 v13, s[40:43], s48 offen offset:0 lds
buffer_load_dwordx4 v14, s[40:43], s48 offen offset:1024 lds
buffer_load_dwordx4 v15, s[40:43], s48 offen offset:2048 lds
buffer_load_dwordx4 v36, s[40:43], s48 offen offset:3072 lds
s_mov_b32 m0, 40960
s_add_u32 s48, s48, s49
buffer_load_dwordx4 v13, s[40:43], s48 offen offset:0 lds
buffer_load_dwordx4 v14, s[40:43], s48 offen offset:1024 lds
buffer_load_dwordx4 v15, s[40:43], s48 offen offset:2048 lds
buffer_load_dwordx4 v36, s[40:43], s48 offen offset:3072 lds
s_mov_b32 m0, 45056
s_add_u32 s48, s48, s49
buffer_load_dwordx4 v13, s[40:43], s48 offen offset:0 lds
buffer_load_dwordx4 v14, s[40:43], s48 offen offset:1024 lds
buffer_load_dwordx4 v15, s[40:43], s48 offen offset:2048 lds
buffer_load_dwordx4 v36, s[40:43], s48 offen offset:3072 lds
s_mov_b32 m0, 49152
s_add_u32 s48, s48, s49
buffer_load_dwordx4 v13, s[40:43], s48 offen offset:0 lds
buffer_load_dwordx4 v14, s[40:43], s48 offen offset:1024 lds
buffer_load_dwordx4 v15, s[40:43], s48 offen offset:2048 lds
buffer_load_dwordx4 v36, s[40:43], s48 offen offset:3072 lds
s_mov_b32 m0, 53248
s_add_u32 s48, s48, s49
buffer_load_dwordx4 v13, s[40:43], s48 offen offset:0 lds
buffer_load_dwordx4 v14, s[40:43], s48 offen offset:1024 lds
buffer_load_dwordx4 v15, s[40:43], s48 offen offset:2048 lds
buffer_load_dwordx4 v36, s[40:43], s48 offen offset:3072 lds
s_load_dword s53, s[36:37], 0
s_mov_b32 s14, 819200
s_mov_b32 s15, 0x20000
v_cmp_eq_u32 vcc, 0, v1
v_mov_b32 v37, 1073741824
s_nop 0
v_cndmask_b32 v5, v37, v1, vcc
v_lshrrev_b32 v11, 10, v5
s_lshl_b32 s48, s64, 2
s_add_u32 s48, s48, 163328
v_add_u32 v11, s48, v11
v_lshrrev_b32 v12, 4, v1
v_lshlrev_b32 v12, 3, v12
v_bfe_u32 v9, v1, 2, 2
v_add_u32 v12, v12, v9
v_and_b32 v9, 3, v1
v_lshlrev_b32 v9, 3, v9
v_mul_u32_u24 v10, 160, v12
v_add_u32 v10, v10, v9
v_lshl_add_u32 v12, v12, 7, v9
s_waitcnt lgkmcnt(0)
s_mul_i32 s53, s53, 1664525
s_add_u32 s53, s53, 1013904223
v_mov_b32 v2, s53
s_sub_u32 s48, s65, 10
s_cmp_gt_u32 s48, 4
s_subb_u32 s49, s48, 0
s_lshl_b32 s49, s49, 8
s_add_u32 s49, s49, 24576
s_cmp_eq_u32 s48, 4
s_cbranch_scc1 L312
s_cmp_ge_u32 s48, 9
s_cbranch_scc1 L312
s_cmp_lg_u32 s56, 0
s_cbranch_scc1 L312
s_mov_b32 s66, 0
s_mov_b32 s67, s53
s_atomic_swap_x2 s[66:67], s[36:37], s49 glc
s_add_u32 s49, s49, 128
s_mov_b32 s68, 0
s_mov_b32 s69, s53
s_atomic_swap_x2 s[68:69], s[36:37], s49 glc
s_add_u32 s49, s49, 128
L312:
v_mov_b32 v40, 0x3f803f80
v_mov_b32 v41, 0x3f803f80
v_mov_b32 v42, 0x3f803f80
v_mov_b32 v43, 0x3f803f80
v_mov_b32 v9, 1
s_waitcnt vmcnt(0)
ds_read_b64_tr_b16 v[44:45], v12 offset:36864
ds_read_b64_tr_b16 v[46:47], v12 offset:37376
ds_read_b64_tr_b16 v[48:49], v12 offset:40960
ds_read_b64_tr_b16 v[50:51], v12 offset:41472
ds_read_b64_tr_b16 v[52:53], v12 offset:45056
ds_read_b64_tr_b16 v[54:55], v12 offset:45568
ds_read_b64_tr_b16 v[56:57], v12 offset:49152
ds_read_b64_tr_b16 v[58:59], v12 offset:49664
ds_read_b64_tr_b16 v[60:61], v12 offset:53248
ds_read_b64_tr_b16 v[62:63], v12 offset:53760
ds_read_b64_tr_b16 v[64:65], v12 offset:36896
ds_read_b64_tr_b16 v[66:67], v12 offset:37408
ds_read_b64_tr_b16 v[68:69], v12 offset:40992
ds_read_b64_tr_b16 v[70:71], v12 offset:41504
ds_read_b64_tr_b16 v[72:73], v12 offset:45088
ds_read_b64_tr_b16 v[74:75], v12 offset:45600
ds_read_b64_tr_b16 v[76:77], v12 offset:49184
ds_read_b64_tr_b16 v[78:79], v12 offset:49696
ds_read_b64_tr_b16 v[80:81], v12 offset:53280
ds_read_b64_tr_b16 v[82:83], v12 offset:53792
ds_read_b64_tr_b16 v[84:85], v12 offset:36928
ds_read_b64_tr_b16 v[86:87], v12 offset:37440
ds_read_b64_tr_b16 v[88:89], v12 offset:41024
ds_read_b64_tr_b16 v[90:91], v12 offset:41536
ds_read_b64_tr_b16 v[92:93], v12 offset:45120
ds_read_b64_tr_b16 v[94:95], v12 offset:45632
ds_read_b64_tr_b16 v[96:97], v12 offset:49216
ds_read_b64_tr_b16 v[98:99], v12 offset:49728
ds_read_b64_tr_b16 v[100:101], v12 offset:53312
ds_read_b64_tr_b16 v[102:103], v12 offset:53824
ds_read_b64_tr_b16 v[104:105], v12 offset:36960
ds_read_b64_tr_b16 v[106:107], v12 offset:37472
ds_read_b64_tr_b16 v[108:109], v12 offset:41056
ds_read_b64_tr_b16 v[110:111], v12 offset:41568
ds_read_b64_tr_b16 v[112:113], v12 offset:45152
ds_read_b64_tr_b16 v[114:115], v12 offset:45664
ds_read_b64_tr_b16 v[116:117], v12 offset:49248
ds_read_b64_tr_b16 v[118:119], v12 offset:49760
ds_read_b64_tr_b16 v[120:121], v12 offset:53344
ds_read_b64_tr_b16 v[122:123], v12 offset:53856
ds_write_b32 v11, v9 offset:8
s_waitcnt lgkmcnt(0)
v_mfma_f32_16x16x32_bf16 v[124:127], v[40:43], v[44:47], 0
v_mfma_f32_16x16x32_bf16 v[124:127], v[40:43], v[48:51], v[124:127]
v_mfma_f32_16x16x32_bf16 v[124:127], v[40:43], v[52:55], v[124:127]
v_mfma_f32_16x16x32_bf16 v[124:127], v[40:43], v[56:59], v[124:127]
v_mfma_f32_16x16x32_bf16 v[124:127], v[40:43], v[60:63], v[124:127]
v_mfma_f32_16x16x32_bf16 v[128:131], v[40:43], v[64:67], 0
v_mfma_f32_16x16x32_bf16 v[128:131], v[40:43], v[68:71], v[128:131]
v_mfma_f32_16x16x32_bf16 v[128:131], v[40:43], v[72:75], v[128:131]
v_mfma_f32_16x16x32_bf16 v[128:131], v[40:43], v[76:79], v[128:131]
v_mfma_f32_16x16x32_bf16 v[128:131], v[40:43], v[80:83], v[128:131]
v_mfma_f32_16x16x32_bf16 v[132:135], v[40:43], v[84:87], 0
v_mfma_f32_16x16x32_bf16 v[132:135], v[40:43], v[88:91], v[132:135]
v_mfma_f32_16x16x32_bf16 v[132:135], v[40:43], v[92:95], v[132:135]
v_mfma_f32_16x16x32_bf16 v[132:135], v[40:43], v[96:99], v[132:135]
v_mfma_f32_16x16x32_bf16 v[132:135], v[40:43], v[100:103], v[132:135]
v_mfma_f32_16x16x32_bf16 v[136:139], v[40:43], v[104:107], 0
v_mfma_f32_16x16x32_bf16 v[136:139], v[40:43], v[108:111], v[136:139]
v_mfma_f32_16x16x32_bf16 v[136:139], v[40:43], v[112:115], v[136:139]
v_mfma_f32_16x16x32_bf16 v[136:139], v[40:43], v[116:119], v[136:139]
v_mfma_f32_16x16x32_bf16 v[136:139], v[40:43], v[120:123], v[136:139]
s_lshl_b32 s65, s65, 9
s_lshl_b32 s48, s56, 15
s_add_u32 s65, s65, s48
s_add_u32 s65, s65, 98304
v_lshlrev_b32 v13, 3, v1
v_cmp_le_u32 vcc, 16, v1
s_nop 1
v_cndmask_b32 v124, v124, v128, vcc
v_cmp_le_u32 vcc, 32, v1
s_nop 1
v_cndmask_b32 v124, v124, v132, vcc
v_cmp_le_u32 vcc, 48, v1
s_nop 1
v_cndmask_b32 v124, v124, v136, vcc
v_mov_b32 v125, s53
s_waitcnt lgkmcnt(0)
buffer_store_dwordx2 v[124:125], v13, s[36:39], s65 offen sc1
ds_read_b32 v6, v3 offset:12
s_waitcnt lgkmcnt(0)
v_cmp_gt_u32 vcc, 1, v6
s_nop 0
s_cbranch_vccnz W313
B314:
v_mov_b32 v9, 1
ds_write_b32 v11, v9 offset:40
s_lshl1_add_u32 s48, s57, s59
s_cmp_lt_u32 s59, 6
s_cselect_b32 s49, 4, 6
s_cselect_b32 s66, 1920, 0
s_cselect_b32 s67, 0, 1920
s_sub_u32 s48, s48, s49
s_mul_i32 s49, s48, 96
s_add_u32 s66, s66, s49
s_lshl_b32 s49, s48, 6
s_add_u32 s67, s67, s49
s_add_u32 s67, s67, 288
s_lshl2_add_u32 s48, s57, s59
s_mul_i32 s48, s48, 80
s_add_u32 s49, s48, 640
s_add_u32 s48, s48, 1200
s_movk_i32 s68, 96
s_cmp_lt_u32 s59, 4
s_cmov_b32 s66, s49
s_cmov_b32 s67, s48
s_cmovk_i32 s68, 80
s_mul_i32 s50, s62, 96
s_add_u32 s50, s50, 2400
v_add_u32 v9, 0, v1
v_add_u32 v13, s66, v9
v_lshlrev_b32 v13, 3, v13
s_mov_b32 s69, 98304
v_add_u32 v9, 64, v1
v_cmp_gt_u32 vcc, s68, v9
v_add_u32 v14, s66, v9
v_add_u32 v9, s67, v9
v_cndmask_b32 v14, v9, v14, vcc
v_lshlrev_b32 v14, 3, v14
s_mov_b32 s70, 131072
v_add_u32 v9, 128, v1
v_cmp_gt_u32 vcc, 160, v9
v_add_u32 v15, s67, v9
v_add_u32 v9, s50, v9
v_cndmask_b32 v15, v9, v15, vcc
v_lshlrev_b32 v15, 3, v15
s_mov_b32 s71, 163840
v_add_u32 v9, 192, v1
v_add_u32 v36, s50, v9
v_lshlrev_b32 v36, 3, v36
s_mov_b32 s72, 196608
s_lshl_b32 s66, s58, 11
s_add_u32 s66, s66, 65536
s_lshl_b32 s67, s60, 10
s_add_u32 s67, s67, 65536
v_lshlrev_b32 v37, 3, v1
v_add_u32 v37, 155648, v37
v_add_u32 v12, 158720, v4
v_lshlrev_b32 v10, 2, v1
v_add_u32 v10, 160768, v10
ds_read_b64 v[6:7], v3 offset:0
s_waitcnt lgkmcnt(0)
v_min_u32 v6, v6, v7
v_cmp_gt_u32 vcc, 4, v6
s_nop 0
s_cbranch_vccnz W315
B316:
buffer_load_dwordx4 v[40:43], v4, s[36:39], s66 offen offset:0 sc1
buffer_load_dwordx4 v[44:47], v4, s[36:39], s66 offen offset:1024 sc1
buffer_load_dwordx4 v[48:51], v4, s[36:39], s67 offen sc1
buffer_load_dwordx2 v[38:39], v13, s[36:39], s69 offen sc1
buffer_load_dwordx2 v[52:53], v13, s[36:39], s70 offen sc1
buffer_load_dwordx2 v[54:55], v13, s[36:39], s71 offen sc1
buffer_load_dwordx2 v[56:57], v13, s[36:39], s72 offen sc1
buffer_load_dwordx2 v[58:59], v14, s[36:39], s69 offen sc1
buffer_load_dwordx2 v[60:61], v14, s[36:39], s70 offen sc1
buffer_load_dwordx2 v[62:63], v14, s[36:39], s71 offen sc1
buffer_load_dwordx2 v[64:65], v14, s[36:39], s72 offen sc1
buffer_load_dwordx2 v[66:67], v15, s[36:39], s69 offen sc1
buffer_load_dwordx2 v[68:69], v15, s[36:39], s70 offen sc1
buffer_load_dwordx2 v[70:71], v15, s[36:39], s71 offen sc1
buffer_load_dwordx2 v[72:73], v15, s[36:39], s72 offen sc1
buffer_load_dwordx2 v[74:75], v36, s[36:39], s69 offen sc1
buffer_load_dwordx2 v[76:77], v36, s[36:39], s70 offen sc1
buffer_load_dwordx2 v[78:79], v36, s[36:39], s71 offen sc1
buffer_load_dwordx2 v[80:81], v36, s[36:39], s72 offen sc1
s_waitcnt vmcnt(18)
v_xor_b32 v82, s53, v43
s_waitcnt vmcnt(17)
v_bitop3_b32 v82, v82, v2, v47 bitop3:0xf6
s_waitcnt vmcnt(16)
v_bitop3_b32 v82, v82, v2, v51 bitop3:0xf6
s_waitcnt vmcnt(15)
v_bitop3_b32 v82, v82, v2, v39 bitop3:0xf6
s_waitcnt vmcnt(14)
v_bitop3_b32 v82, v82, v2, v53 bitop3:0xf6
s_waitcnt vmcnt(13)
v_bitop3_b32 v82, v82, v2, v55 bitop3:0xf6
s_waitcnt vmcnt(12)
v_bitop3_b32 v82, v82, v2, v57 bitop3:0xf6
s_waitcnt vmcnt(11)
v_bitop3_b32 v82, v82, v2, v59 bitop3:0xf6
s_waitcnt vmcnt(10)
v_bitop3_b32 v82, v82, v2, v61 bitop3:0xf6
s_waitcnt vmcnt(9)
v_bitop3_b32 v82, v82, v2, v63 bitop3:0xf6
s_waitcnt vmcnt(8)
v_bitop3_b32 v82, v82, v2, v65 bitop3:0xf6
s_waitcnt vmcnt(7)
v_bitop3_b32 v82, v82, v2, v67 bitop3:0xf6
s_waitcnt vmcnt(6)
v_bitop3_b32 v82, v82, v2, v69 bitop3:0xf6
s_waitcnt vmcnt(5)
v_bitop3_b32 v82, v82, v2, v71 bitop3:0xf6
s_waitcnt vmcnt(4)
v_bitop3_b32 v82, v82, v2, v73 bitop3:0xf6
s_waitcnt vmcnt(3)
v_bitop3_b32 v82, v82, v2, v75 bitop3:0xf6
s_waitcnt vmcnt(2)
v_bitop3_b32 v82, v82, v2, v77 bitop3:0xf6
s_waitcnt vmcnt(1)
v_bitop3_b32 v82, v82, v2, v79 bitop3:0xf6
s_waitcnt vmcnt(0)
v_bitop3_b32 v82, v82, v2, v81 bitop3:0xf6
v_cmp_ne_u32 vcc, 0, v82
s_nop 0
s_cbranch_vccnz R317
B318:
v_add_f32 v38, v38, v52
v_add_f32 v54, v54, v56
v_add_f32 v38, v38, v54
v_cvt_pk_bf16_f32 v53, v38, v38
v_and_b32 v54, 0xffff0000, v53
v_sub_f32 v55, v38, v54
v_cvt_pk_bf16_f32 v52, v54, v55
v_and_b32 v53, 0xffff, v53
ds_write_b64 v37, v[52:53] offset:0
v_add_f32 v58, v58, v60
v_add_f32 v62, v62, v64
v_add_f32 v58, v58, v62
v_cvt_pk_bf16_f32 v61, v58, v58
v_and_b32 v62, 0xffff0000, v61
v_sub_f32 v63, v58, v62
v_cvt_pk_bf16_f32 v60, v62, v63
v_and_b32 v61, 0xffff, v61
ds_write_b64 v37, v[60:61] offset:512
v_add_f32 v66, v66, v68
v_add_f32 v70, v70, v72
v_add_f32 v66, v66, v70
v_cvt_pk_bf16_f32 v69, v66, v66
v_and_b32 v70, 0xffff0000, v69
v_sub_f32 v71, v66, v70
v_cvt_pk_bf16_f32 v68, v70, v71
v_and_b32 v69, 0xffff, v69
ds_write_b64 v37, v[68:69] offset:1024
v_add_f32 v74, v74, v76
v_add_f32 v78, v78, v80
v_add_f32 v74, v74, v78
v_cvt_pk_bf16_f32 v77, v74, v74
v_and_b32 v78, 0xffff0000, v77
v_sub_f32 v79, v74, v78
v_cvt_pk_bf16_f32 v76, v78, v79
v_and_b32 v77, 0xffff, v77
ds_write_b64 v37, v[76:77] offset:1536
v_cvt_pk_bf16_f32 v38, -v41, -v41
v_and_b32 v39, 0xffff0000, v38
v_sub_f32 v39, -v41, v39
v_cvt_pk_bf16_f32 v39, v39, 0
ds_write_b64 v37, v[38:39] offset:2048
ds_write_b32 v10, v40 offset:0
v_mul_f32 v9, v40, v42
v_mov_b32 v43, v40
v_rcp_f32 v42, v9
v_mul_f32 v40, 0xc0135761, v9
v_mul_f32 v41, v9, v9
v_mul_f32 v41, v41, v9
v_mul_f32 v41, 0xbdd2d3e8, v41
ds_write_b128 v12, v[40:43] offset:0
v_cvt_pk_bf16_f32 v58, -v45, -v45
v_and_b32 v59, 0xffff0000, v58
v_sub_f32 v59, -v45, v59
v_cvt_pk_bf16_f32 v59, v59, 0
ds_write_b64 v37, v[58:59] offset:2560
ds_write_b32 v10, v44 offset:256
v_mul_f32 v9, v44, v46
v_mov_b32 v47, v44
v_rcp_f32 v46, v9
v_mul_f32 v44, 0xc0135761, v9
v_mul_f32 v45, v9, v9
v_mul_f32 v45, v45, v9
v_mul_f32 v45, 0xbdd2d3e8, v45
ds_write_b128 v12, v[44:47] offset:1024
v_mul_f32 v49, v48, v49
ds_write_b64 v37, v[48:49] offset:5632
ds_write_b32 v11, v2 offset:76
v_mov_b32 v9, 1
ds_write_b32 v11, v9 offset:36
s_waitcnt vmcnt(0) lgkmcnt(0)
v_lshrrev_b32 v9, 4, v1
v_and_b32 v10, 15, v1
v_lshlrev_b32 v10, 4, v10
s_mul_i32 s48, s61, 274688
s_add_u32 s48, s48, 7168
v_mul_u32_u24 v20, 8576, v9
v_add3_u32 v20, v20, v10, s48
s_mul_i32 s48, s60, 81920
s_mul_i32 s49, s61, 2560
s_add_u32 s48, s48, s49
s_add_u32 s48, s48, 4718592
v_mul_u32_u24 v21, 20480, v9
v_add3_u32 v21, v21, v10, s48
s_lshl_b32 s65, s60, 7
s_add_u32 s75, s65, 36864
s_add_u32 s65, s65, 16384
s_lshl_b32 s72, s61, 8
s_add_u32 s72, s72, 24576
s_add_u32 s73, s72, 128
s_lshl_b32 s51, 1, s61
v_mov_b32 v8, s51
s_add_u32 s48, s60, 0
s_and_b32 s48, s48, 31
s_lshl_b32 s48, s48, 7
s_add_u32 s48, s48, 8192
s_add_u32 s49, s60, 31
s_and_b32 s49, s49, 31
s_lshl_b32 s49, s49, 7
s_add_u32 s49, s49, 8192
s_add_u32 s50, s60, 1
s_and_b32 s50, s50, 31
s_lshl_b32 s50, s50, 7
s_add_u32 s50, s50, 8192
L322:
ds_read_b128 v[16:19], v3 offset:16
s_sleep 2
s_sub_u32 s54, s54, 1
s_cmp_lt_i32 s54, 0
s_cbranch_scc1 L323
s_waitcnt lgkmcnt(0)
v_min3_u32 v16, v16, v17, v18
v_min_u32 v16, v16, v19
v_cmp_gt_u32 vcc, 10, v16
s_nop 0
s_cbranch_vccnz L322
L323:
s_sleep 16
L320:
s_mov_b64 s[66:67], 0
s_atomic_add_x2 s[66:67], s[36:37], s48 glc
s_mov_b64 s[68:69], 0
s_atomic_add_x2 s[68:69], s[36:37], s49 glc
s_mov_b64 s[70:71], 0
s_atomic_add_x2 s[70:71], s[36:37], s50 glc
s_sub_u32 s54, s54, 1
s_cmp_lt_i32 s54, 0
s_cbranch_scc1 L321
s_waitcnt lgkmcnt(0)
s_cmp_lg_u32 s67, s53
s_cmov_b32 s66, 0
s_cmp_lg_u32 s69, s53
s_cmov_b32 s68, 0
s_cmp_lg_u32 s71, s53
s_cmov_b32 s70, 0
s_and_b32 s68, s68, s66
s_and_b32 s70, s70, s66
v_mov_b32 v16, s68
v_mov_b32 v17, s66
v_mov_b32 v18, s66
v_mov_b32 v19, s70
ds_write_b128 v11, v[16:19] offset:80
s_and_b32 s68, s68, s70
s_cmp_lg_u32 s68, 0xffff
s_cbranch_scc1 L320
L321:
s_waitcnt lgkmcnt(0)
s_lshl3_add_u32 s48, s60, s61
s_lshl_b32 s48, s48, 7
s_add_u32 s48, s48, 524288
s_mov_b32 s66, 0
s_mov_b32 s67, s53
s_atomic_swap_x2 s[66:67], s[36:37], s48 glc
s_branch P326
P324:
s_sleep 2
P326:
s_mov_b64 s[68:69], 0
s_atomic_add_x2 s[68:69], s[36:37], s65 glc
s_mov_b64 s[70:71], 0
s_atomic_add_x2 s[70:71], s[36:37], s72 glc
s_mov_b64 s[76:77], 0
s_atomic_add_x2 s[76:77], s[36:37], s73 glc
s_sub_u32 s54, s54, 1
s_cmp_lt_i32 s54, 0
s_cbranch_scc1 PD325
s_waitcnt lgkmcnt(0)
s_cmp_lg_u32 s68, 65535
s_cbranch_scc1 P324
s_cmp_lg_u32 s69, s53
s_cbranch_scc1 P324
s_cmp_lg_u32 s70, 65535
s_cbranch_scc1 P324
s_cmp_lg_u32 s71, s53
s_cbranch_scc1 P324
s_cmp_lg_u32 s76, 65535
s_cbranch_scc1 P324
s_cmp_lg_u32 s77, s53
s_cbranch_scc1 P324
PD325:
s_waitcnt lgkmcnt(0)
s_setprio 2
s_mov_b32 s74, 19922944
buffer_load_dwordx4 v[24:27], v20, s[36:39], s74 offen sc1
s_mov_b32 s74, 19957248
buffer_load_dwordx4 v[28:31], v20, s[36:39], s74 offen sc1
s_mov_b32 s74, 19991552
buffer_load_dwordx4 v[32:35], v20, s[36:39], s74 offen sc1
s_mov_b32 s74, 20025856
buffer_load_dwordx4 v[40:43], v20, s[36:39], s74 offen sc1
buffer_load_dwordx4 v[60:63], v21, s[36:39], 0 offen offset:0 sc1
buffer_load_dwordx4 v[64:67], v21, s[36:39], 0 offen offset:256 sc1
buffer_load_dwordx4 v[68:71], v21, s[36:39], 0 offen offset:512 sc1
buffer_load_dwordx4 v[72:75], v21, s[36:39], 0 offen offset:768 sc1
buffer_load_dwordx4 v[76:79], v21, s[36:39], 0 offen offset:1024 sc1
s_mov_b32 s74, 20060288
buffer_load_dwordx4 v[44:47], v20, s[36:39], s74 offen sc1
s_mov_b32 s74, 20094592
buffer_load_dwordx4 v[48:51], v20, s[36:39], s74 offen sc1
s_mov_b32 s74, 20128896
buffer_load_dwordx4 v[52:55], v20, s[36:39], s74 offen sc1
s_mov_b32 s74, 20163200
buffer_load_dwordx4 v[56:59], v20, s[36:39], s74 offen sc1
buffer_load_dwordx4 v[80:83], v21, s[36:39], 0 offen offset:1280 sc1
buffer_load_dwordx4 v[84:87], v21, s[36:39], 0 offen offset:1536 sc1
buffer_load_dwordx4 v[88:91], v21, s[36:39], 0 offen offset:1792 sc1
buffer_load_dwordx4 v[92:95], v21, s[36:39], 0 offen offset:2048 sc1
buffer_load_dwordx4 v[96:99], v21, s[36:39], 0 offen offset:2304 sc1
s_waitcnt vmcnt(16)
v_add_f32 v24, v24, v28
v_add_f32 v25, v25, v29
v_add_f32 v26, v26, v30
s_waitcnt vmcnt(15)
v_add_f32 v24, v24, v32
v_add_f32 v25, v25, v33
v_add_f32 v26, v26, v34
s_waitcnt vmcnt(14)
v_add_f32 v24, v24, v40
v_add_f32 v25, v25, v41
v_add_f32 v26, v26, v42
v_mov_b32 v28, v24
v_mov_b32 v29, v25
v_mov_b32 v30, v26
v_permlane16_swap_b32 v24, v28
v_permlane16_swap_b32 v25, v29
v_permlane16_swap_b32 v26, v30
v_add_f32 v24, v24, v28
v_add_f32 v25, v25, v29
v_add_f32 v26, v26, v30
v_mov_b32 v28, v24
v_mov_b32 v29, v25
v_mov_b32 v30, v26
v_permlane32_swap_b32 v24, v28
v_permlane32_swap_b32 v25, v29
v_permlane32_swap_b32 v26, v30
v_add_f32 v24, v24, v28
v_add_f32 v25, v25, v29
v_add_f32 v26, v26, v30
s_waitcnt vmcnt(13)
v_lshlrev_b32 v100, 16, v60
v_and_b32 v101, 0xffff0000, v60
v_lshlrev_b32 v102, 16, v61
v_and_b32 v103, 0xffff0000, v61
v_lshlrev_b32 v104, 16, v62
v_and_b32 v105, 0xffff0000, v62
v_lshlrev_b32 v106, 16, v63
v_and_b32 v107, 0xffff0000, v63
s_waitcnt vmcnt(12)
v_lshlrev_b32 v108, 16, v64
v_and_b32 v109, 0xffff0000, v64
v_lshlrev_b32 v110, 16, v65
v_and_b32 v111, 0xffff0000, v65
v_lshlrev_b32 v112, 16, v66
v_and_b32 v113, 0xffff0000, v66
v_lshlrev_b32 v114, 16, v67
v_and_b32 v115, 0xffff0000, v67
s_waitcnt vmcnt(11)
v_lshlrev_b32 v116, 16, v68
v_and_b32 v117, 0xffff0000, v68
v_lshlrev_b32 v118, 16, v69
v_and_b32 v119, 0xffff0000, v69
v_lshlrev_b32 v120, 16, v70
v_and_b32 v121, 0xffff0000, v70
v_lshlrev_b32 v122, 16, v71
v_and_b32 v123, 0xffff0000, v71
s_waitcnt vmcnt(10)
v_lshlrev_b32 v124, 16, v72
v_and_b32 v125, 0xffff0000, v72
v_lshlrev_b32 v126, 16, v73
v_and_b32 v127, 0xffff0000, v73
v_lshlrev_b32 v128, 16, v74
v_and_b32 v129, 0xffff0000, v74
v_lshlrev_b32 v130, 16, v75
v_and_b32 v131, 0xffff0000, v75
s_waitcnt vmcnt(9)
v_lshlrev_b32 v132, 16, v76
v_and_b32 v133, 0xffff0000, v76
v_lshlrev_b32 v134, 16, v77
v_and_b32 v135, 0xffff0000, v77
v_lshlrev_b32 v136, 16, v78
v_and_b32 v137, 0xffff0000, v78
v_lshlrev_b32 v138, 16, v79
v_and_b32 v139, 0xffff0000, v79
v_mov_b32 v22, 0x358637bd
v_mov_b32 v23, 0x358637bd
v_fmac_f32_dpp v22, v24, v100 row_newbcast:0 row_mask:0xf bank_mask:0xf
v_fmac_f32_dpp v23, v25, v120 row_newbcast:4 row_mask:0xf bank_mask:0xf
v_fmac_f32_dpp v22, v24, v101 row_newbcast:1 row_mask:0xf bank_mask:0xf
v_fmac_f32_dpp v23, v25, v121 row_newbcast:5 row_mask:0xf bank_mask:0xf
v_fmac_f32_dpp v22, v24, v102 row_newbcast:2 row_mask:0xf bank_mask:0xf
v_fmac_f32_dpp v23, v25, v122 row_newbcast:6 row_mask:0xf bank_mask:0xf
v_fmac_f32_dpp v22, v24, v103 row_newbcast:3 row_mask:0xf bank_mask:0xf
v_fmac_f32_dpp v23, v25, v123 row_newbcast:7 row_mask:0xf bank_mask:0xf
v_fmac_f32_dpp v22, v24, v104 row_newbcast:4 row_mask:0xf bank_mask:0xf
v_fmac_f32_dpp v23, v25, v124 row_newbcast:8 row_mask:0xf bank_mask:0xf
v_fmac_f32_dpp v22, v24, v105 row_newbcast:5 row_mask:0xf bank_mask:0xf
v_fmac_f32_dpp v23, v25, v125 row_newbcast:9 row_mask:0xf bank_mask:0xf
v_fmac_f32_dpp v22, v24, v106 row_newbcast:6 row_mask:0xf bank_mask:0xf
v_fmac_f32_dpp v23, v25, v126 row_newbcast:10 row_mask:0xf bank_mask:0xf
v_fmac_f32_dpp v22, v24, v107 row_newbcast:7 row_mask:0xf bank_mask:0xf
v_fmac_f32_dpp v23, v25, v127 row_newbcast:11 row_mask:0xf bank_mask:0xf
v_fmac_f32_dpp v22, v24, v108 row_newbcast:8 row_mask:0xf bank_mask:0xf
v_fmac_f32_dpp v23, v25, v128 row_newbcast:12 row_mask:0xf bank_mask:0xf
v_fmac_f32_dpp v22, v24, v109 row_newbcast:9 row_mask:0xf bank_mask:0xf
v_fmac_f32_dpp v23, v25, v129 row_newbcast:13 row_mask:0xf bank_mask:0xf
v_fmac_f32_dpp v22, v24, v110 row_newbcast:10 row_mask:0xf bank_mask:0xf
v_fmac_f32_dpp v23, v25, v130 row_newbcast:14 row_mask:0xf bank_mask:0xf
v_fmac_f32_dpp v22, v24, v111 row_newbcast:11 row_mask:0xf bank_mask:0xf
v_fmac_f32_dpp v23, v25, v131 row_newbcast:15 row_mask:0xf bank_mask:0xf
v_fmac_f32_dpp v22, v24, v112 row_newbcast:12 row_mask:0xf bank_mask:0xf
v_fmac_f32_dpp v23, v26, v132 row_newbcast:0 row_mask:0xf bank_mask:0xf
v_fmac_f32_dpp v22, v24, v113 row_newbcast:13 row_mask:0xf bank_mask:0xf
v_fmac_f32_dpp v23, v26, v133 row_newbcast:1 row_mask:0xf bank_mask:0xf
v_fmac_f32_dpp v22, v24, v114 row_newbcast:14 row_mask:0xf bank_mask:0xf
v_fmac_f32_dpp v23, v26, v134 row_newbcast:2 row_mask:0xf bank_mask:0xf
v_fmac_f32_dpp v22, v24, v115 row_newbcast:15 row_mask:0xf bank_mask:0xf
v_fmac_f32_dpp v23, v26, v135 row_newbcast:3 row_mask:0xf bank_mask:0xf
v_fmac_f32_dpp v22, v25, v116 row_newbcast:0 row_mask:0xf bank_mask:0xf
v_fmac_f32_dpp v23, v26, v136 row_newbcast:4 row_mask:0xf bank_mask:0xf
v_fmac_f32_dpp v22, v25, v117 row_newbcast:1 row_mask:0xf bank_mask:0xf
v_fmac_f32_dpp v23, v26, v137 row_newbcast:5 row_mask:0xf bank_mask:0xf
v_fmac_f32_dpp v22, v25, v118 row_newbcast:2 row_mask:0xf bank_mask:0xf
v_fmac_f32_dpp v23, v26, v138 row_newbcast:6 row_mask:0xf bank_mask:0xf
v_fmac_f32_dpp v22, v25, v119 row_newbcast:3 row_mask:0xf bank_mask:0xf
v_fmac_f32_dpp v23, v26, v139 row_newbcast:7 row_mask:0xf bank_mask:0xf
v_rcp_f32 v22, v22
v_rcp_f32 v23, v23
v_mul_f32 v100, v22, v100
v_mul_f32 v101, v22, v101
v_cvt_pk_bf16_f32 v60, v100, v101
v_mul_f32 v102, v22, v102
v_mul_f32 v103, v22, v103
v_cvt_pk_bf16_f32 v61, v102, v103
v_mul_f32 v104, v22, v104
v_mul_f32 v105, v22, v105
v_cvt_pk_bf16_f32 v62, v104, v105
v_mul_f32 v106, v22, v106
v_mul_f32 v107, v22, v107
v_cvt_pk_bf16_f32 v63, v106, v107
buffer_store_dwordx4 v[60:63], v21, s[36:39], 0 offen offset:0 sc1
v_mul_f32 v108, v22, v108
v_mul_f32 v109, v22, v109
v_cvt_pk_bf16_f32 v64, v108, v109
v_mul_f32 v110, v22, v110
v_mul_f32 v111, v22, v111
v_cvt_pk_bf16_f32 v65, v110, v111
v_mul_f32 v112, v22, v112
v_mul_f32 v113, v22, v113
v_cvt_pk_bf16_f32 v66, v112, v113
v_mul_f32 v114, v22, v114
v_mul_f32 v115, v22, v115
v_cvt_pk_bf16_f32 v67, v114, v115
buffer_store_dwordx4 v[64:67], v21, s[36:39], 0 offen offset:256 sc1
v_mul_f32 v116, v22, v116
v_mul_f32 v117, v22, v117
v_cvt_pk_bf16_f32 v68, v116, v117
v_mul_f32 v118, v22, v118
v_mul_f32 v119, v22, v119
v_cvt_pk_bf16_f32 v69, v118, v119
v_mul_f32 v120, v23, v120
v_mul_f32 v121, v23, v121
v_cvt_pk_bf16_f32 v70, v120, v121
v_mul_f32 v122, v23, v122
v_mul_f32 v123, v23, v123
v_cvt_pk_bf16_f32 v71, v122, v123
buffer_store_dwordx4 v[68:71], v21, s[36:39], 0 offen offset:512 sc1
v_mul_f32 v124, v23, v124
v_mul_f32 v125, v23, v125
v_cvt_pk_bf16_f32 v72, v124, v125
v_mul_f32 v126, v23, v126
v_mul_f32 v127, v23, v127
v_cvt_pk_bf16_f32 v73, v126, v127
v_mul_f32 v128, v23, v128
v_mul_f32 v129, v23, v129
v_cvt_pk_bf16_f32 v74, v128, v129
v_mul_f32 v130, v23, v130
v_mul_f32 v131, v23, v131
v_cvt_pk_bf16_f32 v75, v130, v131
buffer_store_dwordx4 v[72:75], v21, s[36:39], 0 offen offset:768 sc1
v_mul_f32 v132, v23, v132
v_mul_f32 v133, v23, v133
v_cvt_pk_bf16_f32 v76, v132, v133
v_mul_f32 v134, v23, v134
v_mul_f32 v135, v23, v135
v_cvt_pk_bf16_f32 v77, v134, v135
v_mul_f32 v136, v23, v136
v_mul_f32 v137, v23, v137
v_cvt_pk_bf16_f32 v78, v136, v137
v_mul_f32 v138, v23, v138
v_mul_f32 v139, v23, v139
v_cvt_pk_bf16_f32 v79, v138, v139
buffer_store_dwordx4 v[76:79], v21, s[36:39], 0 offen offset:1024 sc1
s_waitcnt vmcnt(12)
v_add_f32 v44, v44, v48
v_add_f32 v45, v45, v49
v_add_f32 v46, v46, v50
s_waitcnt vmcnt(11)
v_add_f32 v44, v44, v52
v_add_f32 v45, v45, v53
v_add_f32 v46, v46, v54
s_waitcnt vmcnt(10)
v_add_f32 v44, v44, v56
v_add_f32 v45, v45, v57
v_add_f32 v46, v46, v58
v_mov_b32 v48, v44
v_mov_b32 v49, v45
v_mov_b32 v50, v46
v_permlane16_swap_b32 v44, v48
v_permlane16_swap_b32 v45, v49
v_permlane16_swap_b32 v46, v50
v_add_f32 v44, v44, v48
v_add_f32 v45, v45, v49
v_add_f32 v46, v46, v50
v_mov_b32 v48, v44
v_mov_b32 v49, v45
v_mov_b32 v50, v46
v_permlane32_swap_b32 v44, v48
v_permlane32_swap_b32 v45, v49
v_permlane32_swap_b32 v46, v50
v_add_f32 v44, v44, v48
v_add_f32 v45, v45, v49
v_add_f32 v46, v46, v50
s_waitcnt vmcnt(9)
v_lshlrev_b32 v100, 16, v80
v_and_b32 v101, 0xffff0000, v80
v_lshlrev_b32 v102, 16, v81
v_and_b32 v103, 0xffff0000, v81
v_lshlrev_b32 v104, 16, v82
v_and_b32 v105, 0xffff0000, v82
v_lshlrev_b32 v106, 16, v83
v_and_b32 v107, 0xffff0000, v83
s_waitcnt vmcnt(8)
v_lshlrev_b32 v108, 16, v84
v_and_b32 v109, 0xffff0000, v84
v_lshlrev_b32 v110, 16, v85
v_and_b32 v111, 0xffff0000, v85
v_lshlrev_b32 v112, 16, v86
v_and_b32 v113, 0xffff0000, v86
v_lshlrev_b32 v114, 16, v87
v_and_b32 v115, 0xffff0000, v87
s_waitcnt vmcnt(7)
v_lshlrev_b32 v116, 16, v88
v_and_b32 v117, 0xffff0000, v88
v_lshlrev_b32 v118, 16, v89
v_and_b32 v119, 0xffff0000, v89
v_lshlrev_b32 v120, 16, v90
v_and_b32 v121, 0xffff0000, v90
v_lshlrev_b32 v122, 16, v91
v_and_b32 v123, 0xffff0000, v91
s_waitcnt vmcnt(6)
v_lshlrev_b32 v124, 16, v92
v_and_b32 v125, 0xffff0000, v92
v_lshlrev_b32 v126, 16, v93
v_and_b32 v127, 0xffff0000, v93
v_lshlrev_b32 v128, 16, v94
v_and_b32 v129, 0xffff0000, v94
v_lshlrev_b32 v130, 16, v95
v_and_b32 v131, 0xffff0000, v95
s_waitcnt vmcnt(5)
v_lshlrev_b32 v132, 16, v96
v_and_b32 v133, 0xffff0000, v96
v_lshlrev_b32 v134, 16, v97
v_and_b32 v135, 0xffff0000, v97
v_lshlrev_b32 v136, 16, v98
v_and_b32 v137, 0xffff0000, v98
v_lshlrev_b32 v138, 16, v99
v_and_b32 v139, 0xffff0000, v99
v_mov_b32 v22, 0x358637bd
v_mov_b32 v23, 0x358637bd
v_fmac_f32_dpp v22, v44, v100 row_newbcast:0 row_mask:0xf bank_mask:0xf
v_fmac_f32_dpp v23, v45, v120 row_newbcast:4 row_mask:0xf bank_mask:0xf
v_fmac_f32_dpp v22, v44, v101 row_newbcast:1 row_mask:0xf bank_mask:0xf
v_fmac_f32_dpp v23, v45, v121 row_newbcast:5 row_mask:0xf bank_mask:0xf
v_fmac_f32_dpp v22, v44, v102 row_newbcast:2 row_mask:0xf bank_mask:0xf
v_fmac_f32_dpp v23, v45, v122 row_newbcast:6 row_mask:0xf bank_mask:0xf
v_fmac_f32_dpp v22, v44, v103 row_newbcast:3 row_mask:0xf bank_mask:0xf
v_fmac_f32_dpp v23, v45, v123 row_newbcast:7 row_mask:0xf bank_mask:0xf
v_fmac_f32_dpp v22, v44, v104 row_newbcast:4 row_mask:0xf bank_mask:0xf
v_fmac_f32_dpp v23, v45, v124 row_newbcast:8 row_mask:0xf bank_mask:0xf
v_fmac_f32_dpp v22, v44, v105 row_newbcast:5 row_mask:0xf bank_mask:0xf
v_fmac_f32_dpp v23, v45, v125 row_newbcast:9 row_mask:0xf bank_mask:0xf
v_fmac_f32_dpp v22, v44, v106 row_newbcast:6 row_mask:0xf bank_mask:0xf
v_fmac_f32_dpp v23, v45, v126 row_newbcast:10 row_mask:0xf bank_mask:0xf
v_fmac_f32_dpp v22, v44, v107 row_newbcast:7 row_mask:0xf bank_mask:0xf
v_fmac_f32_dpp v23, v45, v127 row_newbcast:11 row_mask:0xf bank_mask:0xf
v_fmac_f32_dpp v22, v44, v108 row_newbcast:8 row_mask:0xf bank_mask:0xf
v_fmac_f32_dpp v23, v45, v128 row_newbcast:12 row_mask:0xf bank_mask:0xf
v_fmac_f32_dpp v22, v44, v109 row_newbcast:9 row_mask:0xf bank_mask:0xf
v_fmac_f32_dpp v23, v45, v129 row_newbcast:13 row_mask:0xf bank_mask:0xf
v_fmac_f32_dpp v22, v44, v110 row_newbcast:10 row_mask:0xf bank_mask:0xf
v_fmac_f32_dpp v23, v45, v130 row_newbcast:14 row_mask:0xf bank_mask:0xf
v_fmac_f32_dpp v22, v44, v111 row_newbcast:11 row_mask:0xf bank_mask:0xf
v_fmac_f32_dpp v23, v45, v131 row_newbcast:15 row_mask:0xf bank_mask:0xf
v_fmac_f32_dpp v22, v44, v112 row_newbcast:12 row_mask:0xf bank_mask:0xf
v_fmac_f32_dpp v23, v46, v132 row_newbcast:0 row_mask:0xf bank_mask:0xf
v_fmac_f32_dpp v22, v44, v113 row_newbcast:13 row_mask:0xf bank_mask:0xf
v_fmac_f32_dpp v23, v46, v133 row_newbcast:1 row_mask:0xf bank_mask:0xf
v_fmac_f32_dpp v22, v44, v114 row_newbcast:14 row_mask:0xf bank_mask:0xf
v_fmac_f32_dpp v23, v46, v134 row_newbcast:2 row_mask:0xf bank_mask:0xf
v_fmac_f32_dpp v22, v44, v115 row_newbcast:15 row_mask:0xf bank_mask:0xf
v_fmac_f32_dpp v23, v46, v135 row_newbcast:3 row_mask:0xf bank_mask:0xf
v_fmac_f32_dpp v22, v45, v116 row_newbcast:0 row_mask:0xf bank_mask:0xf
v_fmac_f32_dpp v23, v46, v136 row_newbcast:4 row_mask:0xf bank_mask:0xf
v_fmac_f32_dpp v22, v45, v117 row_newbcast:1 row_mask:0xf bank_mask:0xf
v_fmac_f32_dpp v23, v46, v137 row_newbcast:5 row_mask:0xf bank_mask:0xf
v_fmac_f32_dpp v22, v45, v118 row_newbcast:2 row_mask:0xf bank_mask:0xf
v_fmac_f32_dpp v23, v46, v138 row_newbcast:6 row_mask:0xf bank_mask:0xf
v_fmac_f32_dpp v22, v45, v119 row_newbcast:3 row_mask:0xf bank_mask:0xf
v_fmac_f32_dpp v23, v46, v139 row_newbcast:7 row_mask:0xf bank_mask:0xf
v_rcp_f32 v22, v22
v_rcp_f32 v23, v23
v_mul_f32 v100, v22, v100
v_mul_f32 v101, v22, v101
v_cvt_pk_bf16_f32 v80, v100, v101
v_mul_f32 v102, v22, v102
v_mul_f32 v103, v22, v103
v_cvt_pk_bf16_f32 v81, v102, v103
v_mul_f32 v104, v22, v104
v_mul_f32 v105, v22, v105
v_cvt_pk_bf16_f32 v82, v104, v105
v_mul_f32 v106, v22, v106
v_mul_f32 v107, v22, v107
v_cvt_pk_bf16_f32 v83, v106, v107
buffer_store_dwordx4 v[80:83], v21, s[36:39], 0 offen offset:1280 sc1
v_mul_f32 v108, v22, v108
v_mul_f32 v109, v22, v109
v_cvt_pk_bf16_f32 v84, v108, v109
v_mul_f32 v110, v22, v110
v_mul_f32 v111, v22, v111
v_cvt_pk_bf16_f32 v85, v110, v111
v_mul_f32 v112, v22, v112
v_mul_f32 v113, v22, v113
v_cvt_pk_bf16_f32 v86, v112, v113
v_mul_f32 v114, v22, v114
v_mul_f32 v115, v22, v115
v_cvt_pk_bf16_f32 v87, v114, v115
buffer_store_dwordx4 v[84:87], v21, s[36:39], 0 offen offset:1536 sc1
v_mul_f32 v116, v22, v116
v_mul_f32 v117, v22, v117
v_cvt_pk_bf16_f32 v88, v116, v117
v_mul_f32 v118, v22, v118
v_mul_f32 v119, v22, v119
v_cvt_pk_bf16_f32 v89, v118, v119
v_mul_f32 v120, v23, v120
v_mul_f32 v121, v23, v121
v_cvt_pk_bf16_f32 v90, v120, v121
v_mul_f32 v122, v23, v122
v_mul_f32 v123, v23, v123
v_cvt_pk_bf16_f32 v91, v122, v123
buffer_store_dwordx4 v[88:91], v21, s[36:39], 0 offen offset:1792 sc1
v_mul_f32 v124, v23, v124
v_mul_f32 v125, v23, v125
v_cvt_pk_bf16_f32 v92, v124, v125
v_mul_f32 v126, v23, v126
v_mul_f32 v127, v23, v127
v_cvt_pk_bf16_f32 v93, v126, v127
v_mul_f32 v128, v23, v128
v_mul_f32 v129, v23, v129
v_cvt_pk_bf16_f32 v94, v128, v129
v_mul_f32 v130, v23, v130
v_mul_f32 v131, v23, v131
v_cvt_pk_bf16_f32 v95, v130, v131
buffer_store_dwordx4 v[92:95], v21, s[36:39], 0 offen offset:2048 sc1
v_mul_f32 v132, v23, v132
v_mul_f32 v133, v23, v133
v_cvt_pk_bf16_f32 v96, v132, v133
v_mul_f32 v134, v23, v134
v_mul_f32 v135, v23, v135
v_cvt_pk_bf16_f32 v97, v134, v135
v_mul_f32 v136, v23, v136
v_mul_f32 v137, v23, v137
v_cvt_pk_bf16_f32 v98, v136, v137
v_mul_f32 v138, v23, v138
v_mul_f32 v139, v23, v139
v_cvt_pk_bf16_f32 v99, v138, v139
buffer_store_dwordx4 v[96:99], v21, s[36:39], 0 offen offset:2304 sc1
s_waitcnt lgkmcnt(0)
s_waitcnt vmcnt(0)
buffer_atomic_or v8, v5, s[36:39], s75 offen sc1
s_branch L_fin
L_job1:
v_mul_u32_u24 v13, 1280, v9
v_lshl_add_u32 v13, v10, 4, v13
v_add_u32 v14, 9216, v13
v_add_u32 v15, 9216, v14
v_add_u32 v36, 9216, v15
s_mov_b32 s38, 29884416
s_mov_b32 s39, 0x20000
s_mov_b32 s30, 1966080
s_mov_b32 s31, 0x20000
s_mov_b32 s22, 819200
s_mov_b32 s23, 0x20000
s_add_u32 s67, s2, 0
s_mul_i32 s65, s67, 6554
s_lshr_b32 s65, s65, 16
s_mul_i32 s50, s65, 10
s_sub_u32 s67, s67, s50
s_add_u32 s68, s2, 256
s_mul_i32 s66, s68, 6554
s_lshr_b32 s66, s66, 16
s_mul_i32 s50, s66, 10
s_sub_u32 s68, s68, s50
s_mov_b32 s6, 2621440
s_mov_b32 s7, 0x20000
s_lshl1_add_u32 s69, s56, s57
s_lshl_b32 s69, s69, 5
s_add_u32 s69, s69, s55
s_mul_i32 s51, s69, 10240
s_waitcnt lgkmcnt(0)
s_mov_b64 s[4:5], s[88:89]
s_mov_b64 s[20:21], s[94:95]
s_mov_b64 s[28:29], s[98:99]
buffer_load_dwordx4 v[104:107], v13, s[4:7], s51 offen offset:0
buffer_load_dwordx4 v[108:111], v13, s[4:7], s51 offen offset:128
buffer_load_dwordx4 v[112:115], v13, s[4:7], s51 offen offset:256
buffer_load_dwordx4 v[116:119], v13, s[4:7], s51 offen offset:384
buffer_load_dwordx4 v[120:123], v13, s[4:7], s51 offen offset:512
buffer_load_dwordx4 v[124:127], v13, s[4:7], s51 offen offset:640
buffer_load_dwordx4 v[128:131], v13, s[4:7], s51 offen offset:768
buffer_load_dwordx4 v[132:135], v13, s[4:7], s51 offen offset:896
buffer_load_dwordx4 v[136:139], v13, s[4:7], s51 offen offset:1024
buffer_load_dwordx4 v[140:143], v13, s[4:7], s51 offen offset:1152
s_mul_i32 s48, s65, 40960
s_lshl_b32 s50, s67, 7
s_mov_b32 m0, 147456
s_add_u32 s48, s48, s50
buffer_load_dwordx4 v13, s[20:23], s48 offen offset:0 nt lds
buffer_load_dwordx4 v14, s[20:23], s48 offen offset:1024 nt lds
buffer_load_dwordx4 v15, s[20:23], s48 offen offset:2048 nt lds
buffer_load_dwordx4 v36, s[20:23], s48 offen offset:3072 nt lds
s_load_dword s53, s[36:37], 0
s_mov_b32 s14, 819200
s_mov_b32 s15, 0x20000
v_cmp_eq_u32 vcc, 0, v1
v_mov_b32 v144, 1073741824
s_nop 0
v_cndmask_b32 v5, v144, v1, vcc
v_lshrrev_b32 v11, 10, v5
s_lshl_b32 s48, s64, 2
s_add_u32 s48, s48, 163328
v_add_u32 v11, s48, v11
v_lshrrev_b32 v12, 4, v1
v_lshlrev_b32 v12, 3, v12
v_bfe_u32 v9, v1, 2, 2
v_add_u32 v12, v12, v9
v_and_b32 v9, 3, v1
v_lshlrev_b32 v9, 3, v9
v_mul_u32_u24 v10, 160, v12
v_add_u32 v10, v10, v9
v_lshl_add_u32 v12, v12, 7, v9
v_add_u32 v149, 0, v1
v_mul_u32_u24 v149, 6554, v149
v_lshrrev_b32 v149, 16, v149
v_mul_u32_u24 v149, 1120, v149
v_add_u32 v144, v149, v4
v_add_u32 v149, 64, v1
v_mul_u32_u24 v149, 6554, v149
v_lshrrev_b32 v149, 16, v149
v_mul_u32_u24 v149, 1120, v149
v_add_u32 v145, v149, v4
v_add_u32 v149, 128, v1
v_mul_u32_u24 v149, 6554, v149
v_lshrrev_b32 v149, 16, v149
v_mul_u32_u24 v149, 1120, v149
v_add_u32 v146, v149, v4
v_add_u32 v149, 192, v1
v_mul_u32_u24 v149, 6554, v149
v_lshrrev_b32 v149, 16, v149
v_mul_u32_u24 v149, 1120, v149
v_add_u32 v147, v149, v4
v_add_u32 v149, 256, v1
v_mul_u32_u24 v149, 6554, v149
v_lshrrev_b32 v149, 16, v149
v_mul_u32_u24 v149, 1120, v149
v_add_u32 v148, v149, v4
v_add_u32 v148, 4096, v148
s_mul_i32 s49, s60, 25600
s_mul_i32 s50, s61, 160
s_mov_b32 m0, 151552
s_add_u32 s49, s49, s50
buffer_load_dwordx4 v144, s[12:15], s49 offen offset:0 nt lds
buffer_load_dwordx4 v145, s[12:15], s49 offen offset:1024 nt lds
buffer_load_dwordx4 v146, s[12:15], s49 offen offset:2048 nt lds
buffer_load_dwordx4 v147, s[12:15], s49 offen offset:3072 nt lds
s_mov_b32 m0, 155648
s_nop 0
buffer_load_dwordx4 v148, s[12:15], s49 offen nt lds
s_cmp_lt_u32 s2, 220
s_cbranch_scc1 L327
s_lshl_b32 s48, s2, 7
s_add_u32 s48, s48, 25088
s_mov_b32 s49, 0
s_atomic_add s49, s[36:37], s48 glc
L327:
s_waitcnt lgkmcnt(0)
s_mul_i32 s53, s53, 1664525
s_add_u32 s53, s53, 1013904223
v_mov_b32 v2, s53
s_and_b32 s49, s69, 7
s_cbranch_scc1 L328
s_lshl_b32 s48, s69, 4
s_add_u32 s48, s48, 8192
s_mov_b32 s80, 0
s_mov_b32 s81, s53
s_atomic_swap_x2 s[80:81], s[36:37], s48 glc
s_lshl_b32 s48, s69, 4
s_add_u32 s48, s48, 16384
s_mov_b32 s78, 0
s_mov_b32 s79, s53
s_atomic_swap_x2 s[78:79], s[36:37], s48 glc
s_lshl_b32 s48, s69, 4
s_add_u32 s48, s48, 36864
s_mov_b32 s76, 0
s_mov_b32 s77, s53
s_atomic_swap_x2 s[76:77], s[36:37], s48 glc
L328:
s_and_b32 s49, s69, 3
s_cbranch_scc1 L329
s_lshl_b32 s48, s69, 5
s_add_u32 s48, s48, 28672
s_mov_b32 s74, 0
s_mov_b32 s75, s53
s_atomic_swap_x2 s[74:75], s[36:37], s48 glc
s_lshl_b32 s48, s69, 5
s_add_u32 s48, s48, 45056
s_mov_b32 s72, 0
s_mov_b32 s73, s53
s_atomic_swap_x2 s[72:73], s[36:37], s48 glc
L329:
s_and_b32 s49, s69, -8
s_cbranch_scc1 L330
s_lshl_b32 s48, s69, 7
s_add_u32 s48, s48, 40960
s_mov_b32 s70, 0
s_mov_b32 s71, s53
s_atomic_swap_x2 s[70:71], s[36:37], s48 glc
L330:
v_add_u32 v12, 147456, v12
v_mov_b32 v149, 0x3f803f80
v_mov_b32 v145, 0
v_mov_b32 v148, 0
s_waitcnt vmcnt(18)
v_dot2c_f32_bf16 v145, v104, v149
v_dot2c_f32_bf16 v148, v104, v104
v_dot2c_f32_bf16 v145, v105, v149
v_dot2c_f32_bf16 v148, v105, v105
v_dot2c_f32_bf16 v145, v106, v149
v_dot2c_f32_bf16 v148, v106, v106
v_dot2c_f32_bf16 v145, v107, v149
v_dot2c_f32_bf16 v148, v107, v107
s_waitcnt vmcnt(17)
v_dot2c_f32_bf16 v145, v108, v149
v_dot2c_f32_bf16 v148, v108, v108
v_dot2c_f32_bf16 v145, v109, v149
v_dot2c_f32_bf16 v148, v109, v109
v_dot2c_f32_bf16 v145, v110, v149
v_dot2c_f32_bf16 v148, v110, v110
v_dot2c_f32_bf16 v145, v111, v149
v_dot2c_f32_bf16 v148, v111, v111
s_waitcnt vmcnt(16)
v_dot2c_f32_bf16 v145, v112, v149
v_dot2c_f32_bf16 v148, v112, v112
v_dot2c_f32_bf16 v145, v113, v149
v_dot2c_f32_bf16 v148, v113, v113
v_dot2c_f32_bf16 v145, v114, v149
v_dot2c_f32_bf16 v148, v114, v114
v_dot2c_f32_bf16 v145, v115, v149
v_dot2c_f32_bf16 v148, v115, v115
s_waitcnt vmcnt(15)
v_dot2c_f32_bf16 v145, v116, v149
v_dot2c_f32_bf16 v148, v116, v116
v_dot2c_f32_bf16 v145, v117, v149
v_dot2c_f32_bf16 v148, v117, v117
v_dot2c_f32_bf16 v145, v118, v149
v_dot2c_f32_bf16 v148, v118, v118
v_dot2c_f32_bf16 v145, v119, v149
v_dot2c_f32_bf16 v148, v119, v119
s_waitcnt vmcnt(14)
v_dot2c_f32_bf16 v145, v120, v149
v_dot2c_f32_bf16 v148, v120, v120
v_dot2c_f32_bf16 v145, v121, v149
v_dot2c_f32_bf16 v148, v121, v121
v_dot2c_f32_bf16 v145, v122, v149
v_dot2c_f32_bf16 v148, v122, v122
v_dot2c_f32_bf16 v145, v123, v149
v_dot2c_f32_bf16 v148, v123, v123
s_waitcnt vmcnt(13)
v_dot2c_f32_bf16 v145, v124, v149
v_dot2c_f32_bf16 v148, v124, v124
v_dot2c_f32_bf16 v145, v125, v149
v_dot2c_f32_bf16 v148, v125, v125
v_dot2c_f32_bf16 v145, v126, v149
v_dot2c_f32_bf16 v148, v126, v126
v_dot2c_f32_bf16 v145, v127, v149
v_dot2c_f32_bf16 v148, v127, v127
s_waitcnt vmcnt(12)
v_dot2c_f32_bf16 v145, v128, v149
v_dot2c_f32_bf16 v148, v128, v128
v_dot2c_f32_bf16 v145, v129, v149
v_dot2c_f32_bf16 v148, v129, v129
v_dot2c_f32_bf16 v145, v130, v149
v_dot2c_f32_bf16 v148, v130, v130
v_dot2c_f32_bf16 v145, v131, v149
v_dot2c_f32_bf16 v148, v131, v131
s_waitcnt vmcnt(11)
v_dot2c_f32_bf16 v145, v132, v149
v_dot2c_f32_bf16 v148, v132, v132
v_dot2c_f32_bf16 v145, v133, v149
v_dot2c_f32_bf16 v148, v133, v133
v_dot2c_f32_bf16 v145, v134, v149
v_dot2c_f32_bf16 v148, v134, v134
v_dot2c_f32_bf16 v145, v135, v149
v_dot2c_f32_bf16 v148, v135, v135
s_waitcnt vmcnt(10)
v_dot2c_f32_bf16 v145, v136, v149
v_dot2c_f32_bf16 v148, v136, v136
v_dot2c_f32_bf16 v145, v137, v149
v_dot2c_f32_bf16 v148, v137, v137
v_dot2c_f32_bf16 v145, v138, v149
v_dot2c_f32_bf16 v148, v138, v138
v_dot2c_f32_bf16 v145, v139, v149
v_dot2c_f32_bf16 v148, v139, v139
s_waitcnt vmcnt(9)
v_dot2c_f32_bf16 v145, v140, v149
v_dot2c_f32_bf16 v148, v140, v140
v_dot2c_f32_bf16 v145, v141, v149
v_dot2c_f32_bf16 v148, v141, v141
v_dot2c_f32_bf16 v145, v142, v149
v_dot2c_f32_bf16 v148, v142, v142
v_dot2c_f32_bf16 v145, v143, v149
v_dot2c_f32_bf16 v148, v143, v143
s_nop 1
v_add_f32_dpp v145, v145, v145 quad_perm:[1,0,3,2] row_mask:0xf bank_mask:0xf
v_add_f32_dpp v148, v148, v148 quad_perm:[1,0,3,2] row_mask:0xf bank_mask:0xf
s_nop 0
v_add_f32_dpp v145, v145, v145 quad_perm:[2,3,0,1] row_mask:0xf bank_mask:0xf
v_add_f32_dpp v148, v148, v148 quad_perm:[2,3,0,1] row_mask:0xf bank_mask:0xf
s_nop 0
v_add_f32_dpp v145, v145, v145 row_half_mirror row_mask:0xf bank_mask:0xf
v_add_f32_dpp v148, v148, v148 row_half_mirror row_mask:0xf bank_mask:0xf
v_mul_f32 v145, 0x3acccccd, v145
v_mul_f32 v148, 0x3acccccd, v148
v_fma_f32 v148, -v145, v145, v148
v_max_f32 v148, 0, v148
v_cvt_pk_bf16_f32 v144, v148, v148
v_and_b32 v144, 0xffff0000, v144
v_add_f32 v144, 0x3727c5ac, v144
v_cvt_pk_bf16_f32 v144, v144, v144
v_and_b32 v144, 0xffff0000, v144
v_sqrt_f32 v144, v144
s_nop 0
v_cvt_pk_bf16_f32 v144, v144, v144
v_and_b32 v144, 0xffff0000, v144
v_rcp_f32 v144, v144
v_mov_b32 v147, s53
v_mul_f32 v148, v148, v144
v_mul_f32 v148, v148, v144
v_cvt_pk_bf16_f32 v146, v148, v148
v_and_b32 v146, 0xffff0000, v146
v_add_f32 v146, 0x3727c5ac, v146
v_cvt_pk_bf16_f32 v146, v146, v146
v_and_b32 v146, 0xffff0000, v146
v_sqrt_f32 v146, v146
s_nop 0
v_cvt_pk_bf16_f32 v146, v146, v146
v_and_b32 v146, 0xffff0000, v146
v_rcp_f32 v146, v146
v_lshlrev_b32 v9, 5, v1
ds_bpermute_b32 v144, v9, v144
ds_bpermute_b32 v145, v9, v145
ds_bpermute_b32 v146, v9, v146
s_lshl_b32 s48, s69, 7
s_add_u32 s48, s48, 65536
s_waitcnt lgkmcnt(0)
s_mov_b64 exec, 0xff
buffer_store_dwordx4 v[144:147], v4, s[36:39], s48 offen sc1
s_mov_b64 exec, -1
s_waitcnt vmcnt(6)
ds_read_b64_tr_b16 v[40:41], v12 offset:0
ds_read_b64_tr_b16 v[42:43], v12 offset:512
ds_read_b64_tr_b16 v[44:45], v12 offset:32
ds_read_b64_tr_b16 v[46:47], v12 offset:544
ds_read_b64_tr_b16 v[48:49], v12 offset:64
ds_read_b64_tr_b16 v[50:51], v12 offset:576
ds_read_b64_tr_b16 v[52:53], v12 offset:96
ds_read_b64_tr_b16 v[54:55], v12 offset:608
s_mul_i32 s49, s65, 5
s_lshl_b32 s48, s67, 2
s_add_u32 s48, s48, 0
s_mul_i32 s50, s48, 52
s_lshr_b32 s50, s50, 8
s_mul_i32 s50, s50, 95
s_add_u32 s48, s48, s50
s_add_u32 s48, s48, s49
s_lshl_b32 s48, s48, 10
s_add_u32 s48, s48, 7340032
s_cmp_ge_u32 s65, 20
s_cmov_b32 s48, 1073741824
s_waitcnt lgkmcnt(6)
buffer_store_dwordx4 v[40:43], v4, s[36:39], s48 offen sc1
s_lshl_b32 s48, s67, 2
s_add_u32 s48, s48, 1
s_mul_i32 s50, s48, 52
s_lshr_b32 s50, s50, 8
s_mul_i32 s50, s50, 95
s_add_u32 s48, s48, s50
s_add_u32 s48, s48, s49
s_lshl_b32 s48, s48, 10
s_add_u32 s48, s48, 7340032
s_cmp_ge_u32 s65, 20
s_cmov_b32 s48, 1073741824
s_waitcnt lgkmcnt(4)
buffer_store_dwordx4 v[44:47], v4, s[36:39], s48 offen sc1
s_lshl_b32 s48, s67, 2
s_add_u32 s48, s48, 2
s_mul_i32 s50, s48, 52
s_lshr_b32 s50, s50, 8
s_mul_i32 s50, s50, 95
s_add_u32 s48, s48, s50
s_add_u32 s48, s48, s49
s_lshl_b32 s48, s48, 10
s_add_u32 s48, s48, 7340032
s_cmp_ge_u32 s65, 20
s_cmov_b32 s48, 1073741824
s_waitcnt lgkmcnt(2)
buffer_store_dwordx4 v[48:51], v4, s[36:39], s48 offen sc1
s_lshl_b32 s48, s67, 2
s_add_u32 s48, s48, 3
s_mul_i32 s50, s48, 52
s_lshr_b32 s50, s50, 8
s_mul_i32 s50, s50, 95
s_add_u32 s48, s48, s50
s_add_u32 s48, s48, s49
s_lshl_b32 s48, s48, 10
s_add_u32 s48, s48, 7340032
s_cmp_ge_u32 s65, 20
s_cmov_b32 s48, 1073741824
s_waitcnt lgkmcnt(0)
buffer_store_dwordx4 v[52:55], v4, s[36:39], s48 offen sc1
v_mov_b32 v9, 1
s_waitcnt vmcnt(5)
v_add_u32 v10, 151552, v10
ds_read_b64_tr_b16 v[16:17], v10 offset:0
ds_read_b64_tr_b16 v[18:19], v10 offset:640
ds_read_b64_tr_b16 v[20:21], v10 offset:32
ds_read_b64_tr_b16 v[22:23], v10 offset:672
ds_read_b64_tr_b16 v[24:25], v10 offset:64
ds_read_b64_tr_b16 v[26:27], v10 offset:704
ds_read_b64_tr_b16 v[28:29], v10 offset:96
ds_read_b64_tr_b16 v[30:31], v10 offset:736
ds_read_b64_tr_b16 v[32:33], v10 offset:128
ds_read_b64_tr_b16 v[34:35], v10 offset:768
ds_write_b32 v11, v9 offset:8
s_waitcnt vmcnt(0)
s_lshl_b32 s48, s67, 7
s_lshl2_add_u32 s48, s65, s48
s_add_u32 s48, s48, 53248
buffer_atomic_swap v2, v5, s[36:39], s48 offen sc1
v_mov_b32 v9, 1
s_add_u32 s67, s2, 0
s_mul_i32 s65, s67, 6554
s_lshr_b32 s65, s65, 16
s_mul_i32 s50, s65, 10
s_sub_u32 s67, s67, s50
s_add_u32 s68, s2, 256
s_mul_i32 s66, s68, 6554
s_lshr_b32 s66, s66, 16
s_mul_i32 s50, s66, 10
s_sub_u32 s68, s68, s50
v_add_u32 v37, 147456, v4
v_lshlrev_b32 v148, 7, v1
v_mov_b32 v38, 0
ds_read_b64 v[6:7], v3 offset:0
s_waitcnt lgkmcnt(0)
v_min_u32 v6, v6, v7
v_cmp_gt_u32 vcc, 8, v6
s_nop 0
s_cbranch_vccnz W332
B333:
s_mul_i32 s48, s65, 40960
s_lshl_b32 s50, s67, 7
s_add_u32 s48, s48, s50
buffer_load_dwordx4 v[40:43], v13, s[28:31], s48 offen offset:0 nt
buffer_load_dwordx4 v[44:47], v14, s[28:31], s48 offen offset:1024 nt
buffer_load_dwordx4 v[48:51], v15, s[28:31], s48 offen offset:2048 nt
buffer_load_dwordx4 v[52:55], v36, s[28:31], s48 offen offset:3072 nt
s_mul_i32 s48, s66, 40960
s_lshl_b32 s50, s68, 7
s_add_u32 s48, s48, s50
buffer_load_dwordx4 v[56:59], v13, s[28:31], s48 offen offset:0 nt
buffer_load_dwordx4 v[60:63], v14, s[28:31], s48 offen offset:1024 nt
buffer_load_dwordx4 v[64:67], v15, s[28:31], s48 offen offset:2048 nt
buffer_load_dwordx4 v[68:71], v36, s[28:31], s48 offen offset:3072 nt
s_mul_i32 s48, s2, 3200
s_add_u32 s48, s48, 18874368
s_waitcnt vmcnt(7)
ds_write_b128 v37, v[40:43] offset:0
s_waitcnt vmcnt(6)
ds_write_b128 v37, v[44:47] offset:1024
s_waitcnt vmcnt(5)
ds_write_b128 v37, v[48:51] offset:2048
s_waitcnt vmcnt(4)
ds_write_b128 v37, v[52:55] offset:3072
s_waitcnt lgkmcnt(0)
ds_read_b64_tr_b16 v[40:41], v12 offset:0
ds_read_b64_tr_b16 v[42:43], v12 offset:512
ds_read_b64_tr_b16 v[44:45], v12 offset:32
ds_read_b64_tr_b16 v[46:47], v12 offset:544
ds_read_b64_tr_b16 v[48:49], v12 offset:64
ds_read_b64_tr_b16 v[50:51], v12 offset:576
ds_read_b64_tr_b16 v[52:53], v12 offset:96
ds_read_b64_tr_b16 v[54:55], v12 offset:608
s_waitcnt vmcnt(3)
ds_write_b128 v37, v[56:59] offset:0
s_waitcnt vmcnt(2)
ds_write_b128 v37, v[60:63] offset:1024
s_waitcnt vmcnt(1)
ds_write_b128 v37, v[64:67] offset:2048
s_waitcnt vmcnt(0)
ds_write_b128 v37, v[68:71] offset:3072
s_waitcnt lgkmcnt(0)
ds_read_b64_tr_b16 v[56:57], v12 offset:0
ds_read_b64_tr_b16 v[58:59], v12 offset:512
ds_read_b64_tr_b16 v[60:61], v12 offset:32
ds_read_b64_tr_b16 v[62:63], v12 offset:544
ds_read_b64_tr_b16 v[64:65], v12 offset:64
ds_read_b64_tr_b16 v[66:67], v12 offset:576
ds_read_b64_tr_b16 v[68:69], v12 offset:96
ds_read_b64_tr_b16 v[70:71], v12 offset:608
ds_write_b32 v11, v9 offset:40
s_mul_i32 s49, s65, 5
s_lshl_b32 s48, s67, 2
s_add_u32 s48, s48, 0
s_mul_i32 s50, s48, 52
s_lshr_b32 s50, s50, 8
s_mul_i32 s50, s50, 235
s_add_u32 s48, s48, s50
s_add_u32 s48, s48, s49
s_lshl_b32 s48, s48, 10
s_add_u32 s48, s48, 22544384
s_cmp_ge_u32 s65, 48
s_cmov_b32 s48, 1073741824
buffer_store_dwordx4 v[40:43], v4, s[36:39], s48 offen sc1
s_lshl_b32 s48, s67, 2
s_add_u32 s48, s48, 1
s_mul_i32 s50, s48, 52
s_lshr_b32 s50, s50, 8
s_mul_i32 s50, s50, 235
s_add_u32 s48, s48, s50
s_add_u32 s48, s48, s49
s_lshl_b32 s48, s48, 10
s_add_u32 s48, s48, 22544384
s_cmp_ge_u32 s65, 48
s_cmov_b32 s48, 1073741824
buffer_store_dwordx4 v[44:47], v4, s[36:39], s48 offen sc1
s_lshl_b32 s48, s67, 2
s_add_u32 s48, s48, 2
s_mul_i32 s50, s48, 52
s_lshr_b32 s50, s50, 8
s_mul_i32 s50, s50, 235
s_add_u32 s48, s48, s50
s_add_u32 s48, s48, s49
s_lshl_b32 s48, s48, 10
s_add_u32 s48, s48, 22544384
s_cmp_ge_u32 s65, 48
s_cmov_b32 s48, 1073741824
buffer_store_dwordx4 v[48:51], v4, s[36:39], s48 offen sc1
s_lshl_b32 s48, s67, 2
s_add_u32 s48, s48, 3
s_mul_i32 s50, s48, 52
s_lshr_b32 s50, s50, 8
s_mul_i32 s50, s50, 235
s_add_u32 s48, s48, s50
s_add_u32 s48, s48, s49
s_lshl_b32 s48, s48, 10
s_add_u32 s48, s48, 22544384
s_cmp_ge_u32 s65, 48
s_cmov_b32 s48, 1073741824
buffer_store_dwordx4 v[52:55], v4, s[36:39], s48 offen sc1
s_mul_i32 s49, s66, 5
s_lshl_b32 s48, s68, 2
s_add_u32 s48, s48, 0
s_mul_i32 s50, s48, 52
s_lshr_b32 s50, s50, 8
s_mul_i32 s50, s50, 235
s_add_u32 s48, s48, s50
s_add_u32 s48, s48, s49
s_lshl_b32 s48, s48, 10
s_add_u32 s48, s48, 22544384
s_cmp_ge_u32 s66, 48
s_cmov_b32 s48, 1073741824
s_waitcnt lgkmcnt(7)
buffer_store_dwordx4 v[56:59], v4, s[36:39], s48 offen sc1
s_lshl_b32 s48, s68, 2
s_add_u32 s48, s48, 1
s_mul_i32 s50, s48, 52
s_lshr_b32 s50, s50, 8
s_mul_i32 s50, s50, 235
s_add_u32 s48, s48, s50
s_add_u32 s48, s48, s49
s_lshl_b32 s48, s48, 10
s_add_u32 s48, s48, 22544384
s_cmp_ge_u32 s66, 48
s_cmov_b32 s48, 1073741824
s_waitcnt lgkmcnt(5)
buffer_store_dwordx4 v[60:63], v4, s[36:39], s48 offen sc1
s_lshl_b32 s48, s68, 2
s_add_u32 s48, s48, 2
s_mul_i32 s50, s48, 52
s_lshr_b32 s50, s50, 8
s_mul_i32 s50, s50, 235
s_add_u32 s48, s48, s50
s_add_u32 s48, s48, s49
s_lshl_b32 s48, s48, 10
s_add_u32 s48, s48, 22544384
s_cmp_ge_u32 s66, 48
s_cmov_b32 s48, 1073741824
s_waitcnt lgkmcnt(3)
buffer_store_dwordx4 v[64:67], v4, s[36:39], s48 offen sc1
s_lshl_b32 s48, s68, 2
s_add_u32 s48, s48, 3
s_mul_i32 s50, s48, 52
s_lshr_b32 s50, s50, 8
s_mul_i32 s50, s50, 235
s_add_u32 s48, s48, s50
s_add_u32 s48, s48, s49
s_lshl_b32 s48, s48, 10
s_add_u32 s48, s48, 22544384
s_cmp_ge_u32 s66, 48
s_cmov_b32 s48, 1073741824
s_waitcnt lgkmcnt(1)
buffer_store_dwordx4 v[68:71], v4, s[36:39], s48 offen sc1
s_waitcnt vmcnt(0)
s_lshl_b32 s48, s67, 8
s_lshl2_add_u32 s48, s65, s48
s_add_u32 s48, s48, 55296
buffer_atomic_swap v2, v5, s[36:39], s48 offen sc1
s_lshl_b32 s48, s68, 8
s_lshl2_add_u32 s48, s66, s48
s_add_u32 s48, s48, 55296
buffer_atomic_swap v2, v5, s[36:39], s48 offen sc1
L331:
ds_write_b32 v11, v9 offset:40
s_waitcnt vmcnt(0) lgkmcnt(0)
v_and_b32 v37, 15, v1
s_lshr_b32 s65, s60, 1
s_mul_i32 s49, s65, 137344
s_lshl_b32 s65, s65, 7
s_add_u32 s65, s65, 24576
s_and_b32 s48, s60, 1
s_mul_i32 s48, s48, 20
s_add_u32 s50, s48, 8
v_min_u32 v39, 49, v1
v_add_u32 v39, 0, v39
v_mul_u32_u24 v10, 3277, v39
v_lshrrev_b32 v10, 16, v10
v_mul_u32_u24 v40, 20, v10
v_sub_u32 v40, v39, v40
v_lshlrev_b32 v39, 6, v40
v_lshl_add_u32 v39, v10, 3, v39
v_add_u32 v42, 161792, v39
v_add_u32 v40, s48, v40
v_lshl_add_u32 v12, v10, 2, s50
v_lshlrev_b32 v12, 6, v12
v_lshrrev_b32 v10, 4, v40
v_lshl_add_u32 v12, v10, 11, v12
v_and_b32 v40, 15, v40
v_lshl_add_u32 v12, v40, 4, v12
v_add_u32 v40, s49, v12
v_min_u32 v39, 49, v1
v_add_u32 v39, 50, v39
v_mul_u32_u24 v10, 3277, v39
v_lshrrev_b32 v10, 16, v10
v_mul_u32_u24 v41, 20, v10
v_sub_u32 v41, v39, v41
v_lshlrev_b32 v39, 6, v41
v_lshl_add_u32 v39, v10, 3, v39
v_add_u32 v43, 161792, v39
v_add_u32 v41, s48, v41
v_lshl_add_u32 v12, v10, 2, s50
v_lshlrev_b32 v12, 6, v12
v_lshrrev_b32 v10, 4, v41
v_lshl_add_u32 v12, v10, 11, v12
v_and_b32 v41, 15, v41
v_lshl_add_u32 v12, v41, 4, v12
v_add_u32 v41, s49, v12
v_lshrrev_b32 v9, 4, v1
v_lshlrev_b32 v38, 6, v37
v_lshl_add_u32 v38, v9, 4, v38
v_add_u32 v38, 161792, v38
s_mul_i32 s48, s60, 5
s_mul_i32 s49, s61, 102400
s_add_u32 s49, s49, 18874368
v_add3_u32 v39, v9, s48, 0
v_lshrrev_b32 v12, 3, v39
v_mul_u32_u24 v44, 5120, v12
v_bfe_u32 v12, v39, 1, 2
v_lshl_add_u32 v44, v12, 7, v44
v_and_b32 v12, 1, v39
v_lshl_add_u32 v44, v12, 9, v44
v_lshl_add_u32 v44, v37, 3, v44
v_add_u32 v44, s49, v44
v_add3_u32 v39, v9, s48, 4
v_lshrrev_b32 v12, 3, v39
v_mul_u32_u24 v45, 5120, v12
v_bfe_u32 v12, v39, 1, 2
v_lshl_add_u32 v45, v12, 7, v45
v_and_b32 v12, 1, v39
v_lshl_add_u32 v45, v12, 9, v45
v_lshl_add_u32 v45, v37, 3, v45
v_add_u32 v45, s49, v45
v_cmp_gt_u32 vcc, 16, v1
v_mov_b32 v39, 1073741824
s_nop 0
v_cndmask_b32 v45, v39, v45, vcc
s_lshl_b32 s67, s60, 7
s_add_u32 s67, s67, 36864
s_lshl_b32 s66, s61, 7
s_add_u32 s66, s66, 40960
s_lshl_b32 s51, 1, s60
v_mov_b32 v8, s51
v_min_u32 v9, 59, v1
v_mul_u32_u24 v10, 21846, v9
v_lshrrev_b32 v10, 16, v10
v_mul_u32_u24 v10, 40, v10
v_lshl_add_u32 v9, v9, 3, v10
v_add_u32 v12, 161832, v9
v_mov_b32 v46, 0
v_mov_b32 v47, 0
ds_write_b64 v12, v[46:47]
L334:
ds_read_b128 v[116:119], v3 offset:16
s_sleep 4
s_sub_u32 s54, s54, 1
s_cmp_lt_i32 s54, 0
s_cbranch_scc1 L335
s_waitcnt lgkmcnt(0)
v_min3_u32 v116, v116, v117, v118
v_min_u32 v116, v116, v119
v_cmp_gt_u32 vcc, 11, v116
s_nop 0
s_cbranch_vccnz L334
L335:
s_sleep 8
s_mov_b64 s[70:71], 0
s_atomic_add_x2 s[70:71], s[36:37], s65 glc
s_waitcnt lgkmcnt(0)
s_cmp_lg_u32 s71, s53
s_cbranch_scc1 N336
s_andn2_b32 s51, 15, s70
s_cbranch_scc1 N336
B337:
s_mov_b32 s68, 19922944
buffer_load_dwordx4 v[52:55], v40, s[36:39], s68 offen sc1
buffer_load_dwordx4 v[56:59], v41, s[36:39], s68 offen sc1
s_mov_b32 s68, 19931520
buffer_load_dwordx4 v[60:63], v40, s[36:39], s68 offen sc1
buffer_load_dwordx4 v[64:67], v41, s[36:39], s68 offen sc1
s_mov_b32 s68, 19940096
buffer_load_dwordx4 v[68:71], v40, s[36:39], s68 offen sc1
buffer_load_dwordx4 v[72:75], v41, s[36:39], s68 offen sc1
s_mov_b32 s68, 19948672
buffer_load_dwordx4 v[76:79], v40, s[36:39], s68 offen sc1
buffer_load_dwordx4 v[80:83], v41, s[36:39], s68 offen sc1
s_cmp_lg_u32 s71, s53
s_cbranch_scc1 N338
s_andn2_b32 s51, 240, s70
s_cbranch_scc1 N338
B339:
s_mov_b32 s68, 19957248
buffer_load_dwordx4 v[84:87], v40, s[36:39], s68 offen sc1
buffer_load_dwordx4 v[88:91], v41, s[36:39], s68 offen sc1
s_mov_b32 s68, 19965824
buffer_load_dwordx4 v[92:95], v40, s[36:39], s68 offen sc1
buffer_load_dwordx4 v[96:99], v41, s[36:39], s68 offen sc1
s_mov_b32 s68, 19974400
buffer_load_dwordx4 v[100:103], v40, s[36:39], s68 offen sc1
buffer_load_dwordx4 v[104:107], v41, s[36:39], s68 offen sc1
s_mov_b32 s68, 19982976
buffer_load_dwordx4 v[108:111], v40, s[36:39], s68 offen sc1
buffer_load_dwordx4 v[112:115], v41, s[36:39], s68 offen sc1
s_waitcnt vmcnt(15)
v_mov_b32 v116, v52
v_mov_b32 v117, v53
v_mov_b32 v118, v54
v_mov_b32 v119, v55
s_waitcnt vmcnt(14)
v_mov_b32 v120, v56
v_mov_b32 v121, v57
v_mov_b32 v122, v58
v_mov_b32 v123, v59
s_waitcnt vmcnt(13)
v_add_f32 v116, v116, v60
v_add_f32 v117, v117, v61
v_add_f32 v118, v118, v62
v_add_f32 v119, v119, v63
s_waitcnt vmcnt(12)
v_add_f32 v120, v120, v64
v_add_f32 v121, v121, v65
v_add_f32 v122, v122, v66
v_add_f32 v123, v123, v67
s_waitcnt vmcnt(11)
v_add_f32 v116, v116, v68
v_add_f32 v117, v117, v69
v_add_f32 v118, v118, v70
v_add_f32 v119, v119, v71
s_waitcnt vmcnt(10)
v_add_f32 v120, v120, v72
v_add_f32 v121, v121, v73
v_add_f32 v122, v122, v74
v_add_f32 v123, v123, v75
s_waitcnt vmcnt(9)
v_add_f32 v116, v116, v76
v_add_f32 v117, v117, v77
v_add_f32 v118, v118, v78
v_add_f32 v119, v119, v79
s_waitcnt vmcnt(8)
v_add_f32 v120, v120, v80
v_add_f32 v121, v121, v81
v_add_f32 v122, v122, v82
v_add_f32 v123, v123, v83
s_cmp_lg_u32 s71, s53
s_cbranch_scc1 N340
s_andn2_b32 s51, 3840, s70
s_cbranch_scc1 N340
B341:
s_mov_b32 s68, 19991552
buffer_load_dwordx4 v[52:55], v40, s[36:39], s68 offen sc1
buffer_load_dwordx4 v[56:59], v41, s[36:39], s68 offen sc1
s_mov_b32 s68, 20000128
buffer_load_dwordx4 v[60:63], v40, s[36:39], s68 offen sc1
buffer_load_dwordx4 v[64:67], v41, s[36:39], s68 offen sc1
s_mov_b32 s68, 20008704
buffer_load_dwordx4 v[68:71], v40, s[36:39], s68 offen sc1
buffer_load_dwordx4 v[72:75], v41, s[36:39], s68 offen sc1
s_mov_b32 s68, 20017280
buffer_load_dwordx4 v[76:79], v40, s[36:39], s68 offen sc1
buffer_load_dwordx4 v[80:83], v41, s[36:39], s68 offen sc1
s_waitcnt vmcnt(15)
v_add_f32 v116, v116, v84
v_add_f32 v117, v117, v85
v_add_f32 v118, v118, v86
v_add_f32 v119, v119, v87
s_waitcnt vmcnt(14)
v_add_f32 v120, v120, v88
v_add_f32 v121, v121, v89
v_add_f32 v122, v122, v90
v_add_f32 v123, v123, v91
s_waitcnt vmcnt(13)
v_add_f32 v116, v116, v92
v_add_f32 v117, v117, v93
v_add_f32 v118, v118, v94
v_add_f32 v119, v119, v95
s_waitcnt vmcnt(12)
v_add_f32 v120, v120, v96
v_add_f32 v121, v121, v97
v_add_f32 v122, v122, v98
v_add_f32 v123, v123, v99
s_waitcnt vmcnt(11)
v_add_f32 v116, v116, v100
v_add_f32 v117, v117, v101
v_add_f32 v118, v118, v102
v_add_f32 v119, v119, v103
s_waitcnt vmcnt(10)
v_add_f32 v120, v120, v104
v_add_f32 v121, v121, v105
v_add_f32 v122, v122, v106
v_add_f32 v123, v123, v107
s_waitcnt vmcnt(9)
v_add_f32 v116, v116, v108
v_add_f32 v117, v117, v109
v_add_f32 v118, v118, v110
v_add_f32 v119, v119, v111
s_waitcnt vmcnt(8)
v_add_f32 v120, v120, v112
v_add_f32 v121, v121, v113
v_add_f32 v122, v122, v114
v_add_f32 v123, v123, v115
s_cmp_lg_u32 s71, s53
s_cbranch_scc1 N342
s_andn2_b32 s51, 61440, s70
s_cbranch_scc1 N342
B343:
s_mov_b32 s68, 20025856
buffer_load_dwordx4 v[84:87], v40, s[36:39], s68 offen sc1
buffer_load_dwordx4 v[88:91], v41, s[36:39], s68 offen sc1
s_mov_b32 s68, 20034432
buffer_load_dwordx4 v[92:95], v40, s[36:39], s68 offen sc1
buffer_load_dwordx4 v[96:99], v41, s[36:39], s68 offen sc1
s_mov_b32 s68, 20043008
buffer_load_dwordx4 v[100:103], v40, s[36:39], s68 offen sc1
buffer_load_dwordx4 v[104:107], v41, s[36:39], s68 offen sc1
s_mov_b32 s68, 20051584
buffer_load_dwordx4 v[108:111], v40, s[36:39], s68 offen sc1
buffer_load_dwordx4 v[112:115], v41, s[36:39], s68 offen sc1
s_waitcnt vmcnt(15)
v_add_f32 v116, v116, v52
v_add_f32 v117, v117, v53
v_add_f32 v118, v118, v54
v_add_f32 v119, v119, v55
s_waitcnt vmcnt(14)
v_add_f32 v120, v120, v56
v_add_f32 v121, v121, v57
v_add_f32 v122, v122, v58
v_add_f32 v123, v123, v59
s_waitcnt vmcnt(13)
v_add_f32 v116, v116, v60
v_add_f32 v117, v117, v61
v_add_f32 v118, v118, v62
v_add_f32 v119, v119, v63
s_waitcnt vmcnt(12)
v_add_f32 v120, v120, v64
v_add_f32 v121, v121, v65
v_add_f32 v122, v122, v66
v_add_f32 v123, v123, v67
s_waitcnt vmcnt(11)
v_add_f32 v116, v116, v68
v_add_f32 v117, v117, v69
v_add_f32 v118, v118, v70
v_add_f32 v119, v119, v71
s_waitcnt vmcnt(10)
v_add_f32 v120, v120, v72
v_add_f32 v121, v121, v73
v_add_f32 v122, v122, v74
v_add_f32 v123, v123, v75
s_waitcnt vmcnt(9)
v_add_f32 v116, v116, v76
v_add_f32 v117, v117, v77
v_add_f32 v118, v118, v78
v_add_f32 v119, v119, v79
s_waitcnt vmcnt(8)
v_add_f32 v120, v120, v80
v_add_f32 v121, v121, v81
v_add_f32 v122, v122, v82
v_add_f32 v123, v123, v83
s_setprio 2
s_waitcnt vmcnt(7)
v_add_f32 v116, v116, v84
v_add_f32 v117, v117, v85
v_add_f32 v118, v118, v86
v_add_f32 v119, v119, v87
s_waitcnt vmcnt(6)
v_add_f32 v120, v120, v88
v_add_f32 v121, v121, v89
v_add_f32 v122, v122, v90
v_add_f32 v123, v123, v91
s_waitcnt vmcnt(5)
v_add_f32 v116, v116, v92
v_add_f32 v117, v117, v93
v_add_f32 v118, v118, v94
v_add_f32 v119, v119, v95
s_waitcnt vmcnt(4)
v_add_f32 v120, v120, v96
v_add_f32 v121, v121, v97
v_add_f32 v122, v122, v98
v_add_f32 v123, v123, v99
s_waitcnt vmcnt(3)
v_add_f32 v116, v116, v100
v_add_f32 v117, v117, v101
v_add_f32 v118, v118, v102
v_add_f32 v119, v119, v103
s_waitcnt vmcnt(2)
v_add_f32 v120, v120, v104
v_add_f32 v121, v121, v105
v_add_f32 v122, v122, v106
v_add_f32 v123, v123, v107
s_waitcnt vmcnt(1)
v_add_f32 v116, v116, v108
v_add_f32 v117, v117, v109
v_add_f32 v118, v118, v110
v_add_f32 v119, v119, v111
s_waitcnt vmcnt(0)
v_add_f32 v120, v120, v112
v_add_f32 v121, v121, v113
v_add_f32 v122, v122, v114
v_add_f32 v123, v123, v115
v_cvt_pk_bf16_f32 v46, v116, v117
v_cvt_pk_bf16_f32 v47, v118, v119
ds_write_b64 v42, v[46:47]
v_cvt_pk_bf16_f32 v48, v120, v121
v_cvt_pk_bf16_f32 v49, v122, v123
ds_write_b64 v43, v[48:49]
ds_read_b128 v[116:119], v38 offset:0
ds_read_b128 v[120:123], v38 offset:1024
s_movk_i32 s68, 4096
s_waitcnt lgkmcnt(1)
v_mfma_f32_16x16x32_bf16 v[52:55], v[116:119], v[16:19], 0
s_waitcnt lgkmcnt(0)
v_mfma_f32_16x16x32_bf16 v[56:59], v[120:123], v[16:19], 0
v_mfma_f32_16x16x32_bf16 v[60:63], v[116:119], v[20:23], 0
v_mfma_f32_16x16x32_bf16 v[64:67], v[120:123], v[20:23], 0
v_mfma_f32_16x16x32_bf16 v[68:71], v[116:119], v[24:27], 0
v_mfma_f32_16x16x32_bf16 v[72:75], v[120:123], v[24:27], 0
v_mfma_f32_16x16x32_bf16 v[76:79], v[116:119], v[28:31], 0
v_mfma_f32_16x16x32_bf16 v[80:83], v[120:123], v[28:31], 0
v_mfma_f32_16x16x32_bf16 v[84:87], v[116:119], v[32:35], 0
v_mfma_f32_16x16x32_bf16 v[88:91], v[120:123], v[32:35], 0
v_cvt_pk_bf16_f32 v52, v52, v53
v_cvt_pk_bf16_f32 v53, v54, v55
buffer_store_dwordx2 v[52:53], v44, s[36:39], 0 offen offset:0 sc1
v_cvt_pk_bf16_f32 v56, v56, v57
v_cvt_pk_bf16_f32 v57, v58, v59
buffer_store_dwordx2 v[56:57], v45, s[36:39], 0 offen offset:0 sc1
v_cvt_pk_bf16_f32 v60, v60, v61
v_cvt_pk_bf16_f32 v61, v62, v63
buffer_store_dwordx2 v[60:61], v44, s[36:39], 0 offen offset:1024 sc1
v_cvt_pk_bf16_f32 v64, v64, v65
v_cvt_pk_bf16_f32 v65, v66, v67
buffer_store_dwordx2 v[64:65], v45, s[36:39], 0 offen offset:1024 sc1
v_cvt_pk_bf16_f32 v68, v68, v69
v_cvt_pk_bf16_f32 v69, v70, v71
buffer_store_dwordx2 v[68:69], v44, s[36:39], 0 offen offset:2048 sc1
v_cvt_pk_bf16_f32 v72, v72, v73
v_cvt_pk_bf16_f32 v73, v74, v75
buffer_store_dwordx2 v[72:73], v45, s[36:39], 0 offen offset:2048 sc1
v_cvt_pk_bf16_f32 v76, v76, v77
v_cvt_pk_bf16_f32 v77, v78, v79
buffer_store_dwordx2 v[76:77], v44, s[36:39], 0 offen offset:3072 sc1
v_cvt_pk_bf16_f32 v80, v80, v81
v_cvt_pk_bf16_f32 v81, v82, v83
buffer_store_dwordx2 v[80:81], v45, s[36:39], 0 offen offset:3072 sc1
v_cvt_pk_bf16_f32 v84, v84, v85
v_cvt_pk_bf16_f32 v85, v86, v87
buffer_store_dwordx2 v[84:85], v44, s[36:39], s68 offen offset:0 sc1
v_cvt_pk_bf16_f32 v88, v88, v89
v_cvt_pk_bf16_f32 v89, v90, v91
buffer_store_dwordx2 v[88:89], v45, s[36:39], s68 offen offset:0 sc1
s_waitcnt vmcnt(0)
buffer_atomic_or v8, v5, s[36:39], s66 offen sc1
s_setprio 0
s_branch P346
P344:
s_sleep 4
P346:
s_mov_b64 s[72:73], 0
s_atomic_add_x2 s[72:73], s[36:37], s66 glc
s_sub_u32 s54, s54, 1
s_cmp_lt_i32 s54, 0
s_cbranch_scc1 PD345
s_waitcnt lgkmcnt(0)
s_cmp_lg_u32 s72, -1
s_cbranch_scc1 P344
s_cmp_lg_u32 s73, s53
s_cbranch_scc1 P344
PD345:
s_waitcnt lgkmcnt(0)
v_mov_b32 v9, 1
ds_write_b32 v11, v9 offset:52
s_xor_b32 s65, s67, 512
s_branch P349
P347:
s_sleep 4
P349:
s_mov_b64 s[72:73], 0
s_atomic_add_x2 s[72:73], s[36:37], s67 glc
s_mov_b64 s[74:75], 0
s_atomic_add_x2 s[74:75], s[36:37], s65 glc
s_sub_u32 s54, s54, 1
s_cmp_lt_i32 s54, 0
s_cbranch_scc1 PD348
s_waitcnt lgkmcnt(0)
s_cmp_lg_u32 s72, 255
s_cbranch_scc1 P347
s_cmp_lg_u32 s73, s53
s_cbranch_scc1 P347
s_cmp_lg_u32 s74, 255
s_cbranch_scc1 P347
s_cmp_lg_u32 s75, s53
s_cbranch_scc1 P347
PD348:
s_waitcnt lgkmcnt(0)
v_mov_b32 v9, 2
ds_write_b32 v11, v9 offset:52
s_branch L_fin
L_comp:
s_mov_b32 s38, 29884416
s_mov_b32 s39, 0x20000
s_mov_b32 s34, 2621440
s_mov_b32 s35, 0x20000
v_cmp_eq_u32 vcc, 0, v1
v_mov_b32 v32, 1073741824
s_nop 0
v_cndmask_b32 v5, v32, v1, vcc
v_and_b32 v11, 15, v1
v_lshlrev_b32 v12, 2, v11
s_lshl_b32 s48, s52, 2
s_add_u32 s48, s48, 163344
v_lshrrev_b32 v10, 10, v5
v_add_u32 v10, s48, v10
s_mul_i32 s65, s61, 160
s_mov_b32 s66, s62
s_lshr_b32 s48, s52, 1
s_lshl1_add_u32 s67, s60, s48
s_lshl2_add_u32 s69, s60, s52
s_lshl2_add_u32 s68, s56, s63
s_lshl2_add_u32 s68, s68, s52
v_add_u32 v20, 65536, v4
s_lshl_b32 s50, s69, 4
v_and_b32 v31, 48, v1
v_lshlrev_b32 v31, 4, v31
s_and_b32 s51, s60, 3
s_add_u32 s48, s51, 0
s_and_b32 s48, s48, 3
s_lshl_b32 s49, s48, 2
s_lshr_b32 s49, 0x4031, s49
s_and_b32 s49, s49, 15
s_add_u32 s49, s49, s50
s_sub_u32 s49, s49, 2
s_mul_i32 s48, s48, 5120
v_add_u32 v21, s49, v11
v_cmp_gt_u32 vcc, 0x800, v21
v_lshrrev_b32 v30, 4, v21
v_mul_u32_u24 v30, 20480, v30
v_and_b32 v21, 15, v21
v_lshl_add_u32 v30, v21, 4, v30
v_add3_u32 v30, v30, v31, s48
v_mov_b32 v21, 1073741824
v_cndmask_b32 v13, v21, v30, vcc
s_add_u32 s48, s51, 1
s_and_b32 s48, s48, 3
s_lshl_b32 s49, s48, 2
s_lshr_b32 s49, 0x4031, s49
s_and_b32 s49, s49, 15
s_add_u32 s49, s49, s50
s_sub_u32 s49, s49, 2
s_mul_i32 s48, s48, 5120
v_add_u32 v21, s49, v11
v_cmp_gt_u32 vcc, 0x800, v21
v_lshrrev_b32 v30, 4, v21
v_mul_u32_u24 v30, 20480, v30
v_and_b32 v21, 15, v21
v_lshl_add_u32 v30, v21, 4, v30
v_add3_u32 v30, v30, v31, s48
v_mov_b32 v21, 1073741824
v_cndmask_b32 v14, v21, v30, vcc
s_add_u32 s48, s51, 2
s_and_b32 s48, s48, 3
s_lshl_b32 s49, s48, 2
s_lshr_b32 s49, 0x4031, s49
s_and_b32 s49, s49, 15
s_add_u32 s49, s49, s50
s_sub_u32 s49, s49, 2
s_mul_i32 s48, s48, 5120
v_add_u32 v21, s49, v11
v_cmp_gt_u32 vcc, 0x800, v21
v_lshrrev_b32 v30, 4, v21
v_mul_u32_u24 v30, 20480, v30
v_and_b32 v21, 15, v21
v_lshl_add_u32 v30, v21, 4, v30
v_add3_u32 v30, v30, v31, s48
v_mov_b32 v21, 1073741824
v_cndmask_b32 v15, v21, v30, vcc
s_add_u32 s48, s51, 3
s_and_b32 s48, s48, 3
s_lshl_b32 s49, s48, 2
s_lshr_b32 s49, 0x4031, s49
s_and_b32 s49, s49, 15
s_add_u32 s49, s49, s50
s_sub_u32 s49, s49, 2
s_mul_i32 s48, s48, 5120
v_add_u32 v21, s49, v11
v_cmp_gt_u32 vcc, 0x800, v21
v_lshrrev_b32 v30, 4, v21
v_mul_u32_u24 v30, 20480, v30
v_and_b32 v21, 15, v21
v_lshl_add_u32 v30, v21, 4, v30
v_add3_u32 v30, v30, v31, s48
v_mov_b32 v21, 1073741824
v_cndmask_b32 v16, v21, v30, vcc
v_lshrrev_b32 v17, 5, v1
v_lshlrev_b32 v17, 3, v17
v_bfe_u32 v32, v1, 2, 2
v_add_u32 v17, v17, v32
v_mul_u32_u24 v17, 192, v17
v_and_b32 v32, 3, v1
v_lshl_add_u32 v17, v32, 3, v17
v_and_b32 v32, 16, v1
v_lshl_add_u32 v17, v32, 1, v17
v_add_u32 v18, 65536, v17
v_add_u32 v19, 131072, v17
s_and_b32 s48, s52, 2
s_add_u32 s48, s48, s60
s_add_u32 s48, s48, 31
s_and_b32 s48, s48, 31
s_add_u32 s49, s52, 1
s_bitcmp1_b32 s49, 1
s_cmov_b32 s48, s60
s_lshl_b32 s70, s60, 7
s_add_u32 s70, s70, 8192
s_lshl_b32 s71, s48, 7
s_add_u32 s71, s71, 8192
s_cmp_lt_u32 s59, 4
s_cbranch_scc1 L_T1
s_cmp_lt_u32 s59, 6
s_cbranch_scc1 L_TA
s_lshl1_add_u32 s72, s57, s59
s_sub_u32 s72, s72, 6
s_lshr_b32 s73, s52, 1
s_and_b32 s74, s52, 1
v_lshrrev_b32 v30, 1, v11
v_lshrrev_b32 v21, 4, v1
v_xor_b32 v30, v30, v21
s_lshl_b32 s48, s73, 6
v_add_u32 v31, s48, v11
v_lshlrev_b32 v31, 7, v31
v_lshl_add_u32 v31, v30, 4, v31
v_xor_b32 v32, 64, v31
v_add_u32 v33, 65536, v31
v_add_u32 v34, 65536, v32
v_lshlrev_b32 v35, 3, v21
v_bfe_u32 v30, v1, 2, 2
v_add_u32 v35, v35, v30
v_and_b32 v30, 3, v1
v_lshlrev_b32 v30, 3, v30
v_mul_u32_u24 v36, 192, v35
v_add_u32 v36, v36, v30
v_add_u32 v36, 16384, v36
v_lshl_add_u32 v37, v35, 7, v30
v_add_u32 v37, 28672, v37
v_and_b32 v38, 1, v21
v_bfe_u32 v39, v1, 3, 2
s_mul_i32 s48, s74, 3
s_add_u32 s48, s48, 0
v_xor_b32 v40, s48, v38
v_lshl_add_u32 v40, v40, 5, v36
v_add_u32 v41, 65536, v40
s_mul_i32 s48, s74, 3
s_add_u32 s48, s48, 1
v_xor_b32 v42, s48, v38
v_lshl_add_u32 v42, v42, 5, v36
v_add_u32 v43, 65536, v42
s_mul_i32 s48, s74, 3
s_add_u32 s48, s48, 2
v_xor_b32 v44, s48, v38
v_lshl_add_u32 v44, v44, 5, v36
v_add_u32 v45, 65536, v44
s_lshl_b32 s48, s74, 1
s_add_u32 s48, s48, 0
v_xor_b32 v46, s48, v39
v_lshl_add_u32 v46, v46, 5, v37
v_add_u32 v47, 65536, v46
s_lshl_b32 s48, s74, 1
s_add_u32 s48, s48, 1
v_xor_b32 v48, s48, v39
v_lshl_add_u32 v48, v48, 5, v37
v_add_u32 v49, 65536, v48
s_lshl1_add_u32 s48, s58, s73
s_lshl_b32 s64, s48, 7
s_mul_i32 s48, s48, 81920
v_and_b32 v30, 1, v21
v_mul_u32_u24 v35, 20480, v30
v_lshrrev_b32 v30, 1, v21
v_lshl_add_u32 v35, v30, 8, v35
v_lshl_add_u32 v35, v11, 4, v35
v_add_u32 v35, s48, v35
s_lshl1_add_u32 s48, s72, s74
s_add_u32 s64, s64, 8192
s_add_u32 s49, s48, 8
s_lshl_b32 s51, 1, s49
v_mov_b32 v8, s51
s_mul_i32 s75, s48, 1536
s_add_u32 s75, s75, 4718592
s_lshl_b32 s77, s48, 10
s_add_u32 s77, s77, 2109440
s_add_u32 s76, s75, 40960
s_add_u32 s78, s77, 40960
s_lshl_b32 s48, s73, 9
s_add_u32 s48, s48, 157696
v_lshl_add_u32 v21, v11, 3, s48
s_mul_i32 s48, s74, 384
s_add_u32 s48, s48, 155648
v_lshl_add_u32 v50, v11, 3, s48
s_lshl_b32 s48, s74, 8
s_add_u32 s48, s48, 156416
v_lshl_add_u32 v51, v11, 3, s48
s_lshl_b32 s48, s73, 10
s_add_u32 s48, s48, 158720
v_lshl_add_u32 v164, v11, 4, s48
v_mov_b32 v130, 0
v_mov_b32 v131, 0
v_mov_b32 v134, 0
v_mov_b32 v135, 0
v_mov_b32 v138, 0
v_mov_b32 v139, 0
v_mov_b32 v142, 0
v_mov_b32 v143, 0
v_mov_b32 v144, 0
v_mov_b32 v145, 0
v_mov_b32 v146, 0
v_mov_b32 v147, 0
v_mov_b32 v148, 0
v_mov_b32 v149, 0
v_mov_b32 v150, 0
v_mov_b32 v151, 0
v_mov_b32 v152, 0
v_mov_b32 v153, 0
v_mov_b32 v154, 0
v_mov_b32 v155, 0
v_mov_b32 v156, 0
v_mov_b32 v157, 0
v_mov_b32 v158, 0
v_mov_b32 v159, 0
v_mov_b32 v160, 0
v_mov_b32 v161, 0
v_mov_b32 v162, 0
v_mov_b32 v163, 0
ds_read_b64 v[6:7], v3 offset:0
s_waitcnt lgkmcnt(0)
v_min_u32 v6, v6, v7
v_cmp_gt_u32 vcc, 1, v6
s_nop 0
s_cbranch_vccnz W1
B2:
ds_read_b128 a[0:3], v33 offset:8192
ds_read_b64_tr_b16 a[44:45], v47 offset:8192
ds_read_b64_tr_b16 a[46:47], v47 offset:8704
ds_read_b128 a[4:7], v33 offset:10240
ds_read_b128 a[8:11], v33 offset:12288
ds_read_b128 a[12:15], v33 offset:14336
ds_read_b64_tr_b16 a[48:49], v49 offset:8192
ds_read_b64_tr_b16 a[50:51], v49 offset:8704
ds_read_b64_tr_b16 a[32:33], v41 offset:8192
ds_read_b64_tr_b16 a[34:35], v41 offset:8960
s_waitcnt lgkmcnt(7)
v_mfma_f32_16x16x32_bf16 v[60:63], a[44:47], a[0:3], 0
ds_read_b64_tr_b16 a[36:37], v43 offset:8192
s_waitcnt lgkmcnt(7)
v_mfma_f32_16x16x32_bf16 v[80:83], a[44:47], a[4:7], 0
ds_read_b64_tr_b16 a[38:39], v43 offset:8960
s_waitcnt lgkmcnt(7)
v_mfma_f32_16x16x32_bf16 v[100:103], a[44:47], a[8:11], 0
s_waitcnt lgkmcnt(6)
v_mfma_f32_16x16x32_bf16 v[120:123], a[44:47], a[12:15], 0
s_waitcnt lgkmcnt(4)
v_mfma_f32_16x16x32_bf16 v[64:67], a[48:51], a[0:3], 0
ds_read_b64_tr_b16 a[40:41], v45 offset:8192
v_mfma_f32_16x16x32_bf16 v[84:87], a[48:51], a[4:7], 0
ds_read_b64_tr_b16 a[42:43], v45 offset:8960
v_mfma_f32_16x16x32_bf16 v[104:107], a[48:51], a[8:11], 0
v_mfma_f32_16x16x32_bf16 v[124:127], a[48:51], a[12:15], 0
s_waitcnt lgkmcnt(4)
v_mfma_f32_16x16x32_bf16 v[36:39], a[32:35], a[0:3], 0
ds_read_b128 a[16:19], v34 offset:8192
v_mfma_f32_16x16x32_bf16 v[68:71], a[32:35], a[4:7], 0
ds_read_b64_tr_b16 a[64:65], v47 offset:12288
v_mfma_f32_16x16x32_bf16 v[88:91], a[32:35], a[8:11], 0
ds_read_b64_tr_b16 a[66:67], v47 offset:12800
v_mfma_f32_16x16x32_bf16 v[108:111], a[32:35], a[12:15], 0
ds_read_b128 a[20:23], v34 offset:10240
s_waitcnt lgkmcnt(6)
v_mfma_f32_16x16x32_bf16 v[52:55], a[36:39], a[0:3], 0
ds_read_b128 a[24:27], v34 offset:12288
v_mfma_f32_16x16x32_bf16 v[72:75], a[36:39], a[4:7], 0
ds_read_b128 a[28:31], v34 offset:14336
v_mfma_f32_16x16x32_bf16 v[92:95], a[36:39], a[8:11], 0
ds_read_b64_tr_b16 a[68:69], v49 offset:12288
v_mfma_f32_16x16x32_bf16 v[112:115], a[36:39], a[12:15], 0
ds_read_b64_tr_b16 a[70:71], v49 offset:12800
s_waitcnt lgkmcnt(8)
v_mfma_f32_16x16x32_bf16 v[56:59], a[40:43], a[0:3], 0
ds_read_b64_tr_b16 a[52:53], v41 offset:14336
v_mfma_f32_16x16x32_bf16 v[76:79], a[40:43], a[4:7], 0
ds_read_b64_tr_b16 a[54:55], v41 offset:15104
ds_read_b64 v[6:7], v3
v_mfma_f32_16x16x32_bf16 v[96:99], a[40:43], a[8:11], 0
v_mfma_f32_16x16x32_bf16 v[116:119], a[40:43], a[12:15], 0
s_waitcnt lgkmcnt(8)
v_mfma_f32_16x16x32_bf16 v[60:63], a[64:67], a[16:19], v[60:63]
ds_read_b64_tr_b16 a[56:57], v43 offset:14336
s_waitcnt lgkmcnt(8)
v_mfma_f32_16x16x32_bf16 v[80:83], a[64:67], a[20:23], v[80:83]
ds_read_b64_tr_b16 a[58:59], v43 offset:15104
s_waitcnt lgkmcnt(8)
v_mfma_f32_16x16x32_bf16 v[100:103], a[64:67], a[24:27], v[100:103]
s_waitcnt lgkmcnt(7)
v_mfma_f32_16x16x32_bf16 v[120:123], a[64:67], a[28:31], v[120:123]
s_waitcnt lgkmcnt(5)
v_mfma_f32_16x16x32_bf16 v[64:67], a[68:71], a[16:19], v[64:67]
ds_read_b64_tr_b16 a[60:61], v45 offset:14336
v_mfma_f32_16x16x32_bf16 v[84:87], a[68:71], a[20:23], v[84:87]
ds_read_b64_tr_b16 a[62:63], v45 offset:15104
v_mov_b32 v9, 1
ds_write_b32 v10, v9
v_mfma_f32_16x16x32_bf16 v[104:107], a[68:71], a[24:27], v[104:107]
v_mfma_f32_16x16x32_bf16 v[124:127], a[68:71], a[28:31], v[124:127]
s_waitcnt lgkmcnt(6)
v_mfma_f32_16x16x32_bf16 v[36:39], a[52:55], a[16:19], v[36:39]
s_waitcnt lgkmcnt(5)
v_min_u32 v6, v6, v7
v_cmp_gt_u32 vcc, 2, v6
s_nop 0
s_cbranch_vccnz W3
B4:
ds_read_b128 a[0:3], v33 offset:45056
v_mfma_f32_16x16x32_bf16 v[68:71], a[52:55], a[20:23], v[68:71]
ds_read_b64_tr_b16 a[44:45], v47 offset:45056
v_mfma_f32_16x16x32_bf16 v[88:91], a[52:55], a[24:27], v[88:91]
ds_read_b64_tr_b16 a[46:47], v47 offset:45568
v_mfma_f32_16x16x32_bf16 v[108:111], a[52:55], a[28:31], v[108:111]
ds_read_b128 a[4:7], v33 offset:47104
s_waitcnt lgkmcnt(7)
v_mfma_f32_16x16x32_bf16 v[52:55], a[56:59], a[16:19], v[52:55]
ds_read_b128 a[8:11], v33 offset:49152
v_mfma_f32_16x16x32_bf16 v[72:75], a[56:59], a[20:23], v[72:75]
ds_read_b128 a[12:15], v33 offset:51200
v_mfma_f32_16x16x32_bf16 v[92:95], a[56:59], a[24:27], v[92:95]
ds_read_b64_tr_b16 a[48:49], v49 offset:45056
v_mfma_f32_16x16x32_bf16 v[112:115], a[56:59], a[28:31], v[112:115]
ds_read_b64_tr_b16 a[50:51], v49 offset:45568
s_waitcnt lgkmcnt(9)
v_mfma_f32_16x16x32_bf16 v[56:59], a[60:63], a[16:19], v[56:59]
ds_read_b64_tr_b16 a[32:33], v41 offset:45056
v_mfma_f32_16x16x32_bf16 v[76:79], a[60:63], a[20:23], v[76:79]
ds_read_b64_tr_b16 a[34:35], v41 offset:45824
v_mfma_f32_16x16x32_bf16 v[96:99], a[60:63], a[24:27], v[96:99]
v_mfma_f32_16x16x32_bf16 v[116:119], a[60:63], a[28:31], v[116:119]
s_waitcnt lgkmcnt(7)
v_mfma_f32_16x16x32_bf16 v[60:63], a[44:47], a[0:3], v[60:63]
ds_read_b64_tr_b16 a[36:37], v43 offset:45056
s_waitcnt lgkmcnt(7)
v_mfma_f32_16x16x32_bf16 v[80:83], a[44:47], a[4:7], v[80:83]
ds_read_b64_tr_b16 a[38:39], v43 offset:45824
s_waitcnt lgkmcnt(7)
v_mfma_f32_16x16x32_bf16 v[100:103], a[44:47], a[8:11], v[100:103]
s_waitcnt lgkmcnt(6)
v_mfma_f32_16x16x32_bf16 v[120:123], a[44:47], a[12:15], v[120:123]
s_waitcnt lgkmcnt(4)
v_mfma_f32_16x16x32_bf16 v[64:67], a[48:51], a[0:3], v[64:67]
ds_read_b64_tr_b16 a[40:41], v45 offset:45056
v_mfma_f32_16x16x32_bf16 v[84:87], a[48:51], a[4:7], v[84:87]
ds_read_b64_tr_b16 a[42:43], v45 offset:45824
v_mfma_f32_16x16x32_bf16 v[104:107], a[48:51], a[8:11], v[104:107]
v_mfma_f32_16x16x32_bf16 v[124:127], a[48:51], a[12:15], v[124:127]
s_waitcnt lgkmcnt(4)
v_mfma_f32_16x16x32_bf16 v[36:39], a[32:35], a[0:3], v[36:39]
ds_read_b128 a[16:19], v34 offset:45056
v_mfma_f32_16x16x32_bf16 v[68:71], a[32:35], a[4:7], v[68:71]
ds_read_b64_tr_b16 a[64:65], v47 offset:49152
v_mfma_f32_16x16x32_bf16 v[88:91], a[32:35], a[8:11], v[88:91]
ds_read_b64_tr_b16 a[66:67], v47 offset:49664
v_mfma_f32_16x16x32_bf16 v[108:111], a[32:35], a[12:15], v[108:111]
ds_read_b128 a[20:23], v34 offset:47104
s_waitcnt lgkmcnt(6)
v_mfma_f32_16x16x32_bf16 v[52:55], a[36:39], a[0:3], v[52:55]
ds_read_b128 a[24:27], v34 offset:49152
v_mfma_f32_16x16x32_bf16 v[72:75], a[36:39], a[4:7], v[72:75]
ds_read_b128 a[28:31], v34 offset:51200
v_mfma_f32_16x16x32_bf16 v[92:95], a[36:39], a[8:11], v[92:95]
ds_read_b64_tr_b16 a[68:69], v49 offset:49152
v_mfma_f32_16x16x32_bf16 v[112:115], a[36:39], a[12:15], v[112:115]
ds_read_b64_tr_b16 a[70:71], v49 offset:49664
s_waitcnt lgkmcnt(8)
v_mfma_f32_16x16x32_bf16 v[56:59], a[40:43], a[0:3], v[56:59]
ds_read_b64_tr_b16 a[52:53], v41 offset:51200
v_mfma_f32_16x16x32_bf16 v[76:79], a[40:43], a[4:7], v[76:79]
ds_read_b64_tr_b16 a[54:55], v41 offset:51968
ds_read_b64 v[6:7], v3
v_mfma_f32_16x16x32_bf16 v[96:99], a[40:43], a[8:11], v[96:99]
v_mfma_f32_16x16x32_bf16 v[116:119], a[40:43], a[12:15], v[116:119]
s_waitcnt lgkmcnt(8)
v_mfma_f32_16x16x32_bf16 v[60:63], a[64:67], a[16:19], v[60:63]
ds_read_b64_tr_b16 a[56:57], v43 offset:51200
s_waitcnt lgkmcnt(8)
v_mfma_f32_16x16x32_bf16 v[80:83], a[64:67], a[20:23], v[80:83]
ds_read_b64_tr_b16 a[58:59], v43 offset:51968
s_waitcnt lgkmcnt(8)
v_mfma_f32_16x16x32_bf16 v[100:103], a[64:67], a[24:27], v[100:103]
s_waitcnt lgkmcnt(7)
v_mfma_f32_16x16x32_bf16 v[120:123], a[64:67], a[28:31], v[120:123]
s_waitcnt lgkmcnt(5)
v_mfma_f32_16x16x32_bf16 v[64:67], a[68:71], a[16:19], v[64:67]
ds_read_b64_tr_b16 a[60:61], v45 offset:51200
v_mfma_f32_16x16x32_bf16 v[84:87], a[68:71], a[20:23], v[84:87]
ds_read_b64_tr_b16 a[62:63], v45 offset:51968
v_mov_b32 v9, 2
ds_write_b32 v10, v9
v_mfma_f32_16x16x32_bf16 v[104:107], a[68:71], a[24:27], v[104:107]
v_mfma_f32_16x16x32_bf16 v[124:127], a[68:71], a[28:31], v[124:127]
s_waitcnt lgkmcnt(6)
v_mfma_f32_16x16x32_bf16 v[36:39], a[52:55], a[16:19], v[36:39]
s_waitcnt lgkmcnt(5)
v_min_u32 v6, v6, v7
v_cmp_gt_u32 vcc, 3, v6
s_nop 0
s_cbranch_vccnz W5
B6:
ds_read_b128 a[0:3], v31 offset:0
v_mfma_f32_16x16x32_bf16 v[68:71], a[52:55], a[20:23], v[68:71]
ds_read_b64_tr_b16 a[44:45], v46 offset:0
v_mfma_f32_16x16x32_bf16 v[88:91], a[52:55], a[24:27], v[88:91]
ds_read_b64_tr_b16 a[46:47], v46 offset:512
v_mfma_f32_16x16x32_bf16 v[108:111], a[52:55], a[28:31], v[108:111]
ds_read_b128 a[4:7], v31 offset:2048
s_waitcnt lgkmcnt(7)
v_mfma_f32_16x16x32_bf16 v[52:55], a[56:59], a[16:19], v[52:55]
ds_read_b128 a[8:11], v31 offset:4096
v_mfma_f32_16x16x32_bf16 v[72:75], a[56:59], a[20:23], v[72:75]
ds_read_b128 a[12:15], v31 offset:6144
v_mfma_f32_16x16x32_bf16 v[92:95], a[56:59], a[24:27], v[92:95]
ds_read_b64_tr_b16 a[48:49], v48 offset:0
v_mfma_f32_16x16x32_bf16 v[112:115], a[56:59], a[28:31], v[112:115]
ds_read_b64_tr_b16 a[50:51], v48 offset:512
s_waitcnt lgkmcnt(9)
v_mfma_f32_16x16x32_bf16 v[56:59], a[60:63], a[16:19], v[56:59]
ds_read_b64_tr_b16 a[32:33], v40 offset:0
v_mfma_f32_16x16x32_bf16 v[76:79], a[60:63], a[20:23], v[76:79]
ds_read_b64_tr_b16 a[34:35], v40 offset:768
v_mfma_f32_16x16x32_bf16 v[96:99], a[60:63], a[24:27], v[96:99]
v_mfma_f32_16x16x32_bf16 v[116:119], a[60:63], a[28:31], v[116:119]
s_waitcnt lgkmcnt(7)
v_mfma_f32_16x16x32_bf16 v[60:63], a[44:47], a[0:3], v[60:63]
ds_read_b64_tr_b16 a[36:37], v42 offset:0
s_waitcnt lgkmcnt(7)
v_mfma_f32_16x16x32_bf16 v[80:83], a[44:47], a[4:7], v[80:83]
ds_read_b64_tr_b16 a[38:39], v42 offset:768
s_waitcnt lgkmcnt(7)
v_mfma_f32_16x16x32_bf16 v[100:103], a[44:47], a[8:11], v[100:103]
s_waitcnt lgkmcnt(6)
v_mfma_f32_16x16x32_bf16 v[120:123], a[44:47], a[12:15], v[120:123]
s_waitcnt lgkmcnt(4)
v_mfma_f32_16x16x32_bf16 v[64:67], a[48:51], a[0:3], v[64:67]
ds_read_b64_tr_b16 a[40:41], v44 offset:0
v_mfma_f32_16x16x32_bf16 v[84:87], a[48:51], a[4:7], v[84:87]
ds_read_b64_tr_b16 a[42:43], v44 offset:768
v_mfma_f32_16x16x32_bf16 v[104:107], a[48:51], a[8:11], v[104:107]
v_mfma_f32_16x16x32_bf16 v[124:127], a[48:51], a[12:15], v[124:127]
s_waitcnt lgkmcnt(4)
v_mfma_f32_16x16x32_bf16 v[36:39], a[32:35], a[0:3], v[36:39]
ds_read_b128 a[16:19], v32 offset:0
v_mfma_f32_16x16x32_bf16 v[68:71], a[32:35], a[4:7], v[68:71]
ds_read_b64_tr_b16 a[64:65], v46 offset:4096
v_mfma_f32_16x16x32_bf16 v[88:91], a[32:35], a[8:11], v[88:91]
ds_read_b64_tr_b16 a[66:67], v46 offset:4608
v_mfma_f32_16x16x32_bf16 v[108:111], a[32:35], a[12:15], v[108:111]
ds_read_b128 a[20:23], v32 offset:2048
s_waitcnt lgkmcnt(6)
v_mfma_f32_16x16x32_bf16 v[52:55], a[36:39], a[0:3], v[52:55]
ds_read_b128 a[24:27], v32 offset:4096
v_mfma_f32_16x16x32_bf16 v[72:75], a[36:39], a[4:7], v[72:75]
ds_read_b128 a[28:31], v32 offset:6144
v_mfma_f32_16x16x32_bf16 v[92:95], a[36:39], a[8:11], v[92:95]
ds_read_b64_tr_b16 a[68:69], v48 offset:4096
v_mfma_f32_16x16x32_bf16 v[112:115], a[36:39], a[12:15], v[112:115]
ds_read_b64_tr_b16 a[70:71], v48 offset:4608
s_waitcnt lgkmcnt(8)
v_mfma_f32_16x16x32_bf16 v[56:59], a[40:43], a[0:3], v[56:59]
ds_read_b64_tr_b16 a[52:53], v40 offset:6144
v_mfma_f32_16x16x32_bf16 v[76:79], a[40:43], a[4:7], v[76:79]
ds_read_b64_tr_b16 a[54:55], v40 offset:6912
ds_read_b64 v[6:7], v3
v_mfma_f32_16x16x32_bf16 v[96:99], a[40:43], a[8:11], v[96:99]
v_mfma_f32_16x16x32_bf16 v[116:119], a[40:43], a[12:15], v[116:119]
s_waitcnt lgkmcnt(8)
v_mfma_f32_16x16x32_bf16 v[60:63], a[64:67], a[16:19], v[60:63]
ds_read_b64_tr_b16 a[56:57], v42 offset:6144
s_waitcnt lgkmcnt(8)
v_mfma_f32_16x16x32_bf16 v[80:83], a[64:67], a[20:23], v[80:83]
ds_read_b64_tr_b16 a[58:59], v42 offset:6912
s_waitcnt lgkmcnt(8)
v_mfma_f32_16x16x32_bf16 v[100:103], a[64:67], a[24:27], v[100:103]
s_waitcnt lgkmcnt(7)
v_mfma_f32_16x16x32_bf16 v[120:123], a[64:67], a[28:31], v[120:123]
s_waitcnt lgkmcnt(5)
v_mfma_f32_16x16x32_bf16 v[64:67], a[68:71], a[16:19], v[64:67]
ds_read_b64_tr_b16 a[60:61], v44 offset:6144
v_mfma_f32_16x16x32_bf16 v[84:87], a[68:71], a[20:23], v[84:87]
ds_read_b64_tr_b16 a[62:63], v44 offset:6912
v_mov_b32 v9, 3
ds_write_b32 v10, v9
v_mfma_f32_16x16x32_bf16 v[104:107], a[68:71], a[24:27], v[104:107]
v_mfma_f32_16x16x32_bf16 v[124:127], a[68:71], a[28:31], v[124:127]
s_waitcnt lgkmcnt(6)
v_mfma_f32_16x16x32_bf16 v[36:39], a[52:55], a[16:19], v[36:39]
s_waitcnt lgkmcnt(5)
v_min_u32 v6, v6, v7
v_cmp_gt_u32 vcc, 4, v6
s_nop 0
s_cbranch_vccnz W7
B8:
ds_read_b128 a[0:3], v31 offset:36864
v_mfma_f32_16x16x32_bf16 v[68:71], a[52:55], a[20:23], v[68:71]
ds_read_b64_tr_b16 a[44:45], v46 offset:36864
v_mfma_f32_16x16x32_bf16 v[88:91], a[52:55], a[24:27], v[88:91]
ds_read_b64_tr_b16 a[46:47], v46 offset:37376
v_mfma_f32_16x16x32_bf16 v[108:111], a[52:55], a[28:31], v[108:111]
ds_read_b128 a[4:7], v31 offset:38912
s_waitcnt lgkmcnt(7)
v_mfma_f32_16x16x32_bf16 v[52:55], a[56:59], a[16:19], v[52:55]
ds_read_b128 a[8:11], v31 offset:40960
v_mfma_f32_16x16x32_bf16 v[72:75], a[56:59], a[20:23], v[72:75]
ds_read_b128 a[12:15], v31 offset:43008
v_mfma_f32_16x16x32_bf16 v[92:95], a[56:59], a[24:27], v[92:95]
ds_read_b64_tr_b16 a[48:49], v48 offset:36864
v_mfma_f32_16x16x32_bf16 v[112:115], a[56:59], a[28:31], v[112:115]
ds_read_b64_tr_b16 a[50:51], v48 offset:37376
s_waitcnt lgkmcnt(9)
v_mfma_f32_16x16x32_bf16 v[56:59], a[60:63], a[16:19], v[56:59]
ds_read_b64_tr_b16 a[32:33], v40 offset:36864
v_mfma_f32_16x16x32_bf16 v[76:79], a[60:63], a[20:23], v[76:79]
ds_read_b64_tr_b16 a[34:35], v40 offset:37632
v_mfma_f32_16x16x32_bf16 v[96:99], a[60:63], a[24:27], v[96:99]
v_mfma_f32_16x16x32_bf16 v[116:119], a[60:63], a[28:31], v[116:119]
s_waitcnt lgkmcnt(7)
v_mfma_f32_16x16x32_bf16 v[60:63], a[44:47], a[0:3], v[60:63]
ds_read_b64_tr_b16 a[36:37], v42 offset:36864
s_waitcnt lgkmcnt(7)
v_mfma_f32_16x16x32_bf16 v[80:83], a[44:47], a[4:7], v[80:83]
ds_read_b64_tr_b16 a[38:39], v42 offset:37632
s_waitcnt lgkmcnt(7)
v_mfma_f32_16x16x32_bf16 v[100:103], a[44:47], a[8:11], v[100:103]
s_waitcnt lgkmcnt(6)
v_mfma_f32_16x16x32_bf16 v[120:123], a[44:47], a[12:15], v[120:123]
s_waitcnt lgkmcnt(4)
v_mfma_f32_16x16x32_bf16 v[64:67], a[48:51], a[0:3], v[64:67]
ds_read_b64_tr_b16 a[40:41], v44 offset:36864
v_mfma_f32_16x16x32_bf16 v[84:87], a[48:51], a[4:7], v[84:87]
ds_read_b64_tr_b16 a[42:43], v44 offset:37632
v_mfma_f32_16x16x32_bf16 v[104:107], a[48:51], a[8:11], v[104:107]
v_mfma_f32_16x16x32_bf16 v[124:127], a[48:51], a[12:15], v[124:127]
s_waitcnt lgkmcnt(4)
v_mfma_f32_16x16x32_bf16 v[36:39], a[32:35], a[0:3], v[36:39]
ds_read_b128 a[16:19], v32 offset:36864
v_mfma_f32_16x16x32_bf16 v[68:71], a[32:35], a[4:7], v[68:71]
ds_read_b64_tr_b16 a[64:65], v46 offset:40960
v_mfma_f32_16x16x32_bf16 v[88:91], a[32:35], a[8:11], v[88:91]
ds_read_b64_tr_b16 a[66:67], v46 offset:41472
v_mfma_f32_16x16x32_bf16 v[108:111], a[32:35], a[12:15], v[108:111]
ds_read_b128 a[20:23], v32 offset:38912
s_waitcnt lgkmcnt(6)
v_mfma_f32_16x16x32_bf16 v[52:55], a[36:39], a[0:3], v[52:55]
ds_read_b128 a[24:27], v32 offset:40960
v_mfma_f32_16x16x32_bf16 v[72:75], a[36:39], a[4:7], v[72:75]
ds_read_b128 a[28:31], v32 offset:43008
v_mfma_f32_16x16x32_bf16 v[92:95], a[36:39], a[8:11], v[92:95]
ds_read_b64_tr_b16 a[68:69], v48 offset:40960
v_mfma_f32_16x16x32_bf16 v[112:115], a[36:39], a[12:15], v[112:115]
ds_read_b64_tr_b16 a[70:71], v48 offset:41472
s_waitcnt lgkmcnt(8)
v_mfma_f32_16x16x32_bf16 v[56:59], a[40:43], a[0:3], v[56:59]
ds_read_b64_tr_b16 a[52:53], v40 offset:43008
v_mfma_f32_16x16x32_bf16 v[76:79], a[40:43], a[4:7], v[76:79]
ds_read_b64_tr_b16 a[54:55], v40 offset:43776
ds_read_b64 v[6:7], v3
v_mfma_f32_16x16x32_bf16 v[96:99], a[40:43], a[8:11], v[96:99]
v_mfma_f32_16x16x32_bf16 v[116:119], a[40:43], a[12:15], v[116:119]
s_waitcnt lgkmcnt(8)
v_mfma_f32_16x16x32_bf16 v[60:63], a[64:67], a[16:19], v[60:63]
ds_read_b64_tr_b16 a[56:57], v42 offset:43008
s_waitcnt lgkmcnt(8)
v_mfma_f32_16x16x32_bf16 v[80:83], a[64:67], a[20:23], v[80:83]
ds_read_b64_tr_b16 a[58:59], v42 offset:43776
s_waitcnt lgkmcnt(8)
v_mfma_f32_16x16x32_bf16 v[100:103], a[64:67], a[24:27], v[100:103]
s_waitcnt lgkmcnt(7)
v_mfma_f32_16x16x32_bf16 v[120:123], a[64:67], a[28:31], v[120:123]
s_waitcnt lgkmcnt(5)
v_mfma_f32_16x16x32_bf16 v[64:67], a[68:71], a[16:19], v[64:67]
ds_read_b64_tr_b16 a[60:61], v44 offset:43008
v_mfma_f32_16x16x32_bf16 v[84:87], a[68:71], a[20:23], v[84:87]
ds_read_b64_tr_b16 a[62:63], v44 offset:43776
v_mov_b32 v9, 4
ds_write_b32 v10, v9
v_mfma_f32_16x16x32_bf16 v[104:107], a[68:71], a[24:27], v[104:107]
v_mfma_f32_16x16x32_bf16 v[124:127], a[68:71], a[28:31], v[124:127]
s_waitcnt lgkmcnt(6)
v_mfma_f32_16x16x32_bf16 v[36:39], a[52:55], a[16:19], v[36:39]
s_waitcnt lgkmcnt(5)
v_min_u32 v6, v6, v7
v_cmp_gt_u32 vcc, 5, v6
s_nop 0
s_cbranch_vccnz W9
B10:
ds_read_b128 a[0:3], v33 offset:8192
v_mfma_f32_16x16x32_bf16 v[68:71], a[52:55], a[20:23], v[68:71]
ds_read_b64_tr_b16 a[44:45], v47 offset:8192
v_mfma_f32_16x16x32_bf16 v[88:91], a[52:55], a[24:27], v[88:91]
ds_read_b64_tr_b16 a[46:47], v47 offset:8704
v_mfma_f32_16x16x32_bf16 v[108:111], a[52:55], a[28:31], v[108:111]
ds_read_b128 a[4:7], v33 offset:10240
s_waitcnt lgkmcnt(7)
v_mfma_f32_16x16x32_bf16 v[52:55], a[56:59], a[16:19], v[52:55]
ds_read_b128 a[8:11], v33 offset:12288
v_mfma_f32_16x16x32_bf16 v[72:75], a[56:59], a[20:23], v[72:75]
ds_read_b128 a[12:15], v33 offset:14336
v_mfma_f32_16x16x32_bf16 v[92:95], a[56:59], a[24:27], v[92:95]
ds_read_b64_tr_b16 a[48:49], v49 offset:8192
v_mfma_f32_16x16x32_bf16 v[112:115], a[56:59], a[28:31], v[112:115]
ds_read_b64_tr_b16 a[50:51], v49 offset:8704
s_waitcnt lgkmcnt(9)
v_mfma_f32_16x16x32_bf16 v[56:59], a[60:63], a[16:19], v[56:59]
ds_read_b64_tr_b16 a[32:33], v41 offset:8192
v_mfma_f32_16x16x32_bf16 v[76:79], a[60:63], a[20:23], v[76:79]
ds_read_b64_tr_b16 a[34:35], v41 offset:8960
v_mfma_f32_16x16x32_bf16 v[96:99], a[60:63], a[24:27], v[96:99]
v_mfma_f32_16x16x32_bf16 v[116:119], a[60:63], a[28:31], v[116:119]
s_waitcnt lgkmcnt(7)
v_mfma_f32_16x16x32_bf16 v[60:63], a[44:47], a[0:3], v[60:63]
ds_read_b64_tr_b16 a[36:37], v43 offset:8192
s_waitcnt lgkmcnt(7)
v_mfma_f32_16x16x32_bf16 v[80:83], a[44:47], a[4:7], v[80:83]
ds_read_b64_tr_b16 a[38:39], v43 offset:8960
s_waitcnt lgkmcnt(7)
v_mfma_f32_16x16x32_bf16 v[100:103], a[44:47], a[8:11], v[100:103]
s_waitcnt lgkmcnt(6)
v_mfma_f32_16x16x32_bf16 v[120:123], a[44:47], a[12:15], v[120:123]
s_waitcnt lgkmcnt(4)
v_mfma_f32_16x16x32_bf16 v[64:67], a[48:51], a[0:3], v[64:67]
ds_read_b64_tr_b16 a[40:41], v45 offset:8192
v_mfma_f32_16x16x32_bf16 v[84:87], a[48:51], a[4:7], v[84:87]
ds_read_b64_tr_b16 a[42:43], v45 offset:8960
v_mfma_f32_16x16x32_bf16 v[104:107], a[48:51], a[8:11], v[104:107]
v_mfma_f32_16x16x32_bf16 v[124:127], a[48:51], a[12:15], v[124:127]
s_waitcnt lgkmcnt(4)
v_mfma_f32_16x16x32_bf16 v[36:39], a[32:35], a[0:3], v[36:39]
ds_read_b128 a[16:19], v34 offset:8192
v_mfma_f32_16x16x32_bf16 v[68:71], a[32:35], a[4:7], v[68:71]
ds_read_b64_tr_b16 a[64:65], v47 offset:12288
v_mfma_f32_16x16x32_bf16 v[88:91], a[32:35], a[8:11], v[88:91]
ds_read_b64_tr_b16 a[66:67], v47 offset:12800
v_mfma_f32_16x16x32_bf16 v[108:111], a[32:35], a[12:15], v[108:111]
ds_read_b128 a[20:23], v34 offset:10240
s_waitcnt lgkmcnt(6)
v_mfma_f32_16x16x32_bf16 v[52:55], a[36:39], a[0:3], v[52:55]
ds_read_b128 a[24:27], v34 offset:12288
v_mfma_f32_16x16x32_bf16 v[72:75], a[36:39], a[4:7], v[72:75]
ds_read_b128 a[28:31], v34 offset:14336
v_mfma_f32_16x16x32_bf16 v[92:95], a[36:39], a[8:11], v[92:95]
ds_read_b64_tr_b16 a[68:69], v49 offset:12288
v_mfma_f32_16x16x32_bf16 v[112:115], a[36:39], a[12:15], v[112:115]
ds_read_b64_tr_b16 a[70:71], v49 offset:12800
s_waitcnt lgkmcnt(8)
v_mfma_f32_16x16x32_bf16 v[56:59], a[40:43], a[0:3], v[56:59]
ds_read_b64_tr_b16 a[52:53], v41 offset:14336
v_mfma_f32_16x16x32_bf16 v[76:79], a[40:43], a[4:7], v[76:79]
ds_read_b64_tr_b16 a[54:55], v41 offset:15104
ds_read_b64 v[6:7], v3
v_mfma_f32_16x16x32_bf16 v[96:99], a[40:43], a[8:11], v[96:99]
v_mfma_f32_16x16x32_bf16 v[116:119], a[40:43], a[12:15], v[116:119]
s_waitcnt lgkmcnt(8)
v_mfma_f32_16x16x32_bf16 v[60:63], a[64:67], a[16:19], v[60:63]
ds_read_b64_tr_b16 a[56:57], v43 offset:14336
s_waitcnt lgkmcnt(8)
v_mfma_f32_16x16x32_bf16 v[80:83], a[64:67], a[20:23], v[80:83]
ds_read_b64_tr_b16 a[58:59], v43 offset:15104
s_waitcnt lgkmcnt(8)
v_mfma_f32_16x16x32_bf16 v[100:103], a[64:67], a[24:27], v[100:103]
s_waitcnt lgkmcnt(7)
v_mfma_f32_16x16x32_bf16 v[120:123], a[64:67], a[28:31], v[120:123]
s_waitcnt lgkmcnt(5)
v_mfma_f32_16x16x32_bf16 v[64:67], a[68:71], a[16:19], v[64:67]
ds_read_b64_tr_b16 a[60:61], v45 offset:14336
v_mfma_f32_16x16x32_bf16 v[84:87], a[68:71], a[20:23], v[84:87]
ds_read_b64_tr_b16 a[62:63], v45 offset:15104
v_mov_b32 v9, 5
ds_write_b32 v10, v9
v_mfma_f32_16x16x32_bf16 v[104:107], a[68:71], a[24:27], v[104:107]
v_mfma_f32_16x16x32_bf16 v[124:127], a[68:71], a[28:31], v[124:127]
s_waitcnt lgkmcnt(6)
v_mfma_f32_16x16x32_bf16 v[36:39], a[52:55], a[16:19], v[36:39]
s_waitcnt lgkmcnt(5)
v_min_u32 v6, v6, v7
v_cmp_gt_u32 vcc, 6, v6
s_nop 0
s_cbranch_vccnz W11
B12:
ds_read_b128 a[0:3], v33 offset:45056
v_mfma_f32_16x16x32_bf16 v[68:71], a[52:55], a[20:23], v[68:71]
ds_read_b64_tr_b16 a[44:45], v47 offset:45056
v_mfma_f32_16x16x32_bf16 v[88:91], a[52:55], a[24:27], v[88:91]
ds_read_b64_tr_b16 a[46:47], v47 offset:45568
v_mfma_f32_16x16x32_bf16 v[108:111], a[52:55], a[28:31], v[108:111]
ds_read_b128 a[4:7], v33 offset:47104
s_waitcnt lgkmcnt(7)
v_mfma_f32_16x16x32_bf16 v[52:55], a[56:59], a[16:19], v[52:55]
ds_read_b128 a[8:11], v33 offset:49152
v_mfma_f32_16x16x32_bf16 v[72:75], a[56:59], a[20:23], v[72:75]
ds_read_b128 a[12:15], v33 offset:51200
v_mfma_f32_16x16x32_bf16 v[92:95], a[56:59], a[24:27], v[92:95]
ds_read_b64_tr_b16 a[48:49], v49 offset:45056
v_mfma_f32_16x16x32_bf16 v[112:115], a[56:59], a[28:31], v[112:115]
ds_read_b64_tr_b16 a[50:51], v49 offset:45568
s_waitcnt lgkmcnt(9)
v_mfma_f32_16x16x32_bf16 v[56:59], a[60:63], a[16:19], v[56:59]
ds_read_b64_tr_b16 a[32:33], v41 offset:45056
v_mfma_f32_16x16x32_bf16 v[76:79], a[60:63], a[20:23], v[76:79]
ds_read_b64_tr_b16 a[34:35], v41 offset:45824
v_mfma_f32_16x16x32_bf16 v[96:99], a[60:63], a[24:27], v[96:99]
v_mfma_f32_16x16x32_bf16 v[116:119], a[60:63], a[28:31], v[116:119]
s_waitcnt lgkmcnt(7)
v_mfma_f32_16x16x32_bf16 v[60:63], a[44:47], a[0:3], v[60:63]
ds_read_b64_tr_b16 a[36:37], v43 offset:45056
s_waitcnt lgkmcnt(7)
v_mfma_f32_16x16x32_bf16 v[80:83], a[44:47], a[4:7], v[80:83]
ds_read_b64_tr_b16 a[38:39], v43 offset:45824
s_waitcnt lgkmcnt(7)
v_mfma_f32_16x16x32_bf16 v[100:103], a[44:47], a[8:11], v[100:103]
s_waitcnt lgkmcnt(6)
v_mfma_f32_16x16x32_bf16 v[120:123], a[44:47], a[12:15], v[120:123]
s_waitcnt lgkmcnt(4)
v_mfma_f32_16x16x32_bf16 v[64:67], a[48:51], a[0:3], v[64:67]
ds_read_b64_tr_b16 a[40:41], v45 offset:45056
v_mfma_f32_16x16x32_bf16 v[84:87], a[48:51], a[4:7], v[84:87]
ds_read_b64_tr_b16 a[42:43], v45 offset:45824
v_mfma_f32_16x16x32_bf16 v[104:107], a[48:51], a[8:11], v[104:107]
v_mfma_f32_16x16x32_bf16 v[124:127], a[48:51], a[12:15], v[124:127]
s_waitcnt lgkmcnt(4)
v_mfma_f32_16x16x32_bf16 v[36:39], a[32:35], a[0:3], v[36:39]
ds_read_b128 a[16:19], v34 offset:45056
v_mfma_f32_16x16x32_bf16 v[68:71], a[32:35], a[4:7], v[68:71]
ds_read_b64_tr_b16 a[64:65], v47 offset:49152
v_mfma_f32_16x16x32_bf16 v[88:91], a[32:35], a[8:11], v[88:91]
ds_read_b64_tr_b16 a[66:67], v47 offset:49664
v_mfma_f32_16x16x32_bf16 v[108:111], a[32:35], a[12:15], v[108:111]
ds_read_b128 a[20:23], v34 offset:47104
s_waitcnt lgkmcnt(6)
v_mfma_f32_16x16x32_bf16 v[52:55], a[36:39], a[0:3], v[52:55]
ds_read_b128 a[24:27], v34 offset:49152
v_mfma_f32_16x16x32_bf16 v[72:75], a[36:39], a[4:7], v[72:75]
ds_read_b128 a[28:31], v34 offset:51200
v_mfma_f32_16x16x32_bf16 v[92:95], a[36:39], a[8:11], v[92:95]
ds_read_b64_tr_b16 a[68:69], v49 offset:49152
v_mfma_f32_16x16x32_bf16 v[112:115], a[36:39], a[12:15], v[112:115]
ds_read_b64_tr_b16 a[70:71], v49 offset:49664
s_waitcnt lgkmcnt(8)
v_mfma_f32_16x16x32_bf16 v[56:59], a[40:43], a[0:3], v[56:59]
ds_read_b64_tr_b16 a[52:53], v41 offset:51200
v_mfma_f32_16x16x32_bf16 v[76:79], a[40:43], a[4:7], v[76:79]
ds_read_b64_tr_b16 a[54:55], v41 offset:51968
ds_read_b64 v[6:7], v3
v_mfma_f32_16x16x32_bf16 v[96:99], a[40:43], a[8:11], v[96:99]
v_mfma_f32_16x16x32_bf16 v[116:119], a[40:43], a[12:15], v[116:119]
s_waitcnt lgkmcnt(8)
v_mfma_f32_16x16x32_bf16 v[60:63], a[64:67], a[16:19], v[60:63]
ds_read_b64_tr_b16 a[56:57], v43 offset:51200
s_waitcnt lgkmcnt(8)
v_mfma_f32_16x16x32_bf16 v[80:83], a[64:67], a[20:23], v[80:83]
ds_read_b64_tr_b16 a[58:59], v43 offset:51968
s_waitcnt lgkmcnt(8)
v_mfma_f32_16x16x32_bf16 v[100:103], a[64:67], a[24:27], v[100:103]
s_waitcnt lgkmcnt(7)
v_mfma_f32_16x16x32_bf16 v[120:123], a[64:67], a[28:31], v[120:123]
s_waitcnt lgkmcnt(5)
v_mfma_f32_16x16x32_bf16 v[64:67], a[68:71], a[16:19], v[64:67]
ds_read_b64_tr_b16 a[60:61], v45 offset:51200
v_mfma_f32_16x16x32_bf16 v[84:87], a[68:71], a[20:23], v[84:87]
ds_read_b64_tr_b16 a[62:63], v45 offset:51968
v_mov_b32 v9, 6
ds_write_b32 v10, v9
v_mfma_f32_16x16x32_bf16 v[104:107], a[68:71], a[24:27], v[104:107]
v_mfma_f32_16x16x32_bf16 v[124:127], a[68:71], a[28:31], v[124:127]
s_waitcnt lgkmcnt(6)
v_mfma_f32_16x16x32_bf16 v[36:39], a[52:55], a[16:19], v[36:39]
s_waitcnt lgkmcnt(5)
v_min_u32 v6, v6, v7
v_cmp_gt_u32 vcc, 7, v6
s_nop 0
s_cbranch_vccnz W13
B14:
ds_read_b128 a[0:3], v31 offset:0
v_mfma_f32_16x16x32_bf16 v[68:71], a[52:55], a[20:23], v[68:71]
ds_read_b64_tr_b16 a[44:45], v46 offset:0
v_mfma_f32_16x16x32_bf16 v[88:91], a[52:55], a[24:27], v[88:91]
ds_read_b64_tr_b16 a[46:47], v46 offset:512
v_mfma_f32_16x16x32_bf16 v[108:111], a[52:55], a[28:31], v[108:111]
ds_read_b128 a[4:7], v31 offset:2048
s_waitcnt lgkmcnt(7)
v_mfma_f32_16x16x32_bf16 v[52:55], a[56:59], a[16:19], v[52:55]
ds_read_b128 a[8:11], v31 offset:4096
v_mfma_f32_16x16x32_bf16 v[72:75], a[56:59], a[20:23], v[72:75]
ds_read_b128 a[12:15], v31 offset:6144
v_mfma_f32_16x16x32_bf16 v[92:95], a[56:59], a[24:27], v[92:95]
ds_read_b64_tr_b16 a[48:49], v48 offset:0
v_mfma_f32_16x16x32_bf16 v[112:115], a[56:59], a[28:31], v[112:115]
ds_read_b64_tr_b16 a[50:51], v48 offset:512
s_waitcnt lgkmcnt(9)
v_mfma_f32_16x16x32_bf16 v[56:59], a[60:63], a[16:19], v[56:59]
ds_read_b64_tr_b16 a[32:33], v40 offset:0
v_mfma_f32_16x16x32_bf16 v[76:79], a[60:63], a[20:23], v[76:79]
ds_read_b64_tr_b16 a[34:35], v40 offset:768
v_mfma_f32_16x16x32_bf16 v[96:99], a[60:63], a[24:27], v[96:99]
v_mfma_f32_16x16x32_bf16 v[116:119], a[60:63], a[28:31], v[116:119]
s_waitcnt lgkmcnt(7)
v_mfma_f32_16x16x32_bf16 v[60:63], a[44:47], a[0:3], v[60:63]
ds_read_b64_tr_b16 a[36:37], v42 offset:0
s_waitcnt lgkmcnt(7)
v_mfma_f32_16x16x32_bf16 v[80:83], a[44:47], a[4:7], v[80:83]
ds_read_b64_tr_b16 a[38:39], v42 offset:768
s_waitcnt lgkmcnt(7)
v_mfma_f32_16x16x32_bf16 v[100:103], a[44:47], a[8:11], v[100:103]
s_waitcnt lgkmcnt(6)
v_mfma_f32_16x16x32_bf16 v[120:123], a[44:47], a[12:15], v[120:123]
s_waitcnt lgkmcnt(4)
v_mfma_f32_16x16x32_bf16 v[64:67], a[48:51], a[0:3], v[64:67]
ds_read_b64_tr_b16 a[40:41], v44 offset:0
v_mfma_f32_16x16x32_bf16 v[84:87], a[48:51], a[4:7], v[84:87]
ds_read_b64_tr_b16 a[42:43], v44 offset:768
v_mfma_f32_16x16x32_bf16 v[104:107], a[48:51], a[8:11], v[104:107]
v_mfma_f32_16x16x32_bf16 v[124:127], a[48:51], a[12:15], v[124:127]
s_waitcnt lgkmcnt(4)
v_mfma_f32_16x16x32_bf16 v[36:39], a[32:35], a[0:3], v[36:39]
ds_read_b128 a[16:19], v32 offset:0
v_mfma_f32_16x16x32_bf16 v[68:71], a[32:35], a[4:7], v[68:71]
ds_read_b64_tr_b16 a[64:65], v46 offset:4096
v_mfma_f32_16x16x32_bf16 v[88:91], a[32:35], a[8:11], v[88:91]
ds_read_b64_tr_b16 a[66:67], v46 offset:4608
v_mfma_f32_16x16x32_bf16 v[108:111], a[32:35], a[12:15], v[108:111]
ds_read_b128 a[20:23], v32 offset:2048
s_waitcnt lgkmcnt(6)
v_mfma_f32_16x16x32_bf16 v[52:55], a[36:39], a[0:3], v[52:55]
ds_read_b128 a[24:27], v32 offset:4096
v_mfma_f32_16x16x32_bf16 v[72:75], a[36:39], a[4:7], v[72:75]
ds_read_b128 a[28:31], v32 offset:6144
v_mfma_f32_16x16x32_bf16 v[92:95], a[36:39], a[8:11], v[92:95]
ds_read_b64_tr_b16 a[68:69], v48 offset:4096
v_mfma_f32_16x16x32_bf16 v[112:115], a[36:39], a[12:15], v[112:115]
ds_read_b64_tr_b16 a[70:71], v48 offset:4608
s_waitcnt lgkmcnt(8)
v_mfma_f32_16x16x32_bf16 v[56:59], a[40:43], a[0:3], v[56:59]
ds_read_b64_tr_b16 a[52:53], v40 offset:6144
v_mfma_f32_16x16x32_bf16 v[76:79], a[40:43], a[4:7], v[76:79]
ds_read_b64_tr_b16 a[54:55], v40 offset:6912
ds_read_b64 v[6:7], v3
v_mfma_f32_16x16x32_bf16 v[96:99], a[40:43], a[8:11], v[96:99]
v_mfma_f32_16x16x32_bf16 v[116:119], a[40:43], a[12:15], v[116:119]
s_waitcnt lgkmcnt(8)
v_mfma_f32_16x16x32_bf16 v[60:63], a[64:67], a[16:19], v[60:63]
ds_read_b64_tr_b16 a[56:57], v42 offset:6144
s_waitcnt lgkmcnt(8)
v_mfma_f32_16x16x32_bf16 v[80:83], a[64:67], a[20:23], v[80:83]
ds_read_b64_tr_b16 a[58:59], v42 offset:6912
s_waitcnt lgkmcnt(8)
v_mfma_f32_16x16x32_bf16 v[100:103], a[64:67], a[24:27], v[100:103]
s_waitcnt lgkmcnt(7)
v_mfma_f32_16x16x32_bf16 v[120:123], a[64:67], a[28:31], v[120:123]
s_waitcnt lgkmcnt(5)
v_mfma_f32_16x16x32_bf16 v[64:67], a[68:71], a[16:19], v[64:67]
ds_read_b64_tr_b16 a[60:61], v44 offset:6144
v_mfma_f32_16x16x32_bf16 v[84:87], a[68:71], a[20:23], v[84:87]
ds_read_b64_tr_b16 a[62:63], v44 offset:6912
v_mov_b32 v9, 7
ds_write_b32 v10, v9
v_mfma_f32_16x16x32_bf16 v[104:107], a[68:71], a[24:27], v[104:107]
v_mfma_f32_16x16x32_bf16 v[124:127], a[68:71], a[28:31], v[124:127]
s_waitcnt lgkmcnt(6)
v_mfma_f32_16x16x32_bf16 v[36:39], a[52:55], a[16:19], v[36:39]
s_waitcnt lgkmcnt(5)
v_min_u32 v6, v6, v7
v_cmp_gt_u32 vcc, 8, v6
s_nop 0
s_cbranch_vccnz W15
B16:
ds_read_b128 a[0:3], v31 offset:36864
v_mfma_f32_16x16x32_bf16 v[68:71], a[52:55], a[20:23], v[68:71]
ds_read_b64_tr_b16 a[44:45], v46 offset:36864
v_mfma_f32_16x16x32_bf16 v[88:91], a[52:55], a[24:27], v[88:91]
ds_read_b64_tr_b16 a[46:47], v46 offset:37376
v_mfma_f32_16x16x32_bf16 v[108:111], a[52:55], a[28:31], v[108:111]
ds_read_b128 a[4:7], v31 offset:38912
s_waitcnt lgkmcnt(7)
v_mfma_f32_16x16x32_bf16 v[52:55], a[56:59], a[16:19], v[52:55]
ds_read_b128 a[8:11], v31 offset:40960
v_mfma_f32_16x16x32_bf16 v[72:75], a[56:59], a[20:23], v[72:75]
ds_read_b128 a[12:15], v31 offset:43008
v_mfma_f32_16x16x32_bf16 v[92:95], a[56:59], a[24:27], v[92:95]
ds_read_b64_tr_b16 a[48:49], v48 offset:36864
v_mfma_f32_16x16x32_bf16 v[112:115], a[56:59], a[28:31], v[112:115]
ds_read_b64_tr_b16 a[50:51], v48 offset:37376
s_waitcnt lgkmcnt(9)
v_mfma_f32_16x16x32_bf16 v[56:59], a[60:63], a[16:19], v[56:59]
ds_read_b64_tr_b16 a[32:33], v40 offset:36864
v_mfma_f32_16x16x32_bf16 v[76:79], a[60:63], a[20:23], v[76:79]
ds_read_b64_tr_b16 a[34:35], v40 offset:37632
v_mfma_f32_16x16x32_bf16 v[96:99], a[60:63], a[24:27], v[96:99]
v_mfma_f32_16x16x32_bf16 v[116:119], a[60:63], a[28:31], v[116:119]
s_waitcnt lgkmcnt(7)
v_mfma_f32_16x16x32_bf16 v[60:63], a[44:47], a[0:3], v[60:63]
ds_read_b64_tr_b16 a[36:37], v42 offset:36864
s_waitcnt lgkmcnt(7)
v_mfma_f32_16x16x32_bf16 v[80:83], a[44:47], a[4:7], v[80:83]
ds_read_b64_tr_b16 a[38:39], v42 offset:37632
s_waitcnt lgkmcnt(7)
v_mfma_f32_16x16x32_bf16 v[100:103], a[44:47], a[8:11], v[100:103]
s_waitcnt lgkmcnt(6)
v_mfma_f32_16x16x32_bf16 v[120:123], a[44:47], a[12:15], v[120:123]
s_waitcnt lgkmcnt(4)
v_mfma_f32_16x16x32_bf16 v[64:67], a[48:51], a[0:3], v[64:67]
ds_read_b64_tr_b16 a[40:41], v44 offset:36864
v_mfma_f32_16x16x32_bf16 v[84:87], a[48:51], a[4:7], v[84:87]
ds_read_b64_tr_b16 a[42:43], v44 offset:37632
v_mfma_f32_16x16x32_bf16 v[104:107], a[48:51], a[8:11], v[104:107]
v_mfma_f32_16x16x32_bf16 v[124:127], a[48:51], a[12:15], v[124:127]
s_waitcnt lgkmcnt(4)
v_mfma_f32_16x16x32_bf16 v[36:39], a[32:35], a[0:3], v[36:39]
ds_read_b128 a[16:19], v32 offset:36864
v_mfma_f32_16x16x32_bf16 v[68:71], a[32:35], a[4:7], v[68:71]
ds_read_b64_tr_b16 a[64:65], v46 offset:40960
ds_read_b32 v6, v3 offset:36
s_waitcnt lgkmcnt(0)
v_cmp_gt_u32 vcc, 1, v6
s_nop 0
s_cbranch_vccnz W17
B18:
s_mov_b64 exec, 0xffff
ds_read_b64 v[144:145], v50 offset:0
ds_read_b64 v[148:149], v50 offset:128
ds_read_b64 v[152:153], v50 offset:256
ds_read_b64 v[156:157], v51 offset:0
ds_read_b64 v[160:161], v51 offset:128
s_mov_b64 exec, -1
v_mfma_f32_16x16x32_bf16 v[88:91], a[32:35], a[8:11], v[88:91]
ds_read_b64_tr_b16 a[66:67], v46 offset:41472
ds_read_b64 v[128:129], v21 offset:0
v_mfma_f32_16x16x32_bf16 v[108:111], a[32:35], a[12:15], v[108:111]
ds_read_b128 a[20:23], v32 offset:38912
ds_read_b64 v[132:133], v21 offset:128
v_mfma_f32_16x16x32_bf16 v[52:55], a[36:39], a[0:3], v[52:55]
ds_read_b128 a[24:27], v32 offset:40960
ds_read_b64 v[136:137], v21 offset:256
v_mfma_f32_16x16x32_bf16 v[72:75], a[36:39], a[4:7], v[72:75]
ds_read_b128 a[28:31], v32 offset:43008
ds_read_b64 v[140:141], v21 offset:384
v_mfma_f32_16x16x32_bf16 v[92:95], a[36:39], a[8:11], v[92:95]
ds_read_b64_tr_b16 a[68:69], v48 offset:40960
ds_read_b32 v2, v3 offset:76
v_mfma_f32_16x16x32_bf16 v[112:115], a[36:39], a[12:15], v[112:115]
ds_read_b64_tr_b16 a[70:71], v48 offset:41472
s_lshl_b32 s48, s52, 7
s_add_u32 s48, s48, 161280
v_lshl_add_u32 v30, v11, 3, s48
v_mfma_f32_16x16x32_bf16 v[56:59], a[40:43], a[0:3], v[56:59]
ds_read_b64_tr_b16 a[52:53], v40 offset:43008
ds_read_b64 v[22:23], v30
v_mfma_f32_16x16x32_bf16 v[76:79], a[40:43], a[4:7], v[76:79]
ds_read_b64_tr_b16 a[54:55], v40 offset:43776
ds_read_b64 v[6:7], v3
v_and_b32 v30, 31, v1
v_mfma_f32_16x16x32_bf16 v[96:99], a[40:43], a[8:11], v[96:99]
v_lshlrev_b32 v30, 3, v30
v_add_u32 v30, 155648, v30
v_mfma_f32_16x16x32_bf16 v[116:119], a[40:43], a[12:15], v[116:119]
ds_read_b64 v[24:25], v30 offset:1280
ds_read_b64 v[26:27], v30 offset:1536
s_waitcnt lgkmcnt(15)
v_mfma_f32_16x16x32_bf16 v[60:63], a[64:67], a[16:19], v[60:63]
ds_read_b64_tr_b16 a[56:57], v42 offset:43008
ds_read_b64 v[28:29], v30 offset:1792
s_waitcnt lgkmcnt(15)
v_mfma_f32_16x16x32_bf16 v[80:83], a[64:67], a[20:23], v[80:83]
ds_read_b64_tr_b16 a[58:59], v42 offset:43776
s_waitcnt lgkmcnt(10)
v_readfirstlane_b32 s53, v2
v_mfma_f32_16x16x32_bf16 v[100:103], a[64:67], a[24:27], v[100:103]
v_mfma_f32_16x16x32_bf16 v[120:123], a[64:67], a[28:31], v[120:123]
s_waitcnt lgkmcnt(9)
v_mfma_f32_16x16x32_bf16 v[64:67], a[68:71], a[16:19], v[64:67]
ds_read_b64_tr_b16 a[60:61], v44 offset:43008
v_mfma_f32_16x16x32_bf16 v[84:87], a[68:71], a[20:23], v[84:87]
ds_read_b64_tr_b16 a[62:63], v44 offset:43776
v_mov_b32 v9, 8
ds_write_b32 v10, v9
v_mfma_f32_16x16x32_bf16 v[104:107], a[68:71], a[24:27], v[104:107]
v_mfma_f32_16x16x32_bf16 v[124:127], a[68:71], a[28:31], v[124:127]
s_waitcnt lgkmcnt(9)
v_mfma_f32_16x16x32_bf16 v[36:39], a[52:55], a[16:19], v[36:39]
s_waitcnt lgkmcnt(8)
v_min_u32 v6, v6, v7
v_cmp_gt_u32 vcc, 9, v6
s_nop 0
s_cbranch_vccnz W19
B20:
ds_read_b128 a[0:3], v33 offset:8192
v_mfma_f32_16x16x32_bf16 v[68:71], a[52:55], a[20:23], v[68:71]
ds_read_b64_tr_b16 a[44:45], v47 offset:8192
v_mfma_f32_16x16x32_bf16 v[88:91], a[52:55], a[24:27], v[88:91]
ds_read_b64_tr_b16 a[46:47], v47 offset:8704
v_mfma_f32_16x16x32_bf16 v[108:111], a[52:55], a[28:31], v[108:111]
ds_read_b128 a[4:7], v33 offset:10240
s_waitcnt lgkmcnt(7)
v_mfma_f32_16x16x32_bf16 v[52:55], a[56:59], a[16:19], v[52:55]
ds_read_b128 a[8:11], v33 offset:12288
v_mfma_f32_16x16x32_bf16 v[72:75], a[56:59], a[20:23], v[72:75]
ds_read_b128 a[12:15], v33 offset:14336
v_mfma_f32_16x16x32_bf16 v[92:95], a[56:59], a[24:27], v[92:95]
ds_read_b64_tr_b16 a[48:49], v49 offset:8192
v_mfma_f32_16x16x32_bf16 v[112:115], a[56:59], a[28:31], v[112:115]
ds_read_b64_tr_b16 a[50:51], v49 offset:8704
s_waitcnt lgkmcnt(9)
v_mfma_f32_16x16x32_bf16 v[56:59], a[60:63], a[16:19], v[56:59]
ds_read_b64_tr_b16 a[32:33], v41 offset:8192
v_mfma_f32_16x16x32_bf16 v[76:79], a[60:63], a[20:23], v[76:79]
ds_read_b64_tr_b16 a[34:35], v41 offset:8960
v_mfma_f32_16x16x32_bf16 v[96:99], a[60:63], a[24:27], v[96:99]
v_mfma_f32_16x16x32_bf16 v[116:119], a[60:63], a[28:31], v[116:119]
s_waitcnt lgkmcnt(7)
v_mfma_f32_16x16x32_bf16 v[60:63], a[44:47], a[0:3], v[60:63]
ds_read_b64_tr_b16 a[36:37], v43 offset:8192
s_waitcnt lgkmcnt(7)
v_mfma_f32_16x16x32_bf16 v[80:83], a[44:47], a[4:7], v[80:83]
ds_read_b64_tr_b16 a[38:39], v43 offset:8960
s_waitcnt lgkmcnt(7)
v_mfma_f32_16x16x32_bf16 v[100:103], a[44:47], a[8:11], v[100:103]
s_waitcnt lgkmcnt(6)
v_mfma_f32_16x16x32_bf16 v[120:123], a[44:47], a[12:15], v[120:123]
s_waitcnt lgkmcnt(4)
v_mfma_f32_16x16x32_bf16 v[64:67], a[48:51], a[0:3], v[64:67]
ds_read_b64_tr_b16 a[40:41], v45 offset:8192
v_mfma_f32_16x16x32_bf16 v[84:87], a[48:51], a[4:7], v[84:87]
ds_read_b64_tr_b16 a[42:43], v45 offset:8960
v_mfma_f32_16x16x32_bf16 v[104:107], a[48:51], a[8:11], v[104:107]
v_mfma_f32_16x16x32_bf16 v[124:127], a[48:51], a[12:15], v[124:127]
s_waitcnt lgkmcnt(4)
v_mfma_f32_16x16x32_bf16 v[36:39], a[32:35], a[0:3], v[36:39]
v_mfma_f32_16x16x32_bf16 v[68:71], a[32:35], a[4:7], v[68:71]
v_mfma_f32_16x16x32_bf16 v[88:91], a[32:35], a[8:11], v[88:91]
v_mfma_f32_16x16x32_bf16 v[108:111], a[32:35], a[12:15], v[108:111]
s_waitcnt lgkmcnt(2)
v_mfma_f32_16x16x32_bf16 v[52:55], a[36:39], a[0:3], v[52:55]
v_mfma_f32_16x16x32_bf16 v[72:75], a[36:39], a[4:7], v[72:75]
v_mfma_f32_16x16x32_bf16 v[92:95], a[36:39], a[8:11], v[92:95]
v_mfma_f32_16x16x32_bf16 v[112:115], a[36:39], a[12:15], v[112:115]
s_waitcnt lgkmcnt(0)
v_mfma_f32_16x16x32_bf16 v[56:59], a[40:43], a[0:3], v[56:59]
v_mfma_f32_16x16x32_bf16 v[76:79], a[40:43], a[4:7], v[76:79]
v_mfma_f32_16x16x32_bf16 v[96:99], a[40:43], a[8:11], v[96:99]
v_mfma_f32_16x16x32_bf16 v[116:119], a[40:43], a[12:15], v[116:119]
v_mfma_f32_16x16x32_bf16 v[36:39], v[144:147], v[128:131], v[36:39]
v_mfma_f32_16x16x32_bf16 v[68:71], v[144:147], v[132:135], v[68:71]
v_mfma_f32_16x16x32_bf16 v[88:91], v[144:147], v[136:139], v[88:91]
v_mfma_f32_16x16x32_bf16 v[108:111], v[144:147], v[140:143], v[108:111]
v_mfma_f32_16x16x32_bf16 v[52:55], v[148:151], v[128:131], v[52:55]
v_mfma_f32_16x16x32_bf16 v[72:75], v[148:151], v[132:135], v[72:75]
v_mfma_f32_16x16x32_bf16 v[92:95], v[148:151], v[136:139], v[92:95]
v_mfma_f32_16x16x32_bf16 v[112:115], v[148:151], v[140:143], v[112:115]
v_mfma_f32_16x16x32_bf16 v[56:59], v[152:155], v[128:131], v[56:59]
ds_read_b128 a[16:19], v34 offset:8192
v_mfma_f32_16x16x32_bf16 v[76:79], v[152:155], v[132:135], v[76:79]
ds_read_b64_tr_b16 a[64:65], v47 offset:12288
v_mfma_f32_16x16x32_bf16 v[96:99], v[152:155], v[136:139], v[96:99]
ds_read_b64_tr_b16 a[66:67], v47 offset:12800
v_mfma_f32_16x16x32_bf16 v[116:119], v[152:155], v[140:143], v[116:119]
ds_read_b128 a[20:23], v34 offset:10240
v_mfma_f32_16x16x32_bf16 v[60:63], v[156:159], v[128:131], v[60:63]
ds_read_b128 a[24:27], v34 offset:12288
v_mfma_f32_16x16x32_bf16 v[80:83], v[156:159], v[132:135], v[80:83]
ds_read_b128 a[28:31], v34 offset:14336
v_mfma_f32_16x16x32_bf16 v[100:103], v[156:159], v[136:139], v[100:103]
ds_read_b64_tr_b16 a[68:69], v49 offset:12288
v_mfma_f32_16x16x32_bf16 v[120:123], v[156:159], v[140:143], v[120:123]
ds_read_b64_tr_b16 a[70:71], v49 offset:12800
v_mfma_f32_16x16x32_bf16 v[64:67], v[160:163], v[128:131], v[64:67]
ds_read_b64_tr_b16 a[52:53], v41 offset:14336
v_mfma_f32_16x16x32_bf16 v[84:87], v[160:163], v[132:135], v[84:87]
ds_read_b64_tr_b16 a[54:55], v41 offset:15104
ds_read_b64 v[6:7], v3
v_mfma_f32_16x16x32_bf16 v[104:107], v[160:163], v[136:139], v[104:107]
v_mfma_f32_16x16x32_bf16 v[124:127], v[160:163], v[140:143], v[124:127]
s_waitcnt lgkmcnt(8)
v_mfma_f32_16x16x32_bf16 v[60:63], a[64:67], a[16:19], v[60:63]
ds_read_b64_tr_b16 a[56:57], v43 offset:14336
s_waitcnt lgkmcnt(8)
v_mfma_f32_16x16x32_bf16 v[80:83], a[64:67], a[20:23], v[80:83]
ds_read_b64_tr_b16 a[58:59], v43 offset:15104
s_waitcnt lgkmcnt(8)
v_mfma_f32_16x16x32_bf16 v[100:103], a[64:67], a[24:27], v[100:103]
s_waitcnt lgkmcnt(7)
v_mfma_f32_16x16x32_bf16 v[120:123], a[64:67], a[28:31], v[120:123]
s_waitcnt lgkmcnt(5)
v_mfma_f32_16x16x32_bf16 v[64:67], a[68:71], a[16:19], v[64:67]
ds_read_b64_tr_b16 a[60:61], v45 offset:14336
v_mfma_f32_16x16x32_bf16 v[84:87], a[68:71], a[20:23], v[84:87]
ds_read_b64_tr_b16 a[62:63], v45 offset:15104
v_mov_b32 v9, 9
ds_write_b32 v10, v9
v_mfma_f32_16x16x32_bf16 v[104:107], a[68:71], a[24:27], v[104:107]
v_mfma_f32_16x16x32_bf16 v[124:127], a[68:71], a[28:31], v[124:127]
s_waitcnt lgkmcnt(6)
v_mfma_f32_16x16x32_bf16 v[36:39], a[52:55], a[16:19], v[36:39]
s_waitcnt lgkmcnt(5)
v_min_u32 v6, v6, v7
v_cmp_gt_u32 vcc, 10, v6
s_nop 0
s_cbranch_vccnz W21
B22:
ds_read_b128 a[0:3], v33 offset:45056
v_mfma_f32_16x16x32_bf16 v[68:71], a[52:55], a[20:23], v[68:71]
ds_read_b64_tr_b16 a[44:45], v47 offset:45056
v_mfma_f32_16x16x32_bf16 v[88:91], a[52:55], a[24:27], v[88:91]
ds_read_b64_tr_b16 a[46:47], v47 offset:45568
v_mfma_f32_16x16x32_bf16 v[108:111], a[52:55], a[28:31], v[108:111]
ds_read_b128 a[4:7], v33 offset:47104
s_waitcnt lgkmcnt(7)
v_mfma_f32_16x16x32_bf16 v[52:55], a[56:59], a[16:19], v[52:55]
ds_read_b128 a[8:11], v33 offset:49152
v_mfma_f32_16x16x32_bf16 v[72:75], a[56:59], a[20:23], v[72:75]
ds_read_b128 a[12:15], v33 offset:51200
v_mfma_f32_16x16x32_bf16 v[92:95], a[56:59], a[24:27], v[92:95]
ds_read_b64_tr_b16 a[48:49], v49 offset:45056
v_mfma_f32_16x16x32_bf16 v[112:115], a[56:59], a[28:31], v[112:115]
ds_read_b64_tr_b16 a[50:51], v49 offset:45568
s_waitcnt lgkmcnt(9)
v_mfma_f32_16x16x32_bf16 v[56:59], a[60:63], a[16:19], v[56:59]
ds_read_b128 a[16:19], v34 offset:45056
v_mfma_f32_16x16x32_bf16 v[76:79], a[60:63], a[20:23], v[76:79]
ds_read_b64_tr_b16 a[64:65], v47 offset:49152
v_mfma_f32_16x16x32_bf16 v[96:99], a[60:63], a[24:27], v[96:99]
ds_read_b64_tr_b16 a[66:67], v47 offset:49664
v_mfma_f32_16x16x32_bf16 v[116:119], a[60:63], a[28:31], v[116:119]
ds_read_b128 a[20:23], v34 offset:47104
ds_read_b128 v[128:131], v164 offset:0
ds_read_b128 v[132:135], v164 offset:256
ds_read_b128 v[136:139], v164 offset:512
ds_read_b128 v[140:143], v164 offset:768
s_waitcnt lgkmcnt(13)
v_mfma_f32_16x16x32_bf16 v[60:63], a[44:47], a[0:3], v[60:63]
ds_read_b128 a[24:27], v34 offset:49152
s_waitcnt lgkmcnt(13)
v_mfma_f32_16x16x32_bf16 v[80:83], a[44:47], a[4:7], v[80:83]
ds_read_b128 a[28:31], v34 offset:51200
s_waitcnt lgkmcnt(13)
v_mfma_f32_16x16x32_bf16 v[100:103], a[44:47], a[8:11], v[100:103]
ds_read_b64_tr_b16 a[68:69], v49 offset:49152
s_waitcnt lgkmcnt(13)
v_mfma_f32_16x16x32_bf16 v[120:123], a[44:47], a[12:15], v[120:123]
ds_read_b64_tr_b16 a[70:71], v49 offset:49664
s_waitcnt lgkmcnt(12)
v_mfma_f32_16x16x32_bf16 v[64:67], a[48:51], a[0:3], v[64:67]
ds_read_b64_tr_b16 a[32:33], v41 offset:45056
v_mfma_f32_16x16x32_bf16 v[84:87], a[48:51], a[4:7], v[84:87]
ds_read_b64_tr_b16 a[34:35], v41 offset:45824
v_mfma_f32_16x16x32_bf16 v[104:107], a[48:51], a[8:11], v[104:107]
ds_read_b64_tr_b16 a[36:37], v43 offset:45056
v_mfma_f32_16x16x32_bf16 v[124:127], a[48:51], a[12:15], v[124:127]
ds_read_b64_tr_b16 a[38:39], v43 offset:45824
s_waitcnt lgkmcnt(13)
v_mfma_f32_16x16x32_bf16 v[60:63], a[64:67], a[16:19], v[60:63]
ds_read_b64_tr_b16 a[40:41], v45 offset:45056
s_waitcnt lgkmcnt(13)
v_mfma_f32_16x16x32_bf16 v[80:83], a[64:67], a[20:23], v[80:83]
ds_read_b64_tr_b16 a[42:43], v45 offset:45824
s_waitcnt lgkmcnt(9)
v_mfma_f32_16x16x32_bf16 v[100:103], a[64:67], a[24:27], v[100:103]
ds_read_b64_tr_b16 a[52:53], v41 offset:51200
s_waitcnt lgkmcnt(9)
v_mfma_f32_16x16x32_bf16 v[120:123], a[64:67], a[28:31], v[120:123]
ds_read_b64_tr_b16 a[54:55], v41 offset:51968
s_waitcnt lgkmcnt(8)
v_mfma_f32_16x16x32_bf16 v[64:67], a[68:71], a[16:19], v[64:67]
ds_read_b64_tr_b16 a[56:57], v43 offset:51200
v_mfma_f32_16x16x32_bf16 v[84:87], a[68:71], a[20:23], v[84:87]
ds_read_b64_tr_b16 a[58:59], v43 offset:51968
v_mfma_f32_16x16x32_bf16 v[104:107], a[68:71], a[24:27], v[104:107]
ds_read_b64_tr_b16 a[60:61], v45 offset:51200
v_mfma_f32_16x16x32_bf16 v[124:127], a[68:71], a[28:31], v[124:127]
ds_read_b64_tr_b16 a[62:63], v45 offset:51968
v_mov_b32 v9, 10
ds_write_b32 v10, v9
v_pk_mul_f32 v[32:33], v[60:61], v[60:61]
v_pk_mul_f32 v[40:41], v[62:63], v[62:63]
v_pk_mul_f32 v[42:43], v[80:81], v[80:81]
v_pk_mul_f32 v[44:45], v[82:83], v[82:83]
v_pk_fma_f32 v[32:33], v[32:33], v[128:129], v[128:129] op_sel:[0,1,0] op_sel_hi:[1,1,0]
v_pk_fma_f32 v[40:41], v[40:41], v[128:129], v[128:129] op_sel:[0,1,0] op_sel_hi:[1,1,0]
v_pk_fma_f32 v[42:43], v[42:43], v[132:133], v[132:133] op_sel:[0,1,0] op_sel_hi:[1,1,0]
v_pk_fma_f32 v[44:45], v[44:45], v[132:133], v[132:133] op_sel:[0,1,0] op_sel_hi:[1,1,0]
v_pk_mul_f32 v[32:33], v[32:33], v[60:61]
v_pk_mul_f32 v[40:41], v[40:41], v[62:63]
v_pk_mul_f32 v[42:43], v[42:43], v[80:81]
v_pk_mul_f32 v[44:45], v[44:45], v[82:83]
v_exp_f32 v32, v32
v_exp_f32 v33, v33
v_exp_f32 v40, v40
v_exp_f32 v41, v41
v_exp_f32 v42, v42
v_exp_f32 v43, v43
v_exp_f32 v44, v44
v_exp_f32 v45, v45
v_pk_fma_f32 v[32:33], v[32:33], v[130:131], v[130:131] op_sel_hi:[1,0,0]
v_pk_fma_f32 v[40:41], v[40:41], v[130:131], v[130:131] op_sel_hi:[1,0,0]
v_pk_fma_f32 v[42:43], v[42:43], v[134:135], v[134:135] op_sel_hi:[1,0,0]
v_pk_fma_f32 v[44:45], v[44:45], v[134:135], v[134:135] op_sel_hi:[1,0,0]
v_rcp_f32 v32, v32
v_rcp_f32 v33, v33
v_rcp_f32 v40, v40
v_rcp_f32 v41, v41
v_rcp_f32 v42, v42
v_rcp_f32 v43, v43
v_rcp_f32 v44, v44
v_rcp_f32 v45, v45
v_pk_mul_f32 v[60:61], v[60:61], v[32:33]
v_pk_mul_f32 v[62:63], v[62:63], v[40:41]
v_pk_mul_f32 v[80:81], v[80:81], v[42:43]
v_pk_mul_f32 v[82:83], v[82:83], v[44:45]
v_cvt_pk_bf16_f32 v60, v60, v61
v_cvt_pk_bf16_f32 v61, v62, v63
v_cvt_pk_bf16_f32 v62, v80, v81
v_cvt_pk_bf16_f32 v63, v82, v83
s_nop 0
v_permlane16_swap_b32 v60, v62
v_permlane16_swap_b32 v61, v63
buffer_store_dwordx4 v[60:63], v35, s[36:39], s77 offen offset:0 sc1
v_pk_mul_f32 v[32:33], v[100:101], v[100:101]
v_pk_mul_f32 v[40:41], v[102:103], v[102:103]
v_pk_mul_f32 v[42:43], v[120:121], v[120:121]
v_pk_mul_f32 v[44:45], v[122:123], v[122:123]
v_pk_fma_f32 v[32:33], v[32:33], v[136:137], v[136:137] op_sel:[0,1,0] op_sel_hi:[1,1,0]
v_pk_fma_f32 v[40:41], v[40:41], v[136:137], v[136:137] op_sel:[0,1,0] op_sel_hi:[1,1,0]
v_pk_fma_f32 v[42:43], v[42:43], v[140:141], v[140:141] op_sel:[0,1,0] op_sel_hi:[1,1,0]
v_pk_fma_f32 v[44:45], v[44:45], v[140:141], v[140:141] op_sel:[0,1,0] op_sel_hi:[1,1,0]
v_pk_mul_f32 v[32:33], v[32:33], v[100:101]
v_pk_mul_f32 v[40:41], v[40:41], v[102:103]
v_pk_mul_f32 v[42:43], v[42:43], v[120:121]
v_pk_mul_f32 v[44:45], v[44:45], v[122:123]
v_exp_f32 v32, v32
v_exp_f32 v33, v33
v_exp_f32 v40, v40
v_exp_f32 v41, v41
v_exp_f32 v42, v42
v_exp_f32 v43, v43
v_exp_f32 v44, v44
v_exp_f32 v45, v45
v_pk_fma_f32 v[32:33], v[32:33], v[138:139], v[138:139] op_sel_hi:[1,0,0]
v_pk_fma_f32 v[40:41], v[40:41], v[138:139], v[138:139] op_sel_hi:[1,0,0]
v_pk_fma_f32 v[42:43], v[42:43], v[142:143], v[142:143] op_sel_hi:[1,0,0]
v_pk_fma_f32 v[44:45], v[44:45], v[142:143], v[142:143] op_sel_hi:[1,0,0]
v_rcp_f32 v32, v32
v_rcp_f32 v33, v33
v_rcp_f32 v40, v40
v_rcp_f32 v41, v41
v_rcp_f32 v42, v42
v_rcp_f32 v43, v43
v_rcp_f32 v44, v44
v_rcp_f32 v45, v45
v_pk_mul_f32 v[100:101], v[100:101], v[32:33]
v_pk_mul_f32 v[102:103], v[102:103], v[40:41]
v_pk_mul_f32 v[120:121], v[120:121], v[42:43]
v_pk_mul_f32 v[122:123], v[122:123], v[44:45]
v_cvt_pk_bf16_f32 v100, v100, v101
v_cvt_pk_bf16_f32 v101, v102, v103
v_cvt_pk_bf16_f32 v102, v120, v121
v_cvt_pk_bf16_f32 v103, v122, v123
s_nop 0
v_permlane16_swap_b32 v100, v102
v_permlane16_swap_b32 v101, v103
buffer_store_dwordx4 v[100:103], v35, s[36:39], s78 offen offset:0 sc1
v_pk_mul_f32 v[32:33], v[64:65], v[64:65]
v_pk_mul_f32 v[40:41], v[66:67], v[66:67]
v_pk_mul_f32 v[42:43], v[84:85], v[84:85]
v_pk_mul_f32 v[44:45], v[86:87], v[86:87]
v_pk_fma_f32 v[32:33], v[32:33], v[128:129], v[128:129] op_sel:[0,1,0] op_sel_hi:[1,1,0]
v_pk_fma_f32 v[40:41], v[40:41], v[128:129], v[128:129] op_sel:[0,1,0] op_sel_hi:[1,1,0]
v_pk_fma_f32 v[42:43], v[42:43], v[132:133], v[132:133] op_sel:[0,1,0] op_sel_hi:[1,1,0]
v_pk_fma_f32 v[44:45], v[44:45], v[132:133], v[132:133] op_sel:[0,1,0] op_sel_hi:[1,1,0]
v_pk_mul_f32 v[32:33], v[32:33], v[64:65]
v_pk_mul_f32 v[40:41], v[40:41], v[66:67]
v_pk_mul_f32 v[42:43], v[42:43], v[84:85]
v_pk_mul_f32 v[44:45], v[44:45], v[86:87]
v_exp_f32 v32, v32
v_exp_f32 v33, v33
v_exp_f32 v40, v40
v_exp_f32 v41, v41
v_exp_f32 v42, v42
v_exp_f32 v43, v43
v_exp_f32 v44, v44
v_exp_f32 v45, v45
v_pk_fma_f32 v[32:33], v[32:33], v[130:131], v[130:131] op_sel_hi:[1,0,0]
v_pk_fma_f32 v[40:41], v[40:41], v[130:131], v[130:131] op_sel_hi:[1,0,0]
v_pk_fma_f32 v[42:43], v[42:43], v[134:135], v[134:135] op_sel_hi:[1,0,0]
v_pk_fma_f32 v[44:45], v[44:45], v[134:135], v[134:135] op_sel_hi:[1,0,0]
v_rcp_f32 v32, v32
v_rcp_f32 v33, v33
v_rcp_f32 v40, v40
v_rcp_f32 v41, v41
v_rcp_f32 v42, v42
v_rcp_f32 v43, v43
v_rcp_f32 v44, v44
v_rcp_f32 v45, v45
v_pk_mul_f32 v[64:65], v[64:65], v[32:33]
v_pk_mul_f32 v[66:67], v[66:67], v[40:41]
v_pk_mul_f32 v[84:85], v[84:85], v[42:43]
v_pk_mul_f32 v[86:87], v[86:87], v[44:45]
v_cvt_pk_bf16_f32 v64, v64, v65
v_cvt_pk_bf16_f32 v65, v66, v67
v_cvt_pk_bf16_f32 v66, v84, v85
v_cvt_pk_bf16_f32 v67, v86, v87
s_nop 0
v_permlane16_swap_b32 v64, v66
v_permlane16_swap_b32 v65, v67
buffer_store_dwordx4 v[64:67], v35, s[36:39], s77 offen offset:512 sc1
v_pk_mul_f32 v[32:33], v[104:105], v[104:105]
v_pk_mul_f32 v[40:41], v[106:107], v[106:107]
v_pk_mul_f32 v[42:43], v[124:125], v[124:125]
v_pk_mul_f32 v[44:45], v[126:127], v[126:127]
v_pk_fma_f32 v[32:33], v[32:33], v[136:137], v[136:137] op_sel:[0,1,0] op_sel_hi:[1,1,0]
v_pk_fma_f32 v[40:41], v[40:41], v[136:137], v[136:137] op_sel:[0,1,0] op_sel_hi:[1,1,0]
v_pk_fma_f32 v[42:43], v[42:43], v[140:141], v[140:141] op_sel:[0,1,0] op_sel_hi:[1,1,0]
v_pk_fma_f32 v[44:45], v[44:45], v[140:141], v[140:141] op_sel:[0,1,0] op_sel_hi:[1,1,0]
v_pk_mul_f32 v[32:33], v[32:33], v[104:105]
v_pk_mul_f32 v[40:41], v[40:41], v[106:107]
v_pk_mul_f32 v[42:43], v[42:43], v[124:125]
v_pk_mul_f32 v[44:45], v[44:45], v[126:127]
v_exp_f32 v32, v32
v_exp_f32 v33, v33
v_exp_f32 v40, v40
v_exp_f32 v41, v41
v_exp_f32 v42, v42
v_exp_f32 v43, v43
v_exp_f32 v44, v44
v_exp_f32 v45, v45
v_pk_fma_f32 v[32:33], v[32:33], v[138:139], v[138:139] op_sel_hi:[1,0,0]
v_pk_fma_f32 v[40:41], v[40:41], v[138:139], v[138:139] op_sel_hi:[1,0,0]
v_pk_fma_f32 v[42:43], v[42:43], v[142:143], v[142:143] op_sel_hi:[1,0,0]
v_pk_fma_f32 v[44:45], v[44:45], v[142:143], v[142:143] op_sel_hi:[1,0,0]
v_rcp_f32 v32, v32
v_rcp_f32 v33, v33
v_rcp_f32 v40, v40
v_rcp_f32 v41, v41
v_rcp_f32 v42, v42
v_rcp_f32 v43, v43
v_rcp_f32 v44, v44
v_rcp_f32 v45, v45
v_pk_mul_f32 v[104:105], v[104:105], v[32:33]
v_pk_mul_f32 v[106:107], v[106:107], v[40:41]
v_pk_mul_f32 v[124:125], v[124:125], v[42:43]
v_pk_mul_f32 v[126:127], v[126:127], v[44:45]
v_cvt_pk_bf16_f32 v104, v104, v105
v_cvt_pk_bf16_f32 v105, v106, v107
v_cvt_pk_bf16_f32 v106, v124, v125
v_cvt_pk_bf16_f32 v107, v126, v127
s_nop 0
v_permlane16_swap_b32 v104, v106
v_permlane16_swap_b32 v105, v107
buffer_store_dwordx4 v[104:107], v35, s[36:39], s78 offen offset:512 sc1
s_waitcnt lgkmcnt(11)
v_mfma_f32_16x16x32_bf16 v[36:39], a[32:35], a[0:3], v[36:39]
v_mfma_f32_16x16x32_bf16 v[68:71], a[32:35], a[4:7], v[68:71]
v_mfma_f32_16x16x32_bf16 v[88:91], a[32:35], a[8:11], v[88:91]
v_mfma_f32_16x16x32_bf16 v[108:111], a[32:35], a[12:15], v[108:111]
s_waitcnt lgkmcnt(9)
v_mfma_f32_16x16x32_bf16 v[52:55], a[36:39], a[0:3], v[52:55]
v_mfma_f32_16x16x32_bf16 v[72:75], a[36:39], a[4:7], v[72:75]
v_mfma_f32_16x16x32_bf16 v[92:95], a[36:39], a[8:11], v[92:95]
v_mfma_f32_16x16x32_bf16 v[112:115], a[36:39], a[12:15], v[112:115]
s_waitcnt lgkmcnt(7)
v_mfma_f32_16x16x32_bf16 v[56:59], a[40:43], a[0:3], v[56:59]
v_mfma_f32_16x16x32_bf16 v[76:79], a[40:43], a[4:7], v[76:79]
v_mfma_f32_16x16x32_bf16 v[96:99], a[40:43], a[8:11], v[96:99]
v_mfma_f32_16x16x32_bf16 v[116:119], a[40:43], a[12:15], v[116:119]
s_waitcnt lgkmcnt(5)
v_mfma_f32_16x16x32_bf16 v[36:39], a[52:55], a[16:19], v[36:39]
v_mfma_f32_16x16x32_bf16 v[68:71], a[52:55], a[20:23], v[68:71]
v_mfma_f32_16x16x32_bf16 v[88:91], a[52:55], a[24:27], v[88:91]
v_mfma_f32_16x16x32_bf16 v[108:111], a[52:55], a[28:31], v[108:111]
s_waitcnt lgkmcnt(3)
v_mfma_f32_16x16x32_bf16 v[52:55], a[56:59], a[16:19], v[52:55]
v_mfma_f32_16x16x32_bf16 v[72:75], a[56:59], a[20:23], v[72:75]
v_mfma_f32_16x16x32_bf16 v[92:95], a[56:59], a[24:27], v[92:95]
v_mfma_f32_16x16x32_bf16 v[112:115], a[56:59], a[28:31], v[112:115]
s_waitcnt lgkmcnt(1)
v_mfma_f32_16x16x32_bf16 v[56:59], a[60:63], a[16:19], v[56:59]
v_mfma_f32_16x16x32_bf16 v[76:79], a[60:63], a[20:23], v[76:79]
v_mfma_f32_16x16x32_bf16 v[96:99], a[60:63], a[24:27], v[96:99]
v_mfma_f32_16x16x32_bf16 v[116:119], a[60:63], a[28:31], v[116:119]
v_mov_b32 v46, 0x358637bd
v_mul_f32 v128, 0x3fb8aa3b, v131
v_mul_f32 v132, 0x3fb8aa3b, v135
v_mul_f32 v136, 0x3fb8aa3b, v139
v_mul_f32 v140, 0x3fb8aa3b, v143
v_pk_mul_f32 v[32:33], v[36:37], v[128:129] op_sel_hi:[1,0]
v_pk_mul_f32 v[40:41], v[38:39], v[128:129] op_sel_hi:[1,0]
v_pk_mul_f32 v[42:43], v[68:69], v[132:133] op_sel_hi:[1,0]
v_pk_mul_f32 v[44:45], v[70:71], v[132:133] op_sel_hi:[1,0]
v_pk_fma_f32 v[36:37], v[36:37], v[130:131], v[46:47] op_sel:[0,1,0] op_sel_hi:[1,1,0]
v_pk_fma_f32 v[38:39], v[38:39], v[130:131], v[46:47] op_sel:[0,1,0] op_sel_hi:[1,1,0]
v_pk_fma_f32 v[68:69], v[68:69], v[134:135], v[46:47] op_sel:[0,1,0] op_sel_hi:[1,1,0]
v_pk_fma_f32 v[70:71], v[70:71], v[134:135], v[46:47] op_sel:[0,1,0] op_sel_hi:[1,1,0]
v_exp_f32_e64 v32, v32 clamp
v_exp_f32_e64 v33, v33 clamp
v_exp_f32_e64 v40, v40 clamp
v_exp_f32_e64 v41, v41 clamp
v_exp_f32_e64 v42, v42 clamp
v_exp_f32_e64 v43, v43 clamp
v_exp_f32_e64 v44, v44 clamp
v_exp_f32_e64 v45, v45 clamp
v_max_f32 v36, v46, v36
v_max_f32 v37, v46, v37
v_max_f32 v38, v46, v38
v_max_f32 v39, v46, v39
v_max_f32 v68, v46, v68
v_max_f32 v69, v46, v69
v_max_f32 v70, v46, v70
v_max_f32 v71, v46, v71
v_pk_add_f32 v[36:37], v[36:37], v[32:33]
v_pk_add_f32 v[38:39], v[38:39], v[40:41]
v_pk_add_f32 v[68:69], v[68:69], v[42:43]
v_pk_add_f32 v[70:71], v[70:71], v[44:45]
v_cvt_pk_bf16_f32 v36, v36, v37
v_cvt_pk_bf16_f32 v37, v38, v39
v_cvt_pk_bf16_f32 v38, v68, v69
v_cvt_pk_bf16_f32 v39, v70, v71
s_nop 0
v_permlane16_swap_b32 v36, v38
v_permlane16_swap_b32 v37, v39
v_pk_mul_f32 v[32:33], v[88:89], v[136:137] op_sel_hi:[1,0]
v_pk_mul_f32 v[40:41], v[90:91], v[136:137] op_sel_hi:[1,0]
v_pk_mul_f32 v[42:43], v[108:109], v[140:141] op_sel_hi:[1,0]
v_pk_mul_f32 v[44:45], v[110:111], v[140:141] op_sel_hi:[1,0]
v_pk_fma_f32 v[88:89], v[88:89], v[138:139], v[46:47] op_sel:[0,1,0] op_sel_hi:[1,1,0]
v_pk_fma_f32 v[90:91], v[90:91], v[138:139], v[46:47] op_sel:[0,1,0] op_sel_hi:[1,1,0]
v_pk_fma_f32 v[108:109], v[108:109], v[142:143], v[46:47] op_sel:[0,1,0] op_sel_hi:[1,1,0]
v_pk_fma_f32 v[110:111], v[110:111], v[142:143], v[46:47] op_sel:[0,1,0] op_sel_hi:[1,1,0]
v_exp_f32_e64 v32, v32 clamp
v_exp_f32_e64 v33, v33 clamp
v_exp_f32_e64 v40, v40 clamp
v_exp_f32_e64 v41, v41 clamp
v_exp_f32_e64 v42, v42 clamp
v_exp_f32_e64 v43, v43 clamp
v_exp_f32_e64 v44, v44 clamp
v_exp_f32_e64 v45, v45 clamp
v_max_f32 v88, v46, v88
v_max_f32 v89, v46, v89
v_max_f32 v90, v46, v90
v_max_f32 v91, v46, v91
v_max_f32 v108, v46, v108
v_max_f32 v109, v46, v109
v_max_f32 v110, v46, v110
v_max_f32 v111, v46, v111
v_pk_add_f32 v[88:89], v[88:89], v[32:33]
v_pk_add_f32 v[90:91], v[90:91], v[40:41]
v_pk_add_f32 v[108:109], v[108:109], v[42:43]
v_pk_add_f32 v[110:111], v[110:111], v[44:45]
v_cvt_pk_bf16_f32 v88, v88, v89
v_cvt_pk_bf16_f32 v89, v90, v91
v_cvt_pk_bf16_f32 v90, v108, v109
v_cvt_pk_bf16_f32 v91, v110, v111
s_nop 0
v_permlane16_swap_b32 v88, v90
v_permlane16_swap_b32 v89, v91
s_waitcnt vmcnt(0)
buffer_atomic_or v8, v5, s[36:39], s64 offen sc1
s_add_u32 s64, s64, 8192
v_pk_mul_f32 v[32:33], v[52:53], v[128:129] op_sel_hi:[1,0]
v_pk_mul_f32 v[40:41], v[54:55], v[128:129] op_sel_hi:[1,0]
v_pk_mul_f32 v[42:43], v[72:73], v[132:133] op_sel_hi:[1,0]
v_pk_mul_f32 v[44:45], v[74:75], v[132:133] op_sel_hi:[1,0]
v_pk_fma_f32 v[52:53], v[52:53], v[130:131], v[46:47] op_sel:[0,1,0] op_sel_hi:[1,1,0]
v_pk_fma_f32 v[54:55], v[54:55], v[130:131], v[46:47] op_sel:[0,1,0] op_sel_hi:[1,1,0]
v_pk_fma_f32 v[72:73], v[72:73], v[134:135], v[46:47] op_sel:[0,1,0] op_sel_hi:[1,1,0]
v_pk_fma_f32 v[74:75], v[74:75], v[134:135], v[46:47] op_sel:[0,1,0] op_sel_hi:[1,1,0]
v_exp_f32_e64 v32, v32 clamp
v_exp_f32_e64 v33, v33 clamp
v_exp_f32_e64 v40, v40 clamp
v_exp_f32_e64 v41, v41 clamp
v_exp_f32_e64 v42, v42 clamp
v_exp_f32_e64 v43, v43 clamp
v_exp_f32_e64 v44, v44 clamp
v_exp_f32_e64 v45, v45 clamp
v_max_f32 v52, v46, v52
v_max_f32 v53, v46, v53
v_max_f32 v54, v46, v54
v_max_f32 v55, v46, v55
v_max_f32 v72, v46, v72
v_max_f32 v73, v46, v73
v_max_f32 v74, v46, v74
v_max_f32 v75, v46, v75
v_pk_add_f32 v[52:53], v[52:53], v[32:33]
v_pk_add_f32 v[54:55], v[54:55], v[40:41]
v_pk_add_f32 v[72:73], v[72:73], v[42:43]
v_pk_add_f32 v[74:75], v[74:75], v[44:45]
v_cvt_pk_bf16_f32 v52, v52, v53
v_cvt_pk_bf16_f32 v53, v54, v55
v_cvt_pk_bf16_f32 v54, v72, v73
v_cvt_pk_bf16_f32 v55, v74, v75
s_nop 0
v_permlane16_swap_b32 v52, v54
v_permlane16_swap_b32 v53, v55
v_pk_mul_f32 v[32:33], v[92:93], v[136:137] op_sel_hi:[1,0]
v_pk_mul_f32 v[40:41], v[94:95], v[136:137] op_sel_hi:[1,0]
v_pk_mul_f32 v[42:43], v[112:113], v[140:141] op_sel_hi:[1,0]
v_pk_mul_f32 v[44:45], v[114:115], v[140:141] op_sel_hi:[1,0]
v_pk_fma_f32 v[92:93], v[92:93], v[138:139], v[46:47] op_sel:[0,1,0] op_sel_hi:[1,1,0]
v_pk_fma_f32 v[94:95], v[94:95], v[138:139], v[46:47] op_sel:[0,1,0] op_sel_hi:[1,1,0]
v_pk_fma_f32 v[112:113], v[112:113], v[142:143], v[46:47] op_sel:[0,1,0] op_sel_hi:[1,1,0]
v_pk_fma_f32 v[114:115], v[114:115], v[142:143], v[46:47] op_sel:[0,1,0] op_sel_hi:[1,1,0]
v_exp_f32_e64 v32, v32 clamp
v_exp_f32_e64 v33, v33 clamp
v_exp_f32_e64 v40, v40 clamp
v_exp_f32_e64 v41, v41 clamp
v_exp_f32_e64 v42, v42 clamp
v_exp_f32_e64 v43, v43 clamp
v_exp_f32_e64 v44, v44 clamp
v_exp_f32_e64 v45, v45 clamp
v_max_f32 v92, v46, v92
v_max_f32 v93, v46, v93
v_max_f32 v94, v46, v94
v_max_f32 v95, v46, v95
v_max_f32 v112, v46, v112
v_max_f32 v113, v46, v113
v_max_f32 v114, v46, v114
v_max_f32 v115, v46, v115
v_pk_add_f32 v[92:93], v[92:93], v[32:33]
v_pk_add_f32 v[94:95], v[94:95], v[40:41]
v_pk_add_f32 v[112:113], v[112:113], v[42:43]
v_pk_add_f32 v[114:115], v[114:115], v[44:45]
v_cvt_pk_bf16_f32 v92, v92, v93
v_cvt_pk_bf16_f32 v93, v94, v95
v_cvt_pk_bf16_f32 v94, v112, v113
v_cvt_pk_bf16_f32 v95, v114, v115
s_nop 0
v_permlane16_swap_b32 v92, v94
v_permlane16_swap_b32 v93, v95
v_pk_mul_f32 v[32:33], v[56:57], v[128:129] op_sel_hi:[1,0]
v_pk_mul_f32 v[40:41], v[58:59], v[128:129] op_sel_hi:[1,0]
v_pk_mul_f32 v[42:43], v[76:77], v[132:133] op_sel_hi:[1,0]
v_pk_mul_f32 v[44:45], v[78:79], v[132:133] op_sel_hi:[1,0]
v_pk_fma_f32 v[56:57], v[56:57], v[130:131], v[46:47] op_sel:[0,1,0] op_sel_hi:[1,1,0]
v_pk_fma_f32 v[58:59], v[58:59], v[130:131], v[46:47] op_sel:[0,1,0] op_sel_hi:[1,1,0]
v_pk_fma_f32 v[76:77], v[76:77], v[134:135], v[46:47] op_sel:[0,1,0] op_sel_hi:[1,1,0]
v_pk_fma_f32 v[78:79], v[78:79], v[134:135], v[46:47] op_sel:[0,1,0] op_sel_hi:[1,1,0]
v_exp_f32_e64 v32, v32 clamp
v_exp_f32_e64 v33, v33 clamp
v_exp_f32_e64 v40, v40 clamp
v_exp_f32_e64 v41, v41 clamp
v_exp_f32_e64 v42, v42 clamp
v_exp_f32_e64 v43, v43 clamp
v_exp_f32_e64 v44, v44 clamp
v_exp_f32_e64 v45, v45 clamp
v_max_f32 v56, v46, v56
v_max_f32 v57, v46, v57
v_max_f32 v58, v46, v58
v_max_f32 v59, v46, v59
v_max_f32 v76, v46, v76
v_max_f32 v77, v46, v77
v_max_f32 v78, v46, v78
v_max_f32 v79, v46, v79
v_pk_add_f32 v[56:57], v[56:57], v[32:33]
v_pk_add_f32 v[58:59], v[58:59], v[40:41]
v_pk_add_f32 v[76:77], v[76:77], v[42:43]
v_pk_add_f32 v[78:79], v[78:79], v[44:45]
v_cvt_pk_bf16_f32 v56, v56, v57
v_cvt_pk_bf16_f32 v57, v58, v59
v_cvt_pk_bf16_f32 v58, v76, v77
v_cvt_pk_bf16_f32 v59, v78, v79
s_nop 0
v_permlane16_swap_b32 v56, v58
v_permlane16_swap_b32 v57, v59
v_pk_mul_f32 v[32:33], v[96:97], v[136:137] op_sel_hi:[1,0]
v_pk_mul_f32 v[40:41], v[98:99], v[136:137] op_sel_hi:[1,0]
v_pk_mul_f32 v[42:43], v[116:117], v[140:141] op_sel_hi:[1,0]
v_pk_mul_f32 v[44:45], v[118:119], v[140:141] op_sel_hi:[1,0]
v_pk_fma_f32 v[96:97], v[96:97], v[138:139], v[46:47] op_sel:[0,1,0] op_sel_hi:[1,1,0]
v_pk_fma_f32 v[98:99], v[98:99], v[138:139], v[46:47] op_sel:[0,1,0] op_sel_hi:[1,1,0]
v_pk_fma_f32 v[116:117], v[116:117], v[142:143], v[46:47] op_sel:[0,1,0] op_sel_hi:[1,1,0]
v_pk_fma_f32 v[118:119], v[118:119], v[142:143], v[46:47] op_sel:[0,1,0] op_sel_hi:[1,1,0]
v_exp_f32_e64 v32, v32 clamp
v_exp_f32_e64 v33, v33 clamp
v_exp_f32_e64 v40, v40 clamp
v_exp_f32_e64 v41, v41 clamp
v_exp_f32_e64 v42, v42 clamp
v_exp_f32_e64 v43, v43 clamp
v_exp_f32_e64 v44, v44 clamp
v_exp_f32_e64 v45, v45 clamp
v_max_f32 v96, v46, v96
v_max_f32 v97, v46, v97
v_max_f32 v98, v46, v98
v_max_f32 v99, v46, v99
v_max_f32 v116, v46, v116
v_max_f32 v117, v46, v117
v_max_f32 v118, v46, v118
v_max_f32 v119, v46, v119
v_pk_add_f32 v[96:97], v[96:97], v[32:33]
v_pk_add_f32 v[98:99], v[98:99], v[40:41]
v_pk_add_f32 v[116:117], v[116:117], v[42:43]
v_pk_add_f32 v[118:119], v[118:119], v[44:45]
v_cvt_pk_bf16_f32 v96, v96, v97
v_cvt_pk_bf16_f32 v97, v98, v99
v_cvt_pk_bf16_f32 v98, v116, v117
v_cvt_pk_bf16_f32 v99, v118, v119
s_nop 0
v_permlane16_swap_b32 v96, v98
v_permlane16_swap_b32 v97, v99
buffer_store_dwordx4 v[36:39], v35, s[36:39], s75 offen offset:0 sc1
buffer_store_dwordx4 v[88:91], v35, s[36:39], s76 offen offset:0 sc1
buffer_store_dwordx4 v[52:55], v35, s[36:39], s75 offen offset:512 sc1
buffer_store_dwordx4 v[92:95], v35, s[36:39], s76 offen offset:512 sc1
buffer_store_dwordx4 v[56:59], v35, s[36:39], s75 offen offset:1024 sc1
buffer_store_dwordx4 v[96:99], v35, s[36:39], s76 offen offset:1024 sc1
v_mov_b32 v9, 11
ds_write_b32 v10, v9
s_waitcnt lgkmcnt(0)
s_branch L_join
L_TA:
s_lshl1_add_u32 s72, s57, s59
s_sub_u32 s72, s72, 4
s_lshr_b32 s73, s52, 1
s_and_b32 s74, s52, 1
v_lshrrev_b32 v30, 1, v11
v_lshrrev_b32 v21, 4, v1
v_xor_b32 v30, v30, v21
s_lshl_b32 s48, s73, 6
v_add_u32 v31, s48, v11
v_lshlrev_b32 v31, 7, v31
v_lshl_add_u32 v31, v30, 4, v31
v_xor_b32 v32, 64, v31
v_add_u32 v33, 65536, v31
v_add_u32 v34, 65536, v32
v_lshlrev_b32 v35, 3, v21
v_bfe_u32 v30, v1, 2, 2
v_add_u32 v35, v35, v30
v_and_b32 v30, 3, v1
v_lshlrev_b32 v30, 3, v30
v_mul_u32_u24 v36, 192, v35
v_add_u32 v36, v36, v30
v_add_u32 v36, 16384, v36
v_lshl_add_u32 v37, v35, 7, v30
v_add_u32 v37, 28672, v37
v_and_b32 v38, 1, v21
v_bfe_u32 v39, v1, 3, 2
s_mul_i32 s48, s74, 3
s_add_u32 s48, s48, 0
v_xor_b32 v40, s48, v38
v_lshl_add_u32 v40, v40, 5, v36
v_add_u32 v41, 65536, v40
s_mul_i32 s48, s74, 3
s_add_u32 s48, s48, 1
v_xor_b32 v42, s48, v38
v_lshl_add_u32 v42, v42, 5, v36
v_add_u32 v43, 65536, v42
s_mul_i32 s48, s74, 3
s_add_u32 s48, s48, 2
v_xor_b32 v44, s48, v38
v_lshl_add_u32 v44, v44, 5, v36
v_add_u32 v45, 65536, v44
s_lshl_b32 s48, s74, 1
s_add_u32 s48, s48, 0
v_xor_b32 v46, s48, v39
v_lshl_add_u32 v46, v46, 5, v37
v_add_u32 v47, 65536, v46
s_lshl_b32 s48, s74, 1
s_add_u32 s48, s48, 1
v_xor_b32 v48, s48, v39
v_lshl_add_u32 v48, v48, 5, v37
v_add_u32 v49, 65536, v48
s_lshl1_add_u32 s48, s58, s73
s_lshl_b32 s64, s48, 7
s_mul_i32 s48, s48, 81920
v_and_b32 v30, 1, v21
v_mul_u32_u24 v35, 20480, v30
v_lshrrev_b32 v30, 1, v21
v_lshl_add_u32 v35, v30, 8, v35
v_lshl_add_u32 v35, v11, 4, v35
v_add_u32 v35, s48, v35
s_lshl1_add_u32 s48, s72, s74
s_add_u32 s64, s64, 8192
s_add_u32 s49, s48, 0
s_lshl_b32 s51, 1, s49
v_mov_b32 v8, s51
s_mul_i32 s75, s48, 1536
s_add_u32 s75, s75, 2097152
s_lshl_b32 s77, s48, 10
s_add_u32 s77, s77, 4730880
s_add_u32 s76, s75, 40960
s_add_u32 s78, s77, 40960
s_lshl_b32 s48, s73, 9
s_add_u32 s48, s48, 157696
v_lshl_add_u32 v21, v11, 3, s48
s_mul_i32 s48, s74, 384
s_add_u32 s48, s48, 155648
v_lshl_add_u32 v50, v11, 3, s48
s_lshl_b32 s48, s74, 8
s_add_u32 s48, s48, 156416
v_lshl_add_u32 v51, v11, 3, s48
s_lshl_b32 s48, s73, 10
s_add_u32 s48, s48, 158720
v_lshl_add_u32 v164, v11, 4, s48
v_mov_b32 v130, 0
v_mov_b32 v131, 0
v_mov_b32 v134, 0
v_mov_b32 v135, 0
v_mov_b32 v138, 0
v_mov_b32 v139, 0
v_mov_b32 v142, 0
v_mov_b32 v143, 0
v_mov_b32 v144, 0
v_mov_b32 v145, 0
v_mov_b32 v146, 0
v_mov_b32 v147, 0
v_mov_b32 v148, 0
v_mov_b32 v149, 0
v_mov_b32 v150, 0
v_mov_b32 v151, 0
v_mov_b32 v152, 0
v_mov_b32 v153, 0
v_mov_b32 v154, 0
v_mov_b32 v155, 0
v_mov_b32 v156, 0
v_mov_b32 v157, 0
v_mov_b32 v158, 0
v_mov_b32 v159, 0
v_mov_b32 v160, 0
v_mov_b32 v161, 0
v_mov_b32 v162, 0
v_mov_b32 v163, 0
ds_read_b64 v[6:7], v3 offset:0
s_waitcnt lgkmcnt(0)
v_min_u32 v6, v6, v7
v_cmp_gt_u32 vcc, 1, v6
s_nop 0
s_cbranch_vccnz W23
B24:
ds_read_b128 a[0:3], v33 offset:8192
ds_read_b64_tr_b16 a[32:33], v41 offset:8192
ds_read_b64_tr_b16 a[34:35], v41 offset:8960
ds_read_b128 a[4:7], v33 offset:10240
ds_read_b128 a[8:11], v33 offset:12288
ds_read_b128 a[12:15], v33 offset:14336
ds_read_b64_tr_b16 a[36:37], v43 offset:8192
ds_read_b64_tr_b16 a[38:39], v43 offset:8960
ds_read_b64_tr_b16 a[40:41], v45 offset:8192
ds_read_b64_tr_b16 a[42:43], v45 offset:8960
s_waitcnt lgkmcnt(7)
v_mfma_f32_16x16x32_bf16 v[36:39], a[32:35], a[0:3], 0
ds_read_b64_tr_b16 a[44:45], v47 offset:8192
s_waitcnt lgkmcnt(7)
v_mfma_f32_16x16x32_bf16 v[68:71], a[32:35], a[4:7], 0
ds_read_b64_tr_b16 a[46:47], v47 offset:8704
s_waitcnt lgkmcnt(7)
v_mfma_f32_16x16x32_bf16 v[88:91], a[32:35], a[8:11], 0
s_waitcnt lgkmcnt(6)
v_mfma_f32_16x16x32_bf16 v[108:111], a[32:35], a[12:15], 0
s_waitcnt lgkmcnt(4)
v_mfma_f32_16x16x32_bf16 v[52:55], a[36:39], a[0:3], 0
ds_read_b64_tr_b16 a[48:49], v49 offset:8192
v_mfma_f32_16x16x32_bf16 v[72:75], a[36:39], a[4:7], 0
ds_read_b64_tr_b16 a[50:51], v49 offset:8704
v_mfma_f32_16x16x32_bf16 v[92:95], a[36:39], a[8:11], 0
v_mfma_f32_16x16x32_bf16 v[112:115], a[36:39], a[12:15], 0
s_waitcnt lgkmcnt(4)
v_mfma_f32_16x16x32_bf16 v[56:59], a[40:43], a[0:3], 0
ds_read_b128 a[16:19], v34 offset:8192
v_mfma_f32_16x16x32_bf16 v[76:79], a[40:43], a[4:7], 0
ds_read_b64_tr_b16 a[52:53], v41 offset:14336
v_mfma_f32_16x16x32_bf16 v[96:99], a[40:43], a[8:11], 0
ds_read_b64_tr_b16 a[54:55], v41 offset:15104
v_mfma_f32_16x16x32_bf16 v[116:119], a[40:43], a[12:15], 0
ds_read_b128 a[20:23], v34 offset:10240
s_waitcnt lgkmcnt(6)
v_mfma_f32_16x16x32_bf16 v[60:63], a[44:47], a[0:3], 0
ds_read_b128 a[24:27], v34 offset:12288
v_mfma_f32_16x16x32_bf16 v[80:83], a[44:47], a[4:7], 0
ds_read_b128 a[28:31], v34 offset:14336
v_mfma_f32_16x16x32_bf16 v[100:103], a[44:47], a[8:11], 0
ds_read_b64_tr_b16 a[56:57], v43 offset:14336
v_mfma_f32_16x16x32_bf16 v[120:123], a[44:47], a[12:15], 0
ds_read_b64_tr_b16 a[58:59], v43 offset:15104
s_waitcnt lgkmcnt(8)
v_mfma_f32_16x16x32_bf16 v[64:67], a[48:51], a[0:3], 0
ds_read_b64_tr_b16 a[60:61], v45 offset:14336
v_mfma_f32_16x16x32_bf16 v[84:87], a[48:51], a[4:7], 0
ds_read_b64_tr_b16 a[62:63], v45 offset:15104
ds_read_b64 v[6:7], v3
v_mfma_f32_16x16x32_bf16 v[104:107], a[48:51], a[8:11], 0
v_mfma_f32_16x16x32_bf16 v[124:127], a[48:51], a[12:15], 0
s_waitcnt lgkmcnt(8)
v_mfma_f32_16x16x32_bf16 v[36:39], a[52:55], a[16:19], v[36:39]
ds_read_b64_tr_b16 a[64:65], v47 offset:12288
s_waitcnt lgkmcnt(8)
v_mfma_f32_16x16x32_bf16 v[68:71], a[52:55], a[20:23], v[68:71]
ds_read_b64_tr_b16 a[66:67], v47 offset:12800
s_waitcnt lgkmcnt(8)
v_mfma_f32_16x16x32_bf16 v[88:91], a[52:55], a[24:27], v[88:91]
s_waitcnt lgkmcnt(7)
v_mfma_f32_16x16x32_bf16 v[108:111], a[52:55], a[28:31], v[108:111]
s_waitcnt lgkmcnt(5)
v_mfma_f32_16x16x32_bf16 v[52:55], a[56:59], a[16:19], v[52:55]
ds_read_b64_tr_b16 a[68:69], v49 offset:12288
v_mfma_f32_16x16x32_bf16 v[72:75], a[56:59], a[20:23], v[72:75]
ds_read_b64_tr_b16 a[70:71], v49 offset:12800
v_mov_b32 v9, 1
ds_write_b32 v10, v9
v_mfma_f32_16x16x32_bf16 v[92:95], a[56:59], a[24:27], v[92:95]
v_mfma_f32_16x16x32_bf16 v[112:115], a[56:59], a[28:31], v[112:115]
s_waitcnt lgkmcnt(6)
v_mfma_f32_16x16x32_bf16 v[56:59], a[60:63], a[16:19], v[56:59]
s_waitcnt lgkmcnt(5)
v_min_u32 v6, v6, v7
v_cmp_gt_u32 vcc, 2, v6
s_nop 0
s_cbranch_vccnz W25
B26:
ds_read_b128 a[0:3], v33 offset:45056
v_mfma_f32_16x16x32_bf16 v[76:79], a[60:63], a[20:23], v[76:79]
ds_read_b64_tr_b16 a[32:33], v41 offset:45056
v_mfma_f32_16x16x32_bf16 v[96:99], a[60:63], a[24:27], v[96:99]
ds_read_b64_tr_b16 a[34:35], v41 offset:45824
v_mfma_f32_16x16x32_bf16 v[116:119], a[60:63], a[28:31], v[116:119]
ds_read_b128 a[4:7], v33 offset:47104
s_waitcnt lgkmcnt(7)
v_mfma_f32_16x16x32_bf16 v[60:63], a[64:67], a[16:19], v[60:63]
ds_read_b128 a[8:11], v33 offset:49152
v_mfma_f32_16x16x32_bf16 v[80:83], a[64:67], a[20:23], v[80:83]
ds_read_b128 a[12:15], v33 offset:51200
v_mfma_f32_16x16x32_bf16 v[100:103], a[64:67], a[24:27], v[100:103]
ds_read_b64_tr_b16 a[36:37], v43 offset:45056
v_mfma_f32_16x16x32_bf16 v[120:123], a[64:67], a[28:31], v[120:123]
ds_read_b64_tr_b16 a[38:39], v43 offset:45824
s_waitcnt lgkmcnt(9)
v_mfma_f32_16x16x32_bf16 v[64:67], a[68:71], a[16:19], v[64:67]
ds_read_b64_tr_b16 a[40:41], v45 offset:45056
v_mfma_f32_16x16x32_bf16 v[84:87], a[68:71], a[20:23], v[84:87]
ds_read_b64_tr_b16 a[42:43], v45 offset:45824
v_mfma_f32_16x16x32_bf16 v[104:107], a[68:71], a[24:27], v[104:107]
v_mfma_f32_16x16x32_bf16 v[124:127], a[68:71], a[28:31], v[124:127]
s_waitcnt lgkmcnt(7)
v_mfma_f32_16x16x32_bf16 v[36:39], a[32:35], a[0:3], v[36:39]
ds_read_b64_tr_b16 a[44:45], v47 offset:45056
s_waitcnt lgkmcnt(7)
v_mfma_f32_16x16x32_bf16 v[68:71], a[32:35], a[4:7], v[68:71]
ds_read_b64_tr_b16 a[46:47], v47 offset:45568
s_waitcnt lgkmcnt(7)
v_mfma_f32_16x16x32_bf16 v[88:91], a[32:35], a[8:11], v[88:91]
s_waitcnt lgkmcnt(6)
v_mfma_f32_16x16x32_bf16 v[108:111], a[32:35], a[12:15], v[108:111]
s_waitcnt lgkmcnt(4)
v_mfma_f32_16x16x32_bf16 v[52:55], a[36:39], a[0:3], v[52:55]
ds_read_b64_tr_b16 a[48:49], v49 offset:45056
v_mfma_f32_16x16x32_bf16 v[72:75], a[36:39], a[4:7], v[72:75]
ds_read_b64_tr_b16 a[50:51], v49 offset:45568
v_mfma_f32_16x16x32_bf16 v[92:95], a[36:39], a[8:11], v[92:95]
v_mfma_f32_16x16x32_bf16 v[112:115], a[36:39], a[12:15], v[112:115]
s_waitcnt lgkmcnt(4)
v_mfma_f32_16x16x32_bf16 v[56:59], a[40:43], a[0:3], v[56:59]
ds_read_b128 a[16:19], v34 offset:45056
v_mfma_f32_16x16x32_bf16 v[76:79], a[40:43], a[4:7], v[76:79]
ds_read_b64_tr_b16 a[52:53], v41 offset:51200
v_mfma_f32_16x16x32_bf16 v[96:99], a[40:43], a[8:11], v[96:99]
ds_read_b64_tr_b16 a[54:55], v41 offset:51968
v_mfma_f32_16x16x32_bf16 v[116:119], a[40:43], a[12:15], v[116:119]
ds_read_b128 a[20:23], v34 offset:47104
s_waitcnt lgkmcnt(6)
v_mfma_f32_16x16x32_bf16 v[60:63], a[44:47], a[0:3], v[60:63]
ds_read_b128 a[24:27], v34 offset:49152
v_mfma_f32_16x16x32_bf16 v[80:83], a[44:47], a[4:7], v[80:83]
ds_read_b128 a[28:31], v34 offset:51200
v_mfma_f32_16x16x32_bf16 v[100:103], a[44:47], a[8:11], v[100:103]
ds_read_b64_tr_b16 a[56:57], v43 offset:51200
v_mfma_f32_16x16x32_bf16 v[120:123], a[44:47], a[12:15], v[120:123]
ds_read_b64_tr_b16 a[58:59], v43 offset:51968
s_waitcnt lgkmcnt(8)
v_mfma_f32_16x16x32_bf16 v[64:67], a[48:51], a[0:3], v[64:67]
ds_read_b64_tr_b16 a[60:61], v45 offset:51200
v_mfma_f32_16x16x32_bf16 v[84:87], a[48:51], a[4:7], v[84:87]
ds_read_b64_tr_b16 a[62:63], v45 offset:51968
ds_read_b64 v[6:7], v3
v_mfma_f32_16x16x32_bf16 v[104:107], a[48:51], a[8:11], v[104:107]
v_mfma_f32_16x16x32_bf16 v[124:127], a[48:51], a[12:15], v[124:127]
s_waitcnt lgkmcnt(8)
v_mfma_f32_16x16x32_bf16 v[36:39], a[52:55], a[16:19], v[36:39]
ds_read_b64_tr_b16 a[64:65], v47 offset:49152
s_waitcnt lgkmcnt(8)
v_mfma_f32_16x16x32_bf16 v[68:71], a[52:55], a[20:23], v[68:71]
ds_read_b64_tr_b16 a[66:67], v47 offset:49664
s_waitcnt lgkmcnt(8)
v_mfma_f32_16x16x32_bf16 v[88:91], a[52:55], a[24:27], v[88:91]
s_waitcnt lgkmcnt(7)
v_mfma_f32_16x16x32_bf16 v[108:111], a[52:55], a[28:31], v[108:111]
s_waitcnt lgkmcnt(5)
v_mfma_f32_16x16x32_bf16 v[52:55], a[56:59], a[16:19], v[52:55]
ds_read_b64_tr_b16 a[68:69], v49 offset:49152
v_mfma_f32_16x16x32_bf16 v[72:75], a[56:59], a[20:23], v[72:75]
ds_read_b64_tr_b16 a[70:71], v49 offset:49664
v_mov_b32 v9, 2
ds_write_b32 v10, v9
v_mfma_f32_16x16x32_bf16 v[92:95], a[56:59], a[24:27], v[92:95]
v_mfma_f32_16x16x32_bf16 v[112:115], a[56:59], a[28:31], v[112:115]
s_waitcnt lgkmcnt(6)
v_mfma_f32_16x16x32_bf16 v[56:59], a[60:63], a[16:19], v[56:59]
s_waitcnt lgkmcnt(5)
v_min_u32 v6, v6, v7
v_cmp_gt_u32 vcc, 3, v6
s_nop 0
s_cbranch_vccnz W27
B28:
ds_read_b128 a[0:3], v31 offset:0
v_mfma_f32_16x16x32_bf16 v[76:79], a[60:63], a[20:23], v[76:79]
ds_read_b64_tr_b16 a[32:33], v40 offset:0
v_mfma_f32_16x16x32_bf16 v[96:99], a[60:63], a[24:27], v[96:99]
ds_read_b64_tr_b16 a[34:35], v40 offset:768
v_mfma_f32_16x16x32_bf16 v[116:119], a[60:63], a[28:31], v[116:119]
ds_read_b128 a[4:7], v31 offset:2048
s_waitcnt lgkmcnt(7)
v_mfma_f32_16x16x32_bf16 v[60:63], a[64:67], a[16:19], v[60:63]
ds_read_b128 a[8:11], v31 offset:4096
v_mfma_f32_16x16x32_bf16 v[80:83], a[64:67], a[20:23], v[80:83]
ds_read_b128 a[12:15], v31 offset:6144
v_mfma_f32_16x16x32_bf16 v[100:103], a[64:67], a[24:27], v[100:103]
ds_read_b64_tr_b16 a[36:37], v42 offset:0
v_mfma_f32_16x16x32_bf16 v[120:123], a[64:67], a[28:31], v[120:123]
ds_read_b64_tr_b16 a[38:39], v42 offset:768
s_waitcnt lgkmcnt(9)
v_mfma_f32_16x16x32_bf16 v[64:67], a[68:71], a[16:19], v[64:67]
ds_read_b64_tr_b16 a[40:41], v44 offset:0
v_mfma_f32_16x16x32_bf16 v[84:87], a[68:71], a[20:23], v[84:87]
ds_read_b64_tr_b16 a[42:43], v44 offset:768
v_mfma_f32_16x16x32_bf16 v[104:107], a[68:71], a[24:27], v[104:107]
v_mfma_f32_16x16x32_bf16 v[124:127], a[68:71], a[28:31], v[124:127]
s_waitcnt lgkmcnt(7)
v_mfma_f32_16x16x32_bf16 v[36:39], a[32:35], a[0:3], v[36:39]
ds_read_b64_tr_b16 a[44:45], v46 offset:0
s_waitcnt lgkmcnt(7)
v_mfma_f32_16x16x32_bf16 v[68:71], a[32:35], a[4:7], v[68:71]
ds_read_b64_tr_b16 a[46:47], v46 offset:512
s_waitcnt lgkmcnt(7)
v_mfma_f32_16x16x32_bf16 v[88:91], a[32:35], a[8:11], v[88:91]
s_waitcnt lgkmcnt(6)
v_mfma_f32_16x16x32_bf16 v[108:111], a[32:35], a[12:15], v[108:111]
s_waitcnt lgkmcnt(4)
v_mfma_f32_16x16x32_bf16 v[52:55], a[36:39], a[0:3], v[52:55]
ds_read_b64_tr_b16 a[48:49], v48 offset:0
v_mfma_f32_16x16x32_bf16 v[72:75], a[36:39], a[4:7], v[72:75]
ds_read_b64_tr_b16 a[50:51], v48 offset:512
v_mfma_f32_16x16x32_bf16 v[92:95], a[36:39], a[8:11], v[92:95]
v_mfma_f32_16x16x32_bf16 v[112:115], a[36:39], a[12:15], v[112:115]
s_waitcnt lgkmcnt(4)
v_mfma_f32_16x16x32_bf16 v[56:59], a[40:43], a[0:3], v[56:59]
ds_read_b128 a[16:19], v32 offset:0
v_mfma_f32_16x16x32_bf16 v[76:79], a[40:43], a[4:7], v[76:79]
ds_read_b64_tr_b16 a[52:53], v40 offset:6144
v_mfma_f32_16x16x32_bf16 v[96:99], a[40:43], a[8:11], v[96:99]
ds_read_b64_tr_b16 a[54:55], v40 offset:6912
v_mfma_f32_16x16x32_bf16 v[116:119], a[40:43], a[12:15], v[116:119]
ds_read_b128 a[20:23], v32 offset:2048
s_waitcnt lgkmcnt(6)
v_mfma_f32_16x16x32_bf16 v[60:63], a[44:47], a[0:3], v[60:63]
ds_read_b128 a[24:27], v32 offset:4096
v_mfma_f32_16x16x32_bf16 v[80:83], a[44:47], a[4:7], v[80:83]
ds_read_b128 a[28:31], v32 offset:6144
v_mfma_f32_16x16x32_bf16 v[100:103], a[44:47], a[8:11], v[100:103]
ds_read_b64_tr_b16 a[56:57], v42 offset:6144
v_mfma_f32_16x16x32_bf16 v[120:123], a[44:47], a[12:15], v[120:123]
ds_read_b64_tr_b16 a[58:59], v42 offset:6912
s_waitcnt lgkmcnt(8)
v_mfma_f32_16x16x32_bf16 v[64:67], a[48:51], a[0:3], v[64:67]
ds_read_b64_tr_b16 a[60:61], v44 offset:6144
v_mfma_f32_16x16x32_bf16 v[84:87], a[48:51], a[4:7], v[84:87]
ds_read_b64_tr_b16 a[62:63], v44 offset:6912
ds_read_b64 v[6:7], v3
v_mfma_f32_16x16x32_bf16 v[104:107], a[48:51], a[8:11], v[104:107]
v_mfma_f32_16x16x32_bf16 v[124:127], a[48:51], a[12:15], v[124:127]
s_waitcnt lgkmcnt(8)
v_mfma_f32_16x16x32_bf16 v[36:39], a[52:55], a[16:19], v[36:39]
ds_read_b64_tr_b16 a[64:65], v46 offset:4096
s_waitcnt lgkmcnt(8)
v_mfma_f32_16x16x32_bf16 v[68:71], a[52:55], a[20:23], v[68:71]
ds_read_b64_tr_b16 a[66:67], v46 offset:4608
s_waitcnt lgkmcnt(8)
v_mfma_f32_16x16x32_bf16 v[88:91], a[52:55], a[24:27], v[88:91]
s_waitcnt lgkmcnt(7)
v_mfma_f32_16x16x32_bf16 v[108:111], a[52:55], a[28:31], v[108:111]
s_waitcnt lgkmcnt(5)
v_mfma_f32_16x16x32_bf16 v[52:55], a[56:59], a[16:19], v[52:55]
ds_read_b64_tr_b16 a[68:69], v48 offset:4096
v_mfma_f32_16x16x32_bf16 v[72:75], a[56:59], a[20:23], v[72:75]
ds_read_b64_tr_b16 a[70:71], v48 offset:4608
v_mov_b32 v9, 3
ds_write_b32 v10, v9
v_mfma_f32_16x16x32_bf16 v[92:95], a[56:59], a[24:27], v[92:95]
v_mfma_f32_16x16x32_bf16 v[112:115], a[56:59], a[28:31], v[112:115]
s_waitcnt lgkmcnt(6)
v_mfma_f32_16x16x32_bf16 v[56:59], a[60:63], a[16:19], v[56:59]
s_waitcnt lgkmcnt(5)
v_min_u32 v6, v6, v7
v_cmp_gt_u32 vcc, 4, v6
s_nop 0
s_cbranch_vccnz W29
B30:
ds_read_b128 a[0:3], v31 offset:36864
v_mfma_f32_16x16x32_bf16 v[76:79], a[60:63], a[20:23], v[76:79]
ds_read_b64_tr_b16 a[32:33], v40 offset:36864
v_mfma_f32_16x16x32_bf16 v[96:99], a[60:63], a[24:27], v[96:99]
ds_read_b64_tr_b16 a[34:35], v40 offset:37632
v_mfma_f32_16x16x32_bf16 v[116:119], a[60:63], a[28:31], v[116:119]
ds_read_b128 a[4:7], v31 offset:38912
s_waitcnt lgkmcnt(7)
v_mfma_f32_16x16x32_bf16 v[60:63], a[64:67], a[16:19], v[60:63]
ds_read_b128 a[8:11], v31 offset:40960
v_mfma_f32_16x16x32_bf16 v[80:83], a[64:67], a[20:23], v[80:83]
ds_read_b128 a[12:15], v31 offset:43008
v_mfma_f32_16x16x32_bf16 v[100:103], a[64:67], a[24:27], v[100:103]
ds_read_b64_tr_b16 a[36:37], v42 offset:36864
v_mfma_f32_16x16x32_bf16 v[120:123], a[64:67], a[28:31], v[120:123]
ds_read_b64_tr_b16 a[38:39], v42 offset:37632
s_waitcnt lgkmcnt(9)
v_mfma_f32_16x16x32_bf16 v[64:67], a[68:71], a[16:19], v[64:67]
ds_read_b64_tr_b16 a[40:41], v44 offset:36864
v_mfma_f32_16x16x32_bf16 v[84:87], a[68:71], a[20:23], v[84:87]
ds_read_b64_tr_b16 a[42:43], v44 offset:37632
v_mfma_f32_16x16x32_bf16 v[104:107], a[68:71], a[24:27], v[104:107]
v_mfma_f32_16x16x32_bf16 v[124:127], a[68:71], a[28:31], v[124:127]
s_waitcnt lgkmcnt(7)
v_mfma_f32_16x16x32_bf16 v[36:39], a[32:35], a[0:3], v[36:39]
ds_read_b64_tr_b16 a[44:45], v46 offset:36864
s_waitcnt lgkmcnt(7)
v_mfma_f32_16x16x32_bf16 v[68:71], a[32:35], a[4:7], v[68:71]
ds_read_b64_tr_b16 a[46:47], v46 offset:37376
s_waitcnt lgkmcnt(7)
v_mfma_f32_16x16x32_bf16 v[88:91], a[32:35], a[8:11], v[88:91]
s_waitcnt lgkmcnt(6)
v_mfma_f32_16x16x32_bf16 v[108:111], a[32:35], a[12:15], v[108:111]
s_waitcnt lgkmcnt(4)
v_mfma_f32_16x16x32_bf16 v[52:55], a[36:39], a[0:3], v[52:55]
ds_read_b64_tr_b16 a[48:49], v48 offset:36864
v_mfma_f32_16x16x32_bf16 v[72:75], a[36:39], a[4:7], v[72:75]
ds_read_b64_tr_b16 a[50:51], v48 offset:37376
v_mfma_f32_16x16x32_bf16 v[92:95], a[36:39], a[8:11], v[92:95]
v_mfma_f32_16x16x32_bf16 v[112:115], a[36:39], a[12:15], v[112:115]
s_waitcnt lgkmcnt(4)
v_mfma_f32_16x16x32_bf16 v[56:59], a[40:43], a[0:3], v[56:59]
ds_read_b128 a[16:19], v32 offset:36864
v_mfma_f32_16x16x32_bf16 v[76:79], a[40:43], a[4:7], v[76:79]
ds_read_b64_tr_b16 a[52:53], v40 offset:43008
v_mfma_f32_16x16x32_bf16 v[96:99], a[40:43], a[8:11], v[96:99]
ds_read_b64_tr_b16 a[54:55], v40 offset:43776
v_mfma_f32_16x16x32_bf16 v[116:119], a[40:43], a[12:15], v[116:119]
ds_read_b128 a[20:23], v32 offset:38912
s_waitcnt lgkmcnt(6)
v_mfma_f32_16x16x32_bf16 v[60:63], a[44:47], a[0:3], v[60:63]
ds_read_b128 a[24:27], v32 offset:40960
v_mfma_f32_16x16x32_bf16 v[80:83], a[44:47], a[4:7], v[80:83]
ds_read_b128 a[28:31], v32 offset:43008
v_mfma_f32_16x16x32_bf16 v[100:103], a[44:47], a[8:11], v[100:103]
ds_read_b64_tr_b16 a[56:57], v42 offset:43008
v_mfma_f32_16x16x32_bf16 v[120:123], a[44:47], a[12:15], v[120:123]
ds_read_b64_tr_b16 a[58:59], v42 offset:43776
s_waitcnt lgkmcnt(8)
v_mfma_f32_16x16x32_bf16 v[64:67], a[48:51], a[0:3], v[64:67]
ds_read_b64_tr_b16 a[60:61], v44 offset:43008
v_mfma_f32_16x16x32_bf16 v[84:87], a[48:51], a[4:7], v[84:87]
ds_read_b64_tr_b16 a[62:63], v44 offset:43776
ds_read_b64 v[6:7], v3
v_mfma_f32_16x16x32_bf16 v[104:107], a[48:51], a[8:11], v[104:107]
v_mfma_f32_16x16x32_bf16 v[124:127], a[48:51], a[12:15], v[124:127]
s_waitcnt lgkmcnt(8)
v_mfma_f32_16x16x32_bf16 v[36:39], a[52:55], a[16:19], v[36:39]
ds_read_b64_tr_b16 a[64:65], v46 offset:40960
s_waitcnt lgkmcnt(8)
v_mfma_f32_16x16x32_bf16 v[68:71], a[52:55], a[20:23], v[68:71]
ds_read_b64_tr_b16 a[66:67], v46 offset:41472
s_waitcnt lgkmcnt(8)
v_mfma_f32_16x16x32_bf16 v[88:91], a[52:55], a[24:27], v[88:91]
s_waitcnt lgkmcnt(7)
v_mfma_f32_16x16x32_bf16 v[108:111], a[52:55], a[28:31], v[108:111]
s_waitcnt lgkmcnt(5)
v_mfma_f32_16x16x32_bf16 v[52:55], a[56:59], a[16:19], v[52:55]
ds_read_b64_tr_b16 a[68:69], v48 offset:40960
v_mfma_f32_16x16x32_bf16 v[72:75], a[56:59], a[20:23], v[72:75]
ds_read_b64_tr_b16 a[70:71], v48 offset:41472
v_mov_b32 v9, 4
ds_write_b32 v10, v9
v_mfma_f32_16x16x32_bf16 v[92:95], a[56:59], a[24:27], v[92:95]
v_mfma_f32_16x16x32_bf16 v[112:115], a[56:59], a[28:31], v[112:115]
s_waitcnt lgkmcnt(6)
v_mfma_f32_16x16x32_bf16 v[56:59], a[60:63], a[16:19], v[56:59]
s_waitcnt lgkmcnt(5)
v_min_u32 v6, v6, v7
v_cmp_gt_u32 vcc, 5, v6
s_nop 0
s_cbranch_vccnz W31
B32:
ds_read_b128 a[0:3], v33 offset:8192
v_mfma_f32_16x16x32_bf16 v[76:79], a[60:63], a[20:23], v[76:79]
ds_read_b64_tr_b16 a[32:33], v41 offset:8192
v_mfma_f32_16x16x32_bf16 v[96:99], a[60:63], a[24:27], v[96:99]
ds_read_b64_tr_b16 a[34:35], v41 offset:8960
v_mfma_f32_16x16x32_bf16 v[116:119], a[60:63], a[28:31], v[116:119]
ds_read_b128 a[4:7], v33 offset:10240
s_waitcnt lgkmcnt(7)
v_mfma_f32_16x16x32_bf16 v[60:63], a[64:67], a[16:19], v[60:63]
ds_read_b128 a[8:11], v33 offset:12288
v_mfma_f32_16x16x32_bf16 v[80:83], a[64:67], a[20:23], v[80:83]
ds_read_b128 a[12:15], v33 offset:14336
v_mfma_f32_16x16x32_bf16 v[100:103], a[64:67], a[24:27], v[100:103]
ds_read_b64_tr_b16 a[36:37], v43 offset:8192
v_mfma_f32_16x16x32_bf16 v[120:123], a[64:67], a[28:31], v[120:123]
ds_read_b64_tr_b16 a[38:39], v43 offset:8960
s_waitcnt lgkmcnt(9)
v_mfma_f32_16x16x32_bf16 v[64:67], a[68:71], a[16:19], v[64:67]
ds_read_b64_tr_b16 a[40:41], v45 offset:8192
v_mfma_f32_16x16x32_bf16 v[84:87], a[68:71], a[20:23], v[84:87]
ds_read_b64_tr_b16 a[42:43], v45 offset:8960
v_mfma_f32_16x16x32_bf16 v[104:107], a[68:71], a[24:27], v[104:107]
v_mfma_f32_16x16x32_bf16 v[124:127], a[68:71], a[28:31], v[124:127]
s_waitcnt lgkmcnt(7)
v_mfma_f32_16x16x32_bf16 v[36:39], a[32:35], a[0:3], v[36:39]
ds_read_b64_tr_b16 a[44:45], v47 offset:8192
s_waitcnt lgkmcnt(7)
v_mfma_f32_16x16x32_bf16 v[68:71], a[32:35], a[4:7], v[68:71]
ds_read_b64_tr_b16 a[46:47], v47 offset:8704
s_waitcnt lgkmcnt(7)
v_mfma_f32_16x16x32_bf16 v[88:91], a[32:35], a[8:11], v[88:91]
s_waitcnt lgkmcnt(6)
v_mfma_f32_16x16x32_bf16 v[108:111], a[32:35], a[12:15], v[108:111]
s_waitcnt lgkmcnt(4)
v_mfma_f32_16x16x32_bf16 v[52:55], a[36:39], a[0:3], v[52:55]
ds_read_b64_tr_b16 a[48:49], v49 offset:8192
v_mfma_f32_16x16x32_bf16 v[72:75], a[36:39], a[4:7], v[72:75]
ds_read_b64_tr_b16 a[50:51], v49 offset:8704
v_mfma_f32_16x16x32_bf16 v[92:95], a[36:39], a[8:11], v[92:95]
v_mfma_f32_16x16x32_bf16 v[112:115], a[36:39], a[12:15], v[112:115]
s_waitcnt lgkmcnt(4)
v_mfma_f32_16x16x32_bf16 v[56:59], a[40:43], a[0:3], v[56:59]
ds_read_b128 a[16:19], v34 offset:8192
v_mfma_f32_16x16x32_bf16 v[76:79], a[40:43], a[4:7], v[76:79]
ds_read_b64_tr_b16 a[52:53], v41 offset:14336
v_mfma_f32_16x16x32_bf16 v[96:99], a[40:43], a[8:11], v[96:99]
ds_read_b64_tr_b16 a[54:55], v41 offset:15104
v_mfma_f32_16x16x32_bf16 v[116:119], a[40:43], a[12:15], v[116:119]
ds_read_b128 a[20:23], v34 offset:10240
s_waitcnt lgkmcnt(6)
v_mfma_f32_16x16x32_bf16 v[60:63], a[44:47], a[0:3], v[60:63]
ds_read_b128 a[24:27], v34 offset:12288
v_mfma_f32_16x16x32_bf16 v[80:83], a[44:47], a[4:7], v[80:83]
ds_read_b128 a[28:31], v34 offset:14336
v_mfma_f32_16x16x32_bf16 v[100:103], a[44:47], a[8:11], v[100:103]
ds_read_b64_tr_b16 a[56:57], v43 offset:14336
v_mfma_f32_16x16x32_bf16 v[120:123], a[44:47], a[12:15], v[120:123]
ds_read_b64_tr_b16 a[58:59], v43 offset:15104
s_waitcnt lgkmcnt(8)
v_mfma_f32_16x16x32_bf16 v[64:67], a[48:51], a[0:3], v[64:67]
ds_read_b64_tr_b16 a[60:61], v45 offset:14336
v_mfma_f32_16x16x32_bf16 v[84:87], a[48:51], a[4:7], v[84:87]
ds_read_b64_tr_b16 a[62:63], v45 offset:15104
ds_read_b64 v[6:7], v3
v_mfma_f32_16x16x32_bf16 v[104:107], a[48:51], a[8:11], v[104:107]
v_mfma_f32_16x16x32_bf16 v[124:127], a[48:51], a[12:15], v[124:127]
s_waitcnt lgkmcnt(8)
v_mfma_f32_16x16x32_bf16 v[36:39], a[52:55], a[16:19], v[36:39]
ds_read_b64_tr_b16 a[64:65], v47 offset:12288
s_waitcnt lgkmcnt(8)
v_mfma_f32_16x16x32_bf16 v[68:71], a[52:55], a[20:23], v[68:71]
ds_read_b64_tr_b16 a[66:67], v47 offset:12800
s_waitcnt lgkmcnt(8)
v_mfma_f32_16x16x32_bf16 v[88:91], a[52:55], a[24:27], v[88:91]
s_waitcnt lgkmcnt(7)
v_mfma_f32_16x16x32_bf16 v[108:111], a[52:55], a[28:31], v[108:111]
s_waitcnt lgkmcnt(5)
v_mfma_f32_16x16x32_bf16 v[52:55], a[56:59], a[16:19], v[52:55]
ds_read_b64_tr_b16 a[68:69], v49 offset:12288
v_mfma_f32_16x16x32_bf16 v[72:75], a[56:59], a[20:23], v[72:75]
ds_read_b64_tr_b16 a[70:71], v49 offset:12800
v_mov_b32 v9, 5
ds_write_b32 v10, v9
v_mfma_f32_16x16x32_bf16 v[92:95], a[56:59], a[24:27], v[92:95]
v_mfma_f32_16x16x32_bf16 v[112:115], a[56:59], a[28:31], v[112:115]
s_waitcnt lgkmcnt(6)
v_mfma_f32_16x16x32_bf16 v[56:59], a[60:63], a[16:19], v[56:59]
s_waitcnt lgkmcnt(5)
v_min_u32 v6, v6, v7
v_cmp_gt_u32 vcc, 6, v6
s_nop 0
s_cbranch_vccnz W33
B34:
ds_read_b128 a[0:3], v33 offset:45056
v_mfma_f32_16x16x32_bf16 v[76:79], a[60:63], a[20:23], v[76:79]
ds_read_b64_tr_b16 a[32:33], v41 offset:45056
v_mfma_f32_16x16x32_bf16 v[96:99], a[60:63], a[24:27], v[96:99]
ds_read_b64_tr_b16 a[34:35], v41 offset:45824
v_mfma_f32_16x16x32_bf16 v[116:119], a[60:63], a[28:31], v[116:119]
ds_read_b128 a[4:7], v33 offset:47104
s_waitcnt lgkmcnt(7)
v_mfma_f32_16x16x32_bf16 v[60:63], a[64:67], a[16:19], v[60:63]
ds_read_b128 a[8:11], v33 offset:49152
v_mfma_f32_16x16x32_bf16 v[80:83], a[64:67], a[20:23], v[80:83]
ds_read_b128 a[12:15], v33 offset:51200
v_mfma_f32_16x16x32_bf16 v[100:103], a[64:67], a[24:27], v[100:103]
ds_read_b64_tr_b16 a[36:37], v43 offset:45056
v_mfma_f32_16x16x32_bf16 v[120:123], a[64:67], a[28:31], v[120:123]
ds_read_b64_tr_b16 a[38:39], v43 offset:45824
s_waitcnt lgkmcnt(9)
v_mfma_f32_16x16x32_bf16 v[64:67], a[68:71], a[16:19], v[64:67]
ds_read_b64_tr_b16 a[40:41], v45 offset:45056
v_mfma_f32_16x16x32_bf16 v[84:87], a[68:71], a[20:23], v[84:87]
ds_read_b64_tr_b16 a[42:43], v45 offset:45824
v_mfma_f32_16x16x32_bf16 v[104:107], a[68:71], a[24:27], v[104:107]
v_mfma_f32_16x16x32_bf16 v[124:127], a[68:71], a[28:31], v[124:127]
s_waitcnt lgkmcnt(7)
v_mfma_f32_16x16x32_bf16 v[36:39], a[32:35], a[0:3], v[36:39]
ds_read_b64_tr_b16 a[44:45], v47 offset:45056
s_waitcnt lgkmcnt(7)
v_mfma_f32_16x16x32_bf16 v[68:71], a[32:35], a[4:7], v[68:71]
ds_read_b64_tr_b16 a[46:47], v47 offset:45568
s_waitcnt lgkmcnt(7)
v_mfma_f32_16x16x32_bf16 v[88:91], a[32:35], a[8:11], v[88:91]
s_waitcnt lgkmcnt(6)
v_mfma_f32_16x16x32_bf16 v[108:111], a[32:35], a[12:15], v[108:111]
s_waitcnt lgkmcnt(4)
v_mfma_f32_16x16x32_bf16 v[52:55], a[36:39], a[0:3], v[52:55]
ds_read_b64_tr_b16 a[48:49], v49 offset:45056
v_mfma_f32_16x16x32_bf16 v[72:75], a[36:39], a[4:7], v[72:75]
ds_read_b64_tr_b16 a[50:51], v49 offset:45568
v_mfma_f32_16x16x32_bf16 v[92:95], a[36:39], a[8:11], v[92:95]
v_mfma_f32_16x16x32_bf16 v[112:115], a[36:39], a[12:15], v[112:115]
s_waitcnt lgkmcnt(4)
v_mfma_f32_16x16x32_bf16 v[56:59], a[40:43], a[0:3], v[56:59]
ds_read_b128 a[16:19], v34 offset:45056
v_mfma_f32_16x16x32_bf16 v[76:79], a[40:43], a[4:7], v[76:79]
ds_read_b64_tr_b16 a[52:53], v41 offset:51200
v_mfma_f32_16x16x32_bf16 v[96:99], a[40:43], a[8:11], v[96:99]
ds_read_b64_tr_b16 a[54:55], v41 offset:51968
v_mfma_f32_16x16x32_bf16 v[116:119], a[40:43], a[12:15], v[116:119]
ds_read_b128 a[20:23], v34 offset:47104
s_waitcnt lgkmcnt(6)
v_mfma_f32_16x16x32_bf16 v[60:63], a[44:47], a[0:3], v[60:63]
ds_read_b128 a[24:27], v34 offset:49152
v_mfma_f32_16x16x32_bf16 v[80:83], a[44:47], a[4:7], v[80:83]
ds_read_b128 a[28:31], v34 offset:51200
v_mfma_f32_16x16x32_bf16 v[100:103], a[44:47], a[8:11], v[100:103]
ds_read_b64_tr_b16 a[56:57], v43 offset:51200
v_mfma_f32_16x16x32_bf16 v[120:123], a[44:47], a[12:15], v[120:123]
ds_read_b64_tr_b16 a[58:59], v43 offset:51968
s_waitcnt lgkmcnt(8)
v_mfma_f32_16x16x32_bf16 v[64:67], a[48:51], a[0:3], v[64:67]
ds_read_b64_tr_b16 a[60:61], v45 offset:51200
v_mfma_f32_16x16x32_bf16 v[84:87], a[48:51], a[4:7], v[84:87]
ds_read_b64_tr_b16 a[62:63], v45 offset:51968
ds_read_b64 v[6:7], v3
v_mfma_f32_16x16x32_bf16 v[104:107], a[48:51], a[8:11], v[104:107]
v_mfma_f32_16x16x32_bf16 v[124:127], a[48:51], a[12:15], v[124:127]
s_waitcnt lgkmcnt(8)
v_mfma_f32_16x16x32_bf16 v[36:39], a[52:55], a[16:19], v[36:39]
ds_read_b64_tr_b16 a[64:65], v47 offset:49152
s_waitcnt lgkmcnt(8)
v_mfma_f32_16x16x32_bf16 v[68:71], a[52:55], a[20:23], v[68:71]
ds_read_b64_tr_b16 a[66:67], v47 offset:49664
s_waitcnt lgkmcnt(8)
v_mfma_f32_16x16x32_bf16 v[88:91], a[52:55], a[24:27], v[88:91]
s_waitcnt lgkmcnt(7)
v_mfma_f32_16x16x32_bf16 v[108:111], a[52:55], a[28:31], v[108:111]
s_waitcnt lgkmcnt(5)
v_mfma_f32_16x16x32_bf16 v[52:55], a[56:59], a[16:19], v[52:55]
ds_read_b64_tr_b16 a[68:69], v49 offset:49152
v_mfma_f32_16x16x32_bf16 v[72:75], a[56:59], a[20:23], v[72:75]
ds_read_b64_tr_b16 a[70:71], v49 offset:49664
v_mov_b32 v9, 6
ds_write_b32 v10, v9
v_mfma_f32_16x16x32_bf16 v[92:95], a[56:59], a[24:27], v[92:95]
v_mfma_f32_16x16x32_bf16 v[112:115], a[56:59], a[28:31], v[112:115]
s_waitcnt lgkmcnt(6)
v_mfma_f32_16x16x32_bf16 v[56:59], a[60:63], a[16:19], v[56:59]
s_waitcnt lgkmcnt(5)
v_min_u32 v6, v6, v7
v_cmp_gt_u32 vcc, 7, v6
s_nop 0
s_cbranch_vccnz W35
B36:
ds_read_b128 a[0:3], v31 offset:0
v_mfma_f32_16x16x32_bf16 v[76:79], a[60:63], a[20:23], v[76:79]
ds_read_b64_tr_b16 a[32:33], v40 offset:0
v_mfma_f32_16x16x32_bf16 v[96:99], a[60:63], a[24:27], v[96:99]
ds_read_b64_tr_b16 a[34:35], v40 offset:768
v_mfma_f32_16x16x32_bf16 v[116:119], a[60:63], a[28:31], v[116:119]
ds_read_b128 a[4:7], v31 offset:2048
s_waitcnt lgkmcnt(7)
v_mfma_f32_16x16x32_bf16 v[60:63], a[64:67], a[16:19], v[60:63]
ds_read_b128 a[8:11], v31 offset:4096
v_mfma_f32_16x16x32_bf16 v[80:83], a[64:67], a[20:23], v[80:83]
ds_read_b128 a[12:15], v31 offset:6144
v_mfma_f32_16x16x32_bf16 v[100:103], a[64:67], a[24:27], v[100:103]
ds_read_b64_tr_b16 a[36:37], v42 offset:0
v_mfma_f32_16x16x32_bf16 v[120:123], a[64:67], a[28:31], v[120:123]
ds_read_b64_tr_b16 a[38:39], v42 offset:768
s_waitcnt lgkmcnt(9)
v_mfma_f32_16x16x32_bf16 v[64:67], a[68:71], a[16:19], v[64:67]
ds_read_b64_tr_b16 a[40:41], v44 offset:0
v_mfma_f32_16x16x32_bf16 v[84:87], a[68:71], a[20:23], v[84:87]
ds_read_b64_tr_b16 a[42:43], v44 offset:768
v_mfma_f32_16x16x32_bf16 v[104:107], a[68:71], a[24:27], v[104:107]
v_mfma_f32_16x16x32_bf16 v[124:127], a[68:71], a[28:31], v[124:127]
s_waitcnt lgkmcnt(7)
v_mfma_f32_16x16x32_bf16 v[36:39], a[32:35], a[0:3], v[36:39]
ds_read_b64_tr_b16 a[44:45], v46 offset:0
s_waitcnt lgkmcnt(7)
v_mfma_f32_16x16x32_bf16 v[68:71], a[32:35], a[4:7], v[68:71]
ds_read_b64_tr_b16 a[46:47], v46 offset:512
s_waitcnt lgkmcnt(7)
v_mfma_f32_16x16x32_bf16 v[88:91], a[32:35], a[8:11], v[88:91]
s_waitcnt lgkmcnt(6)
v_mfma_f32_16x16x32_bf16 v[108:111], a[32:35], a[12:15], v[108:111]
s_waitcnt lgkmcnt(4)
v_mfma_f32_16x16x32_bf16 v[52:55], a[36:39], a[0:3], v[52:55]
ds_read_b64_tr_b16 a[48:49], v48 offset:0
v_mfma_f32_16x16x32_bf16 v[72:75], a[36:39], a[4:7], v[72:75]
ds_read_b64_tr_b16 a[50:51], v48 offset:512
v_mfma_f32_16x16x32_bf16 v[92:95], a[36:39], a[8:11], v[92:95]
v_mfma_f32_16x16x32_bf16 v[112:115], a[36:39], a[12:15], v[112:115]
s_waitcnt lgkmcnt(4)
v_mfma_f32_16x16x32_bf16 v[56:59], a[40:43], a[0:3], v[56:59]
ds_read_b128 a[16:19], v32 offset:0
v_mfma_f32_16x16x32_bf16 v[76:79], a[40:43], a[4:7], v[76:79]
ds_read_b64_tr_b16 a[52:53], v40 offset:6144
v_mfma_f32_16x16x32_bf16 v[96:99], a[40:43], a[8:11], v[96:99]
ds_read_b64_tr_b16 a[54:55], v40 offset:6912
v_mfma_f32_16x16x32_bf16 v[116:119], a[40:43], a[12:15], v[116:119]
ds_read_b128 a[20:23], v32 offset:2048
s_waitcnt lgkmcnt(6)
v_mfma_f32_16x16x32_bf16 v[60:63], a[44:47], a[0:3], v[60:63]
ds_read_b128 a[24:27], v32 offset:4096
v_mfma_f32_16x16x32_bf16 v[80:83], a[44:47], a[4:7], v[80:83]
ds_read_b128 a[28:31], v32 offset:6144
v_mfma_f32_16x16x32_bf16 v[100:103], a[44:47], a[8:11], v[100:103]
ds_read_b64_tr_b16 a[56:57], v42 offset:6144
v_mfma_f32_16x16x32_bf16 v[120:123], a[44:47], a[12:15], v[120:123]
ds_read_b64_tr_b16 a[58:59], v42 offset:6912
s_waitcnt lgkmcnt(8)
v_mfma_f32_16x16x32_bf16 v[64:67], a[48:51], a[0:3], v[64:67]
ds_read_b64_tr_b16 a[60:61], v44 offset:6144
v_mfma_f32_16x16x32_bf16 v[84:87], a[48:51], a[4:7], v[84:87]
ds_read_b64_tr_b16 a[62:63], v44 offset:6912
ds_read_b64 v[6:7], v3
v_mfma_f32_16x16x32_bf16 v[104:107], a[48:51], a[8:11], v[104:107]
v_mfma_f32_16x16x32_bf16 v[124:127], a[48:51], a[12:15], v[124:127]
s_waitcnt lgkmcnt(8)
v_mfma_f32_16x16x32_bf16 v[36:39], a[52:55], a[16:19], v[36:39]
ds_read_b64_tr_b16 a[64:65], v46 offset:4096
s_waitcnt lgkmcnt(8)
v_mfma_f32_16x16x32_bf16 v[68:71], a[52:55], a[20:23], v[68:71]
ds_read_b64_tr_b16 a[66:67], v46 offset:4608
s_waitcnt lgkmcnt(8)
v_mfma_f32_16x16x32_bf16 v[88:91], a[52:55], a[24:27], v[88:91]
s_waitcnt lgkmcnt(7)
v_mfma_f32_16x16x32_bf16 v[108:111], a[52:55], a[28:31], v[108:111]
s_waitcnt lgkmcnt(5)
v_mfma_f32_16x16x32_bf16 v[52:55], a[56:59], a[16:19], v[52:55]
ds_read_b64_tr_b16 a[68:69], v48 offset:4096
v_mfma_f32_16x16x32_bf16 v[72:75], a[56:59], a[20:23], v[72:75]
ds_read_b64_tr_b16 a[70:71], v48 offset:4608
v_mov_b32 v9, 7
ds_write_b32 v10, v9
v_mfma_f32_16x16x32_bf16 v[92:95], a[56:59], a[24:27], v[92:95]
v_mfma_f32_16x16x32_bf16 v[112:115], a[56:59], a[28:31], v[112:115]
s_waitcnt lgkmcnt(6)
v_mfma_f32_16x16x32_bf16 v[56:59], a[60:63], a[16:19], v[56:59]
s_waitcnt lgkmcnt(5)
v_min_u32 v6, v6, v7
v_cmp_gt_u32 vcc, 8, v6
s_nop 0
s_cbranch_vccnz W37
B38:
ds_read_b128 a[0:3], v31 offset:36864
v_mfma_f32_16x16x32_bf16 v[76:79], a[60:63], a[20:23], v[76:79]
ds_read_b64_tr_b16 a[32:33], v40 offset:36864
v_mfma_f32_16x16x32_bf16 v[96:99], a[60:63], a[24:27], v[96:99]
ds_read_b64_tr_b16 a[34:35], v40 offset:37632
v_mfma_f32_16x16x32_bf16 v[116:119], a[60:63], a[28:31], v[116:119]
ds_read_b128 a[4:7], v31 offset:38912
s_waitcnt lgkmcnt(7)
v_mfma_f32_16x16x32_bf16 v[60:63], a[64:67], a[16:19], v[60:63]
ds_read_b128 a[8:11], v31 offset:40960
v_mfma_f32_16x16x32_bf16 v[80:83], a[64:67], a[20:23], v[80:83]
ds_read_b128 a[12:15], v31 offset:43008
v_mfma_f32_16x16x32_bf16 v[100:103], a[64:67], a[24:27], v[100:103]
ds_read_b64_tr_b16 a[36:37], v42 offset:36864
v_mfma_f32_16x16x32_bf16 v[120:123], a[64:67], a[28:31], v[120:123]
ds_read_b64_tr_b16 a[38:39], v42 offset:37632
s_waitcnt lgkmcnt(9)
v_mfma_f32_16x16x32_bf16 v[64:67], a[68:71], a[16:19], v[64:67]
ds_read_b64_tr_b16 a[40:41], v44 offset:36864
v_mfma_f32_16x16x32_bf16 v[84:87], a[68:71], a[20:23], v[84:87]
ds_read_b64_tr_b16 a[42:43], v44 offset:37632
v_mfma_f32_16x16x32_bf16 v[104:107], a[68:71], a[24:27], v[104:107]
v_mfma_f32_16x16x32_bf16 v[124:127], a[68:71], a[28:31], v[124:127]
s_waitcnt lgkmcnt(7)
v_mfma_f32_16x16x32_bf16 v[36:39], a[32:35], a[0:3], v[36:39]
ds_read_b64_tr_b16 a[44:45], v46 offset:36864
s_waitcnt lgkmcnt(7)
v_mfma_f32_16x16x32_bf16 v[68:71], a[32:35], a[4:7], v[68:71]
ds_read_b64_tr_b16 a[46:47], v46 offset:37376
s_waitcnt lgkmcnt(7)
v_mfma_f32_16x16x32_bf16 v[88:91], a[32:35], a[8:11], v[88:91]
s_waitcnt lgkmcnt(6)
v_mfma_f32_16x16x32_bf16 v[108:111], a[32:35], a[12:15], v[108:111]
s_waitcnt lgkmcnt(4)
v_mfma_f32_16x16x32_bf16 v[52:55], a[36:39], a[0:3], v[52:55]
ds_read_b64_tr_b16 a[48:49], v48 offset:36864
v_mfma_f32_16x16x32_bf16 v[72:75], a[36:39], a[4:7], v[72:75]
ds_read_b64_tr_b16 a[50:51], v48 offset:37376
v_mfma_f32_16x16x32_bf16 v[92:95], a[36:39], a[8:11], v[92:95]
v_mfma_f32_16x16x32_bf16 v[112:115], a[36:39], a[12:15], v[112:115]
s_waitcnt lgkmcnt(4)
v_mfma_f32_16x16x32_bf16 v[56:59], a[40:43], a[0:3], v[56:59]
ds_read_b128 a[16:19], v32 offset:36864
v_mfma_f32_16x16x32_bf16 v[76:79], a[40:43], a[4:7], v[76:79]
ds_read_b64_tr_b16 a[52:53], v40 offset:43008
ds_read_b32 v6, v3 offset:36
s_waitcnt lgkmcnt(0)
v_cmp_gt_u32 vcc, 1, v6
s_nop 0
s_cbranch_vccnz W39
B40:
s_mov_b64 exec, 0xffff
ds_read_b64 v[144:145], v50 offset:0
ds_read_b64 v[148:149], v50 offset:128
ds_read_b64 v[152:153], v50 offset:256
ds_read_b64 v[156:157], v51 offset:0
ds_read_b64 v[160:161], v51 offset:128
s_mov_b64 exec, -1
v_mfma_f32_16x16x32_bf16 v[96:99], a[40:43], a[8:11], v[96:99]
ds_read_b64_tr_b16 a[54:55], v40 offset:43776
ds_read_b64 v[128:129], v21 offset:0
v_mfma_f32_16x16x32_bf16 v[116:119], a[40:43], a[12:15], v[116:119]
ds_read_b128 a[20:23], v32 offset:38912
ds_read_b64 v[132:133], v21 offset:128
v_mfma_f32_16x16x32_bf16 v[60:63], a[44:47], a[0:3], v[60:63]
ds_read_b128 a[24:27], v32 offset:40960
ds_read_b64 v[136:137], v21 offset:256
v_mfma_f32_16x16x32_bf16 v[80:83], a[44:47], a[4:7], v[80:83]
ds_read_b128 a[28:31], v32 offset:43008
ds_read_b64 v[140:141], v21 offset:384
v_mfma_f32_16x16x32_bf16 v[100:103], a[44:47], a[8:11], v[100:103]
ds_read_b64_tr_b16 a[56:57], v42 offset:43008
ds_read_b32 v2, v3 offset:76
v_mfma_f32_16x16x32_bf16 v[120:123], a[44:47], a[12:15], v[120:123]
ds_read_b64_tr_b16 a[58:59], v42 offset:43776
s_lshl_b32 s48, s52, 7
s_add_u32 s48, s48, 161280
v_lshl_add_u32 v30, v11, 3, s48
v_mfma_f32_16x16x32_bf16 v[64:67], a[48:51], a[0:3], v[64:67]
ds_read_b64_tr_b16 a[60:61], v44 offset:43008
ds_read_b64 v[22:23], v30
v_mfma_f32_16x16x32_bf16 v[84:87], a[48:51], a[4:7], v[84:87]
ds_read_b64_tr_b16 a[62:63], v44 offset:43776
ds_read_b64 v[6:7], v3
v_and_b32 v30, 31, v1
v_mfma_f32_16x16x32_bf16 v[104:107], a[48:51], a[8:11], v[104:107]
v_lshlrev_b32 v30, 3, v30
v_add_u32 v30, 155648, v30
v_mfma_f32_16x16x32_bf16 v[124:127], a[48:51], a[12:15], v[124:127]
ds_read_b64 v[24:25], v30 offset:1280
ds_read_b64 v[26:27], v30 offset:1536
s_waitcnt lgkmcnt(15)
v_mfma_f32_16x16x32_bf16 v[36:39], a[52:55], a[16:19], v[36:39]
ds_read_b64_tr_b16 a[64:65], v46 offset:40960
ds_read_b64 v[28:29], v30 offset:1792
s_waitcnt lgkmcnt(15)
v_mfma_f32_16x16x32_bf16 v[68:71], a[52:55], a[20:23], v[68:71]
ds_read_b64_tr_b16 a[66:67], v46 offset:41472
s_waitcnt lgkmcnt(10)
v_readfirstlane_b32 s53, v2
v_mfma_f32_16x16x32_bf16 v[88:91], a[52:55], a[24:27], v[88:91]
v_mfma_f32_16x16x32_bf16 v[108:111], a[52:55], a[28:31], v[108:111]
s_waitcnt lgkmcnt(9)
v_mfma_f32_16x16x32_bf16 v[52:55], a[56:59], a[16:19], v[52:55]
ds_read_b64_tr_b16 a[68:69], v48 offset:40960
v_mfma_f32_16x16x32_bf16 v[72:75], a[56:59], a[20:23], v[72:75]
ds_read_b64_tr_b16 a[70:71], v48 offset:41472
v_mov_b32 v9, 8
ds_write_b32 v10, v9
v_mfma_f32_16x16x32_bf16 v[92:95], a[56:59], a[24:27], v[92:95]
v_mfma_f32_16x16x32_bf16 v[112:115], a[56:59], a[28:31], v[112:115]
s_waitcnt lgkmcnt(9)
v_mfma_f32_16x16x32_bf16 v[56:59], a[60:63], a[16:19], v[56:59]
s_waitcnt lgkmcnt(8)
v_min_u32 v6, v6, v7
v_cmp_gt_u32 vcc, 9, v6
s_nop 0
s_cbranch_vccnz W41
B42:
ds_read_b128 a[0:3], v33 offset:8192
v_mfma_f32_16x16x32_bf16 v[76:79], a[60:63], a[20:23], v[76:79]
ds_read_b64_tr_b16 a[32:33], v41 offset:8192
v_mfma_f32_16x16x32_bf16 v[96:99], a[60:63], a[24:27], v[96:99]
ds_read_b64_tr_b16 a[34:35], v41 offset:8960
v_mfma_f32_16x16x32_bf16 v[116:119], a[60:63], a[28:31], v[116:119]
ds_read_b128 a[4:7], v33 offset:10240
s_waitcnt lgkmcnt(7)
v_mfma_f32_16x16x32_bf16 v[60:63], a[64:67], a[16:19], v[60:63]
ds_read_b128 a[8:11], v33 offset:12288
v_mfma_f32_16x16x32_bf16 v[80:83], a[64:67], a[20:23], v[80:83]
ds_read_b128 a[12:15], v33 offset:14336
v_mfma_f32_16x16x32_bf16 v[100:103], a[64:67], a[24:27], v[100:103]
ds_read_b64_tr_b16 a[36:37], v43 offset:8192
v_mfma_f32_16x16x32_bf16 v[120:123], a[64:67], a[28:31], v[120:123]
ds_read_b64_tr_b16 a[38:39], v43 offset:8960
s_waitcnt lgkmcnt(9)
v_mfma_f32_16x16x32_bf16 v[64:67], a[68:71], a[16:19], v[64:67]
ds_read_b64_tr_b16 a[40:41], v45 offset:8192
v_mfma_f32_16x16x32_bf16 v[84:87], a[68:71], a[20:23], v[84:87]
ds_read_b64_tr_b16 a[42:43], v45 offset:8960
v_mfma_f32_16x16x32_bf16 v[104:107], a[68:71], a[24:27], v[104:107]
v_mfma_f32_16x16x32_bf16 v[124:127], a[68:71], a[28:31], v[124:127]
s_waitcnt lgkmcnt(7)
v_mfma_f32_16x16x32_bf16 v[36:39], a[32:35], a[0:3], v[36:39]
ds_read_b64_tr_b16 a[44:45], v47 offset:8192
s_waitcnt lgkmcnt(7)
v_mfma_f32_16x16x32_bf16 v[68:71], a[32:35], a[4:7], v[68:71]
ds_read_b64_tr_b16 a[46:47], v47 offset:8704
s_waitcnt lgkmcnt(7)
v_mfma_f32_16x16x32_bf16 v[88:91], a[32:35], a[8:11], v[88:91]
s_waitcnt lgkmcnt(6)
v_mfma_f32_16x16x32_bf16 v[108:111], a[32:35], a[12:15], v[108:111]
s_waitcnt lgkmcnt(4)
v_mfma_f32_16x16x32_bf16 v[52:55], a[36:39], a[0:3], v[52:55]
ds_read_b64_tr_b16 a[48:49], v49 offset:8192
v_mfma_f32_16x16x32_bf16 v[72:75], a[36:39], a[4:7], v[72:75]
ds_read_b64_tr_b16 a[50:51], v49 offset:8704
v_mfma_f32_16x16x32_bf16 v[92:95], a[36:39], a[8:11], v[92:95]
v_mfma_f32_16x16x32_bf16 v[112:115], a[36:39], a[12:15], v[112:115]
s_waitcnt lgkmcnt(4)
v_mfma_f32_16x16x32_bf16 v[56:59], a[40:43], a[0:3], v[56:59]
v_mfma_f32_16x16x32_bf16 v[76:79], a[40:43], a[4:7], v[76:79]
v_mfma_f32_16x16x32_bf16 v[96:99], a[40:43], a[8:11], v[96:99]
v_mfma_f32_16x16x32_bf16 v[116:119], a[40:43], a[12:15], v[116:119]
s_waitcnt lgkmcnt(2)
v_mfma_f32_16x16x32_bf16 v[60:63], a[44:47], a[0:3], v[60:63]
v_mfma_f32_16x16x32_bf16 v[80:83], a[44:47], a[4:7], v[80:83]
v_mfma_f32_16x16x32_bf16 v[100:103], a[44:47], a[8:11], v[100:103]
v_mfma_f32_16x16x32_bf16 v[120:123], a[44:47], a[12:15], v[120:123]
s_waitcnt lgkmcnt(0)
v_mfma_f32_16x16x32_bf16 v[64:67], a[48:51], a[0:3], v[64:67]
v_mfma_f32_16x16x32_bf16 v[84:87], a[48:51], a[4:7], v[84:87]
v_mfma_f32_16x16x32_bf16 v[104:107], a[48:51], a[8:11], v[104:107]
v_mfma_f32_16x16x32_bf16 v[124:127], a[48:51], a[12:15], v[124:127]
v_mfma_f32_16x16x32_bf16 v[36:39], v[144:147], v[128:131], v[36:39]
v_mfma_f32_16x16x32_bf16 v[68:71], v[144:147], v[132:135], v[68:71]
v_mfma_f32_16x16x32_bf16 v[88:91], v[144:147], v[136:139], v[88:91]
v_mfma_f32_16x16x32_bf16 v[108:111], v[144:147], v[140:143], v[108:111]
v_mfma_f32_16x16x32_bf16 v[52:55], v[148:151], v[128:131], v[52:55]
v_mfma_f32_16x16x32_bf16 v[72:75], v[148:151], v[132:135], v[72:75]
v_mfma_f32_16x16x32_bf16 v[92:95], v[148:151], v[136:139], v[92:95]
v_mfma_f32_16x16x32_bf16 v[112:115], v[148:151], v[140:143], v[112:115]
v_mfma_f32_16x16x32_bf16 v[56:59], v[152:155], v[128:131], v[56:59]
ds_read_b128 a[16:19], v34 offset:8192
v_mfma_f32_16x16x32_bf16 v[76:79], v[152:155], v[132:135], v[76:79]
ds_read_b64_tr_b16 a[52:53], v41 offset:14336
v_mfma_f32_16x16x32_bf16 v[96:99], v[152:155], v[136:139], v[96:99]
ds_read_b64_tr_b16 a[54:55], v41 offset:15104
v_mfma_f32_16x16x32_bf16 v[116:119], v[152:155], v[140:143], v[116:119]
ds_read_b128 a[20:23], v34 offset:10240
v_mfma_f32_16x16x32_bf16 v[60:63], v[156:159], v[128:131], v[60:63]
ds_read_b128 a[24:27], v34 offset:12288
v_mfma_f32_16x16x32_bf16 v[80:83], v[156:159], v[132:135], v[80:83]
ds_read_b128 a[28:31], v34 offset:14336
v_mfma_f32_16x16x32_bf16 v[100:103], v[156:159], v[136:139], v[100:103]
ds_read_b64_tr_b16 a[56:57], v43 offset:14336
v_mfma_f32_16x16x32_bf16 v[120:123], v[156:159], v[140:143], v[120:123]
ds_read_b64_tr_b16 a[58:59], v43 offset:15104
v_mfma_f32_16x16x32_bf16 v[64:67], v[160:163], v[128:131], v[64:67]
ds_read_b64_tr_b16 a[60:61], v45 offset:14336
v_mfma_f32_16x16x32_bf16 v[84:87], v[160:163], v[132:135], v[84:87]
ds_read_b64_tr_b16 a[62:63], v45 offset:15104
ds_read_b64 v[6:7], v3
v_mfma_f32_16x16x32_bf16 v[104:107], v[160:163], v[136:139], v[104:107]
v_mfma_f32_16x16x32_bf16 v[124:127], v[160:163], v[140:143], v[124:127]
s_waitcnt lgkmcnt(8)
v_mfma_f32_16x16x32_bf16 v[36:39], a[52:55], a[16:19], v[36:39]
ds_read_b64_tr_b16 a[64:65], v47 offset:12288
s_waitcnt lgkmcnt(8)
v_mfma_f32_16x16x32_bf16 v[68:71], a[52:55], a[20:23], v[68:71]
ds_read_b64_tr_b16 a[66:67], v47 offset:12800
s_waitcnt lgkmcnt(8)
v_mfma_f32_16x16x32_bf16 v[88:91], a[52:55], a[24:27], v[88:91]
s_waitcnt lgkmcnt(7)
v_mfma_f32_16x16x32_bf16 v[108:111], a[52:55], a[28:31], v[108:111]
s_waitcnt lgkmcnt(5)
v_mfma_f32_16x16x32_bf16 v[52:55], a[56:59], a[16:19], v[52:55]
ds_read_b64_tr_b16 a[68:69], v49 offset:12288
v_mfma_f32_16x16x32_bf16 v[72:75], a[56:59], a[20:23], v[72:75]
ds_read_b64_tr_b16 a[70:71], v49 offset:12800
v_mov_b32 v9, 9
ds_write_b32 v10, v9
v_mfma_f32_16x16x32_bf16 v[92:95], a[56:59], a[24:27], v[92:95]
v_mfma_f32_16x16x32_bf16 v[112:115], a[56:59], a[28:31], v[112:115]
s_waitcnt lgkmcnt(6)
v_mfma_f32_16x16x32_bf16 v[56:59], a[60:63], a[16:19], v[56:59]
s_waitcnt lgkmcnt(5)
v_min_u32 v6, v6, v7
v_cmp_gt_u32 vcc, 10, v6
s_nop 0
s_cbranch_vccnz W43
B44:
ds_read_b128 a[0:3], v33 offset:45056
v_mfma_f32_16x16x32_bf16 v[76:79], a[60:63], a[20:23], v[76:79]
ds_read_b64_tr_b16 a[32:33], v41 offset:45056
v_mfma_f32_16x16x32_bf16 v[96:99], a[60:63], a[24:27], v[96:99]
ds_read_b64_tr_b16 a[34:35], v41 offset:45824
v_mfma_f32_16x16x32_bf16 v[116:119], a[60:63], a[28:31], v[116:119]
ds_read_b128 a[4:7], v33 offset:47104
s_waitcnt lgkmcnt(7)
v_mfma_f32_16x16x32_bf16 v[60:63], a[64:67], a[16:19], v[60:63]
ds_read_b128 a[8:11], v33 offset:49152
v_mfma_f32_16x16x32_bf16 v[80:83], a[64:67], a[20:23], v[80:83]
ds_read_b128 a[12:15], v33 offset:51200
v_mfma_f32_16x16x32_bf16 v[100:103], a[64:67], a[24:27], v[100:103]
ds_read_b64_tr_b16 a[36:37], v43 offset:45056
v_mfma_f32_16x16x32_bf16 v[120:123], a[64:67], a[28:31], v[120:123]
ds_read_b64_tr_b16 a[38:39], v43 offset:45824
s_waitcnt lgkmcnt(9)
v_mfma_f32_16x16x32_bf16 v[64:67], a[68:71], a[16:19], v[64:67]
ds_read_b64_tr_b16 a[40:41], v45 offset:45056
v_mfma_f32_16x16x32_bf16 v[84:87], a[68:71], a[20:23], v[84:87]
ds_read_b64_tr_b16 a[42:43], v45 offset:45824
v_mfma_f32_16x16x32_bf16 v[104:107], a[68:71], a[24:27], v[104:107]
v_mfma_f32_16x16x32_bf16 v[124:127], a[68:71], a[28:31], v[124:127]
ds_read_b128 v[128:131], v164 offset:0
ds_read_b128 v[132:135], v164 offset:256
ds_read_b128 v[136:139], v164 offset:512
ds_read_b128 v[140:143], v164 offset:768
s_waitcnt lgkmcnt(11)
v_mfma_f32_16x16x32_bf16 v[36:39], a[32:35], a[0:3], v[36:39]
ds_read_b128 a[16:19], v34 offset:45056
s_waitcnt lgkmcnt(11)
v_mfma_f32_16x16x32_bf16 v[68:71], a[32:35], a[4:7], v[68:71]
ds_read_b64_tr_b16 a[52:53], v41 offset:51200
s_waitcnt lgkmcnt(11)
v_mfma_f32_16x16x32_bf16 v[88:91], a[32:35], a[8:11], v[88:91]
ds_read_b64_tr_b16 a[54:55], v41 offset:51968
s_waitcnt lgkmcnt(11)
v_mfma_f32_16x16x32_bf16 v[108:111], a[32:35], a[12:15], v[108:111]
ds_read_b128 a[20:23], v34 offset:47104
s_waitcnt lgkmcnt(10)
v_mfma_f32_16x16x32_bf16 v[52:55], a[36:39], a[0:3], v[52:55]
ds_read_b128 a[24:27], v34 offset:49152
v_mfma_f32_16x16x32_bf16 v[72:75], a[36:39], a[4:7], v[72:75]
ds_read_b128 a[28:31], v34 offset:51200
v_mfma_f32_16x16x32_bf16 v[92:95], a[36:39], a[8:11], v[92:95]
ds_read_b64_tr_b16 a[56:57], v43 offset:51200
v_mfma_f32_16x16x32_bf16 v[112:115], a[36:39], a[12:15], v[112:115]
ds_read_b64_tr_b16 a[58:59], v43 offset:51968
s_waitcnt lgkmcnt(12)
v_mfma_f32_16x16x32_bf16 v[56:59], a[40:43], a[0:3], v[56:59]
ds_read_b64_tr_b16 a[60:61], v45 offset:51200
v_mfma_f32_16x16x32_bf16 v[76:79], a[40:43], a[4:7], v[76:79]
ds_read_b64_tr_b16 a[62:63], v45 offset:51968
v_mfma_f32_16x16x32_bf16 v[96:99], a[40:43], a[8:11], v[96:99]
v_mfma_f32_16x16x32_bf16 v[116:119], a[40:43], a[12:15], v[116:119]
s_waitcnt lgkmcnt(7)
v_mfma_f32_16x16x32_bf16 v[36:39], a[52:55], a[16:19], v[36:39]
ds_read_b64_tr_b16 a[44:45], v47 offset:45056
s_waitcnt lgkmcnt(7)
v_mfma_f32_16x16x32_bf16 v[68:71], a[52:55], a[20:23], v[68:71]
ds_read_b64_tr_b16 a[46:47], v47 offset:45568
s_waitcnt lgkmcnt(7)
v_mfma_f32_16x16x32_bf16 v[88:91], a[52:55], a[24:27], v[88:91]
ds_read_b64_tr_b16 a[48:49], v49 offset:45056
s_waitcnt lgkmcnt(7)
v_mfma_f32_16x16x32_bf16 v[108:111], a[52:55], a[28:31], v[108:111]
ds_read_b64_tr_b16 a[50:51], v49 offset:45568
s_waitcnt lgkmcnt(6)
v_mfma_f32_16x16x32_bf16 v[52:55], a[56:59], a[16:19], v[52:55]
ds_read_b64_tr_b16 a[64:65], v47 offset:49152
v_mfma_f32_16x16x32_bf16 v[72:75], a[56:59], a[20:23], v[72:75]
ds_read_b64_tr_b16 a[66:67], v47 offset:49664
v_mfma_f32_16x16x32_bf16 v[92:95], a[56:59], a[24:27], v[92:95]
ds_read_b64_tr_b16 a[68:69], v49 offset:49152
v_mfma_f32_16x16x32_bf16 v[112:115], a[56:59], a[28:31], v[112:115]
ds_read_b64_tr_b16 a[70:71], v49 offset:49664
v_mov_b32 v9, 10
ds_write_b32 v10, v9
s_waitcnt lgkmcnt(9)
v_mfma_f32_16x16x32_bf16 v[56:59], a[60:63], a[16:19], v[56:59]
v_mfma_f32_16x16x32_bf16 v[76:79], a[60:63], a[20:23], v[76:79]
v_mfma_f32_16x16x32_bf16 v[96:99], a[60:63], a[24:27], v[96:99]
v_mfma_f32_16x16x32_bf16 v[116:119], a[60:63], a[28:31], v[116:119]
v_pk_mul_f32 v[32:33], v[36:37], v[36:37]
v_pk_mul_f32 v[40:41], v[38:39], v[38:39]
v_pk_mul_f32 v[42:43], v[68:69], v[68:69]
v_pk_mul_f32 v[44:45], v[70:71], v[70:71]
v_pk_fma_f32 v[32:33], v[32:33], v[128:129], v[128:129] op_sel:[0,1,0] op_sel_hi:[1,1,0]
v_pk_fma_f32 v[40:41], v[40:41], v[128:129], v[128:129] op_sel:[0,1,0] op_sel_hi:[1,1,0]
v_pk_fma_f32 v[42:43], v[42:43], v[132:133], v[132:133] op_sel:[0,1,0] op_sel_hi:[1,1,0]
v_pk_fma_f32 v[44:45], v[44:45], v[132:133], v[132:133] op_sel:[0,1,0] op_sel_hi:[1,1,0]
v_pk_mul_f32 v[32:33], v[32:33], v[36:37]
v_pk_mul_f32 v[40:41], v[40:41], v[38:39]
v_pk_mul_f32 v[42:43], v[42:43], v[68:69]
v_pk_mul_f32 v[44:45], v[44:45], v[70:71]
v_exp_f32 v32, v32
v_exp_f32 v33, v33
v_exp_f32 v40, v40
v_exp_f32 v41, v41
v_exp_f32 v42, v42
v_exp_f32 v43, v43
v_exp_f32 v44, v44
v_exp_f32 v45, v45
v_pk_fma_f32 v[32:33], v[32:33], v[130:131], v[130:131] op_sel_hi:[1,0,0]
v_pk_fma_f32 v[40:41], v[40:41], v[130:131], v[130:131] op_sel_hi:[1,0,0]
v_pk_fma_f32 v[42:43], v[42:43], v[134:135], v[134:135] op_sel_hi:[1,0,0]
v_pk_fma_f32 v[44:45], v[44:45], v[134:135], v[134:135] op_sel_hi:[1,0,0]
v_rcp_f32 v32, v32
v_rcp_f32 v33, v33
v_rcp_f32 v40, v40
v_rcp_f32 v41, v41
v_rcp_f32 v42, v42
v_rcp_f32 v43, v43
v_rcp_f32 v44, v44
v_rcp_f32 v45, v45
v_pk_mul_f32 v[36:37], v[36:37], v[32:33]
v_pk_mul_f32 v[38:39], v[38:39], v[40:41]
v_pk_mul_f32 v[68:69], v[68:69], v[42:43]
v_pk_mul_f32 v[70:71], v[70:71], v[44:45]
v_cvt_pk_bf16_f32 v36, v36, v37
v_cvt_pk_bf16_f32 v37, v38, v39
v_cvt_pk_bf16_f32 v38, v68, v69
v_cvt_pk_bf16_f32 v39, v70, v71
s_nop 0
v_permlane16_swap_b32 v36, v38
v_permlane16_swap_b32 v37, v39
buffer_store_dwordx4 v[36:39], v35, s[36:39], s75 offen offset:0 sc1
v_pk_mul_f32 v[32:33], v[88:89], v[88:89]
v_pk_mul_f32 v[40:41], v[90:91], v[90:91]
v_pk_mul_f32 v[42:43], v[108:109], v[108:109]
v_pk_mul_f32 v[44:45], v[110:111], v[110:111]
v_pk_fma_f32 v[32:33], v[32:33], v[136:137], v[136:137] op_sel:[0,1,0] op_sel_hi:[1,1,0]
v_pk_fma_f32 v[40:41], v[40:41], v[136:137], v[136:137] op_sel:[0,1,0] op_sel_hi:[1,1,0]
v_pk_fma_f32 v[42:43], v[42:43], v[140:141], v[140:141] op_sel:[0,1,0] op_sel_hi:[1,1,0]
v_pk_fma_f32 v[44:45], v[44:45], v[140:141], v[140:141] op_sel:[0,1,0] op_sel_hi:[1,1,0]
v_pk_mul_f32 v[32:33], v[32:33], v[88:89]
v_pk_mul_f32 v[40:41], v[40:41], v[90:91]
v_pk_mul_f32 v[42:43], v[42:43], v[108:109]
v_pk_mul_f32 v[44:45], v[44:45], v[110:111]
v_exp_f32 v32, v32
v_exp_f32 v33, v33
v_exp_f32 v40, v40
v_exp_f32 v41, v41
v_exp_f32 v42, v42
v_exp_f32 v43, v43
v_exp_f32 v44, v44
v_exp_f32 v45, v45
v_pk_fma_f32 v[32:33], v[32:33], v[138:139], v[138:139] op_sel_hi:[1,0,0]
v_pk_fma_f32 v[40:41], v[40:41], v[138:139], v[138:139] op_sel_hi:[1,0,0]
v_pk_fma_f32 v[42:43], v[42:43], v[142:143], v[142:143] op_sel_hi:[1,0,0]
v_pk_fma_f32 v[44:45], v[44:45], v[142:143], v[142:143] op_sel_hi:[1,0,0]
v_rcp_f32 v32, v32
v_rcp_f32 v33, v33
v_rcp_f32 v40, v40
v_rcp_f32 v41, v41
v_rcp_f32 v42, v42
v_rcp_f32 v43, v43
v_rcp_f32 v44, v44
v_rcp_f32 v45, v45
v_pk_mul_f32 v[88:89], v[88:89], v[32:33]
v_pk_mul_f32 v[90:91], v[90:91], v[40:41]
v_pk_mul_f32 v[108:109], v[108:109], v[42:43]
v_pk_mul_f32 v[110:111], v[110:111], v[44:45]
v_cvt_pk_bf16_f32 v88, v88, v89
v_cvt_pk_bf16_f32 v89, v90, v91
v_cvt_pk_bf16_f32 v90, v108, v109
v_cvt_pk_bf16_f32 v91, v110, v111
s_nop 0
v_permlane16_swap_b32 v88, v90
v_permlane16_swap_b32 v89, v91
buffer_store_dwordx4 v[88:91], v35, s[36:39], s76 offen offset:0 sc1
v_pk_mul_f32 v[32:33], v[52:53], v[52:53]
v_pk_mul_f32 v[40:41], v[54:55], v[54:55]
v_pk_mul_f32 v[42:43], v[72:73], v[72:73]
v_pk_mul_f32 v[44:45], v[74:75], v[74:75]
v_pk_fma_f32 v[32:33], v[32:33], v[128:129], v[128:129] op_sel:[0,1,0] op_sel_hi:[1,1,0]
v_pk_fma_f32 v[40:41], v[40:41], v[128:129], v[128:129] op_sel:[0,1,0] op_sel_hi:[1,1,0]
v_pk_fma_f32 v[42:43], v[42:43], v[132:133], v[132:133] op_sel:[0,1,0] op_sel_hi:[1,1,0]
v_pk_fma_f32 v[44:45], v[44:45], v[132:133], v[132:133] op_sel:[0,1,0] op_sel_hi:[1,1,0]
v_pk_mul_f32 v[32:33], v[32:33], v[52:53]
v_pk_mul_f32 v[40:41], v[40:41], v[54:55]
v_pk_mul_f32 v[42:43], v[42:43], v[72:73]
v_pk_mul_f32 v[44:45], v[44:45], v[74:75]
v_exp_f32 v32, v32
v_exp_f32 v33, v33
v_exp_f32 v40, v40
v_exp_f32 v41, v41
v_exp_f32 v42, v42
v_exp_f32 v43, v43
v_exp_f32 v44, v44
v_exp_f32 v45, v45
v_pk_fma_f32 v[32:33], v[32:33], v[130:131], v[130:131] op_sel_hi:[1,0,0]
v_pk_fma_f32 v[40:41], v[40:41], v[130:131], v[130:131] op_sel_hi:[1,0,0]
v_pk_fma_f32 v[42:43], v[42:43], v[134:135], v[134:135] op_sel_hi:[1,0,0]
v_pk_fma_f32 v[44:45], v[44:45], v[134:135], v[134:135] op_sel_hi:[1,0,0]
v_rcp_f32 v32, v32
v_rcp_f32 v33, v33
v_rcp_f32 v40, v40
v_rcp_f32 v41, v41
v_rcp_f32 v42, v42
v_rcp_f32 v43, v43
v_rcp_f32 v44, v44
v_rcp_f32 v45, v45
v_pk_mul_f32 v[52:53], v[52:53], v[32:33]
v_pk_mul_f32 v[54:55], v[54:55], v[40:41]
v_pk_mul_f32 v[72:73], v[72:73], v[42:43]
v_pk_mul_f32 v[74:75], v[74:75], v[44:45]
v_cvt_pk_bf16_f32 v52, v52, v53
v_cvt_pk_bf16_f32 v53, v54, v55
v_cvt_pk_bf16_f32 v54, v72, v73
v_cvt_pk_bf16_f32 v55, v74, v75
s_nop 0
v_permlane16_swap_b32 v52, v54
v_permlane16_swap_b32 v53, v55
buffer_store_dwordx4 v[52:55], v35, s[36:39], s75 offen offset:512 sc1
v_pk_mul_f32 v[32:33], v[92:93], v[92:93]
v_pk_mul_f32 v[40:41], v[94:95], v[94:95]
v_pk_mul_f32 v[42:43], v[112:113], v[112:113]
v_pk_mul_f32 v[44:45], v[114:115], v[114:115]
v_pk_fma_f32 v[32:33], v[32:33], v[136:137], v[136:137] op_sel:[0,1,0] op_sel_hi:[1,1,0]
v_pk_fma_f32 v[40:41], v[40:41], v[136:137], v[136:137] op_sel:[0,1,0] op_sel_hi:[1,1,0]
v_pk_fma_f32 v[42:43], v[42:43], v[140:141], v[140:141] op_sel:[0,1,0] op_sel_hi:[1,1,0]
v_pk_fma_f32 v[44:45], v[44:45], v[140:141], v[140:141] op_sel:[0,1,0] op_sel_hi:[1,1,0]
v_pk_mul_f32 v[32:33], v[32:33], v[92:93]
v_pk_mul_f32 v[40:41], v[40:41], v[94:95]
v_pk_mul_f32 v[42:43], v[42:43], v[112:113]
v_pk_mul_f32 v[44:45], v[44:45], v[114:115]
v_exp_f32 v32, v32
v_exp_f32 v33, v33
v_exp_f32 v40, v40
v_exp_f32 v41, v41
v_exp_f32 v42, v42
v_exp_f32 v43, v43
v_exp_f32 v44, v44
v_exp_f32 v45, v45
v_pk_fma_f32 v[32:33], v[32:33], v[138:139], v[138:139] op_sel_hi:[1,0,0]
v_pk_fma_f32 v[40:41], v[40:41], v[138:139], v[138:139] op_sel_hi:[1,0,0]
v_pk_fma_f32 v[42:43], v[42:43], v[142:143], v[142:143] op_sel_hi:[1,0,0]
v_pk_fma_f32 v[44:45], v[44:45], v[142:143], v[142:143] op_sel_hi:[1,0,0]
v_rcp_f32 v32, v32
v_rcp_f32 v33, v33
v_rcp_f32 v40, v40
v_rcp_f32 v41, v41
v_rcp_f32 v42, v42
v_rcp_f32 v43, v43
v_rcp_f32 v44, v44
v_rcp_f32 v45, v45
v_pk_mul_f32 v[92:93], v[92:93], v[32:33]
v_pk_mul_f32 v[94:95], v[94:95], v[40:41]
v_pk_mul_f32 v[112:113], v[112:113], v[42:43]
v_pk_mul_f32 v[114:115], v[114:115], v[44:45]
v_cvt_pk_bf16_f32 v92, v92, v93
v_cvt_pk_bf16_f32 v93, v94, v95
v_cvt_pk_bf16_f32 v94, v112, v113
v_cvt_pk_bf16_f32 v95, v114, v115
s_nop 0
v_permlane16_swap_b32 v92, v94
v_permlane16_swap_b32 v93, v95
buffer_store_dwordx4 v[92:95], v35, s[36:39], s76 offen offset:512 sc1
v_pk_mul_f32 v[32:33], v[56:57], v[56:57]
v_pk_mul_f32 v[40:41], v[58:59], v[58:59]
v_pk_mul_f32 v[42:43], v[76:77], v[76:77]
v_pk_mul_f32 v[44:45], v[78:79], v[78:79]
v_pk_fma_f32 v[32:33], v[32:33], v[128:129], v[128:129] op_sel:[0,1,0] op_sel_hi:[1,1,0]
v_pk_fma_f32 v[40:41], v[40:41], v[128:129], v[128:129] op_sel:[0,1,0] op_sel_hi:[1,1,0]
v_pk_fma_f32 v[42:43], v[42:43], v[132:133], v[132:133] op_sel:[0,1,0] op_sel_hi:[1,1,0]
v_pk_fma_f32 v[44:45], v[44:45], v[132:133], v[132:133] op_sel:[0,1,0] op_sel_hi:[1,1,0]
v_pk_mul_f32 v[32:33], v[32:33], v[56:57]
v_pk_mul_f32 v[40:41], v[40:41], v[58:59]
v_pk_mul_f32 v[42:43], v[42:43], v[76:77]
v_pk_mul_f32 v[44:45], v[44:45], v[78:79]
v_exp_f32 v32, v32
v_exp_f32 v33, v33
v_exp_f32 v40, v40
v_exp_f32 v41, v41
v_exp_f32 v42, v42
v_exp_f32 v43, v43
v_exp_f32 v44, v44
v_exp_f32 v45, v45
v_pk_fma_f32 v[32:33], v[32:33], v[130:131], v[130:131] op_sel_hi:[1,0,0]
v_pk_fma_f32 v[40:41], v[40:41], v[130:131], v[130:131] op_sel_hi:[1,0,0]
v_pk_fma_f32 v[42:43], v[42:43], v[134:135], v[134:135] op_sel_hi:[1,0,0]
v_pk_fma_f32 v[44:45], v[44:45], v[134:135], v[134:135] op_sel_hi:[1,0,0]
v_rcp_f32 v32, v32
v_rcp_f32 v33, v33
v_rcp_f32 v40, v40
v_rcp_f32 v41, v41
v_rcp_f32 v42, v42
v_rcp_f32 v43, v43
v_rcp_f32 v44, v44
v_rcp_f32 v45, v45
v_pk_mul_f32 v[56:57], v[56:57], v[32:33]
v_pk_mul_f32 v[58:59], v[58:59], v[40:41]
v_pk_mul_f32 v[76:77], v[76:77], v[42:43]
v_pk_mul_f32 v[78:79], v[78:79], v[44:45]
v_cvt_pk_bf16_f32 v56, v56, v57
v_cvt_pk_bf16_f32 v57, v58, v59
v_cvt_pk_bf16_f32 v58, v76, v77
v_cvt_pk_bf16_f32 v59, v78, v79
s_nop 0
v_permlane16_swap_b32 v56, v58
v_permlane16_swap_b32 v57, v59
buffer_store_dwordx4 v[56:59], v35, s[36:39], s75 offen offset:1024 sc1
v_pk_mul_f32 v[32:33], v[96:97], v[96:97]
v_pk_mul_f32 v[40:41], v[98:99], v[98:99]
v_pk_mul_f32 v[42:43], v[116:117], v[116:117]
v_pk_mul_f32 v[44:45], v[118:119], v[118:119]
v_pk_fma_f32 v[32:33], v[32:33], v[136:137], v[136:137] op_sel:[0,1,0] op_sel_hi:[1,1,0]
v_pk_fma_f32 v[40:41], v[40:41], v[136:137], v[136:137] op_sel:[0,1,0] op_sel_hi:[1,1,0]
v_pk_fma_f32 v[42:43], v[42:43], v[140:141], v[140:141] op_sel:[0,1,0] op_sel_hi:[1,1,0]
v_pk_fma_f32 v[44:45], v[44:45], v[140:141], v[140:141] op_sel:[0,1,0] op_sel_hi:[1,1,0]
v_pk_mul_f32 v[32:33], v[32:33], v[96:97]
v_pk_mul_f32 v[40:41], v[40:41], v[98:99]
v_pk_mul_f32 v[42:43], v[42:43], v[116:117]
v_pk_mul_f32 v[44:45], v[44:45], v[118:119]
v_exp_f32 v32, v32
v_exp_f32 v33, v33
v_exp_f32 v40, v40
v_exp_f32 v41, v41
v_exp_f32 v42, v42
v_exp_f32 v43, v43
v_exp_f32 v44, v44
v_exp_f32 v45, v45
v_pk_fma_f32 v[32:33], v[32:33], v[138:139], v[138:139] op_sel_hi:[1,0,0]
v_pk_fma_f32 v[40:41], v[40:41], v[138:139], v[138:139] op_sel_hi:[1,0,0]
v_pk_fma_f32 v[42:43], v[42:43], v[142:143], v[142:143] op_sel_hi:[1,0,0]
v_pk_fma_f32 v[44:45], v[44:45], v[142:143], v[142:143] op_sel_hi:[1,0,0]
v_rcp_f32 v32, v32
v_rcp_f32 v33, v33
v_rcp_f32 v40, v40
v_rcp_f32 v41, v41
v_rcp_f32 v42, v42
v_rcp_f32 v43, v43
v_rcp_f32 v44, v44
v_rcp_f32 v45, v45
v_pk_mul_f32 v[96:97], v[96:97], v[32:33]
v_pk_mul_f32 v[98:99], v[98:99], v[40:41]
v_pk_mul_f32 v[116:117], v[116:117], v[42:43]
v_pk_mul_f32 v[118:119], v[118:119], v[44:45]
v_cvt_pk_bf16_f32 v96, v96, v97
v_cvt_pk_bf16_f32 v97, v98, v99
v_cvt_pk_bf16_f32 v98, v116, v117
v_cvt_pk_bf16_f32 v99, v118, v119
s_nop 0
v_permlane16_swap_b32 v96, v98
v_permlane16_swap_b32 v97, v99
buffer_store_dwordx4 v[96:99], v35, s[36:39], s76 offen offset:1024 sc1
s_waitcnt lgkmcnt(7)
v_mfma_f32_16x16x32_bf16 v[60:63], a[44:47], a[0:3], v[60:63]
v_mfma_f32_16x16x32_bf16 v[80:83], a[44:47], a[4:7], v[80:83]
v_mfma_f32_16x16x32_bf16 v[100:103], a[44:47], a[8:11], v[100:103]
v_mfma_f32_16x16x32_bf16 v[120:123], a[44:47], a[12:15], v[120:123]
s_waitcnt lgkmcnt(5)
v_mfma_f32_16x16x32_bf16 v[64:67], a[48:51], a[0:3], v[64:67]
v_mfma_f32_16x16x32_bf16 v[84:87], a[48:51], a[4:7], v[84:87]
v_mfma_f32_16x16x32_bf16 v[104:107], a[48:51], a[8:11], v[104:107]
v_mfma_f32_16x16x32_bf16 v[124:127], a[48:51], a[12:15], v[124:127]
s_waitcnt lgkmcnt(3)
v_mfma_f32_16x16x32_bf16 v[60:63], a[64:67], a[16:19], v[60:63]
v_mfma_f32_16x16x32_bf16 v[80:83], a[64:67], a[20:23], v[80:83]
v_mfma_f32_16x16x32_bf16 v[100:103], a[64:67], a[24:27], v[100:103]
v_mfma_f32_16x16x32_bf16 v[120:123], a[64:67], a[28:31], v[120:123]
s_waitcnt lgkmcnt(1)
v_mfma_f32_16x16x32_bf16 v[64:67], a[68:71], a[16:19], v[64:67]
v_mfma_f32_16x16x32_bf16 v[84:87], a[68:71], a[20:23], v[84:87]
v_mfma_f32_16x16x32_bf16 v[104:107], a[68:71], a[24:27], v[104:107]
v_mfma_f32_16x16x32_bf16 v[124:127], a[68:71], a[28:31], v[124:127]
v_mov_b32 v46, 0x358637bd
v_mul_f32 v128, 0x3fb8aa3b, v131
v_mul_f32 v132, 0x3fb8aa3b, v135
v_mul_f32 v136, 0x3fb8aa3b, v139
v_mul_f32 v140, 0x3fb8aa3b, v143
v_pk_mul_f32 v[32:33], v[60:61], v[128:129] op_sel_hi:[1,0]
v_pk_mul_f32 v[40:41], v[62:63], v[128:129] op_sel_hi:[1,0]
v_pk_mul_f32 v[42:43], v[80:81], v[132:133] op_sel_hi:[1,0]
v_pk_mul_f32 v[44:45], v[82:83], v[132:133] op_sel_hi:[1,0]
v_pk_fma_f32 v[60:61], v[60:61], v[130:131], v[46:47] op_sel:[0,1,0] op_sel_hi:[1,1,0]
v_pk_fma_f32 v[62:63], v[62:63], v[130:131], v[46:47] op_sel:[0,1,0] op_sel_hi:[1,1,0]
v_pk_fma_f32 v[80:81], v[80:81], v[134:135], v[46:47] op_sel:[0,1,0] op_sel_hi:[1,1,0]
v_pk_fma_f32 v[82:83], v[82:83], v[134:135], v[46:47] op_sel:[0,1,0] op_sel_hi:[1,1,0]
v_exp_f32_e64 v32, v32 clamp
v_exp_f32_e64 v33, v33 clamp
v_exp_f32_e64 v40, v40 clamp
v_exp_f32_e64 v41, v41 clamp
v_exp_f32_e64 v42, v42 clamp
v_exp_f32_e64 v43, v43 clamp
v_exp_f32_e64 v44, v44 clamp
v_exp_f32_e64 v45, v45 clamp
v_max_f32 v60, v46, v60
v_max_f32 v61, v46, v61
v_max_f32 v62, v46, v62
v_max_f32 v63, v46, v63
v_max_f32 v80, v46, v80
v_max_f32 v81, v46, v81
v_max_f32 v82, v46, v82
v_max_f32 v83, v46, v83
v_pk_add_f32 v[60:61], v[60:61], v[32:33]
v_pk_add_f32 v[62:63], v[62:63], v[40:41]
v_pk_add_f32 v[80:81], v[80:81], v[42:43]
v_pk_add_f32 v[82:83], v[82:83], v[44:45]
v_cvt_pk_bf16_f32 v60, v60, v61
v_cvt_pk_bf16_f32 v61, v62, v63
v_cvt_pk_bf16_f32 v62, v80, v81
v_cvt_pk_bf16_f32 v63, v82, v83
s_nop 0
v_permlane16_swap_b32 v60, v62
v_permlane16_swap_b32 v61, v63
v_pk_mul_f32 v[32:33], v[100:101], v[136:137] op_sel_hi:[1,0]
v_pk_mul_f32 v[40:41], v[102:103], v[136:137] op_sel_hi:[1,0]
v_pk_mul_f32 v[42:43], v[120:121], v[140:141] op_sel_hi:[1,0]
v_pk_mul_f32 v[44:45], v[122:123], v[140:141] op_sel_hi:[1,0]
v_pk_fma_f32 v[100:101], v[100:101], v[138:139], v[46:47] op_sel:[0,1,0] op_sel_hi:[1,1,0]
v_pk_fma_f32 v[102:103], v[102:103], v[138:139], v[46:47] op_sel:[0,1,0] op_sel_hi:[1,1,0]
v_pk_fma_f32 v[120:121], v[120:121], v[142:143], v[46:47] op_sel:[0,1,0] op_sel_hi:[1,1,0]
v_pk_fma_f32 v[122:123], v[122:123], v[142:143], v[46:47] op_sel:[0,1,0] op_sel_hi:[1,1,0]
v_exp_f32_e64 v32, v32 clamp
v_exp_f32_e64 v33, v33 clamp
v_exp_f32_e64 v40, v40 clamp
v_exp_f32_e64 v41, v41 clamp
v_exp_f32_e64 v42, v42 clamp
v_exp_f32_e64 v43, v43 clamp
v_exp_f32_e64 v44, v44 clamp
v_exp_f32_e64 v45, v45 clamp
v_max_f32 v100, v46, v100
v_max_f32 v101, v46, v101
v_max_f32 v102, v46, v102
v_max_f32 v103, v46, v103
v_max_f32 v120, v46, v120
v_max_f32 v121, v46, v121
v_max_f32 v122, v46, v122
v_max_f32 v123, v46, v123
v_pk_add_f32 v[100:101], v[100:101], v[32:33]
v_pk_add_f32 v[102:103], v[102:103], v[40:41]
v_pk_add_f32 v[120:121], v[120:121], v[42:43]
v_pk_add_f32 v[122:123], v[122:123], v[44:45]
v_cvt_pk_bf16_f32 v100, v100, v101
v_cvt_pk_bf16_f32 v101, v102, v103
v_cvt_pk_bf16_f32 v102, v120, v121
v_cvt_pk_bf16_f32 v103, v122, v123
s_nop 0
v_permlane16_swap_b32 v100, v102
v_permlane16_swap_b32 v101, v103
s_waitcnt vmcnt(0)
buffer_atomic_or v8, v5, s[36:39], s64 offen sc1
s_add_u32 s64, s64, 8192
v_pk_mul_f32 v[32:33], v[64:65], v[128:129] op_sel_hi:[1,0]
v_pk_mul_f32 v[40:41], v[66:67], v[128:129] op_sel_hi:[1,0]
v_pk_mul_f32 v[42:43], v[84:85], v[132:133] op_sel_hi:[1,0]
v_pk_mul_f32 v[44:45], v[86:87], v[132:133] op_sel_hi:[1,0]
v_pk_fma_f32 v[64:65], v[64:65], v[130:131], v[46:47] op_sel:[0,1,0] op_sel_hi:[1,1,0]
v_pk_fma_f32 v[66:67], v[66:67], v[130:131], v[46:47] op_sel:[0,1,0] op_sel_hi:[1,1,0]
v_pk_fma_f32 v[84:85], v[84:85], v[134:135], v[46:47] op_sel:[0,1,0] op_sel_hi:[1,1,0]
v_pk_fma_f32 v[86:87], v[86:87], v[134:135], v[46:47] op_sel:[0,1,0] op_sel_hi:[1,1,0]
v_exp_f32_e64 v32, v32 clamp
v_exp_f32_e64 v33, v33 clamp
v_exp_f32_e64 v40, v40 clamp
v_exp_f32_e64 v41, v41 clamp
v_exp_f32_e64 v42, v42 clamp
v_exp_f32_e64 v43, v43 clamp
v_exp_f32_e64 v44, v44 clamp
v_exp_f32_e64 v45, v45 clamp
v_max_f32 v64, v46, v64
v_max_f32 v65, v46, v65
v_max_f32 v66, v46, v66
v_max_f32 v67, v46, v67
v_max_f32 v84, v46, v84
v_max_f32 v85, v46, v85
v_max_f32 v86, v46, v86
v_max_f32 v87, v46, v87
v_pk_add_f32 v[64:65], v[64:65], v[32:33]
v_pk_add_f32 v[66:67], v[66:67], v[40:41]
v_pk_add_f32 v[84:85], v[84:85], v[42:43]
v_pk_add_f32 v[86:87], v[86:87], v[44:45]
v_cvt_pk_bf16_f32 v64, v64, v65
v_cvt_pk_bf16_f32 v65, v66, v67
v_cvt_pk_bf16_f32 v66, v84, v85
v_cvt_pk_bf16_f32 v67, v86, v87
s_nop 0
v_permlane16_swap_b32 v64, v66
v_permlane16_swap_b32 v65, v67
v_pk_mul_f32 v[32:33], v[104:105], v[136:137] op_sel_hi:[1,0]
v_pk_mul_f32 v[40:41], v[106:107], v[136:137] op_sel_hi:[1,0]
v_pk_mul_f32 v[42:43], v[124:125], v[140:141] op_sel_hi:[1,0]
v_pk_mul_f32 v[44:45], v[126:127], v[140:141] op_sel_hi:[1,0]
v_pk_fma_f32 v[104:105], v[104:105], v[138:139], v[46:47] op_sel:[0,1,0] op_sel_hi:[1,1,0]
v_pk_fma_f32 v[106:107], v[106:107], v[138:139], v[46:47] op_sel:[0,1,0] op_sel_hi:[1,1,0]
v_pk_fma_f32 v[124:125], v[124:125], v[142:143], v[46:47] op_sel:[0,1,0] op_sel_hi:[1,1,0]
v_pk_fma_f32 v[126:127], v[126:127], v[142:143], v[46:47] op_sel:[0,1,0] op_sel_hi:[1,1,0]
v_exp_f32_e64 v32, v32 clamp
v_exp_f32_e64 v33, v33 clamp
v_exp_f32_e64 v40, v40 clamp
v_exp_f32_e64 v41, v41 clamp
v_exp_f32_e64 v42, v42 clamp
v_exp_f32_e64 v43, v43 clamp
v_exp_f32_e64 v44, v44 clamp
v_exp_f32_e64 v45, v45 clamp
v_max_f32 v104, v46, v104
v_max_f32 v105, v46, v105
v_max_f32 v106, v46, v106
v_max_f32 v107, v46, v107
v_max_f32 v124, v46, v124
v_max_f32 v125, v46, v125
v_max_f32 v126, v46, v126
v_max_f32 v127, v46, v127
v_pk_add_f32 v[104:105], v[104:105], v[32:33]
v_pk_add_f32 v[106:107], v[106:107], v[40:41]
v_pk_add_f32 v[124:125], v[124:125], v[42:43]
v_pk_add_f32 v[126:127], v[126:127], v[44:45]
v_cvt_pk_bf16_f32 v104, v104, v105
v_cvt_pk_bf16_f32 v105, v106, v107
v_cvt_pk_bf16_f32 v106, v124, v125
v_cvt_pk_bf16_f32 v107, v126, v127
s_nop 0
v_permlane16_swap_b32 v104, v106
v_permlane16_swap_b32 v105, v107
buffer_store_dwordx4 v[60:63], v35, s[36:39], s77 offen offset:0 sc1
buffer_store_dwordx4 v[100:103], v35, s[36:39], s78 offen offset:0 sc1
buffer_store_dwordx4 v[64:67], v35, s[36:39], s77 offen offset:512 sc1
buffer_store_dwordx4 v[104:107], v35, s[36:39], s78 offen offset:512 sc1
v_mov_b32 v9, 11
ds_write_b32 v10, v9
s_waitcnt lgkmcnt(0)
s_branch L_join
L_T1:
s_lshl2_add_u32 s72, s57, s59
s_lshr_b32 s73, s52, 1
s_and_b32 s74, s52, 1
v_lshrrev_b32 v30, 1, v11
v_lshrrev_b32 v21, 4, v1
v_xor_b32 v30, v30, v21
s_lshl_b32 s48, s73, 6
v_add_u32 v31, s48, v11
v_lshlrev_b32 v31, 7, v31
v_lshl_add_u32 v31, v30, 4, v31
v_xor_b32 v32, 64, v31
v_add_u32 v33, 65536, v31
v_add_u32 v34, 65536, v32
v_lshlrev_b32 v35, 3, v21
v_bfe_u32 v30, v1, 2, 2
v_add_u32 v35, v35, v30
v_mul_u32_u24 v35, 320, v35
v_and_b32 v30, 1, v1
v_lshl_add_u32 v35, v30, 3, v35
v_add_u32 v35, 16384, v35
v_bfe_u32 v36, v1, 1, 1
v_and_b32 v37, 1, v21
v_lshlrev_b32 v37, 1, v37
s_mul_i32 s48, s74, 5
v_mul_u32_u24 v38, 1, v36
v_add3_u32 v38, v38, 0, s48
v_xor_b32 v38, v38, v37
v_lshl_add_u32 v38, v38, 4, v35
v_add_u32 v39, 65536, v38
v_mul_u32_u24 v40, 1, v36
v_add3_u32 v40, v40, 2, s48
v_xor_b32 v40, v40, v37
v_lshl_add_u32 v40, v40, 4, v35
v_add_u32 v41, 65536, v40
v_mul_u32_u24 v42, 6, v36
v_add3_u32 v42, v42, 4, s48
v_xor_b32 v42, v42, v37
v_lshl_add_u32 v42, v42, 4, v35
v_add_u32 v43, 65536, v42
v_mul_u32_u24 v44, 1, v36
v_add3_u32 v44, v44, 11, s48
v_xor_b32 v44, v44, v37
v_lshl_add_u32 v44, v44, 4, v35
v_add_u32 v45, 65536, v44
v_mul_u32_u24 v46, 1, v36
v_add3_u32 v46, v46, 13, s48
v_xor_b32 v46, v46, v37
v_lshl_add_u32 v46, v46, 4, v35
v_add_u32 v47, 65536, v46
s_lshl1_add_u32 s48, s72, s74
s_mul_i32 s75, s48, 137344
s_mul_i32 s76, s58, 8576
s_add_u32 s75, s75, s76
s_add_u32 s75, s75, 19922944
s_add_u32 s76, s75, 4096
s_lshl_b32 s50, s73, 29
s_lshl_b32 s48, s48, 7
s_add_u32 s48, s48, s50
s_add_u32 s64, s48, 24576
s_lshl_b32 s51, 1, s58
v_mov_b32 v8, s51
s_lshl_b32 s48, s73, 9
s_add_u32 s48, s48, 157696
v_lshl_add_u32 v21, v11, 3, s48
s_mul_i32 s48, s74, 320
s_add_u32 s48, s48, 155648
v_lshl_add_u32 v35, v11, 3, s48
v_lshrrev_b32 v30, 3, v11
v_mul_u32_u24 v30, 320, v30
v_add_u32 v36, v30, v35
s_lshl_b32 s48, s73, 8
s_add_u32 s48, s48, 160768
v_and_b32 v37, 48, v1
v_add_u32 v37, s48, v37
v_mov_b32 v130, 0
v_mov_b32 v131, 0
v_mov_b32 v134, 0
v_mov_b32 v135, 0
v_mov_b32 v138, 0
v_mov_b32 v139, 0
v_mov_b32 v142, 0
v_mov_b32 v143, 0
v_mov_b32 v144, 0
v_mov_b32 v145, 0
v_mov_b32 v146, 0
v_mov_b32 v147, 0
v_mov_b32 v148, 0
v_mov_b32 v149, 0
v_mov_b32 v150, 0
v_mov_b32 v151, 0
v_mov_b32 v152, 0
v_mov_b32 v153, 0
v_mov_b32 v154, 0
v_mov_b32 v155, 0
v_mov_b32 v156, 0
v_mov_b32 v157, 0
v_mov_b32 v158, 0
v_mov_b32 v159, 0
v_mov_b32 v160, 0
v_mov_b32 v161, 0
v_mov_b32 v162, 0
v_mov_b32 v163, 0
ds_read_b64 v[6:7], v3 offset:0
s_waitcnt lgkmcnt(0)
v_min_u32 v6, v6, v7
v_cmp_gt_u32 vcc, 1, v6
s_nop 0
s_cbranch_vccnz W45
B46:
ds_read_b128 a[0:3], v33 offset:8192
ds_read_b64_tr_b16 a[32:33], v39 offset:8192
ds_read_b64_tr_b16 a[34:35], v39 offset:9472
ds_read_b128 a[4:7], v33 offset:10240
ds_read_b128 a[8:11], v33 offset:12288
ds_read_b128 a[12:15], v33 offset:14336
ds_read_b64_tr_b16 a[36:37], v41 offset:8192
ds_read_b64_tr_b16 a[38:39], v41 offset:9472
ds_read_b64_tr_b16 a[40:41], v43 offset:8192
ds_read_b64_tr_b16 a[42:43], v43 offset:9472
s_waitcnt lgkmcnt(7)
v_mfma_f32_16x16x32_bf16 v[48:51], a[0:3], a[32:35], 0
ds_read_b64_tr_b16 a[44:45], v45 offset:8192
s_waitcnt lgkmcnt(7)
v_mfma_f32_16x16x32_bf16 v[68:71], a[4:7], a[32:35], 0
ds_read_b64_tr_b16 a[46:47], v45 offset:9472
s_waitcnt lgkmcnt(7)
v_mfma_f32_16x16x32_bf16 v[88:91], a[8:11], a[32:35], 0
s_waitcnt lgkmcnt(6)
v_mfma_f32_16x16x32_bf16 v[108:111], a[12:15], a[32:35], 0
s_waitcnt lgkmcnt(4)
v_mfma_f32_16x16x32_bf16 v[52:55], a[0:3], a[36:39], 0
ds_read_b64_tr_b16 a[48:49], v47 offset:8192
v_mfma_f32_16x16x32_bf16 v[72:75], a[4:7], a[36:39], 0
ds_read_b64_tr_b16 a[50:51], v47 offset:9472
v_mfma_f32_16x16x32_bf16 v[92:95], a[8:11], a[36:39], 0
v_mfma_f32_16x16x32_bf16 v[112:115], a[12:15], a[36:39], 0
s_waitcnt lgkmcnt(4)
v_mfma_f32_16x16x32_bf16 v[56:59], a[0:3], a[40:43], 0
ds_read_b128 a[16:19], v34 offset:8192
v_mfma_f32_16x16x32_bf16 v[76:79], a[4:7], a[40:43], 0
ds_read_b64_tr_b16 a[52:53], v39 offset:18432
v_mfma_f32_16x16x32_bf16 v[96:99], a[8:11], a[40:43], 0
ds_read_b64_tr_b16 a[54:55], v39 offset:19712
v_mfma_f32_16x16x32_bf16 v[116:119], a[12:15], a[40:43], 0
ds_read_b128 a[20:23], v34 offset:10240
s_waitcnt lgkmcnt(6)
v_mfma_f32_16x16x32_bf16 v[60:63], a[0:3], a[44:47], 0
ds_read_b128 a[24:27], v34 offset:12288
v_mfma_f32_16x16x32_bf16 v[80:83], a[4:7], a[44:47], 0
ds_read_b128 a[28:31], v34 offset:14336
v_mfma_f32_16x16x32_bf16 v[100:103], a[8:11], a[44:47], 0
ds_read_b64_tr_b16 a[56:57], v41 offset:18432
v_mfma_f32_16x16x32_bf16 v[120:123], a[12:15], a[44:47], 0
ds_read_b64_tr_b16 a[58:59], v41 offset:19712
s_waitcnt lgkmcnt(8)
v_mfma_f32_16x16x32_bf16 v[64:67], a[0:3], a[48:51], 0
ds_read_b64_tr_b16 a[60:61], v43 offset:18432
v_mfma_f32_16x16x32_bf16 v[84:87], a[4:7], a[48:51], 0
ds_read_b64_tr_b16 a[62:63], v43 offset:19712
ds_read_b64 v[6:7], v3
v_mfma_f32_16x16x32_bf16 v[104:107], a[8:11], a[48:51], 0
v_mfma_f32_16x16x32_bf16 v[124:127], a[12:15], a[48:51], 0
s_waitcnt lgkmcnt(8)
v_mfma_f32_16x16x32_bf16 v[48:51], a[16:19], a[52:55], v[48:51]
ds_read_b64_tr_b16 a[64:65], v45 offset:18432
s_waitcnt lgkmcnt(8)
v_mfma_f32_16x16x32_bf16 v[68:71], a[20:23], a[52:55], v[68:71]
ds_read_b64_tr_b16 a[66:67], v45 offset:19712
s_waitcnt lgkmcnt(8)
v_mfma_f32_16x16x32_bf16 v[88:91], a[24:27], a[52:55], v[88:91]
s_waitcnt lgkmcnt(7)
v_mfma_f32_16x16x32_bf16 v[108:111], a[28:31], a[52:55], v[108:111]
s_waitcnt lgkmcnt(5)
v_mfma_f32_16x16x32_bf16 v[52:55], a[16:19], a[56:59], v[52:55]
ds_read_b64_tr_b16 a[68:69], v47 offset:18432
v_mfma_f32_16x16x32_bf16 v[72:75], a[20:23], a[56:59], v[72:75]
ds_read_b64_tr_b16 a[70:71], v47 offset:19712
v_mov_b32 v9, 1
ds_write_b32 v10, v9
v_mfma_f32_16x16x32_bf16 v[92:95], a[24:27], a[56:59], v[92:95]
v_mfma_f32_16x16x32_bf16 v[112:115], a[28:31], a[56:59], v[112:115]
s_waitcnt lgkmcnt(6)
v_mfma_f32_16x16x32_bf16 v[56:59], a[16:19], a[60:63], v[56:59]
s_waitcnt lgkmcnt(5)
v_min_u32 v6, v6, v7
v_cmp_gt_u32 vcc, 2, v6
s_nop 0
s_cbranch_vccnz W47
B48:
ds_read_b128 a[0:3], v33 offset:45056
v_mfma_f32_16x16x32_bf16 v[76:79], a[20:23], a[60:63], v[76:79]
ds_read_b64_tr_b16 a[32:33], v39 offset:45056
v_mfma_f32_16x16x32_bf16 v[96:99], a[24:27], a[60:63], v[96:99]
ds_read_b64_tr_b16 a[34:35], v39 offset:46336
v_mfma_f32_16x16x32_bf16 v[116:119], a[28:31], a[60:63], v[116:119]
ds_read_b128 a[4:7], v33 offset:47104
s_waitcnt lgkmcnt(7)
v_mfma_f32_16x16x32_bf16 v[60:63], a[16:19], a[64:67], v[60:63]
ds_read_b128 a[8:11], v33 offset:49152
v_mfma_f32_16x16x32_bf16 v[80:83], a[20:23], a[64:67], v[80:83]
ds_read_b128 a[12:15], v33 offset:51200
v_mfma_f32_16x16x32_bf16 v[100:103], a[24:27], a[64:67], v[100:103]
ds_read_b64_tr_b16 a[36:37], v41 offset:45056
v_mfma_f32_16x16x32_bf16 v[120:123], a[28:31], a[64:67], v[120:123]
ds_read_b64_tr_b16 a[38:39], v41 offset:46336
s_waitcnt lgkmcnt(9)
v_mfma_f32_16x16x32_bf16 v[64:67], a[16:19], a[68:71], v[64:67]
ds_read_b64_tr_b16 a[40:41], v43 offset:45056
v_mfma_f32_16x16x32_bf16 v[84:87], a[20:23], a[68:71], v[84:87]
ds_read_b64_tr_b16 a[42:43], v43 offset:46336
v_mfma_f32_16x16x32_bf16 v[104:107], a[24:27], a[68:71], v[104:107]
v_mfma_f32_16x16x32_bf16 v[124:127], a[28:31], a[68:71], v[124:127]
s_waitcnt lgkmcnt(7)
v_mfma_f32_16x16x32_bf16 v[48:51], a[0:3], a[32:35], v[48:51]
ds_read_b64_tr_b16 a[44:45], v45 offset:45056
s_waitcnt lgkmcnt(7)
v_mfma_f32_16x16x32_bf16 v[68:71], a[4:7], a[32:35], v[68:71]
ds_read_b64_tr_b16 a[46:47], v45 offset:46336
s_waitcnt lgkmcnt(7)
v_mfma_f32_16x16x32_bf16 v[88:91], a[8:11], a[32:35], v[88:91]
s_waitcnt lgkmcnt(6)
v_mfma_f32_16x16x32_bf16 v[108:111], a[12:15], a[32:35], v[108:111]
s_waitcnt lgkmcnt(4)
v_mfma_f32_16x16x32_bf16 v[52:55], a[0:3], a[36:39], v[52:55]
ds_read_b64_tr_b16 a[48:49], v47 offset:45056
v_mfma_f32_16x16x32_bf16 v[72:75], a[4:7], a[36:39], v[72:75]
ds_read_b64_tr_b16 a[50:51], v47 offset:46336
v_mfma_f32_16x16x32_bf16 v[92:95], a[8:11], a[36:39], v[92:95]
v_mfma_f32_16x16x32_bf16 v[112:115], a[12:15], a[36:39], v[112:115]
s_waitcnt lgkmcnt(4)
v_mfma_f32_16x16x32_bf16 v[56:59], a[0:3], a[40:43], v[56:59]
ds_read_b128 a[16:19], v34 offset:45056
v_mfma_f32_16x16x32_bf16 v[76:79], a[4:7], a[40:43], v[76:79]
ds_read_b64_tr_b16 a[52:53], v39 offset:55296
v_mfma_f32_16x16x32_bf16 v[96:99], a[8:11], a[40:43], v[96:99]
ds_read_b64_tr_b16 a[54:55], v39 offset:56576
v_mfma_f32_16x16x32_bf16 v[116:119], a[12:15], a[40:43], v[116:119]
ds_read_b128 a[20:23], v34 offset:47104
s_waitcnt lgkmcnt(6)
v_mfma_f32_16x16x32_bf16 v[60:63], a[0:3], a[44:47], v[60:63]
ds_read_b128 a[24:27], v34 offset:49152
v_mfma_f32_16x16x32_bf16 v[80:83], a[4:7], a[44:47], v[80:83]
ds_read_b128 a[28:31], v34 offset:51200
v_mfma_f32_16x16x32_bf16 v[100:103], a[8:11], a[44:47], v[100:103]
ds_read_b64_tr_b16 a[56:57], v41 offset:55296
v_mfma_f32_16x16x32_bf16 v[120:123], a[12:15], a[44:47], v[120:123]
ds_read_b64_tr_b16 a[58:59], v41 offset:56576
s_waitcnt lgkmcnt(8)
v_mfma_f32_16x16x32_bf16 v[64:67], a[0:3], a[48:51], v[64:67]
ds_read_b64_tr_b16 a[60:61], v43 offset:55296
v_mfma_f32_16x16x32_bf16 v[84:87], a[4:7], a[48:51], v[84:87]
ds_read_b64_tr_b16 a[62:63], v43 offset:56576
ds_read_b64 v[6:7], v3
v_mfma_f32_16x16x32_bf16 v[104:107], a[8:11], a[48:51], v[104:107]
v_mfma_f32_16x16x32_bf16 v[124:127], a[12:15], a[48:51], v[124:127]
s_waitcnt lgkmcnt(8)
v_mfma_f32_16x16x32_bf16 v[48:51], a[16:19], a[52:55], v[48:51]
ds_read_b64_tr_b16 a[64:65], v45 offset:55296
s_waitcnt lgkmcnt(8)
v_mfma_f32_16x16x32_bf16 v[68:71], a[20:23], a[52:55], v[68:71]
ds_read_b64_tr_b16 a[66:67], v45 offset:56576
s_waitcnt lgkmcnt(8)
v_mfma_f32_16x16x32_bf16 v[88:91], a[24:27], a[52:55], v[88:91]
s_waitcnt lgkmcnt(7)
v_mfma_f32_16x16x32_bf16 v[108:111], a[28:31], a[52:55], v[108:111]
s_waitcnt lgkmcnt(5)
v_mfma_f32_16x16x32_bf16 v[52:55], a[16:19], a[56:59], v[52:55]
ds_read_b64_tr_b16 a[68:69], v47 offset:55296
v_mfma_f32_16x16x32_bf16 v[72:75], a[20:23], a[56:59], v[72:75]
ds_read_b64_tr_b16 a[70:71], v47 offset:56576
v_mov_b32 v9, 2
ds_write_b32 v10, v9
v_mfma_f32_16x16x32_bf16 v[92:95], a[24:27], a[56:59], v[92:95]
v_mfma_f32_16x16x32_bf16 v[112:115], a[28:31], a[56:59], v[112:115]
s_waitcnt lgkmcnt(6)
v_mfma_f32_16x16x32_bf16 v[56:59], a[16:19], a[60:63], v[56:59]
s_waitcnt lgkmcnt(5)
v_min_u32 v6, v6, v7
v_cmp_gt_u32 vcc, 3, v6
s_nop 0
s_cbranch_vccnz W49
B50:
ds_read_b128 a[0:3], v31 offset:0
v_mfma_f32_16x16x32_bf16 v[76:79], a[20:23], a[60:63], v[76:79]
ds_read_b64_tr_b16 a[32:33], v38 offset:0
v_mfma_f32_16x16x32_bf16 v[96:99], a[24:27], a[60:63], v[96:99]
ds_read_b64_tr_b16 a[34:35], v38 offset:1280
v_mfma_f32_16x16x32_bf16 v[116:119], a[28:31], a[60:63], v[116:119]
ds_read_b128 a[4:7], v31 offset:2048
s_waitcnt lgkmcnt(7)
v_mfma_f32_16x16x32_bf16 v[60:63], a[16:19], a[64:67], v[60:63]
ds_read_b128 a[8:11], v31 offset:4096
v_mfma_f32_16x16x32_bf16 v[80:83], a[20:23], a[64:67], v[80:83]
ds_read_b128 a[12:15], v31 offset:6144
v_mfma_f32_16x16x32_bf16 v[100:103], a[24:27], a[64:67], v[100:103]
ds_read_b64_tr_b16 a[36:37], v40 offset:0
v_mfma_f32_16x16x32_bf16 v[120:123], a[28:31], a[64:67], v[120:123]
ds_read_b64_tr_b16 a[38:39], v40 offset:1280
s_waitcnt lgkmcnt(9)
v_mfma_f32_16x16x32_bf16 v[64:67], a[16:19], a[68:71], v[64:67]
ds_read_b64_tr_b16 a[40:41], v42 offset:0
v_mfma_f32_16x16x32_bf16 v[84:87], a[20:23], a[68:71], v[84:87]
ds_read_b64_tr_b16 a[42:43], v42 offset:1280
v_mfma_f32_16x16x32_bf16 v[104:107], a[24:27], a[68:71], v[104:107]
v_mfma_f32_16x16x32_bf16 v[124:127], a[28:31], a[68:71], v[124:127]
s_waitcnt lgkmcnt(7)
v_mfma_f32_16x16x32_bf16 v[48:51], a[0:3], a[32:35], v[48:51]
ds_read_b64_tr_b16 a[44:45], v44 offset:0
s_waitcnt lgkmcnt(7)
v_mfma_f32_16x16x32_bf16 v[68:71], a[4:7], a[32:35], v[68:71]
ds_read_b64_tr_b16 a[46:47], v44 offset:1280
s_waitcnt lgkmcnt(7)
v_mfma_f32_16x16x32_bf16 v[88:91], a[8:11], a[32:35], v[88:91]
s_waitcnt lgkmcnt(6)
v_mfma_f32_16x16x32_bf16 v[108:111], a[12:15], a[32:35], v[108:111]
s_waitcnt lgkmcnt(4)
v_mfma_f32_16x16x32_bf16 v[52:55], a[0:3], a[36:39], v[52:55]
ds_read_b64_tr_b16 a[48:49], v46 offset:0
v_mfma_f32_16x16x32_bf16 v[72:75], a[4:7], a[36:39], v[72:75]
ds_read_b64_tr_b16 a[50:51], v46 offset:1280
v_mfma_f32_16x16x32_bf16 v[92:95], a[8:11], a[36:39], v[92:95]
v_mfma_f32_16x16x32_bf16 v[112:115], a[12:15], a[36:39], v[112:115]
s_waitcnt lgkmcnt(4)
v_mfma_f32_16x16x32_bf16 v[56:59], a[0:3], a[40:43], v[56:59]
ds_read_b128 a[16:19], v32 offset:0
v_mfma_f32_16x16x32_bf16 v[76:79], a[4:7], a[40:43], v[76:79]
ds_read_b64_tr_b16 a[52:53], v38 offset:10240
v_mfma_f32_16x16x32_bf16 v[96:99], a[8:11], a[40:43], v[96:99]
ds_read_b64_tr_b16 a[54:55], v38 offset:11520
v_mfma_f32_16x16x32_bf16 v[116:119], a[12:15], a[40:43], v[116:119]
ds_read_b128 a[20:23], v32 offset:2048
s_waitcnt lgkmcnt(6)
v_mfma_f32_16x16x32_bf16 v[60:63], a[0:3], a[44:47], v[60:63]
ds_read_b128 a[24:27], v32 offset:4096
v_mfma_f32_16x16x32_bf16 v[80:83], a[4:7], a[44:47], v[80:83]
ds_read_b128 a[28:31], v32 offset:6144
v_mfma_f32_16x16x32_bf16 v[100:103], a[8:11], a[44:47], v[100:103]
ds_read_b64_tr_b16 a[56:57], v40 offset:10240
v_mfma_f32_16x16x32_bf16 v[120:123], a[12:15], a[44:47], v[120:123]
ds_read_b64_tr_b16 a[58:59], v40 offset:11520
s_waitcnt lgkmcnt(8)
v_mfma_f32_16x16x32_bf16 v[64:67], a[0:3], a[48:51], v[64:67]
ds_read_b64_tr_b16 a[60:61], v42 offset:10240
v_mfma_f32_16x16x32_bf16 v[84:87], a[4:7], a[48:51], v[84:87]
ds_read_b64_tr_b16 a[62:63], v42 offset:11520
ds_read_b64 v[6:7], v3
v_mfma_f32_16x16x32_bf16 v[104:107], a[8:11], a[48:51], v[104:107]
v_mfma_f32_16x16x32_bf16 v[124:127], a[12:15], a[48:51], v[124:127]
s_waitcnt lgkmcnt(8)
v_mfma_f32_16x16x32_bf16 v[48:51], a[16:19], a[52:55], v[48:51]
ds_read_b64_tr_b16 a[64:65], v44 offset:10240
s_waitcnt lgkmcnt(8)
v_mfma_f32_16x16x32_bf16 v[68:71], a[20:23], a[52:55], v[68:71]
ds_read_b64_tr_b16 a[66:67], v44 offset:11520
s_waitcnt lgkmcnt(8)
v_mfma_f32_16x16x32_bf16 v[88:91], a[24:27], a[52:55], v[88:91]
s_waitcnt lgkmcnt(7)
v_mfma_f32_16x16x32_bf16 v[108:111], a[28:31], a[52:55], v[108:111]
s_waitcnt lgkmcnt(5)
v_mfma_f32_16x16x32_bf16 v[52:55], a[16:19], a[56:59], v[52:55]
ds_read_b64_tr_b16 a[68:69], v46 offset:10240
v_mfma_f32_16x16x32_bf16 v[72:75], a[20:23], a[56:59], v[72:75]
ds_read_b64_tr_b16 a[70:71], v46 offset:11520
v_mov_b32 v9, 3
ds_write_b32 v10, v9
v_mfma_f32_16x16x32_bf16 v[92:95], a[24:27], a[56:59], v[92:95]
v_mfma_f32_16x16x32_bf16 v[112:115], a[28:31], a[56:59], v[112:115]
s_waitcnt lgkmcnt(6)
v_mfma_f32_16x16x32_bf16 v[56:59], a[16:19], a[60:63], v[56:59]
s_waitcnt lgkmcnt(5)
v_min_u32 v6, v6, v7
v_cmp_gt_u32 vcc, 4, v6
s_nop 0
s_cbranch_vccnz W51
B52:
ds_read_b128 a[0:3], v31 offset:36864
v_mfma_f32_16x16x32_bf16 v[76:79], a[20:23], a[60:63], v[76:79]
ds_read_b64_tr_b16 a[32:33], v38 offset:36864
v_mfma_f32_16x16x32_bf16 v[96:99], a[24:27], a[60:63], v[96:99]
ds_read_b64_tr_b16 a[34:35], v38 offset:38144
v_mfma_f32_16x16x32_bf16 v[116:119], a[28:31], a[60:63], v[116:119]
ds_read_b128 a[4:7], v31 offset:38912
s_waitcnt lgkmcnt(7)
v_mfma_f32_16x16x32_bf16 v[60:63], a[16:19], a[64:67], v[60:63]
ds_read_b128 a[8:11], v31 offset:40960
v_mfma_f32_16x16x32_bf16 v[80:83], a[20:23], a[64:67], v[80:83]
ds_read_b128 a[12:15], v31 offset:43008
v_mfma_f32_16x16x32_bf16 v[100:103], a[24:27], a[64:67], v[100:103]
ds_read_b64_tr_b16 a[36:37], v40 offset:36864
v_mfma_f32_16x16x32_bf16 v[120:123], a[28:31], a[64:67], v[120:123]
ds_read_b64_tr_b16 a[38:39], v40 offset:38144
s_waitcnt lgkmcnt(9)
v_mfma_f32_16x16x32_bf16 v[64:67], a[16:19], a[68:71], v[64:67]
ds_read_b64_tr_b16 a[40:41], v42 offset:36864
v_mfma_f32_16x16x32_bf16 v[84:87], a[20:23], a[68:71], v[84:87]
ds_read_b64_tr_b16 a[42:43], v42 offset:38144
v_mfma_f32_16x16x32_bf16 v[104:107], a[24:27], a[68:71], v[104:107]
v_mfma_f32_16x16x32_bf16 v[124:127], a[28:31], a[68:71], v[124:127]
s_waitcnt lgkmcnt(7)
v_mfma_f32_16x16x32_bf16 v[48:51], a[0:3], a[32:35], v[48:51]
ds_read_b64_tr_b16 a[44:45], v44 offset:36864
s_waitcnt lgkmcnt(7)
v_mfma_f32_16x16x32_bf16 v[68:71], a[4:7], a[32:35], v[68:71]
ds_read_b64_tr_b16 a[46:47], v44 offset:38144
s_waitcnt lgkmcnt(7)
v_mfma_f32_16x16x32_bf16 v[88:91], a[8:11], a[32:35], v[88:91]
s_waitcnt lgkmcnt(6)
v_mfma_f32_16x16x32_bf16 v[108:111], a[12:15], a[32:35], v[108:111]
s_waitcnt lgkmcnt(4)
v_mfma_f32_16x16x32_bf16 v[52:55], a[0:3], a[36:39], v[52:55]
ds_read_b64_tr_b16 a[48:49], v46 offset:36864
v_mfma_f32_16x16x32_bf16 v[72:75], a[4:7], a[36:39], v[72:75]
ds_read_b64_tr_b16 a[50:51], v46 offset:38144
v_mfma_f32_16x16x32_bf16 v[92:95], a[8:11], a[36:39], v[92:95]
v_mfma_f32_16x16x32_bf16 v[112:115], a[12:15], a[36:39], v[112:115]
s_waitcnt lgkmcnt(4)
v_mfma_f32_16x16x32_bf16 v[56:59], a[0:3], a[40:43], v[56:59]
ds_read_b128 a[16:19], v32 offset:36864
v_mfma_f32_16x16x32_bf16 v[76:79], a[4:7], a[40:43], v[76:79]
ds_read_b64_tr_b16 a[52:53], v38 offset:47104
v_mfma_f32_16x16x32_bf16 v[96:99], a[8:11], a[40:43], v[96:99]
ds_read_b64_tr_b16 a[54:55], v38 offset:48384
v_mfma_f32_16x16x32_bf16 v[116:119], a[12:15], a[40:43], v[116:119]
ds_read_b128 a[20:23], v32 offset:38912
s_waitcnt lgkmcnt(6)
v_mfma_f32_16x16x32_bf16 v[60:63], a[0:3], a[44:47], v[60:63]
ds_read_b128 a[24:27], v32 offset:40960
v_mfma_f32_16x16x32_bf16 v[80:83], a[4:7], a[44:47], v[80:83]
ds_read_b128 a[28:31], v32 offset:43008
v_mfma_f32_16x16x32_bf16 v[100:103], a[8:11], a[44:47], v[100:103]
ds_read_b64_tr_b16 a[56:57], v40 offset:47104
v_mfma_f32_16x16x32_bf16 v[120:123], a[12:15], a[44:47], v[120:123]
ds_read_b64_tr_b16 a[58:59], v40 offset:48384
s_waitcnt lgkmcnt(8)
v_mfma_f32_16x16x32_bf16 v[64:67], a[0:3], a[48:51], v[64:67]
ds_read_b64_tr_b16 a[60:61], v42 offset:47104
v_mfma_f32_16x16x32_bf16 v[84:87], a[4:7], a[48:51], v[84:87]
ds_read_b64_tr_b16 a[62:63], v42 offset:48384
ds_read_b64 v[6:7], v3
v_mfma_f32_16x16x32_bf16 v[104:107], a[8:11], a[48:51], v[104:107]
v_mfma_f32_16x16x32_bf16 v[124:127], a[12:15], a[48:51], v[124:127]
s_waitcnt lgkmcnt(8)
v_mfma_f32_16x16x32_bf16 v[48:51], a[16:19], a[52:55], v[48:51]
ds_read_b64_tr_b16 a[64:65], v44 offset:47104
s_waitcnt lgkmcnt(8)
v_mfma_f32_16x16x32_bf16 v[68:71], a[20:23], a[52:55], v[68:71]
ds_read_b64_tr_b16 a[66:67], v44 offset:48384
s_waitcnt lgkmcnt(8)
v_mfma_f32_16x16x32_bf16 v[88:91], a[24:27], a[52:55], v[88:91]
s_waitcnt lgkmcnt(7)
v_mfma_f32_16x16x32_bf16 v[108:111], a[28:31], a[52:55], v[108:111]
s_waitcnt lgkmcnt(5)
v_mfma_f32_16x16x32_bf16 v[52:55], a[16:19], a[56:59], v[52:55]
ds_read_b64_tr_b16 a[68:69], v46 offset:47104
v_mfma_f32_16x16x32_bf16 v[72:75], a[20:23], a[56:59], v[72:75]
ds_read_b64_tr_b16 a[70:71], v46 offset:48384
v_mov_b32 v9, 4
ds_write_b32 v10, v9
v_mfma_f32_16x16x32_bf16 v[92:95], a[24:27], a[56:59], v[92:95]
v_mfma_f32_16x16x32_bf16 v[112:115], a[28:31], a[56:59], v[112:115]
s_waitcnt lgkmcnt(6)
v_mfma_f32_16x16x32_bf16 v[56:59], a[16:19], a[60:63], v[56:59]
s_waitcnt lgkmcnt(5)
v_min_u32 v6, v6, v7
v_cmp_gt_u32 vcc, 5, v6
s_nop 0
s_cbranch_vccnz W53
B54:
ds_read_b128 a[0:3], v33 offset:8192
v_mfma_f32_16x16x32_bf16 v[76:79], a[20:23], a[60:63], v[76:79]
ds_read_b64_tr_b16 a[32:33], v39 offset:8192
v_mfma_f32_16x16x32_bf16 v[96:99], a[24:27], a[60:63], v[96:99]
ds_read_b64_tr_b16 a[34:35], v39 offset:9472
v_mfma_f32_16x16x32_bf16 v[116:119], a[28:31], a[60:63], v[116:119]
ds_read_b128 a[4:7], v33 offset:10240
s_waitcnt lgkmcnt(7)
v_mfma_f32_16x16x32_bf16 v[60:63], a[16:19], a[64:67], v[60:63]
ds_read_b128 a[8:11], v33 offset:12288
v_mfma_f32_16x16x32_bf16 v[80:83], a[20:23], a[64:67], v[80:83]
ds_read_b128 a[12:15], v33 offset:14336
v_mfma_f32_16x16x32_bf16 v[100:103], a[24:27], a[64:67], v[100:103]
ds_read_b64_tr_b16 a[36:37], v41 offset:8192
v_mfma_f32_16x16x32_bf16 v[120:123], a[28:31], a[64:67], v[120:123]
ds_read_b64_tr_b16 a[38:39], v41 offset:9472
s_waitcnt lgkmcnt(9)
v_mfma_f32_16x16x32_bf16 v[64:67], a[16:19], a[68:71], v[64:67]
ds_read_b64_tr_b16 a[40:41], v43 offset:8192
v_mfma_f32_16x16x32_bf16 v[84:87], a[20:23], a[68:71], v[84:87]
ds_read_b64_tr_b16 a[42:43], v43 offset:9472
v_mfma_f32_16x16x32_bf16 v[104:107], a[24:27], a[68:71], v[104:107]
v_mfma_f32_16x16x32_bf16 v[124:127], a[28:31], a[68:71], v[124:127]
s_waitcnt lgkmcnt(7)
v_mfma_f32_16x16x32_bf16 v[48:51], a[0:3], a[32:35], v[48:51]
ds_read_b64_tr_b16 a[44:45], v45 offset:8192
s_waitcnt lgkmcnt(7)
v_mfma_f32_16x16x32_bf16 v[68:71], a[4:7], a[32:35], v[68:71]
ds_read_b64_tr_b16 a[46:47], v45 offset:9472
s_waitcnt lgkmcnt(7)
v_mfma_f32_16x16x32_bf16 v[88:91], a[8:11], a[32:35], v[88:91]
s_waitcnt lgkmcnt(6)
v_mfma_f32_16x16x32_bf16 v[108:111], a[12:15], a[32:35], v[108:111]
s_waitcnt lgkmcnt(4)
v_mfma_f32_16x16x32_bf16 v[52:55], a[0:3], a[36:39], v[52:55]
ds_read_b64_tr_b16 a[48:49], v47 offset:8192
v_mfma_f32_16x16x32_bf16 v[72:75], a[4:7], a[36:39], v[72:75]
ds_read_b64_tr_b16 a[50:51], v47 offset:9472
v_mfma_f32_16x16x32_bf16 v[92:95], a[8:11], a[36:39], v[92:95]
v_mfma_f32_16x16x32_bf16 v[112:115], a[12:15], a[36:39], v[112:115]
s_waitcnt lgkmcnt(4)
v_mfma_f32_16x16x32_bf16 v[56:59], a[0:3], a[40:43], v[56:59]
ds_read_b128 a[16:19], v34 offset:8192
v_mfma_f32_16x16x32_bf16 v[76:79], a[4:7], a[40:43], v[76:79]
ds_read_b64_tr_b16 a[52:53], v39 offset:18432
v_mfma_f32_16x16x32_bf16 v[96:99], a[8:11], a[40:43], v[96:99]
ds_read_b64_tr_b16 a[54:55], v39 offset:19712
v_mfma_f32_16x16x32_bf16 v[116:119], a[12:15], a[40:43], v[116:119]
ds_read_b128 a[20:23], v34 offset:10240
s_waitcnt lgkmcnt(6)
v_mfma_f32_16x16x32_bf16 v[60:63], a[0:3], a[44:47], v[60:63]
ds_read_b128 a[24:27], v34 offset:12288
v_mfma_f32_16x16x32_bf16 v[80:83], a[4:7], a[44:47], v[80:83]
ds_read_b128 a[28:31], v34 offset:14336
v_mfma_f32_16x16x32_bf16 v[100:103], a[8:11], a[44:47], v[100:103]
ds_read_b64_tr_b16 a[56:57], v41 offset:18432
v_mfma_f32_16x16x32_bf16 v[120:123], a[12:15], a[44:47], v[120:123]
ds_read_b64_tr_b16 a[58:59], v41 offset:19712
s_waitcnt lgkmcnt(8)
v_mfma_f32_16x16x32_bf16 v[64:67], a[0:3], a[48:51], v[64:67]
ds_read_b64_tr_b16 a[60:61], v43 offset:18432
v_mfma_f32_16x16x32_bf16 v[84:87], a[4:7], a[48:51], v[84:87]
ds_read_b64_tr_b16 a[62:63], v43 offset:19712
ds_read_b64 v[6:7], v3
v_mfma_f32_16x16x32_bf16 v[104:107], a[8:11], a[48:51], v[104:107]
v_mfma_f32_16x16x32_bf16 v[124:127], a[12:15], a[48:51], v[124:127]
s_waitcnt lgkmcnt(8)
v_mfma_f32_16x16x32_bf16 v[48:51], a[16:19], a[52:55], v[48:51]
ds_read_b64_tr_b16 a[64:65], v45 offset:18432
s_waitcnt lgkmcnt(8)
v_mfma_f32_16x16x32_bf16 v[68:71], a[20:23], a[52:55], v[68:71]
ds_read_b64_tr_b16 a[66:67], v45 offset:19712
s_waitcnt lgkmcnt(8)
v_mfma_f32_16x16x32_bf16 v[88:91], a[24:27], a[52:55], v[88:91]
s_waitcnt lgkmcnt(7)
v_mfma_f32_16x16x32_bf16 v[108:111], a[28:31], a[52:55], v[108:111]
s_waitcnt lgkmcnt(5)
v_mfma_f32_16x16x32_bf16 v[52:55], a[16:19], a[56:59], v[52:55]
ds_read_b64_tr_b16 a[68:69], v47 offset:18432
v_mfma_f32_16x16x32_bf16 v[72:75], a[20:23], a[56:59], v[72:75]
ds_read_b64_tr_b16 a[70:71], v47 offset:19712
v_mov_b32 v9, 5
ds_write_b32 v10, v9
v_mfma_f32_16x16x32_bf16 v[92:95], a[24:27], a[56:59], v[92:95]
v_mfma_f32_16x16x32_bf16 v[112:115], a[28:31], a[56:59], v[112:115]
s_waitcnt lgkmcnt(6)
v_mfma_f32_16x16x32_bf16 v[56:59], a[16:19], a[60:63], v[56:59]
s_waitcnt lgkmcnt(5)
v_min_u32 v6, v6, v7
v_cmp_gt_u32 vcc, 6, v6
s_nop 0
s_cbranch_vccnz W55
B56:
ds_read_b128 a[0:3], v33 offset:45056
v_mfma_f32_16x16x32_bf16 v[76:79], a[20:23], a[60:63], v[76:79]
ds_read_b64_tr_b16 a[32:33], v39 offset:45056
v_mfma_f32_16x16x32_bf16 v[96:99], a[24:27], a[60:63], v[96:99]
ds_read_b64_tr_b16 a[34:35], v39 offset:46336
v_mfma_f32_16x16x32_bf16 v[116:119], a[28:31], a[60:63], v[116:119]
ds_read_b128 a[4:7], v33 offset:47104
s_waitcnt lgkmcnt(7)
v_mfma_f32_16x16x32_bf16 v[60:63], a[16:19], a[64:67], v[60:63]
ds_read_b128 a[8:11], v33 offset:49152
v_mfma_f32_16x16x32_bf16 v[80:83], a[20:23], a[64:67], v[80:83]
ds_read_b128 a[12:15], v33 offset:51200
v_mfma_f32_16x16x32_bf16 v[100:103], a[24:27], a[64:67], v[100:103]
ds_read_b64_tr_b16 a[36:37], v41 offset:45056
v_mfma_f32_16x16x32_bf16 v[120:123], a[28:31], a[64:67], v[120:123]
ds_read_b64_tr_b16 a[38:39], v41 offset:46336
s_waitcnt lgkmcnt(9)
v_mfma_f32_16x16x32_bf16 v[64:67], a[16:19], a[68:71], v[64:67]
ds_read_b64_tr_b16 a[40:41], v43 offset:45056
v_mfma_f32_16x16x32_bf16 v[84:87], a[20:23], a[68:71], v[84:87]
ds_read_b64_tr_b16 a[42:43], v43 offset:46336
v_mfma_f32_16x16x32_bf16 v[104:107], a[24:27], a[68:71], v[104:107]
v_mfma_f32_16x16x32_bf16 v[124:127], a[28:31], a[68:71], v[124:127]
s_waitcnt lgkmcnt(7)
v_mfma_f32_16x16x32_bf16 v[48:51], a[0:3], a[32:35], v[48:51]
ds_read_b64_tr_b16 a[44:45], v45 offset:45056
s_waitcnt lgkmcnt(7)
v_mfma_f32_16x16x32_bf16 v[68:71], a[4:7], a[32:35], v[68:71]
ds_read_b64_tr_b16 a[46:47], v45 offset:46336
s_waitcnt lgkmcnt(7)
v_mfma_f32_16x16x32_bf16 v[88:91], a[8:11], a[32:35], v[88:91]
s_waitcnt lgkmcnt(6)
v_mfma_f32_16x16x32_bf16 v[108:111], a[12:15], a[32:35], v[108:111]
s_waitcnt lgkmcnt(4)
v_mfma_f32_16x16x32_bf16 v[52:55], a[0:3], a[36:39], v[52:55]
ds_read_b64_tr_b16 a[48:49], v47 offset:45056
v_mfma_f32_16x16x32_bf16 v[72:75], a[4:7], a[36:39], v[72:75]
ds_read_b64_tr_b16 a[50:51], v47 offset:46336
v_mfma_f32_16x16x32_bf16 v[92:95], a[8:11], a[36:39], v[92:95]
v_mfma_f32_16x16x32_bf16 v[112:115], a[12:15], a[36:39], v[112:115]
s_waitcnt lgkmcnt(4)
v_mfma_f32_16x16x32_bf16 v[56:59], a[0:3], a[40:43], v[56:59]
ds_read_b128 a[16:19], v34 offset:45056
v_mfma_f32_16x16x32_bf16 v[76:79], a[4:7], a[40:43], v[76:79]
ds_read_b64_tr_b16 a[52:53], v39 offset:55296
v_mfma_f32_16x16x32_bf16 v[96:99], a[8:11], a[40:43], v[96:99]
ds_read_b64_tr_b16 a[54:55], v39 offset:56576
v_mfma_f32_16x16x32_bf16 v[116:119], a[12:15], a[40:43], v[116:119]
ds_read_b128 a[20:23], v34 offset:47104
s_waitcnt lgkmcnt(6)
v_mfma_f32_16x16x32_bf16 v[60:63], a[0:3], a[44:47], v[60:63]
ds_read_b128 a[24:27], v34 offset:49152
v_mfma_f32_16x16x32_bf16 v[80:83], a[4:7], a[44:47], v[80:83]
ds_read_b128 a[28:31], v34 offset:51200
v_mfma_f32_16x16x32_bf16 v[100:103], a[8:11], a[44:47], v[100:103]
ds_read_b64_tr_b16 a[56:57], v41 offset:55296
v_mfma_f32_16x16x32_bf16 v[120:123], a[12:15], a[44:47], v[120:123]
ds_read_b64_tr_b16 a[58:59], v41 offset:56576
s_waitcnt lgkmcnt(8)
v_mfma_f32_16x16x32_bf16 v[64:67], a[0:3], a[48:51], v[64:67]
ds_read_b64_tr_b16 a[60:61], v43 offset:55296
v_mfma_f32_16x16x32_bf16 v[84:87], a[4:7], a[48:51], v[84:87]
ds_read_b64_tr_b16 a[62:63], v43 offset:56576
ds_read_b64 v[6:7], v3
v_mfma_f32_16x16x32_bf16 v[104:107], a[8:11], a[48:51], v[104:107]
v_mfma_f32_16x16x32_bf16 v[124:127], a[12:15], a[48:51], v[124:127]
s_waitcnt lgkmcnt(8)
v_mfma_f32_16x16x32_bf16 v[48:51], a[16:19], a[52:55], v[48:51]
ds_read_b64_tr_b16 a[64:65], v45 offset:55296
s_waitcnt lgkmcnt(8)
v_mfma_f32_16x16x32_bf16 v[68:71], a[20:23], a[52:55], v[68:71]
ds_read_b64_tr_b16 a[66:67], v45 offset:56576
s_waitcnt lgkmcnt(8)
v_mfma_f32_16x16x32_bf16 v[88:91], a[24:27], a[52:55], v[88:91]
s_waitcnt lgkmcnt(7)
v_mfma_f32_16x16x32_bf16 v[108:111], a[28:31], a[52:55], v[108:111]
s_waitcnt lgkmcnt(5)
v_mfma_f32_16x16x32_bf16 v[52:55], a[16:19], a[56:59], v[52:55]
ds_read_b64_tr_b16 a[68:69], v47 offset:55296
v_mfma_f32_16x16x32_bf16 v[72:75], a[20:23], a[56:59], v[72:75]
ds_read_b64_tr_b16 a[70:71], v47 offset:56576
v_mov_b32 v9, 6
ds_write_b32 v10, v9
v_mfma_f32_16x16x32_bf16 v[92:95], a[24:27], a[56:59], v[92:95]
v_mfma_f32_16x16x32_bf16 v[112:115], a[28:31], a[56:59], v[112:115]
s_waitcnt lgkmcnt(6)
v_mfma_f32_16x16x32_bf16 v[56:59], a[16:19], a[60:63], v[56:59]
s_waitcnt lgkmcnt(5)
v_min_u32 v6, v6, v7
v_cmp_gt_u32 vcc, 7, v6
s_nop 0
s_cbranch_vccnz W57
B58:
ds_read_b128 a[0:3], v31 offset:0
v_mfma_f32_16x16x32_bf16 v[76:79], a[20:23], a[60:63], v[76:79]
ds_read_b64_tr_b16 a[32:33], v38 offset:0
v_mfma_f32_16x16x32_bf16 v[96:99], a[24:27], a[60:63], v[96:99]
ds_read_b64_tr_b16 a[34:35], v38 offset:1280
v_mfma_f32_16x16x32_bf16 v[116:119], a[28:31], a[60:63], v[116:119]
ds_read_b128 a[4:7], v31 offset:2048
s_waitcnt lgkmcnt(7)
v_mfma_f32_16x16x32_bf16 v[60:63], a[16:19], a[64:67], v[60:63]
ds_read_b128 a[8:11], v31 offset:4096
v_mfma_f32_16x16x32_bf16 v[80:83], a[20:23], a[64:67], v[80:83]
ds_read_b128 a[12:15], v31 offset:6144
v_mfma_f32_16x16x32_bf16 v[100:103], a[24:27], a[64:67], v[100:103]
ds_read_b64_tr_b16 a[36:37], v40 offset:0
v_mfma_f32_16x16x32_bf16 v[120:123], a[28:31], a[64:67], v[120:123]
ds_read_b64_tr_b16 a[38:39], v40 offset:1280
s_waitcnt lgkmcnt(9)
v_mfma_f32_16x16x32_bf16 v[64:67], a[16:19], a[68:71], v[64:67]
ds_read_b64_tr_b16 a[40:41], v42 offset:0
v_mfma_f32_16x16x32_bf16 v[84:87], a[20:23], a[68:71], v[84:87]
ds_read_b64_tr_b16 a[42:43], v42 offset:1280
v_mfma_f32_16x16x32_bf16 v[104:107], a[24:27], a[68:71], v[104:107]
v_mfma_f32_16x16x32_bf16 v[124:127], a[28:31], a[68:71], v[124:127]
s_waitcnt lgkmcnt(7)
v_mfma_f32_16x16x32_bf16 v[48:51], a[0:3], a[32:35], v[48:51]
ds_read_b64_tr_b16 a[44:45], v44 offset:0
s_waitcnt lgkmcnt(7)
v_mfma_f32_16x16x32_bf16 v[68:71], a[4:7], a[32:35], v[68:71]
ds_read_b64_tr_b16 a[46:47], v44 offset:1280
s_waitcnt lgkmcnt(7)
v_mfma_f32_16x16x32_bf16 v[88:91], a[8:11], a[32:35], v[88:91]
s_waitcnt lgkmcnt(6)
v_mfma_f32_16x16x32_bf16 v[108:111], a[12:15], a[32:35], v[108:111]
s_waitcnt lgkmcnt(4)
v_mfma_f32_16x16x32_bf16 v[52:55], a[0:3], a[36:39], v[52:55]
ds_read_b64_tr_b16 a[48:49], v46 offset:0
v_mfma_f32_16x16x32_bf16 v[72:75], a[4:7], a[36:39], v[72:75]
ds_read_b64_tr_b16 a[50:51], v46 offset:1280
v_mfma_f32_16x16x32_bf16 v[92:95], a[8:11], a[36:39], v[92:95]
v_mfma_f32_16x16x32_bf16 v[112:115], a[12:15], a[36:39], v[112:115]
s_waitcnt lgkmcnt(4)
v_mfma_f32_16x16x32_bf16 v[56:59], a[0:3], a[40:43], v[56:59]
ds_read_b128 a[16:19], v32 offset:0
v_mfma_f32_16x16x32_bf16 v[76:79], a[4:7], a[40:43], v[76:79]
ds_read_b64_tr_b16 a[52:53], v38 offset:10240
v_mfma_f32_16x16x32_bf16 v[96:99], a[8:11], a[40:43], v[96:99]
ds_read_b64_tr_b16 a[54:55], v38 offset:11520
v_mfma_f32_16x16x32_bf16 v[116:119], a[12:15], a[40:43], v[116:119]
ds_read_b128 a[20:23], v32 offset:2048
s_waitcnt lgkmcnt(6)
v_mfma_f32_16x16x32_bf16 v[60:63], a[0:3], a[44:47], v[60:63]
ds_read_b128 a[24:27], v32 offset:4096
v_mfma_f32_16x16x32_bf16 v[80:83], a[4:7], a[44:47], v[80:83]
ds_read_b128 a[28:31], v32 offset:6144
v_mfma_f32_16x16x32_bf16 v[100:103], a[8:11], a[44:47], v[100:103]
ds_read_b64_tr_b16 a[56:57], v40 offset:10240
v_mfma_f32_16x16x32_bf16 v[120:123], a[12:15], a[44:47], v[120:123]
ds_read_b64_tr_b16 a[58:59], v40 offset:11520
s_waitcnt lgkmcnt(8)
v_mfma_f32_16x16x32_bf16 v[64:67], a[0:3], a[48:51], v[64:67]
ds_read_b64_tr_b16 a[60:61], v42 offset:10240
v_mfma_f32_16x16x32_bf16 v[84:87], a[4:7], a[48:51], v[84:87]
ds_read_b64_tr_b16 a[62:63], v42 offset:11520
ds_read_b64 v[6:7], v3
v_mfma_f32_16x16x32_bf16 v[104:107], a[8:11], a[48:51], v[104:107]
v_mfma_f32_16x16x32_bf16 v[124:127], a[12:15], a[48:51], v[124:127]
s_waitcnt lgkmcnt(8)
v_mfma_f32_16x16x32_bf16 v[48:51], a[16:19], a[52:55], v[48:51]
ds_read_b64_tr_b16 a[64:65], v44 offset:10240
s_waitcnt lgkmcnt(8)
v_mfma_f32_16x16x32_bf16 v[68:71], a[20:23], a[52:55], v[68:71]
ds_read_b64_tr_b16 a[66:67], v44 offset:11520
s_waitcnt lgkmcnt(8)
v_mfma_f32_16x16x32_bf16 v[88:91], a[24:27], a[52:55], v[88:91]
s_waitcnt lgkmcnt(7)
v_mfma_f32_16x16x32_bf16 v[108:111], a[28:31], a[52:55], v[108:111]
s_waitcnt lgkmcnt(5)
v_mfma_f32_16x16x32_bf16 v[52:55], a[16:19], a[56:59], v[52:55]
ds_read_b64_tr_b16 a[68:69], v46 offset:10240
v_mfma_f32_16x16x32_bf16 v[72:75], a[20:23], a[56:59], v[72:75]
ds_read_b64_tr_b16 a[70:71], v46 offset:11520
v_mov_b32 v9, 7
ds_write_b32 v10, v9
v_mfma_f32_16x16x32_bf16 v[92:95], a[24:27], a[56:59], v[92:95]
v_mfma_f32_16x16x32_bf16 v[112:115], a[28:31], a[56:59], v[112:115]
s_waitcnt lgkmcnt(6)
v_mfma_f32_16x16x32_bf16 v[56:59], a[16:19], a[60:63], v[56:59]
s_waitcnt lgkmcnt(5)
v_min_u32 v6, v6, v7
v_cmp_gt_u32 vcc, 8, v6
s_nop 0
s_cbranch_vccnz W59
B60:
ds_read_b128 a[0:3], v31 offset:36864
v_mfma_f32_16x16x32_bf16 v[76:79], a[20:23], a[60:63], v[76:79]
ds_read_b64_tr_b16 a[32:33], v38 offset:36864
v_mfma_f32_16x16x32_bf16 v[96:99], a[24:27], a[60:63], v[96:99]
ds_read_b64_tr_b16 a[34:35], v38 offset:38144
v_mfma_f32_16x16x32_bf16 v[116:119], a[28:31], a[60:63], v[116:119]
ds_read_b128 a[4:7], v31 offset:38912
s_waitcnt lgkmcnt(7)
v_mfma_f32_16x16x32_bf16 v[60:63], a[16:19], a[64:67], v[60:63]
ds_read_b128 a[8:11], v31 offset:40960
v_mfma_f32_16x16x32_bf16 v[80:83], a[20:23], a[64:67], v[80:83]
ds_read_b128 a[12:15], v31 offset:43008
v_mfma_f32_16x16x32_bf16 v[100:103], a[24:27], a[64:67], v[100:103]
ds_read_b64_tr_b16 a[36:37], v40 offset:36864
v_mfma_f32_16x16x32_bf16 v[120:123], a[28:31], a[64:67], v[120:123]
ds_read_b64_tr_b16 a[38:39], v40 offset:38144
s_waitcnt lgkmcnt(9)
v_mfma_f32_16x16x32_bf16 v[64:67], a[16:19], a[68:71], v[64:67]
ds_read_b64_tr_b16 a[40:41], v42 offset:36864
v_mfma_f32_16x16x32_bf16 v[84:87], a[20:23], a[68:71], v[84:87]
ds_read_b64_tr_b16 a[42:43], v42 offset:38144
v_mfma_f32_16x16x32_bf16 v[104:107], a[24:27], a[68:71], v[104:107]
v_mfma_f32_16x16x32_bf16 v[124:127], a[28:31], a[68:71], v[124:127]
s_waitcnt lgkmcnt(7)
v_mfma_f32_16x16x32_bf16 v[48:51], a[0:3], a[32:35], v[48:51]
ds_read_b64_tr_b16 a[44:45], v44 offset:36864
s_waitcnt lgkmcnt(7)
v_mfma_f32_16x16x32_bf16 v[68:71], a[4:7], a[32:35], v[68:71]
ds_read_b64_tr_b16 a[46:47], v44 offset:38144
s_waitcnt lgkmcnt(7)
v_mfma_f32_16x16x32_bf16 v[88:91], a[8:11], a[32:35], v[88:91]
s_waitcnt lgkmcnt(6)
v_mfma_f32_16x16x32_bf16 v[108:111], a[12:15], a[32:35], v[108:111]
s_waitcnt lgkmcnt(4)
v_mfma_f32_16x16x32_bf16 v[52:55], a[0:3], a[36:39], v[52:55]
ds_read_b64_tr_b16 a[48:49], v46 offset:36864
v_mfma_f32_16x16x32_bf16 v[72:75], a[4:7], a[36:39], v[72:75]
ds_read_b64_tr_b16 a[50:51], v46 offset:38144
v_mfma_f32_16x16x32_bf16 v[92:95], a[8:11], a[36:39], v[92:95]
v_mfma_f32_16x16x32_bf16 v[112:115], a[12:15], a[36:39], v[112:115]
s_waitcnt lgkmcnt(4)
v_mfma_f32_16x16x32_bf16 v[56:59], a[0:3], a[40:43], v[56:59]
ds_read_b128 a[16:19], v32 offset:36864
v_mfma_f32_16x16x32_bf16 v[76:79], a[4:7], a[40:43], v[76:79]
ds_read_b64_tr_b16 a[52:53], v38 offset:47104
ds_read_b32 v6, v3 offset:36
s_waitcnt lgkmcnt(0)
v_cmp_gt_u32 vcc, 1, v6
s_nop 0
s_cbranch_vccnz W61
B62:
s_mov_b64 exec, 0xffff
ds_read_b64 v[144:145], v35 offset:0
ds_read_b64 v[148:149], v35 offset:128
ds_read_b64 v[152:153], v36 offset:256
ds_read_b64 v[156:157], v35 offset:704
ds_read_b64 v[160:161], v35 offset:832
s_mov_b64 exec, -1
v_mfma_f32_16x16x32_bf16 v[96:99], a[8:11], a[40:43], v[96:99]
ds_read_b64_tr_b16 a[54:55], v38 offset:48384
ds_read_b64 v[128:129], v21 offset:0
v_mfma_f32_16x16x32_bf16 v[116:119], a[12:15], a[40:43], v[116:119]
ds_read_b128 a[20:23], v32 offset:38912
ds_read_b64 v[132:133], v21 offset:128
v_mfma_f32_16x16x32_bf16 v[60:63], a[0:3], a[44:47], v[60:63]
ds_read_b128 a[24:27], v32 offset:40960
ds_read_b64 v[136:137], v21 offset:256
v_mfma_f32_16x16x32_bf16 v[80:83], a[4:7], a[44:47], v[80:83]
ds_read_b128 a[28:31], v32 offset:43008
ds_read_b64 v[140:141], v21 offset:384
v_mfma_f32_16x16x32_bf16 v[100:103], a[8:11], a[44:47], v[100:103]
ds_read_b64_tr_b16 a[56:57], v40 offset:47104
ds_read_b32 v2, v3 offset:76
v_mfma_f32_16x16x32_bf16 v[120:123], a[12:15], a[44:47], v[120:123]
ds_read_b64_tr_b16 a[58:59], v40 offset:48384
s_lshl_b32 s48, s52, 7
s_add_u32 s48, s48, 161280
v_lshl_add_u32 v30, v11, 3, s48
v_mfma_f32_16x16x32_bf16 v[64:67], a[0:3], a[48:51], v[64:67]
ds_read_b64_tr_b16 a[60:61], v42 offset:47104
ds_read_b64 v[22:23], v30
v_mfma_f32_16x16x32_bf16 v[84:87], a[4:7], a[48:51], v[84:87]
ds_read_b64_tr_b16 a[62:63], v42 offset:48384
ds_read_b64 v[6:7], v3
v_and_b32 v30, 31, v1
v_mfma_f32_16x16x32_bf16 v[104:107], a[8:11], a[48:51], v[104:107]
v_lshlrev_b32 v30, 3, v30
v_add_u32 v30, 155648, v30
v_mfma_f32_16x16x32_bf16 v[124:127], a[12:15], a[48:51], v[124:127]
ds_read_b64 v[24:25], v30 offset:1280
ds_read_b64 v[26:27], v30 offset:1536
s_waitcnt lgkmcnt(15)
v_mfma_f32_16x16x32_bf16 v[48:51], a[16:19], a[52:55], v[48:51]
ds_read_b64_tr_b16 a[64:65], v44 offset:47104
ds_read_b64 v[28:29], v30 offset:1792
s_waitcnt lgkmcnt(15)
v_mfma_f32_16x16x32_bf16 v[68:71], a[20:23], a[52:55], v[68:71]
ds_read_b64_tr_b16 a[66:67], v44 offset:48384
s_waitcnt lgkmcnt(10)
v_readfirstlane_b32 s53, v2
v_mfma_f32_16x16x32_bf16 v[88:91], a[24:27], a[52:55], v[88:91]
v_mfma_f32_16x16x32_bf16 v[108:111], a[28:31], a[52:55], v[108:111]
s_waitcnt lgkmcnt(9)
v_mfma_f32_16x16x32_bf16 v[52:55], a[16:19], a[56:59], v[52:55]
ds_read_b64_tr_b16 a[68:69], v46 offset:47104
v_mfma_f32_16x16x32_bf16 v[72:75], a[20:23], a[56:59], v[72:75]
ds_read_b64_tr_b16 a[70:71], v46 offset:48384
v_mov_b32 v9, 8
ds_write_b32 v10, v9
v_mfma_f32_16x16x32_bf16 v[92:95], a[24:27], a[56:59], v[92:95]
v_mfma_f32_16x16x32_bf16 v[112:115], a[28:31], a[56:59], v[112:115]
s_waitcnt lgkmcnt(9)
v_mfma_f32_16x16x32_bf16 v[56:59], a[16:19], a[60:63], v[56:59]
s_waitcnt lgkmcnt(8)
v_min_u32 v6, v6, v7
v_cmp_gt_u32 vcc, 9, v6
s_nop 0
s_cbranch_vccnz W63
B64:
ds_read_b128 a[0:3], v33 offset:8192
v_mfma_f32_16x16x32_bf16 v[76:79], a[20:23], a[60:63], v[76:79]
ds_read_b64_tr_b16 a[32:33], v39 offset:8192
v_mfma_f32_16x16x32_bf16 v[96:99], a[24:27], a[60:63], v[96:99]
ds_read_b64_tr_b16 a[34:35], v39 offset:9472
v_mfma_f32_16x16x32_bf16 v[116:119], a[28:31], a[60:63], v[116:119]
ds_read_b128 a[4:7], v33 offset:10240
s_waitcnt lgkmcnt(7)
v_mfma_f32_16x16x32_bf16 v[60:63], a[16:19], a[64:67], v[60:63]
ds_read_b128 a[8:11], v33 offset:12288
v_mfma_f32_16x16x32_bf16 v[80:83], a[20:23], a[64:67], v[80:83]
ds_read_b128 a[12:15], v33 offset:14336
v_mfma_f32_16x16x32_bf16 v[100:103], a[24:27], a[64:67], v[100:103]
ds_read_b64_tr_b16 a[36:37], v41 offset:8192
v_mfma_f32_16x16x32_bf16 v[120:123], a[28:31], a[64:67], v[120:123]
ds_read_b64_tr_b16 a[38:39], v41 offset:9472
s_waitcnt lgkmcnt(9)
v_mfma_f32_16x16x32_bf16 v[64:67], a[16:19], a[68:71], v[64:67]
ds_read_b64_tr_b16 a[40:41], v43 offset:8192
v_mfma_f32_16x16x32_bf16 v[84:87], a[20:23], a[68:71], v[84:87]
ds_read_b64_tr_b16 a[42:43], v43 offset:9472
v_mfma_f32_16x16x32_bf16 v[104:107], a[24:27], a[68:71], v[104:107]
v_mfma_f32_16x16x32_bf16 v[124:127], a[28:31], a[68:71], v[124:127]
s_waitcnt lgkmcnt(7)
v_mfma_f32_16x16x32_bf16 v[48:51], a[0:3], a[32:35], v[48:51]
ds_read_b64_tr_b16 a[44:45], v45 offset:8192
s_waitcnt lgkmcnt(7)
v_mfma_f32_16x16x32_bf16 v[68:71], a[4:7], a[32:35], v[68:71]
ds_read_b64_tr_b16 a[46:47], v45 offset:9472
s_waitcnt lgkmcnt(7)
v_mfma_f32_16x16x32_bf16 v[88:91], a[8:11], a[32:35], v[88:91]
s_waitcnt lgkmcnt(6)
v_mfma_f32_16x16x32_bf16 v[108:111], a[12:15], a[32:35], v[108:111]
s_waitcnt lgkmcnt(4)
v_mfma_f32_16x16x32_bf16 v[52:55], a[0:3], a[36:39], v[52:55]
ds_read_b64_tr_b16 a[48:49], v47 offset:8192
v_mfma_f32_16x16x32_bf16 v[72:75], a[4:7], a[36:39], v[72:75]
ds_read_b64_tr_b16 a[50:51], v47 offset:9472
v_mfma_f32_16x16x32_bf16 v[92:95], a[8:11], a[36:39], v[92:95]
v_mfma_f32_16x16x32_bf16 v[112:115], a[12:15], a[36:39], v[112:115]
s_waitcnt lgkmcnt(4)
v_mfma_f32_16x16x32_bf16 v[56:59], a[0:3], a[40:43], v[56:59]
v_mfma_f32_16x16x32_bf16 v[76:79], a[4:7], a[40:43], v[76:79]
v_mfma_f32_16x16x32_bf16 v[96:99], a[8:11], a[40:43], v[96:99]
v_mfma_f32_16x16x32_bf16 v[116:119], a[12:15], a[40:43], v[116:119]
s_waitcnt lgkmcnt(2)
v_mfma_f32_16x16x32_bf16 v[60:63], a[0:3], a[44:47], v[60:63]
v_mfma_f32_16x16x32_bf16 v[80:83], a[4:7], a[44:47], v[80:83]
v_mfma_f32_16x16x32_bf16 v[100:103], a[8:11], a[44:47], v[100:103]
v_mfma_f32_16x16x32_bf16 v[120:123], a[12:15], a[44:47], v[120:123]
s_waitcnt lgkmcnt(0)
v_mfma_f32_16x16x32_bf16 v[64:67], a[0:3], a[48:51], v[64:67]
v_mfma_f32_16x16x32_bf16 v[84:87], a[4:7], a[48:51], v[84:87]
v_mfma_f32_16x16x32_bf16 v[104:107], a[8:11], a[48:51], v[104:107]
v_mfma_f32_16x16x32_bf16 v[124:127], a[12:15], a[48:51], v[124:127]
v_mfma_f32_16x16x32_bf16 v[48:51], v[128:131], v[144:147], v[48:51]
v_mfma_f32_16x16x32_bf16 v[68:71], v[132:135], v[144:147], v[68:71]
v_mfma_f32_16x16x32_bf16 v[88:91], v[136:139], v[144:147], v[88:91]
v_mfma_f32_16x16x32_bf16 v[108:111], v[140:143], v[144:147], v[108:111]
v_mfma_f32_16x16x32_bf16 v[52:55], v[128:131], v[148:151], v[52:55]
v_mfma_f32_16x16x32_bf16 v[72:75], v[132:135], v[148:151], v[72:75]
v_mfma_f32_16x16x32_bf16 v[92:95], v[136:139], v[148:151], v[92:95]
v_mfma_f32_16x16x32_bf16 v[112:115], v[140:143], v[148:151], v[112:115]
v_mfma_f32_16x16x32_bf16 v[56:59], v[128:131], v[152:155], v[56:59]
ds_read_b128 a[16:19], v34 offset:8192
v_mfma_f32_16x16x32_bf16 v[76:79], v[132:135], v[152:155], v[76:79]
ds_read_b64_tr_b16 a[52:53], v39 offset:18432
v_mfma_f32_16x16x32_bf16 v[96:99], v[136:139], v[152:155], v[96:99]
ds_read_b64_tr_b16 a[54:55], v39 offset:19712
v_mfma_f32_16x16x32_bf16 v[116:119], v[140:143], v[152:155], v[116:119]
ds_read_b128 a[20:23], v34 offset:10240
v_mfma_f32_16x16x32_bf16 v[60:63], v[128:131], v[156:159], v[60:63]
ds_read_b128 a[24:27], v34 offset:12288
v_mfma_f32_16x16x32_bf16 v[80:83], v[132:135], v[156:159], v[80:83]
ds_read_b128 a[28:31], v34 offset:14336
v_mfma_f32_16x16x32_bf16 v[100:103], v[136:139], v[156:159], v[100:103]
ds_read_b64_tr_b16 a[56:57], v41 offset:18432
v_mfma_f32_16x16x32_bf16 v[120:123], v[140:143], v[156:159], v[120:123]
ds_read_b64_tr_b16 a[58:59], v41 offset:19712
v_mfma_f32_16x16x32_bf16 v[64:67], v[128:131], v[160:163], v[64:67]
ds_read_b64_tr_b16 a[60:61], v43 offset:18432
v_mfma_f32_16x16x32_bf16 v[84:87], v[132:135], v[160:163], v[84:87]
ds_read_b64_tr_b16 a[62:63], v43 offset:19712
ds_read_b64 v[6:7], v3
v_mfma_f32_16x16x32_bf16 v[104:107], v[136:139], v[160:163], v[104:107]
v_mfma_f32_16x16x32_bf16 v[124:127], v[140:143], v[160:163], v[124:127]
s_waitcnt lgkmcnt(8)
v_mfma_f32_16x16x32_bf16 v[48:51], a[16:19], a[52:55], v[48:51]
ds_read_b64_tr_b16 a[64:65], v45 offset:18432
s_waitcnt lgkmcnt(8)
v_mfma_f32_16x16x32_bf16 v[68:71], a[20:23], a[52:55], v[68:71]
ds_read_b64_tr_b16 a[66:67], v45 offset:19712
s_waitcnt lgkmcnt(8)
v_mfma_f32_16x16x32_bf16 v[88:91], a[24:27], a[52:55], v[88:91]
s_waitcnt lgkmcnt(7)
v_mfma_f32_16x16x32_bf16 v[108:111], a[28:31], a[52:55], v[108:111]
s_waitcnt lgkmcnt(5)
v_mfma_f32_16x16x32_bf16 v[52:55], a[16:19], a[56:59], v[52:55]
ds_read_b64_tr_b16 a[68:69], v47 offset:18432
v_mfma_f32_16x16x32_bf16 v[72:75], a[20:23], a[56:59], v[72:75]
ds_read_b64_tr_b16 a[70:71], v47 offset:19712
v_mov_b32 v9, 9
ds_write_b32 v10, v9
v_mfma_f32_16x16x32_bf16 v[92:95], a[24:27], a[56:59], v[92:95]
v_mfma_f32_16x16x32_bf16 v[112:115], a[28:31], a[56:59], v[112:115]
s_waitcnt lgkmcnt(6)
v_mfma_f32_16x16x32_bf16 v[56:59], a[16:19], a[60:63], v[56:59]
s_waitcnt lgkmcnt(5)
v_min_u32 v6, v6, v7
v_cmp_gt_u32 vcc, 10, v6
s_nop 0
s_cbranch_vccnz W65
B66:
ds_read_b128 a[0:3], v33 offset:45056
v_mfma_f32_16x16x32_bf16 v[76:79], a[20:23], a[60:63], v[76:79]
ds_read_b64_tr_b16 a[32:33], v39 offset:45056
v_mfma_f32_16x16x32_bf16 v[96:99], a[24:27], a[60:63], v[96:99]
ds_read_b64_tr_b16 a[34:35], v39 offset:46336
v_mfma_f32_16x16x32_bf16 v[116:119], a[28:31], a[60:63], v[116:119]
ds_read_b128 a[4:7], v33 offset:47104
s_waitcnt lgkmcnt(7)
v_mfma_f32_16x16x32_bf16 v[60:63], a[16:19], a[64:67], v[60:63]
ds_read_b128 a[8:11], v33 offset:49152
v_mfma_f32_16x16x32_bf16 v[80:83], a[20:23], a[64:67], v[80:83]
ds_read_b128 a[12:15], v33 offset:51200
v_mfma_f32_16x16x32_bf16 v[100:103], a[24:27], a[64:67], v[100:103]
ds_read_b64_tr_b16 a[36:37], v41 offset:45056
v_mfma_f32_16x16x32_bf16 v[120:123], a[28:31], a[64:67], v[120:123]
ds_read_b64_tr_b16 a[38:39], v41 offset:46336
s_waitcnt lgkmcnt(9)
v_mfma_f32_16x16x32_bf16 v[64:67], a[16:19], a[68:71], v[64:67]
ds_read_b64_tr_b16 a[40:41], v43 offset:45056
v_mfma_f32_16x16x32_bf16 v[84:87], a[20:23], a[68:71], v[84:87]
ds_read_b64_tr_b16 a[42:43], v43 offset:46336
v_mfma_f32_16x16x32_bf16 v[104:107], a[24:27], a[68:71], v[104:107]
v_mfma_f32_16x16x32_bf16 v[124:127], a[28:31], a[68:71], v[124:127]
s_waitcnt lgkmcnt(7)
v_mfma_f32_16x16x32_bf16 v[48:51], a[0:3], a[32:35], v[48:51]
ds_read_b64_tr_b16 a[44:45], v45 offset:45056
s_waitcnt lgkmcnt(7)
v_mfma_f32_16x16x32_bf16 v[68:71], a[4:7], a[32:35], v[68:71]
ds_read_b64_tr_b16 a[46:47], v45 offset:46336
s_waitcnt lgkmcnt(7)
v_mfma_f32_16x16x32_bf16 v[88:91], a[8:11], a[32:35], v[88:91]
s_waitcnt lgkmcnt(6)
v_mfma_f32_16x16x32_bf16 v[108:111], a[12:15], a[32:35], v[108:111]
s_waitcnt lgkmcnt(4)
v_mfma_f32_16x16x32_bf16 v[52:55], a[0:3], a[36:39], v[52:55]
ds_read_b64_tr_b16 a[48:49], v47 offset:45056
v_mfma_f32_16x16x32_bf16 v[72:75], a[4:7], a[36:39], v[72:75]
ds_read_b64_tr_b16 a[50:51], v47 offset:46336
v_mfma_f32_16x16x32_bf16 v[92:95], a[8:11], a[36:39], v[92:95]
v_mfma_f32_16x16x32_bf16 v[112:115], a[12:15], a[36:39], v[112:115]
s_waitcnt lgkmcnt(4)
v_mfma_f32_16x16x32_bf16 v[56:59], a[0:3], a[40:43], v[56:59]
ds_read_b128 a[16:19], v34 offset:45056
v_mfma_f32_16x16x32_bf16 v[76:79], a[4:7], a[40:43], v[76:79]
ds_read_b64_tr_b16 a[52:53], v39 offset:55296
v_mfma_f32_16x16x32_bf16 v[96:99], a[8:11], a[40:43], v[96:99]
ds_read_b64_tr_b16 a[54:55], v39 offset:56576
v_mfma_f32_16x16x32_bf16 v[116:119], a[12:15], a[40:43], v[116:119]
ds_read_b128 a[20:23], v34 offset:47104
s_waitcnt lgkmcnt(6)
v_mfma_f32_16x16x32_bf16 v[60:63], a[0:3], a[44:47], v[60:63]
ds_read_b128 a[24:27], v34 offset:49152
v_mfma_f32_16x16x32_bf16 v[80:83], a[4:7], a[44:47], v[80:83]
ds_read_b128 a[28:31], v34 offset:51200
v_mfma_f32_16x16x32_bf16 v[100:103], a[8:11], a[44:47], v[100:103]
ds_read_b64_tr_b16 a[56:57], v41 offset:55296
v_mfma_f32_16x16x32_bf16 v[120:123], a[12:15], a[44:47], v[120:123]
ds_read_b64_tr_b16 a[58:59], v41 offset:56576
s_waitcnt lgkmcnt(8)
v_mfma_f32_16x16x32_bf16 v[64:67], a[0:3], a[48:51], v[64:67]
ds_read_b64_tr_b16 a[60:61], v43 offset:55296
v_mfma_f32_16x16x32_bf16 v[84:87], a[4:7], a[48:51], v[84:87]
ds_read_b64_tr_b16 a[62:63], v43 offset:56576
v_mfma_f32_16x16x32_bf16 v[104:107], a[8:11], a[48:51], v[104:107]
v_mfma_f32_16x16x32_bf16 v[124:127], a[12:15], a[48:51], v[124:127]
ds_read_b128 v[128:131], v37 offset:0
ds_read_b128 v[132:135], v37 offset:64
ds_read_b128 v[136:139], v37 offset:128
ds_read_b128 v[140:143], v37 offset:192
s_waitcnt lgkmcnt(11)
v_mfma_f32_16x16x32_bf16 v[48:51], a[16:19], a[52:55], v[48:51]
ds_read_b64_tr_b16 a[64:65], v45 offset:55296
s_waitcnt lgkmcnt(11)
v_mfma_f32_16x16x32_bf16 v[68:71], a[20:23], a[52:55], v[68:71]
ds_read_b64_tr_b16 a[66:67], v45 offset:56576
s_waitcnt lgkmcnt(11)
v_mfma_f32_16x16x32_bf16 v[88:91], a[24:27], a[52:55], v[88:91]
s_waitcnt lgkmcnt(10)
v_mfma_f32_16x16x32_bf16 v[108:111], a[28:31], a[52:55], v[108:111]
s_waitcnt lgkmcnt(8)
v_mfma_f32_16x16x32_bf16 v[52:55], a[16:19], a[56:59], v[52:55]
ds_read_b64_tr_b16 a[68:69], v47 offset:55296
v_mfma_f32_16x16x32_bf16 v[72:75], a[20:23], a[56:59], v[72:75]
ds_read_b64_tr_b16 a[70:71], v47 offset:56576
v_mov_b32 v9, 10
ds_write_b32 v10, v9
v_mfma_f32_16x16x32_bf16 v[92:95], a[24:27], a[56:59], v[92:95]
v_mfma_f32_16x16x32_bf16 v[112:115], a[28:31], a[56:59], v[112:115]
s_waitcnt lgkmcnt(9)
v_mfma_f32_16x16x32_bf16 v[56:59], a[16:19], a[60:63], v[56:59]
v_mfma_f32_16x16x32_bf16 v[76:79], a[20:23], a[60:63], v[76:79]
v_mfma_f32_16x16x32_bf16 v[96:99], a[24:27], a[60:63], v[96:99]
v_mfma_f32_16x16x32_bf16 v[116:119], a[28:31], a[60:63], v[116:119]
s_waitcnt lgkmcnt(3)
v_mfma_f32_16x16x32_bf16 v[60:63], a[16:19], a[64:67], v[60:63]
v_mfma_f32_16x16x32_bf16 v[80:83], a[20:23], a[64:67], v[80:83]
v_mfma_f32_16x16x32_bf16 v[100:103], a[24:27], a[64:67], v[100:103]
v_mfma_f32_16x16x32_bf16 v[120:123], a[28:31], a[64:67], v[120:123]
s_waitcnt lgkmcnt(1)
v_mfma_f32_16x16x32_bf16 v[64:67], a[16:19], a[68:71], v[64:67]
v_mfma_f32_16x16x32_bf16 v[84:87], a[20:23], a[68:71], v[84:87]
v_mfma_f32_16x16x32_bf16 v[104:107], a[24:27], a[68:71], v[104:107]
v_mfma_f32_16x16x32_bf16 v[124:127], a[28:31], a[68:71], v[124:127]
v_mov_b32 v32, 0x358637bd
v_mov_b32 v36, 0x3fb8aa3b
v_and_b32 v30, 8, v1
v_cmp_eq_u32 s[78:79], 0, v30
s_nop 1
v_cndmask_b32 v34, 0, v32, s[78:79]
v_pk_fma_f32 v[48:49], v[48:49], v[128:129], v[32:33] op_sel_hi:[1,1,0]
v_pk_fma_f32 v[50:51], v[50:51], v[130:131], v[32:33] op_sel_hi:[1,1,0]
v_pk_fma_f32 v[68:69], v[68:69], v[132:133], v[32:33] op_sel_hi:[1,1,0]
v_pk_fma_f32 v[70:71], v[70:71], v[134:135], v[32:33] op_sel_hi:[1,1,0]
v_pk_mul_f32 v[38:39], v[48:49], v[36:37] op_sel_hi:[1,0]
v_pk_mul_f32 v[40:41], v[50:51], v[36:37] op_sel_hi:[1,0]
v_pk_mul_f32 v[42:43], v[68:69], v[36:37] op_sel_hi:[1,0]
v_pk_mul_f32 v[44:45], v[70:71], v[36:37] op_sel_hi:[1,0]
v_exp_f32_e64 v38, v38 clamp
v_exp_f32_e64 v39, v39 clamp
v_exp_f32_e64 v40, v40 clamp
v_exp_f32_e64 v41, v41 clamp
v_exp_f32_e64 v42, v42 clamp
v_exp_f32_e64 v43, v43 clamp
v_exp_f32_e64 v44, v44 clamp
v_exp_f32_e64 v45, v45 clamp
v_max_f32 v48, v32, v48
v_max_f32 v49, v32, v49
v_max_f32 v50, v32, v50
v_max_f32 v51, v32, v51
v_max_f32 v68, v32, v68
v_max_f32 v69, v32, v69
v_max_f32 v70, v32, v70
v_max_f32 v71, v32, v71
v_pk_add_f32 v[48:49], v[48:49], v[38:39]
v_pk_add_f32 v[50:51], v[50:51], v[40:41]
v_pk_add_f32 v[68:69], v[68:69], v[42:43]
v_pk_add_f32 v[70:71], v[70:71], v[44:45]
v_cvt_pk_bf16_f32 v48, v48, v49
v_cvt_pk_bf16_f32 v49, v50, v51
v_cvt_pk_bf16_f32 v50, v68, v69
v_cvt_pk_bf16_f32 v51, v70, v71
v_pk_fma_f32 v[88:89], v[88:89], v[136:137], v[32:33] op_sel_hi:[1,1,0]
v_pk_fma_f32 v[90:91], v[90:91], v[138:139], v[32:33] op_sel_hi:[1,1,0]
v_pk_fma_f32 v[108:109], v[108:109], v[140:141], v[32:33] op_sel_hi:[1,1,0]
v_pk_fma_f32 v[110:111], v[110:111], v[142:143], v[32:33] op_sel_hi:[1,1,0]
v_pk_mul_f32 v[38:39], v[88:89], v[36:37] op_sel_hi:[1,0]
v_pk_mul_f32 v[40:41], v[90:91], v[36:37] op_sel_hi:[1,0]
v_pk_mul_f32 v[42:43], v[108:109], v[36:37] op_sel_hi:[1,0]
v_pk_mul_f32 v[44:45], v[110:111], v[36:37] op_sel_hi:[1,0]
v_exp_f32_e64 v38, v38 clamp
v_exp_f32_e64 v39, v39 clamp
v_exp_f32_e64 v40, v40 clamp
v_exp_f32_e64 v41, v41 clamp
v_exp_f32_e64 v42, v42 clamp
v_exp_f32_e64 v43, v43 clamp
v_exp_f32_e64 v44, v44 clamp
v_exp_f32_e64 v45, v45 clamp
v_max_f32 v88, v32, v88
v_max_f32 v89, v32, v89
v_max_f32 v90, v32, v90
v_max_f32 v91, v32, v91
v_max_f32 v108, v32, v108
v_max_f32 v109, v32, v109
v_max_f32 v110, v32, v110
v_max_f32 v111, v32, v111
v_pk_add_f32 v[88:89], v[88:89], v[38:39]
v_pk_add_f32 v[90:91], v[90:91], v[40:41]
v_pk_add_f32 v[108:109], v[108:109], v[42:43]
v_pk_add_f32 v[110:111], v[110:111], v[44:45]
v_cvt_pk_bf16_f32 v88, v88, v89
v_cvt_pk_bf16_f32 v89, v90, v91
v_cvt_pk_bf16_f32 v90, v108, v109
v_cvt_pk_bf16_f32 v91, v110, v111
v_pk_fma_f32 v[52:53], v[52:53], v[128:129], v[32:33] op_sel_hi:[1,1,0]
v_pk_fma_f32 v[54:55], v[54:55], v[130:131], v[32:33] op_sel_hi:[1,1,0]
v_pk_fma_f32 v[72:73], v[72:73], v[132:133], v[32:33] op_sel_hi:[1,1,0]
v_pk_fma_f32 v[74:75], v[74:75], v[134:135], v[32:33] op_sel_hi:[1,1,0]
v_pk_mul_f32 v[38:39], v[52:53], v[36:37] op_sel_hi:[1,0]
v_pk_mul_f32 v[40:41], v[54:55], v[36:37] op_sel_hi:[1,0]
v_pk_mul_f32 v[42:43], v[72:73], v[36:37] op_sel_hi:[1,0]
v_pk_mul_f32 v[44:45], v[74:75], v[36:37] op_sel_hi:[1,0]
v_exp_f32_e64 v38, v38 clamp
v_exp_f32_e64 v39, v39 clamp
v_exp_f32_e64 v40, v40 clamp
v_exp_f32_e64 v41, v41 clamp
v_exp_f32_e64 v42, v42 clamp
v_exp_f32_e64 v43, v43 clamp
v_exp_f32_e64 v44, v44 clamp
v_exp_f32_e64 v45, v45 clamp
v_max_f32 v52, v32, v52
v_max_f32 v53, v32, v53
v_max_f32 v54, v32, v54
v_max_f32 v55, v32, v55
v_max_f32 v72, v32, v72
v_max_f32 v73, v32, v73
v_max_f32 v74, v32, v74
v_max_f32 v75, v32, v75
v_pk_add_f32 v[52:53], v[52:53], v[38:39]
v_pk_add_f32 v[54:55], v[54:55], v[40:41]
v_pk_add_f32 v[72:73], v[72:73], v[42:43]
v_pk_add_f32 v[74:75], v[74:75], v[44:45]
v_cvt_pk_bf16_f32 v52, v52, v53
v_cvt_pk_bf16_f32 v53, v54, v55
v_cvt_pk_bf16_f32 v54, v72, v73
v_cvt_pk_bf16_f32 v55, v74, v75
v_pk_fma_f32 v[92:93], v[92:93], v[136:137], v[32:33] op_sel_hi:[1,1,0]
v_pk_fma_f32 v[94:95], v[94:95], v[138:139], v[32:33] op_sel_hi:[1,1,0]
v_pk_fma_f32 v[112:113], v[112:113], v[140:141], v[32:33] op_sel_hi:[1,1,0]
v_pk_fma_f32 v[114:115], v[114:115], v[142:143], v[32:33] op_sel_hi:[1,1,0]
v_pk_mul_f32 v[38:39], v[92:93], v[36:37] op_sel_hi:[1,0]
v_pk_mul_f32 v[40:41], v[94:95], v[36:37] op_sel_hi:[1,0]
v_pk_mul_f32 v[42:43], v[112:113], v[36:37] op_sel_hi:[1,0]
v_pk_mul_f32 v[44:45], v[114:115], v[36:37] op_sel_hi:[1,0]
v_exp_f32_e64 v38, v38 clamp
v_exp_f32_e64 v39, v39 clamp
v_exp_f32_e64 v40, v40 clamp
v_exp_f32_e64 v41, v41 clamp
v_exp_f32_e64 v42, v42 clamp
v_exp_f32_e64 v43, v43 clamp
v_exp_f32_e64 v44, v44 clamp
v_exp_f32_e64 v45, v45 clamp
v_max_f32 v92, v32, v92
v_max_f32 v93, v32, v93
v_max_f32 v94, v32, v94
v_max_f32 v95, v32, v95
v_max_f32 v112, v32, v112
v_max_f32 v113, v32, v113
v_max_f32 v114, v32, v114
v_max_f32 v115, v32, v115
v_pk_add_f32 v[92:93], v[92:93], v[38:39]
v_pk_add_f32 v[94:95], v[94:95], v[40:41]
v_pk_add_f32 v[112:113], v[112:113], v[42:43]
v_pk_add_f32 v[114:115], v[114:115], v[44:45]
v_cvt_pk_bf16_f32 v92, v92, v93
v_cvt_pk_bf16_f32 v93, v94, v95
v_cvt_pk_bf16_f32 v94, v112, v113
v_cvt_pk_bf16_f32 v95, v114, v115
v_pk_fma_f32 v[56:57], v[56:57], v[128:129], v[34:35] op_sel_hi:[1,1,0]
v_pk_fma_f32 v[58:59], v[58:59], v[130:131], v[34:35] op_sel_hi:[1,1,0]
v_pk_fma_f32 v[76:77], v[76:77], v[132:133], v[34:35] op_sel_hi:[1,1,0]
v_pk_fma_f32 v[78:79], v[78:79], v[134:135], v[34:35] op_sel_hi:[1,1,0]
v_pk_mul_f32 v[38:39], v[56:57], v[36:37] op_sel_hi:[1,0]
v_pk_mul_f32 v[40:41], v[58:59], v[36:37] op_sel_hi:[1,0]
v_pk_mul_f32 v[42:43], v[76:77], v[36:37] op_sel_hi:[1,0]
v_pk_mul_f32 v[44:45], v[78:79], v[36:37] op_sel_hi:[1,0]
v_exp_f32_e64 v38, v38 clamp
v_exp_f32_e64 v39, v39 clamp
v_exp_f32_e64 v40, v40 clamp
v_exp_f32_e64 v41, v41 clamp
v_exp_f32_e64 v42, v42 clamp
v_exp_f32_e64 v43, v43 clamp
v_exp_f32_e64 v44, v44 clamp
v_exp_f32_e64 v45, v45 clamp
v_max_f32 v30, v32, v56
v_add_f32 v30, v30, v38
v_cndmask_b32 v56, v56, v30, s[78:79]
v_max_f32 v30, v32, v57
v_add_f32 v30, v30, v39
v_cndmask_b32 v57, v57, v30, s[78:79]
v_max_f32 v30, v32, v58
v_add_f32 v30, v30, v40
v_cndmask_b32 v58, v58, v30, s[78:79]
v_max_f32 v30, v32, v59
v_add_f32 v30, v30, v41
v_cndmask_b32 v59, v59, v30, s[78:79]
v_max_f32 v30, v32, v76
v_add_f32 v30, v30, v42
v_cndmask_b32 v76, v76, v30, s[78:79]
v_max_f32 v30, v32, v77
v_add_f32 v30, v30, v43
v_cndmask_b32 v77, v77, v30, s[78:79]
v_max_f32 v30, v32, v78
v_add_f32 v30, v30, v44
v_cndmask_b32 v78, v78, v30, s[78:79]
v_max_f32 v30, v32, v79
v_add_f32 v30, v30, v45
v_cndmask_b32 v79, v79, v30, s[78:79]
v_cvt_pk_bf16_f32 v56, v56, v57
v_cvt_pk_bf16_f32 v57, v58, v59
v_cvt_pk_bf16_f32 v58, v76, v77
v_cvt_pk_bf16_f32 v59, v78, v79
v_pk_fma_f32 v[96:97], v[96:97], v[136:137], v[34:35] op_sel_hi:[1,1,0]
v_pk_fma_f32 v[98:99], v[98:99], v[138:139], v[34:35] op_sel_hi:[1,1,0]
v_pk_fma_f32 v[116:117], v[116:117], v[140:141], v[34:35] op_sel_hi:[1,1,0]
v_pk_fma_f32 v[118:119], v[118:119], v[142:143], v[34:35] op_sel_hi:[1,1,0]
v_pk_mul_f32 v[38:39], v[96:97], v[36:37] op_sel_hi:[1,0]
v_pk_mul_f32 v[40:41], v[98:99], v[36:37] op_sel_hi:[1,0]
v_pk_mul_f32 v[42:43], v[116:117], v[36:37] op_sel_hi:[1,0]
v_pk_mul_f32 v[44:45], v[118:119], v[36:37] op_sel_hi:[1,0]
v_exp_f32_e64 v38, v38 clamp
v_exp_f32_e64 v39, v39 clamp
v_exp_f32_e64 v40, v40 clamp
v_exp_f32_e64 v41, v41 clamp
v_exp_f32_e64 v42, v42 clamp
v_exp_f32_e64 v43, v43 clamp
v_exp_f32_e64 v44, v44 clamp
v_exp_f32_e64 v45, v45 clamp
v_max_f32 v30, v32, v96
v_add_f32 v30, v30, v38
v_cndmask_b32 v96, v96, v30, s[78:79]
v_max_f32 v30, v32, v97
v_add_f32 v30, v30, v39
v_cndmask_b32 v97, v97, v30, s[78:79]
v_max_f32 v30, v32, v98
v_add_f32 v30, v30, v40
v_cndmask_b32 v98, v98, v30, s[78:79]
v_max_f32 v30, v32, v99
v_add_f32 v30, v30, v41
v_cndmask_b32 v99, v99, v30, s[78:79]
v_max_f32 v30, v32, v116
v_add_f32 v30, v30, v42
v_cndmask_b32 v116, v116, v30, s[78:79]
v_max_f32 v30, v32, v117
v_add_f32 v30, v30, v43
v_cndmask_b32 v117, v117, v30, s[78:79]
v_max_f32 v30, v32, v118
v_add_f32 v30, v30, v44
v_cndmask_b32 v118, v118, v30, s[78:79]
v_max_f32 v30, v32, v119
v_add_f32 v30, v30, v45
v_cndmask_b32 v119, v119, v30, s[78:79]
v_cvt_pk_bf16_f32 v96, v96, v97
v_cvt_pk_bf16_f32 v97, v98, v99
v_cvt_pk_bf16_f32 v98, v116, v117
v_cvt_pk_bf16_f32 v99, v118, v119
v_pk_mul_f32 v[60:61], v[60:61], v[128:129]
v_pk_mul_f32 v[62:63], v[62:63], v[130:131]
v_pk_mul_f32 v[80:81], v[80:81], v[132:133]
v_pk_mul_f32 v[82:83], v[82:83], v[134:135]
v_cvt_pk_bf16_f32 v60, v60, v61
v_cvt_pk_bf16_f32 v61, v62, v63
v_cvt_pk_bf16_f32 v62, v80, v81
v_cvt_pk_bf16_f32 v63, v82, v83
v_pk_mul_f32 v[100:101], v[100:101], v[136:137]
v_pk_mul_f32 v[102:103], v[102:103], v[138:139]
v_pk_mul_f32 v[120:121], v[120:121], v[140:141]
v_pk_mul_f32 v[122:123], v[122:123], v[142:143]
v_cvt_pk_bf16_f32 v100, v100, v101
v_cvt_pk_bf16_f32 v101, v102, v103
v_cvt_pk_bf16_f32 v102, v120, v121
v_cvt_pk_bf16_f32 v103, v122, v123
v_pk_mul_f32 v[64:65], v[64:65], v[128:129]
v_pk_mul_f32 v[66:67], v[66:67], v[130:131]
v_pk_mul_f32 v[84:85], v[84:85], v[132:133]
v_pk_mul_f32 v[86:87], v[86:87], v[134:135]
v_cvt_pk_bf16_f32 v64, v64, v65
v_cvt_pk_bf16_f32 v65, v66, v67
v_cvt_pk_bf16_f32 v66, v84, v85
v_cvt_pk_bf16_f32 v67, v86, v87
v_pk_mul_f32 v[104:105], v[104:105], v[136:137]
v_pk_mul_f32 v[106:107], v[106:107], v[138:139]
v_pk_mul_f32 v[124:125], v[124:125], v[140:141]
v_pk_mul_f32 v[126:127], v[126:127], v[142:143]
v_cvt_pk_bf16_f32 v104, v104, v105
v_cvt_pk_bf16_f32 v105, v106, v107
v_cvt_pk_bf16_f32 v106, v124, v125
v_cvt_pk_bf16_f32 v107, v126, v127
v_mov_b32 v32, 0x3f803f80
v_mov_b32 v33, 0x3f803f80
v_mov_b32 v34, 0x3f803f80
v_mov_b32 v35, 0x3f803f80
s_nop 1
v_mfma_f32_16x16x32_bf16 v[84:87], v[32:35], v[48:51], 0
v_mfma_f32_16x16x32_bf16 v[108:111], v[32:35], v[52:55], 0
v_mfma_f32_16x16x32_bf16 v[112:115], v[32:35], v[56:59], 0
v_mfma_f32_16x16x32_bf16 v[36:39], v[56:59], v[48:51], 0
v_mfma_f32_16x16x32_bf16 v[40:43], v[60:63], v[48:51], 0
v_mfma_f32_16x16x32_bf16 v[44:47], v[56:59], v[52:55], 0
v_mfma_f32_16x16x32_bf16 v[68:71], v[60:63], v[52:55], 0
v_mfma_f32_16x16x32_bf16 v[72:75], v[64:67], v[52:55], 0
v_mfma_f32_16x16x32_bf16 v[76:79], v[60:63], v[56:59], 0
v_mfma_f32_16x16x32_bf16 v[80:83], v[64:67], v[56:59], 0
s_lshl_b32 s48, s74, 13
s_add_u32 s48, s48, 126976
v_add_u32 v21, s48, v4
s_lshl_b32 s48, s74, 2
v_add_u32 v30, s48, v3
v_lshrrev_b32 v31, 10, v5
v_add_u32 v31, v31, v30
v_mfma_f32_16x16x32_bf16 v[84:87], v[32:35], v[88:91], v[84:87]
v_mfma_f32_16x16x32_bf16 v[108:111], v[32:35], v[92:95], v[108:111]
v_mfma_f32_16x16x32_bf16 v[112:115], v[32:35], v[96:99], v[112:115]
v_mfma_f32_16x16x32_bf16 v[36:39], v[96:99], v[88:91], v[36:39]
v_mfma_f32_16x16x32_bf16 v[40:43], v[100:103], v[88:91], v[40:43]
v_mfma_f32_16x16x32_bf16 v[44:47], v[96:99], v[92:95], v[44:47]
v_mfma_f32_16x16x32_bf16 v[68:71], v[100:103], v[92:95], v[68:71]
v_mfma_f32_16x16x32_bf16 v[72:75], v[104:107], v[92:95], v[72:75]
v_mfma_f32_16x16x32_bf16 v[76:79], v[100:103], v[96:99], v[76:79]
v_mfma_f32_16x16x32_bf16 v[80:83], v[104:107], v[96:99], v[80:83]
v_mov_b32 v85, v108
v_mov_b32 v86, v112
s_nop 7
s_cmp_eq_u32 s73, 0
s_cbranch_scc1 L67
L72:
ds_read_b128 v[48:51], v3 offset:16
s_sub_u32 s54, s54, 1
s_cmp_lt_i32 s54, 0
s_cbranch_scc1 L73
s_waitcnt lgkmcnt(0)
v_min3_u32 v48, v48, v49, v50
v_min_u32 v48, v48, v51
v_cmp_gt_u32 vcc, 10, v48
s_nop 0
s_cbranch_vccnz L72
L73:
ds_write_b128 v21, v[84:87] offset:0
ds_write_b128 v21, v[36:39] offset:1024
ds_write_b128 v21, v[40:43] offset:2048
ds_write_b128 v21, v[44:47] offset:3072
ds_write_b128 v21, v[68:71] offset:4096
ds_write_b128 v21, v[72:75] offset:5120
ds_write_b128 v21, v[76:79] offset:6144
ds_write_b128 v21, v[80:83] offset:7168
ds_write_b32 v31, v32 offset:48
s_waitcnt lgkmcnt(0)
s_branch L68
L67:
ds_read_b32 v48, v30 offset:48
s_sub_u32 s54, s54, 1
s_cmp_lt_i32 s54, 0
s_cbranch_scc1 L69
s_waitcnt lgkmcnt(0)
v_cmp_eq_u32 vcc, 0, v48
s_nop 0
s_cbranch_vccnz L67
L69:
ds_read_b128 v[52:55], v21 offset:0
ds_read_b128 v[56:59], v21 offset:1024
ds_read_b128 v[60:63], v21 offset:2048
ds_read_b128 v[64:67], v21 offset:3072
ds_read_b128 v[88:91], v21 offset:4096
ds_read_b128 v[92:95], v21 offset:5120
ds_read_b128 v[96:99], v21 offset:6144
ds_read_b128 v[100:103], v21 offset:7168
s_waitcnt lgkmcnt(7)
v_pk_add_f32 v[84:85], v[84:85], v[52:53]
v_pk_add_f32 v[86:87], v[86:87], v[54:55]
buffer_store_dwordx4 v[84:87], v4, s[36:39], s76 offen offset:3072 sc1
s_waitcnt lgkmcnt(6)
v_pk_add_f32 v[36:37], v[36:37], v[56:57]
v_pk_add_f32 v[38:39], v[38:39], v[58:59]
buffer_store_dwordx4 v[36:39], v4, s[36:39], s75 offen offset:0 sc1
s_waitcnt lgkmcnt(5)
v_pk_add_f32 v[40:41], v[40:41], v[60:61]
v_pk_add_f32 v[42:43], v[42:43], v[62:63]
buffer_store_dwordx4 v[40:43], v4, s[36:39], s75 offen offset:1024 sc1
s_waitcnt lgkmcnt(4)
v_pk_add_f32 v[44:45], v[44:45], v[64:65]
v_pk_add_f32 v[46:47], v[46:47], v[66:67]
buffer_store_dwordx4 v[44:47], v4, s[36:39], s75 offen offset:2048 sc1
s_waitcnt lgkmcnt(3)
v_pk_add_f32 v[68:69], v[68:69], v[88:89]
v_pk_add_f32 v[70:71], v[70:71], v[90:91]
buffer_store_dwordx4 v[68:71], v4, s[36:39], s75 offen offset:3072 sc1
s_waitcnt lgkmcnt(2)
v_pk_add_f32 v[72:73], v[72:73], v[92:93]
v_pk_add_f32 v[74:75], v[74:75], v[94:95]
buffer_store_dwordx4 v[72:75], v4, s[36:39], s76 offen offset:0 sc1
s_waitcnt lgkmcnt(1)
v_pk_add_f32 v[76:77], v[76:77], v[96:97]
v_pk_add_f32 v[78:79], v[78:79], v[98:99]
buffer_store_dwordx4 v[76:79], v4, s[36:39], s76 offen offset:1024 sc1
s_waitcnt lgkmcnt(0)
v_pk_add_f32 v[80:81], v[80:81], v[100:101]
v_pk_add_f32 v[82:83], v[82:83], v[102:103]
buffer_store_dwordx4 v[80:83], v4, s[36:39], s76 offen offset:2048 sc1
L68:
v_mov_b32 v9, 11
ds_write_b32 v10, v9
s_waitcnt lgkmcnt(0)
s_branch L_join
L_join:
s_nop 4
v_mul_u32_u24 v21, 160, v11
v_lshrrev_b32 v30, 4, v1
v_lshl_add_u32 v21, v30, 3, v21
s_mul_i32 s48, s52, 2560
s_add_u32 s48, s48, 151552
v_add_u32 v21, s48, v21
s_mov_b32 s72, 2097152
s_mov_b32 s73, 2101248
s_waitcnt vmcnt(0)
buffer_atomic_or v8, v5, s[36:39], s64 offen sc1
s_mov_b32 s70, 133693567
s_and_b32 s49, s60, 3
s_bitcmp1_b32 s49, 1
s_cmov_b32 s70, 4161798080
s_and_b32 s49, s49, 1
s_lshl_b32 s49, s49, 4
s_lshr_b32 s70, s70, s49
s_and_b32 s70, s70, 0xffff
s_lshl_b32 s49, s52, 2
s_add_u32 s49, s49, 163408
v_mov_b32 v31, s49
W74:
ds_read_b32 v6, v31
s_sub_u32 s54, s54, 1
s_cmp_lt_i32 s54, 0
s_cbranch_scc1 B75
s_waitcnt lgkmcnt(0)
v_and_b32 v6, s70, v6
v_cmp_ne_u32 vcc, s70, v6
s_nop 0
s_cbranch_vccnz W74
B75:
buffer_load_dwordx4 a[0:3], v13, s[36:39], s72 offen offset:0 sc1
buffer_load_dwordx4 a[4:7], v13, s[36:39], s72 offen offset:1024 sc1
buffer_load_dwordx4 a[8:11], v13, s[36:39], s72 offen offset:2048 sc1
buffer_load_dwordx4 a[12:15], v13, s[36:39], s72 offen offset:3072 sc1
buffer_load_dwordx4 a[16:19], v13, s[36:39], s73 offen offset:0 sc1
buffer_load_dwordx4 a[20:23], v14, s[36:39], s72 offen offset:0 sc1
buffer_load_dwordx4 a[24:27], v14, s[36:39], s72 offen offset:1024 sc1
buffer_load_dwordx4 a[28:31], v14, s[36:39], s72 offen offset:2048 sc1
ds_read_b64 v[6:7], v3 offset:0
s_waitcnt lgkmcnt(0)
v_min_u32 v6, v6, v7
v_cmp_gt_u32 vcc, 15, v6
s_nop 0
s_cbranch_vccnz W76
B77:
ds_read_b64 v[130:131], v21 offset:0
ds_read_b64 v[134:135], v21 offset:32
ds_read_b64 v[138:139], v21 offset:64
ds_read_b64 v[142:143], v21 offset:96
ds_read_b64 v[146:147], v21 offset:128
ds_read_b128 v[32:35], v4 offset:0
s_mul_i32 s48, s67, 40960
s_mul_i32 s49, s61, 5120
s_add_u32 s48, s48, s49
s_and_b32 s49, s52, 1
s_lshl_b32 s49, s49, 8
s_add_u32 s48, s48, s49
s_add_u32 s48, s48, 9961472
v_lshl_add_u32 v168, v11, 4, s48
v_and_b32 v30, 32, v1
v_lshl_add_u32 v168, v30, 4, v168
ds_read_b128 v[36:39], v4 offset:1024
v_and_b32 v30, 16, v1
v_lshl_add_u32 v169, v30, 26, v168
v_add_u32 v169, 4096, v169
ds_read_b128 v[40:43], v4 offset:2048
v_lshl_add_u32 v168, v30, 6, v168
s_lshl3_add_u32 s48, s67, s61
s_lshl_b32 s48, s48, 9
s_add_u32 s48, s48, s49
s_add_u32 s48, s48, 262144
v_lshl_add_u32 v170, v11, 4, s48
v_and_b32 v30, 48, v1
ds_read_b128 v[44:47], v4 offset:3072
v_lshl_add_u32 v170, v30, 25, v170
s_waitcnt lgkmcnt(8)
v_lshlrev_b32 v148, 16, v130
v_and_b32 v149, 0xffff0000, v130
ds_read_b128 v[48:51], v4 offset:4096
v_pk_fma_f32 v[128:129], v[148:149], v[22:23], v[22:23] op_sel:[0,0,1] op_sel_hi:[1,0,1] neg_lo:[0,0,1] neg_hi:[0,0,1]
v_cvt_pk_bf16_f32 v129, v128, v129
v_lshlrev_b32 v128, 16, v129
ds_read_b128 v[52:55], v4 offset:5120
v_and_b32 v129, 0xffff0000, v129
v_lshlrev_b32 v150, 16, v131
v_and_b32 v151, 0xffff0000, v131
ds_read_b128 v[56:59], v4 offset:6144
v_pk_fma_f32 v[130:131], v[150:151], v[22:23], v[22:23] op_sel:[0,0,1] op_sel_hi:[1,0,1] neg_lo:[0,0,1] neg_hi:[0,0,1]
v_cvt_pk_bf16_f32 v131, v130, v131
v_lshlrev_b32 v130, 16, v131
ds_read_b128 v[60:63], v4 offset:7168
v_and_b32 v131, 0xffff0000, v131
s_waitcnt lgkmcnt(11)
v_lshlrev_b32 v152, 16, v134
v_and_b32 v153, 0xffff0000, v134
ds_read_b128 v[64:67], v4 offset:8192
v_pk_fma_f32 v[132:133], v[152:153], v[22:23], v[22:23] op_sel:[0,0,1] op_sel_hi:[1,0,1] neg_lo:[0,0,1] neg_hi:[0,0,1]
v_cvt_pk_bf16_f32 v133, v132, v133
v_lshlrev_b32 v132, 16, v133
ds_read_b128 v[68:71], v4 offset:9216
v_and_b32 v133, 0xffff0000, v133
v_lshlrev_b32 v154, 16, v135
v_and_b32 v155, 0xffff0000, v135
ds_read_b128 v[72:75], v4 offset:10240
v_pk_fma_f32 v[134:135], v[154:155], v[22:23], v[22:23] op_sel:[0,0,1] op_sel_hi:[1,0,1] neg_lo:[0,0,1] neg_hi:[0,0,1]
v_cvt_pk_bf16_f32 v135, v134, v135
v_lshlrev_b32 v134, 16, v135
ds_read_b128 v[76:79], v4 offset:11264
v_and_b32 v135, 0xffff0000, v135
s_waitcnt lgkmcnt(14)
v_lshlrev_b32 v156, 16, v138
v_and_b32 v157, 0xffff0000, v138
ds_read_b128 v[80:83], v4 offset:12288
v_pk_fma_f32 v[136:137], v[156:157], v[22:23], v[22:23] op_sel:[0,0,1] op_sel_hi:[1,0,1] neg_lo:[0,0,1] neg_hi:[0,0,1]
v_cvt_pk_bf16_f32 v137, v136, v137
v_lshlrev_b32 v136, 16, v137
ds_read_b128 v[84:87], v4 offset:13312
v_and_b32 v137, 0xffff0000, v137
v_lshlrev_b32 v158, 16, v139
v_and_b32 v159, 0xffff0000, v139
ds_read_b128 v[88:91], v4 offset:14336
v_pk_fma_f32 v[138:139], v[158:159], v[22:23], v[22:23] op_sel:[0,0,1] op_sel_hi:[1,0,1] neg_lo:[0,0,1] neg_hi:[0,0,1]
v_cvt_pk_bf16_f32 v139, v138, v139
v_lshlrev_b32 v138, 16, v139
ds_read_b128 v[92:95], v4 offset:15360
v_and_b32 v139, 0xffff0000, v139
s_waitcnt lgkmcnt(15)
v_lshlrev_b32 v160, 16, v142
v_and_b32 v161, 0xffff0000, v142
ds_read_b128 v[96:99], v4 offset:16384
v_pk_fma_f32 v[140:141], v[160:161], v[22:23], v[22:23] op_sel:[0,0,1] op_sel_hi:[1,0,1] neg_lo:[0,0,1] neg_hi:[0,0,1]
v_cvt_pk_bf16_f32 v141, v140, v141
v_lshlrev_b32 v140, 16, v141
ds_read_b128 v[100:103], v4 offset:17408
v_and_b32 v141, 0xffff0000, v141
v_lshlrev_b32 v162, 16, v143
v_and_b32 v163, 0xffff0000, v143
ds_read_b128 v[104:107], v4 offset:18432
v_pk_fma_f32 v[142:143], v[162:163], v[22:23], v[22:23] op_sel:[0,0,1] op_sel_hi:[1,0,1] neg_lo:[0,0,1] neg_hi:[0,0,1]
v_cvt_pk_bf16_f32 v143, v142, v143
v_lshlrev_b32 v142, 16, v143
ds_read_b128 v[108:111], v4 offset:19456
v_and_b32 v143, 0xffff0000, v143
v_lshlrev_b32 v164, 16, v146
v_and_b32 v165, 0xffff0000, v146
ds_read_b128 v[112:115], v4 offset:20480
v_pk_fma_f32 v[144:145], v[164:165], v[22:23], v[22:23] op_sel:[0,0,1] op_sel_hi:[1,0,1] neg_lo:[0,0,1] neg_hi:[0,0,1]
v_cvt_pk_bf16_f32 v145, v144, v145
v_lshlrev_b32 v144, 16, v145
ds_read_b128 v[116:119], v4 offset:21504
v_and_b32 v145, 0xffff0000, v145
v_lshlrev_b32 v166, 16, v147
v_and_b32 v167, 0xffff0000, v147
ds_read_b128 v[120:123], v4 offset:22528
v_pk_fma_f32 v[146:147], v[166:167], v[22:23], v[22:23] op_sel:[0,0,1] op_sel_hi:[1,0,1] neg_lo:[0,0,1] neg_hi:[0,0,1]
v_cvt_pk_bf16_f32 v147, v146, v147
v_lshlrev_b32 v146, 16, v147
ds_read_b128 v[124:127], v4 offset:23552
v_and_b32 v147, 0xffff0000, v147
s_and_b32 s49, s52, 1
s_lshl3_add_u32 s49, s49, s61
s_lshl_b32 s48, s67, 7
s_add_u32 s74, s48, 28672
s_lshl_b32 s51, 1, s49
v_mov_b32 v8, s51
W78:
ds_read_b32 v6, v31
s_sub_u32 s54, s54, 1
s_cmp_lt_i32 s54, 0
s_cbranch_scc1 B79
s_waitcnt lgkmcnt(0)
v_and_b32 v6, 65535, v6
v_cmp_ne_u32 vcc, 65535, v6
s_nop 0
s_cbranch_vccnz W78
B79:
s_waitcnt vmcnt(7)
v_mfma_f32_16x16x32_bf16 v[128:131], v[32:35], a[0:3], v[128:131]
ds_read_b128 v[32:35], v4 offset:24576
v_mfma_f32_16x16x32_bf16 v[132:135], v[36:39], a[0:3], v[132:135]
ds_read_b128 v[36:39], v4 offset:25600
buffer_load_dwordx4 a[32:35], v14, s[36:39], s72 offen offset:3072 sc1
v_mfma_f32_16x16x32_bf16 v[136:139], v[40:43], a[0:3], v[136:139]
ds_read_b128 v[40:43], v4 offset:26624
v_mfma_f32_16x16x32_bf16 v[140:143], v[44:47], a[0:3], v[140:143]
ds_read_b128 v[44:47], v4 offset:27648
v_mfma_f32_16x16x32_bf16 v[144:147], v[48:51], a[0:3], v[144:147]
ds_read_b128 v[48:51], v4 offset:28672
buffer_load_dwordx4 a[36:39], v14, s[36:39], s73 offen offset:0 sc1
s_waitcnt vmcnt(8)
v_mfma_f32_16x16x32_bf16 v[128:131], v[52:55], a[4:7], v[128:131]
ds_read_b128 v[52:55], v4 offset:29696
v_mfma_f32_16x16x32_bf16 v[132:135], v[56:59], a[4:7], v[132:135]
ds_read_b128 v[56:59], v4 offset:30720
buffer_load_dwordx4 a[40:43], v15, s[36:39], s72 offen offset:0 sc1
v_mfma_f32_16x16x32_bf16 v[136:139], v[60:63], a[4:7], v[136:139]
ds_read_b128 v[60:63], v4 offset:31744
v_mfma_f32_16x16x32_bf16 v[140:143], v[64:67], a[4:7], v[140:143]
ds_read_b128 v[64:67], v4 offset:32768
v_mfma_f32_16x16x32_bf16 v[144:147], v[68:71], a[4:7], v[144:147]
ds_read_b128 v[68:71], v4 offset:33792
buffer_load_dwordx4 a[44:47], v15, s[36:39], s72 offen offset:1024 sc1
s_waitcnt vmcnt(9)
v_mfma_f32_16x16x32_bf16 v[128:131], v[72:75], a[8:11], v[128:131]
ds_read_b128 v[72:75], v4 offset:34816
v_mfma_f32_16x16x32_bf16 v[132:135], v[76:79], a[8:11], v[132:135]
ds_read_b128 v[76:79], v4 offset:35840
buffer_load_dwordx4 a[48:51], v15, s[36:39], s72 offen offset:2048 sc1
v_mfma_f32_16x16x32_bf16 v[136:139], v[80:83], a[8:11], v[136:139]
ds_read_b128 v[80:83], v4 offset:36864
v_mfma_f32_16x16x32_bf16 v[140:143], v[84:87], a[8:11], v[140:143]
ds_read_b128 v[84:87], v4 offset:37888
v_mfma_f32_16x16x32_bf16 v[144:147], v[88:91], a[8:11], v[144:147]
ds_read_b128 v[88:91], v4 offset:38912
buffer_load_dwordx4 a[52:55], v15, s[36:39], s72 offen offset:3072 sc1
s_waitcnt vmcnt(10)
v_mfma_f32_16x16x32_bf16 v[128:131], v[92:95], a[12:15], v[128:131]
ds_read_b128 v[92:95], v4 offset:39936
v_mfma_f32_16x16x32_bf16 v[132:135], v[96:99], a[12:15], v[132:135]
ds_read_b128 v[96:99], v4 offset:40960
buffer_load_dwordx4 a[56:59], v15, s[36:39], s73 offen offset:0 sc1
v_mfma_f32_16x16x32_bf16 v[136:139], v[100:103], a[12:15], v[136:139]
ds_read_b128 v[100:103], v4 offset:41984
v_mfma_f32_16x16x32_bf16 v[140:143], v[104:107], a[12:15], v[140:143]
ds_read_b128 v[104:107], v4 offset:43008
v_mfma_f32_16x16x32_bf16 v[144:147], v[108:111], a[12:15], v[144:147]
ds_read_b128 v[108:111], v4 offset:44032
buffer_load_dwordx4 a[60:63], v16, s[36:39], s72 offen offset:0 sc1
s_waitcnt vmcnt(11)
v_mfma_f32_16x16x32_bf16 v[128:131], v[112:115], a[16:19], v[128:131]
ds_read_b128 v[112:115], v4 offset:45056
v_mfma_f32_16x16x32_bf16 v[132:135], v[116:119], a[16:19], v[132:135]
ds_read_b128 v[116:119], v4 offset:46080
buffer_load_dwordx4 a[64:67], v16, s[36:39], s72 offen offset:1024 sc1
v_mfma_f32_16x16x32_bf16 v[136:139], v[120:123], a[16:19], v[136:139]
ds_read_b128 v[120:123], v4 offset:47104
v_mfma_f32_16x16x32_bf16 v[140:143], v[124:127], a[16:19], v[140:143]
ds_read_b128 v[124:127], v4 offset:48128
s_waitcnt lgkmcnt(15)
v_mfma_f32_16x16x32_bf16 v[144:147], v[32:35], a[16:19], v[144:147]
ds_read_b128 v[32:35], v4 offset:49152
buffer_load_dwordx4 a[68:71], v16, s[36:39], s72 offen offset:2048 sc1
s_waitcnt vmcnt(12)
v_mfma_f32_16x16x32_bf16 v[128:131], v[36:39], a[20:23], v[128:131]
ds_read_b128 v[36:39], v4 offset:50176
v_mov_b32 v9, 12
ds_write_b32 v10, v9
v_mfma_f32_16x16x32_bf16 v[132:135], v[40:43], a[20:23], v[132:135]
ds_read_b128 v[40:43], v4 offset:51200
buffer_load_dwordx4 a[72:75], v16, s[36:39], s72 offen offset:3072 sc1
v_mfma_f32_16x16x32_bf16 v[136:139], v[44:47], a[20:23], v[136:139]
ds_read_b128 v[44:47], v4 offset:52224
v_mfma_f32_16x16x32_bf16 v[140:143], v[48:51], a[20:23], v[140:143]
ds_read_b128 v[48:51], v4 offset:53248
v_mfma_f32_16x16x32_bf16 v[144:147], v[52:55], a[20:23], v[144:147]
ds_read_b128 v[52:55], v4 offset:54272
buffer_load_dwordx4 a[76:79], v16, s[36:39], s73 offen offset:0 sc1
s_waitcnt vmcnt(13)
v_mfma_f32_16x16x32_bf16 v[128:131], v[56:59], a[24:27], v[128:131]
ds_read_b128 v[56:59], v4 offset:55296
v_mfma_f32_16x16x32_bf16 v[132:135], v[60:63], a[24:27], v[132:135]
ds_read_b128 v[60:63], v4 offset:56320
v_mfma_f32_16x16x32_bf16 v[136:139], v[64:67], a[24:27], v[136:139]
ds_read_b128 v[64:67], v4 offset:57344
s_waitcnt lgkmcnt(15)
v_mfma_f32_16x16x32_bf16 v[140:143], v[68:71], a[24:27], v[140:143]
ds_read_b128 v[68:71], v4 offset:58368
v_mfma_f32_16x16x32_bf16 v[144:147], v[72:75], a[24:27], v[144:147]
ds_read_b128 v[72:75], v4 offset:59392
s_waitcnt vmcnt(12)
v_mfma_f32_16x16x32_bf16 v[128:131], v[76:79], a[28:31], v[128:131]
ds_read_b128 v[76:79], v4 offset:60416
v_mfma_f32_16x16x32_bf16 v[132:135], v[80:83], a[28:31], v[132:135]
ds_read_b128 v[80:83], v4 offset:61440
v_mfma_f32_16x16x32_bf16 v[136:139], v[84:87], a[28:31], v[136:139]
ds_read_b128 v[84:87], v4 offset:62464
v_mfma_f32_16x16x32_bf16 v[140:143], v[88:91], a[28:31], v[140:143]
ds_read_b128 v[88:91], v4 offset:63488
v_mfma_f32_16x16x32_bf16 v[144:147], v[92:95], a[28:31], v[144:147]
ds_read_b128 v[92:95], v4 offset:64512
s_waitcnt vmcnt(11)
v_mfma_f32_16x16x32_bf16 v[128:131], v[96:99], a[32:35], v[128:131]
ds_read_b128 v[96:99], v20 offset:0
v_mfma_f32_16x16x32_bf16 v[132:135], v[100:103], a[32:35], v[132:135]
ds_read_b128 v[100:103], v20 offset:1024
v_mfma_f32_16x16x32_bf16 v[136:139], v[104:107], a[32:35], v[136:139]
ds_read_b128 v[104:107], v20 offset:2048
s_waitcnt lgkmcnt(15)
v_mfma_f32_16x16x32_bf16 v[140:143], v[108:111], a[32:35], v[140:143]
ds_read_b128 v[108:111], v20 offset:3072
v_mfma_f32_16x16x32_bf16 v[144:147], v[112:115], a[32:35], v[144:147]
ds_read_b128 v[112:115], v20 offset:4096
s_waitcnt vmcnt(10)
v_mfma_f32_16x16x32_bf16 v[128:131], v[116:119], a[36:39], v[128:131]
ds_read_b128 v[116:119], v20 offset:5120
v_mfma_f32_16x16x32_bf16 v[132:135], v[120:123], a[36:39], v[132:135]
ds_read_b128 v[120:123], v20 offset:6144
v_mfma_f32_16x16x32_bf16 v[136:139], v[124:127], a[36:39], v[136:139]
ds_read_b128 v[124:127], v20 offset:7168
v_mfma_f32_16x16x32_bf16 v[140:143], v[32:35], a[36:39], v[140:143]
ds_read_b128 v[32:35], v20 offset:8192
v_mfma_f32_16x16x32_bf16 v[144:147], v[36:39], a[36:39], v[144:147]
ds_read_b128 v[36:39], v20 offset:9216
s_waitcnt vmcnt(9)
v_mfma_f32_16x16x32_bf16 v[128:131], v[40:43], a[40:43], v[128:131]
ds_read_b128 v[40:43], v20 offset:10240
v_mov_b32 v9, 13
ds_write_b32 v10, v9
v_mfma_f32_16x16x32_bf16 v[132:135], v[44:47], a[40:43], v[132:135]
ds_read_b128 v[44:47], v20 offset:11264
s_waitcnt lgkmcnt(15)
v_mfma_f32_16x16x32_bf16 v[136:139], v[48:51], a[40:43], v[136:139]
ds_read_b128 v[48:51], v20 offset:12288
v_mfma_f32_16x16x32_bf16 v[140:143], v[52:55], a[40:43], v[140:143]
ds_read_b128 v[52:55], v20 offset:13312
v_mfma_f32_16x16x32_bf16 v[144:147], v[56:59], a[40:43], v[144:147]
ds_read_b128 v[56:59], v20 offset:14336
s_waitcnt vmcnt(8)
v_mfma_f32_16x16x32_bf16 v[128:131], v[60:63], a[44:47], v[128:131]
ds_read_b128 v[60:63], v20 offset:15360
v_mfma_f32_16x16x32_bf16 v[132:135], v[64:67], a[44:47], v[132:135]
ds_read_b128 v[64:67], v20 offset:16384
v_mfma_f32_16x16x32_bf16 v[136:139], v[68:71], a[44:47], v[136:139]
ds_read_b128 v[68:71], v20 offset:17408
v_mfma_f32_16x16x32_bf16 v[140:143], v[72:75], a[44:47], v[140:143]
ds_read_b128 v[72:75], v20 offset:18432
v_mfma_f32_16x16x32_bf16 v[144:147], v[76:79], a[44:47], v[144:147]
ds_read_b128 v[76:79], v20 offset:19456
s_waitcnt vmcnt(7)
v_mfma_f32_16x16x32_bf16 v[128:131], v[80:83], a[48:51], v[128:131]
ds_read_b128 v[80:83], v20 offset:20480
v_mfma_f32_16x16x32_bf16 v[132:135], v[84:87], a[48:51], v[132:135]
ds_read_b128 v[84:87], v20 offset:21504
s_waitcnt lgkmcnt(15)
v_mfma_f32_16x16x32_bf16 v[136:139], v[88:91], a[48:51], v[136:139]
ds_read_b128 v[88:91], v20 offset:22528
v_mfma_f32_16x16x32_bf16 v[140:143], v[92:95], a[48:51], v[140:143]
ds_read_b128 v[92:95], v20 offset:23552
v_mfma_f32_16x16x32_bf16 v[144:147], v[96:99], a[48:51], v[144:147]
ds_read_b128 v[96:99], v20 offset:24576
s_waitcnt vmcnt(6)
v_mfma_f32_16x16x32_bf16 v[128:131], v[100:103], a[52:55], v[128:131]
ds_read_b128 v[100:103], v20 offset:25600
v_mfma_f32_16x16x32_bf16 v[132:135], v[104:107], a[52:55], v[132:135]
ds_read_b128 v[104:107], v20 offset:26624
v_mfma_f32_16x16x32_bf16 v[136:139], v[108:111], a[52:55], v[136:139]
ds_read_b128 v[108:111], v20 offset:27648
v_mfma_f32_16x16x32_bf16 v[140:143], v[112:115], a[52:55], v[140:143]
ds_read_b128 v[112:115], v20 offset:28672
v_mfma_f32_16x16x32_bf16 v[144:147], v[116:119], a[52:55], v[144:147]
ds_read_b128 v[116:119], v20 offset:29696
s_waitcnt vmcnt(5)
v_mfma_f32_16x16x32_bf16 v[128:131], v[120:123], a[56:59], v[128:131]
ds_read_b128 v[120:123], v20 offset:30720
v_mfma_f32_16x16x32_bf16 v[132:135], v[124:127], a[56:59], v[132:135]
ds_read_b128 v[124:127], v20 offset:31744
s_waitcnt lgkmcnt(15)
v_mfma_f32_16x16x32_bf16 v[136:139], v[32:35], a[56:59], v[136:139]
ds_read_b128 v[32:35], v20 offset:32768
v_mfma_f32_16x16x32_bf16 v[140:143], v[36:39], a[56:59], v[140:143]
ds_read_b128 v[36:39], v20 offset:33792
v_mfma_f32_16x16x32_bf16 v[144:147], v[40:43], a[56:59], v[144:147]
ds_read_b128 v[40:43], v20 offset:34816
s_waitcnt vmcnt(4)
v_mfma_f32_16x16x32_bf16 v[128:131], v[44:47], a[60:63], v[128:131]
ds_read_b128 v[44:47], v20 offset:35840
v_mov_b32 v9, 14
ds_write_b32 v10, v9
v_mfma_f32_16x16x32_bf16 v[132:135], v[48:51], a[60:63], v[132:135]
v_mfma_f32_16x16x32_bf16 v[136:139], v[52:55], a[60:63], v[136:139]
v_mfma_f32_16x16x32_bf16 v[140:143], v[56:59], a[60:63], v[140:143]
v_mfma_f32_16x16x32_bf16 v[144:147], v[60:63], a[60:63], v[144:147]
s_waitcnt vmcnt(3)
v_mfma_f32_16x16x32_bf16 v[128:131], v[64:67], a[64:67], v[128:131]
s_waitcnt lgkmcnt(15)
v_mfma_f32_16x16x32_bf16 v[132:135], v[68:71], a[64:67], v[132:135]
v_mfma_f32_16x16x32_bf16 v[136:139], v[72:75], a[64:67], v[136:139]
v_mfma_f32_16x16x32_bf16 v[140:143], v[76:79], a[64:67], v[140:143]
v_mfma_f32_16x16x32_bf16 v[144:147], v[80:83], a[64:67], v[144:147]
s_waitcnt vmcnt(2)
v_mfma_f32_16x16x32_bf16 v[128:131], v[84:87], a[68:71], v[128:131]
s_waitcnt lgkmcnt(14)
v_mfma_f32_16x16x32_bf16 v[132:135], v[88:91], a[68:71], v[132:135]
s_waitcnt lgkmcnt(13)
v_mfma_f32_16x16x32_bf16 v[136:139], v[92:95], a[68:71], v[136:139]
s_waitcnt lgkmcnt(12)
v_mfma_f32_16x16x32_bf16 v[140:143], v[96:99], a[68:71], v[140:143]
s_waitcnt lgkmcnt(11)
v_mfma_f32_16x16x32_bf16 v[144:147], v[100:103], a[68:71], v[144:147]
s_waitcnt vmcnt(1) lgkmcnt(10)
v_mfma_f32_16x16x32_bf16 v[128:131], v[104:107], a[72:75], v[128:131]
s_waitcnt lgkmcnt(9)
v_mfma_f32_16x16x32_bf16 v[132:135], v[108:111], a[72:75], v[132:135]
s_waitcnt lgkmcnt(8)
v_mfma_f32_16x16x32_bf16 v[136:139], v[112:115], a[72:75], v[136:139]
s_waitcnt lgkmcnt(7)
v_mfma_f32_16x16x32_bf16 v[140:143], v[116:119], a[72:75], v[140:143]
s_waitcnt lgkmcnt(6)
v_mfma_f32_16x16x32_bf16 v[144:147], v[120:123], a[72:75], v[144:147]
s_waitcnt vmcnt(0) lgkmcnt(5)
v_mfma_f32_16x16x32_bf16 v[128:131], v[124:127], a[76:79], v[128:131]
s_waitcnt lgkmcnt(4)
v_mfma_f32_16x16x32_bf16 v[132:135], v[32:35], a[76:79], v[132:135]
s_waitcnt lgkmcnt(3)
v_mfma_f32_16x16x32_bf16 v[136:139], v[36:39], a[76:79], v[136:139]
s_waitcnt lgkmcnt(2)
v_mfma_f32_16x16x32_bf16 v[140:143], v[40:43], a[76:79], v[140:143]
s_waitcnt lgkmcnt(1)
v_mfma_f32_16x16x32_bf16 v[144:147], v[44:47], a[76:79], v[144:147]
v_mov_b32 v42, 0
v_mov_b32 v43, 0
v_mov_b32 v44, 0
v_mov_b32 v45, 0
v_mov_b32 v13, 0x3f803f80
v_cvt_pk_bf16_f32 v32, v128, v129
v_cvt_pk_bf16_f32 v33, v130, v131
v_cvt_pk_bf16_f32 v34, v132, v133
v_cvt_pk_bf16_f32 v35, v134, v135
v_cvt_pk_bf16_f32 v36, v136, v137
v_cvt_pk_bf16_f32 v37, v138, v139
v_cvt_pk_bf16_f32 v38, v140, v141
v_cvt_pk_bf16_f32 v39, v142, v143
v_cvt_pk_bf16_f32 v40, v144, v145
v_cvt_pk_bf16_f32 v41, v146, v147
v_permlane16_swap_b32 v32, v34
v_permlane16_swap_b32 v33, v35
buffer_store_dwordx4 v[32:35], v168, s[36:39], 0 offen offset:0 sc1
v_permlane16_swap_b32 v36, v38
v_permlane16_swap_b32 v37, v39
buffer_store_dwordx4 v[36:39], v168, s[36:39], 0 offen offset:2048 sc1
v_permlane16_swap_b32 v40, v42
v_permlane16_swap_b32 v41, v43
buffer_store_dwordx4 v[40:43], v169, s[36:39], 0 offen offset:0 sc1
v_dot2c_f32_bf16 v44, v32, v13
v_dot2c_f32_bf16 v45, v32, v32
v_dot2c_f32_bf16 v44, v33, v13
v_dot2c_f32_bf16 v45, v33, v33
v_dot2c_f32_bf16 v44, v34, v13
v_dot2c_f32_bf16 v45, v34, v34
v_dot2c_f32_bf16 v44, v35, v13
v_dot2c_f32_bf16 v45, v35, v35
v_dot2c_f32_bf16 v44, v36, v13
v_dot2c_f32_bf16 v45, v36, v36
v_dot2c_f32_bf16 v44, v37, v13
v_dot2c_f32_bf16 v45, v37, v37
v_dot2c_f32_bf16 v44, v38, v13
v_dot2c_f32_bf16 v45, v38, v38
v_dot2c_f32_bf16 v44, v39, v13
v_dot2c_f32_bf16 v45, v39, v39
v_dot2c_f32_bf16 v44, v40, v13
v_dot2c_f32_bf16 v45, v40, v40
v_dot2c_f32_bf16 v44, v41, v13
v_dot2c_f32_bf16 v45, v41, v41
v_dot2c_f32_bf16 v44, v42, v13
v_dot2c_f32_bf16 v45, v42, v42
v_dot2c_f32_bf16 v44, v43, v13
v_dot2c_f32_bf16 v45, v43, v43
s_nop 1
v_mov_b32 v14, v44
v_mov_b32 v15, v45
s_nop 0
v_permlane16_swap_b32 v44, v14
v_permlane16_swap_b32 v45, v15
v_pk_add_f32 v[44:45], v[44:45], v[14:15]
v_mov_b32 v14, v44
v_mov_b32 v15, v45
s_nop 0
v_permlane32_swap_b32 v44, v14
v_permlane32_swap_b32 v45, v15
v_pk_add_f32 v[44:45], v[44:45], v[14:15]
v_mov_b32 v46, s53
v_mov_b32 v47, s53
buffer_store_dwordx4 v[44:47], v170, s[36:39], 0 offen sc1
v_cmp_gt_u32 vcc, 32, v1
v_mov_b32 v50, 0
v_mov_b32 v51, 0
v_cndmask_b32 v48, 0, v24, vcc
v_cndmask_b32 v49, 0, v25, vcc
v_mov_b32 v54, 0
v_mov_b32 v55, 0
v_cndmask_b32 v52, 0, v26, vcc
v_cndmask_b32 v53, 0, v27, vcc
v_mov_b32 v58, 0
v_mov_b32 v59, 0
v_cndmask_b32 v56, 0, v28, vcc
v_cndmask_b32 v57, 0, v29, vcc
v_pk_add_f32 v[148:149], v[148:149], v[128:129]
v_pk_add_f32 v[150:151], v[150:151], v[130:131]
v_pk_add_f32 v[152:153], v[152:153], v[132:133]
v_pk_add_f32 v[154:155], v[154:155], v[134:135]
v_pk_add_f32 v[156:157], v[156:157], v[136:137]
v_pk_add_f32 v[158:159], v[158:159], v[138:139]
v_pk_add_f32 v[160:161], v[160:161], v[140:141]
v_pk_add_f32 v[162:163], v[162:163], v[142:143]
v_pk_add_f32 v[164:165], v[164:165], v[144:145]
v_pk_add_f32 v[166:167], v[166:167], v[146:147]
v_and_b32 v21, 31, v1
v_lshrrev_b32 v26, 4, v21
v_mul_u32_u24 v26, 49152, v26
v_and_b32 v24, 15, v21
v_lshl_add_u32 v24, v24, 4, v26
v_and_b32 v26, 32, v1
v_lshl_add_u32 v24, v26, 3, v24
s_lshl_b32 s48, s68, 12
s_add_u32 s48, s48, 262144
v_lshl_add_u32 v21, v21, 4, s48
v_and_b32 v30, 32, v1
v_lshl_add_u32 v16, v30, 6, v21
s_mul_i32 s70, s68, 98304
s_mul_i32 s48, s66, 3072
s_add_u32 s70, s70, s48
s_add_u32 s70, s70, 12582912
s_mul_i32 s48, s68, 40960
v_add_u32 v25, s48, v4
s_mul_i32 s48, s63, 5
s_lshr_b32 s48, s48, 1
s_mul_i32 s71, s48, 4096
s_add_u32 s71, s71, 9961472
s_waitcnt vmcnt(1)
buffer_atomic_or v8, v5, s[36:39], s74 offen sc1
v_mov_b32 v23, v4
v_add_u32 v31, 65536, v23
v_add_u32 v114, 131072, v23
v_lshlrev_b32 v115, 3, v1
s_mul_i32 s49, s57, 10240
s_xor_b32 s50, s69, 0
s_mul_i32 s50, s50, 20480
s_add_u32 s50, s50, s49
v_add_u32 v13, s50, v4
s_xor_b32 s50, s69, 16
s_mul_i32 s50, s50, 20480
s_add_u32 s50, s50, s49
v_add_u32 v14, s50, v4
s_mul_i32 s49, s57, 24576
s_xor_b32 s50, s69, 0
s_mul_i32 s50, s50, 49152
s_add_u32 s50, s50, s49
v_add_u32 v15, s50, v4
s_xor_b32 s50, s69, 16
s_mul_i32 s50, s50, 49152
s_add_u32 s50, s50, s49
v_add_u32 v22, s50, v4
s_mov_b32 s77, 4718592
s_xor_b32 s50, s60, 4
s_lshl3_add_u32 s50, s50, s61
s_lshl_b32 s78, s50, 7
s_add_u32 s78, s78, 524288
s_lshl2_add_u32 s50, s50, s52
s_mul_i32 s50, s50, 5120
s_add_u32 s50, s50, 24641536
v_add_u32 v118, s50, v4
s_lshl_b32 s50, s68, 7
s_add_u32 s64, s50, 45056
s_lshl_b32 s51, 1, s66
v_mov_b32 v8, s51
ds_read_b64 v[6:7], v3 offset:0
s_waitcnt lgkmcnt(0)
v_min_u32 v6, v6, v7
v_cmp_gt_u32 vcc, 19, v6
s_nop 0
s_cbranch_vccnz W80
B81:
ds_read_b64_tr_b16 a[44:45], v18 offset:36864
ds_read_b64_tr_b16 a[46:47], v18 offset:37632
ds_read_b64_tr_b16 a[48:49], v18 offset:36928
ds_read_b64_tr_b16 a[50:51], v18 offset:37696
ds_read_b64_tr_b16 a[52:53], v18 offset:36992
ds_read_b64_tr_b16 a[54:55], v18 offset:37760
ds_read_b64_tr_b16 a[56:57], v18 offset:39936
ds_read_b64_tr_b16 a[58:59], v18 offset:40704
ds_read_b64_tr_b16 a[60:61], v18 offset:40000
ds_read_b64_tr_b16 a[62:63], v18 offset:40768
ds_read_b64_tr_b16 a[64:65], v18 offset:40064
ds_read_b64_tr_b16 a[66:67], v18 offset:40832
s_lshl_b32 s72, s68, 7
s_add_u32 s72, s72, 28672
s_mov_b64 s[74:75], 0
s_atomic_add_x2 s[74:75], s[36:37], s72 glc
s_lshl_b32 s48, s63, 3
s_lshr_b32 s73, 3761245699, s48
s_and_b32 s73, s73, 0xff
s_mul_i32 s73, s73, 0x101
s_lshr_b32 s76, 3824172559, s48
s_and_b32 s76, s76, 0xff
s_mul_i32 s76, s76, 0x101
s_waitcnt lgkmcnt(0)
s_cmp_lg_u32 s75, s53
s_cbranch_scc1 N82
s_andn2_b32 s74, s73, s74
s_cbranch_scc1 N82
B83:
s_mov_b64 s[74:75], 0
s_atomic_add_x2 s[74:75], s[36:37], s72 glc
buffer_load_dwordx4 a[0:3], v25, s[36:39], s71 offen offset:0 sc1
buffer_load_dwordx4 a[4:7], v25, s[36:39], s71 offen offset:1024 sc1
buffer_load_dwordx4 a[8:11], v25, s[36:39], s71 offen offset:2048 sc1
buffer_load_dwordx4 a[12:15], v25, s[36:39], s71 offen offset:3072 sc1
s_add_u32 s71, s71, 4096
s_cmp_ge_u32 s71, 10002432
s_cmov_b32 s71, 9961472
buffer_load_dwordx4 a[16:19], v25, s[36:39], s71 offen offset:0 sc1
buffer_load_dwordx4 a[20:23], v25, s[36:39], s71 offen offset:1024 sc1
buffer_load_dwordx4 a[24:27], v25, s[36:39], s71 offen offset:2048 sc1
buffer_load_dwordx4 a[28:31], v25, s[36:39], s71 offen offset:3072 sc1
s_add_u32 s71, s71, 4096
s_cmp_ge_u32 s71, 10002432
s_cmov_b32 s71, 9961472
buffer_load_dwordx4 a[32:35], v25, s[36:39], s71 offen offset:0 sc1
buffer_load_dwordx4 a[36:39], v25, s[36:39], s71 offen offset:1024 sc1
s_waitcnt lgkmcnt(0)
s_cmp_lg_u32 s75, s53
s_cbranch_scc1 N84
s_andn2_b32 s74, s76, s74
s_cbranch_scc1 N84
B85:
s_mov_b64 s[74:75], 0
s_atomic_add_x2 s[74:75], s[36:37], s72 glc
s_waitcnt vmcnt(9)
v_mfma_f32_32x32x16_bf16 v[60:75], a[44:47], a[0:3], 0
buffer_load_dwordx4 a[40:43], v25, s[36:39], s71 offen offset:2048 sc1
ds_read_b64_tr_b16 a[68:69], v18 offset:43008
ds_read_b64_tr_b16 a[70:71], v18 offset:43776
v_mfma_f32_32x32x16_bf16 v[76:91], a[48:51], a[0:3], 0
ds_read_b64_tr_b16 a[72:73], v18 offset:43072
ds_read_b64_tr_b16 a[74:75], v18 offset:43840
v_mfma_f32_32x32x16_bf16 v[92:107], a[52:55], a[0:3], 0
ds_read_b64_tr_b16 a[76:77], v18 offset:43136
ds_read_b64_tr_b16 a[78:79], v18 offset:43904
s_waitcnt vmcnt(9)
v_mfma_f32_32x32x16_bf16 v[60:75], a[56:59], a[4:7], v[60:75]
buffer_load_dwordx4 a[0:3], v25, s[36:39], s71 offen offset:3072 sc1
s_add_u32 s71, s71, 4096
s_cmp_ge_u32 s71, 10002432
s_cmov_b32 s71, 9961472
ds_read_b64_tr_b16 a[44:45], v18 offset:46080
ds_read_b64_tr_b16 a[46:47], v18 offset:46848
v_mfma_f32_32x32x16_bf16 v[76:91], a[60:63], a[4:7], v[76:91]
ds_read_b64_tr_b16 a[48:49], v18 offset:46144
ds_read_b64_tr_b16 a[50:51], v18 offset:46912
v_mfma_f32_32x32x16_bf16 v[92:107], a[64:67], a[4:7], v[92:107]
ds_read_b64_tr_b16 a[52:53], v18 offset:46208
ds_read_b64_tr_b16 a[54:55], v18 offset:46976
s_waitcnt vmcnt(9) lgkmcnt(10)
v_mfma_f32_32x32x16_bf16 v[60:75], a[68:71], a[8:11], v[60:75]
buffer_load_dwordx4 a[4:7], v25, s[36:39], s71 offen offset:0 sc1
ds_read_b64_tr_b16 a[56:57], v18 offset:49152
ds_read_b64_tr_b16 a[58:59], v18 offset:49920
s_waitcnt lgkmcnt(10)
v_mfma_f32_32x32x16_bf16 v[76:91], a[72:75], a[8:11], v[76:91]
ds_read_b64_tr_b16 a[60:61], v18 offset:49216
ds_read_b64_tr_b16 a[62:63], v18 offset:49984
s_waitcnt lgkmcnt(10)
v_mfma_f32_32x32x16_bf16 v[92:107], a[76:79], a[8:11], v[92:107]
ds_read_b64_tr_b16 a[64:65], v18 offset:49280
ds_read_b64_tr_b16 a[66:67], v18 offset:50048
s_waitcnt vmcnt(9) lgkmcnt(10)
v_mfma_f32_32x32x16_bf16 v[60:75], a[44:47], a[12:15], v[60:75]
buffer_load_dwordx4 a[8:11], v25, s[36:39], s71 offen offset:1024 sc1
ds_read_b64_tr_b16 a[68:69], v18 offset:52224
ds_read_b64_tr_b16 a[70:71], v18 offset:52992
s_waitcnt lgkmcnt(10)
v_mfma_f32_32x32x16_bf16 v[76:91], a[48:51], a[12:15], v[76:91]
ds_read_b64_tr_b16 a[72:73], v18 offset:52288
ds_read_b64_tr_b16 a[74:75], v18 offset:53056
s_waitcnt lgkmcnt(10)
v_mfma_f32_32x32x16_bf16 v[92:107], a[52:55], a[12:15], v[92:107]
ds_read_b64_tr_b16 a[76:77], v18 offset:52352
ds_read_b64_tr_b16 a[78:79], v18 offset:53120
s_waitcnt vmcnt(9) lgkmcnt(10)
v_mfma_f32_32x32x16_bf16 v[60:75], a[56:59], a[16:19], v[60:75]
buffer_load_dwordx4 a[12:15], v25, s[36:39], s71 offen offset:2048 sc1
ds_read_b64_tr_b16 a[44:45], v18 offset:55296
ds_read_b64_tr_b16 a[46:47], v18 offset:56064
s_waitcnt lgkmcnt(10)
v_mfma_f32_32x32x16_bf16 v[76:91], a[60:63], a[16:19], v[76:91]
ds_read_b64_tr_b16 a[48:49], v18 offset:55360
ds_read_b64_tr_b16 a[50:51], v18 offset:56128
s_waitcnt lgkmcnt(10)
v_mfma_f32_32x32x16_bf16 v[92:107], a[64:67], a[16:19], v[92:107]
ds_read_b64_tr_b16 a[52:53], v18 offset:55424
ds_read_b64_tr_b16 a[54:55], v18 offset:56192
s_waitcnt vmcnt(9) lgkmcnt(10)
v_mfma_f32_32x32x16_bf16 v[60:75], a[68:71], a[20:23], v[60:75]
buffer_load_dwordx4 a[16:19], v25, s[36:39], s71 offen offset:3072 sc1
s_add_u32 s71, s71, 4096
s_cmp_ge_u32 s71, 10002432
s_cmov_b32 s71, 9961472
ds_read_b64_tr_b16 a[56:57], v18 offset:58368
ds_read_b64_tr_b16 a[58:59], v18 offset:59136
s_waitcnt lgkmcnt(10)
v_mfma_f32_32x32x16_bf16 v[76:91], a[72:75], a[20:23], v[76:91]
ds_read_b64_tr_b16 a[60:61], v18 offset:58432
ds_read_b64_tr_b16 a[62:63], v18 offset:59200
s_waitcnt lgkmcnt(10)
v_mfma_f32_32x32x16_bf16 v[92:107], a[76:79], a[20:23], v[92:107]
ds_read_b64_tr_b16 a[64:65], v18 offset:58496
ds_read_b64_tr_b16 a[66:67], v18 offset:59264
v_mov_b32 v9, 15
ds_write_b32 v10, v9
s_waitcnt vmcnt(9) lgkmcnt(11)
v_mfma_f32_32x32x16_bf16 v[60:75], a[44:47], a[24:27], v[60:75]
buffer_load_dwordx4 a[20:23], v25, s[36:39], s71 offen offset:0 sc1
ds_read_b64_tr_b16 a[68:69], v18 offset:61440
ds_read_b64_tr_b16 a[70:71], v18 offset:62208
s_waitcnt lgkmcnt(11)
v_mfma_f32_32x32x16_bf16 v[76:91], a[48:51], a[24:27], v[76:91]
ds_read_b64_tr_b16 a[72:73], v18 offset:61504
ds_read_b64_tr_b16 a[74:75], v18 offset:62272
s_waitcnt lgkmcnt(11)
v_mfma_f32_32x32x16_bf16 v[92:107], a[52:55], a[24:27], v[92:107]
ds_read_b64_tr_b16 a[76:77], v18 offset:61568
ds_read_b64_tr_b16 a[78:79], v18 offset:62336
s_waitcnt vmcnt(9) lgkmcnt(11)
v_mfma_f32_32x32x16_bf16 v[60:75], a[56:59], a[28:31], v[60:75]
buffer_load_dwordx4 a[24:27], v25, s[36:39], s71 offen offset:1024 sc1
ds_read_b64_tr_b16 a[44:45], v18 offset:64512
ds_read_b64_tr_b16 a[46:47], v18 offset:65280
s_waitcnt lgkmcnt(11)
v_mfma_f32_32x32x16_bf16 v[76:91], a[60:63], a[28:31], v[76:91]
ds_read_b64_tr_b16 a[48:49], v18 offset:64576
ds_read_b64_tr_b16 a[50:51], v18 offset:65344
s_waitcnt lgkmcnt(11)
v_mfma_f32_32x32x16_bf16 v[92:107], a[64:67], a[28:31], v[92:107]
ds_read_b64_tr_b16 a[52:53], v18 offset:64640
ds_read_b64_tr_b16 a[54:55], v18 offset:65408
s_waitcnt lgkmcnt(0)
s_cmp_lg_u32 s75, s53
s_cbranch_scc1 N86
s_andn2_b32 s74, 65535, s74
s_cbranch_scc1 N86
B87:
s_waitcnt vmcnt(9)
v_mfma_f32_32x32x16_bf16 v[60:75], a[68:71], a[32:35], v[60:75]
buffer_load_dwordx4 a[28:31], v25, s[36:39], s71 offen offset:2048 sc1
ds_read_b64_tr_b16 a[56:57], v19 offset:2048
ds_read_b64_tr_b16 a[58:59], v19 offset:2816
v_mfma_f32_32x32x16_bf16 v[76:91], a[72:75], a[32:35], v[76:91]
ds_read_b64_tr_b16 a[60:61], v19 offset:2112
ds_read_b64_tr_b16 a[62:63], v19 offset:2880
buffer_load_dwordx4 v[32:35], v16, s[36:39], 0 offen offset:0 sc1
buffer_load_dwordx4 v[36:39], v16, s[36:39], 0 offen offset:512 sc1
buffer_load_dwordx4 v[40:43], v16, s[36:39], 0 offen offset:1024 sc1
buffer_load_dwordx4 v[44:47], v16, s[36:39], 0 offen offset:1536 sc1
v_mfma_f32_32x32x16_bf16 v[92:107], a[76:79], a[32:35], v[92:107]
ds_read_b64_tr_b16 a[64:65], v19 offset:2176
ds_read_b64_tr_b16 a[66:67], v19 offset:2944
s_waitcnt vmcnt(13)
v_mfma_f32_32x32x16_bf16 v[60:75], a[44:47], a[36:39], v[60:75]
buffer_load_dwordx4 a[32:35], v25, s[36:39], s71 offen offset:3072 sc1
s_add_u32 s71, s71, 4096
s_cmp_ge_u32 s71, 10002432
s_cmov_b32 s71, 9961472
ds_read_b64_tr_b16 a[68:69], v19 offset:5120
ds_read_b64_tr_b16 a[70:71], v19 offset:5888
v_mfma_f32_32x32x16_bf16 v[76:91], a[48:51], a[36:39], v[76:91]
ds_read_b64_tr_b16 a[72:73], v19 offset:5184
ds_read_b64_tr_b16 a[74:75], v19 offset:5952
v_mfma_f32_32x32x16_bf16 v[92:107], a[52:55], a[36:39], v[92:107]
ds_read_b64_tr_b16 a[76:77], v19 offset:5248
ds_read_b64_tr_b16 a[78:79], v19 offset:6016
s_waitcnt vmcnt(13) lgkmcnt(10)
v_mfma_f32_32x32x16_bf16 v[60:75], a[56:59], a[40:43], v[60:75]
buffer_load_dwordx4 a[36:39], v25, s[36:39], s71 offen offset:0 sc1
ds_read_b64_tr_b16 a[44:45], v19 offset:8192
ds_read_b64_tr_b16 a[46:47], v19 offset:8960
s_waitcnt lgkmcnt(10)
v_mfma_f32_32x32x16_bf16 v[76:91], a[60:63], a[40:43], v[76:91]
ds_read_b64_tr_b16 a[48:49], v19 offset:8256
ds_read_b64_tr_b16 a[50:51], v19 offset:9024
s_waitcnt lgkmcnt(10)
v_mfma_f32_32x32x16_bf16 v[92:107], a[64:67], a[40:43], v[92:107]
ds_read_b64_tr_b16 a[52:53], v19 offset:8320
ds_read_b64_tr_b16 a[54:55], v19 offset:9088
s_waitcnt vmcnt(13) lgkmcnt(10)
v_mfma_f32_32x32x16_bf16 v[60:75], a[68:71], a[0:3], v[60:75]
buffer_load_dwordx4 a[40:43], v25, s[36:39], s71 offen offset:1024 sc1
ds_read_b64_tr_b16 a[56:57], v19 offset:11264
ds_read_b64_tr_b16 a[58:59], v19 offset:12032
s_waitcnt lgkmcnt(10)
v_mfma_f32_32x32x16_bf16 v[76:91], a[72:75], a[0:3], v[76:91]
ds_read_b64_tr_b16 a[60:61], v19 offset:11328
ds_read_b64_tr_b16 a[62:63], v19 offset:12096
s_waitcnt lgkmcnt(10)
v_mfma_f32_32x32x16_bf16 v[92:107], a[76:79], a[0:3], v[92:107]
ds_read_b64_tr_b16 a[64:65], v19 offset:11392
ds_read_b64_tr_b16 a[66:67], v19 offset:12160
s_waitcnt vmcnt(13) lgkmcnt(10)
v_mfma_f32_32x32x16_bf16 v[60:75], a[44:47], a[4:7], v[60:75]
buffer_load_dwordx4 a[0:3], v25, s[36:39], s71 offen offset:2048 sc1
ds_read_b64_tr_b16 a[68:69], v19 offset:14336
ds_read_b64_tr_b16 a[70:71], v19 offset:15104
s_waitcnt lgkmcnt(10)
v_mfma_f32_32x32x16_bf16 v[76:91], a[48:51], a[4:7], v[76:91]
ds_read_b64_tr_b16 a[72:73], v19 offset:14400
ds_read_b64_tr_b16 a[74:75], v19 offset:15168
s_waitcnt lgkmcnt(10)
v_mfma_f32_32x32x16_bf16 v[92:107], a[52:55], a[4:7], v[92:107]
ds_read_b64_tr_b16 a[76:77], v19 offset:14464
ds_read_b64_tr_b16 a[78:79], v19 offset:15232
s_waitcnt vmcnt(13) lgkmcnt(10)
v_mfma_f32_32x32x16_bf16 v[60:75], a[56:59], a[8:11], v[60:75]
buffer_load_dwordx4 a[4:7], v25, s[36:39], s71 offen offset:3072 sc1
s_add_u32 s71, s71, 4096
s_cmp_ge_u32 s71, 10002432
s_cmov_b32 s71, 9961472
ds_read_b64_tr_b16 a[44:45], v19 offset:17408
ds_read_b64_tr_b16 a[46:47], v19 offset:18176
ds_read_b64 v[6:7], v3
s_waitcnt lgkmcnt(11)
v_mfma_f32_32x32x16_bf16 v[76:91], a[60:63], a[8:11], v[76:91]
ds_read_b64_tr_b16 a[48:49], v19 offset:17472
ds_read_b64_tr_b16 a[50:51], v19 offset:18240
s_waitcnt lgkmcnt(11)
v_mfma_f32_32x32x16_bf16 v[92:107], a[64:67], a[8:11], v[92:107]
ds_read_b64_tr_b16 a[52:53], v19 offset:17536
ds_read_b64_tr_b16 a[54:55], v19 offset:18304
v_mov_b32 v9, 16
ds_write_b32 v10, v9
s_waitcnt vmcnt(13) lgkmcnt(12)
v_mfma_f32_32x32x16_bf16 v[60:75], a[68:71], a[12:15], v[60:75]
buffer_load_dwordx4 a[8:11], v25, s[36:39], s71 offen offset:0 sc1
s_waitcnt lgkmcnt(5)
v_min_u32 v6, v6, v7
v_cmp_gt_u32 vcc, 22, v6
s_nop 0
s_cbranch_vccnz W88
B89:
ds_read_b64_tr_b16 a[56:57], v17 offset:0
ds_read_b64_tr_b16 a[58:59], v17 offset:768
v_mfma_f32_32x32x16_bf16 v[76:91], a[72:75], a[12:15], v[76:91]
ds_read_b64_tr_b16 a[60:61], v17 offset:64
ds_read_b64_tr_b16 a[62:63], v17 offset:832
v_mfma_f32_32x32x16_bf16 v[92:107], a[76:79], a[12:15], v[92:107]
ds_read_b64_tr_b16 a[64:65], v17 offset:128
ds_read_b64_tr_b16 a[66:67], v17 offset:896
s_waitcnt vmcnt(13)
v_mfma_f32_32x32x16_bf16 v[60:75], a[44:47], a[16:19], v[60:75]
buffer_load_dwordx4 a[12:15], v25, s[36:39], s71 offen offset:1024 sc1
ds_read_b64_tr_b16 a[68:69], v17 offset:3072
ds_read_b64_tr_b16 a[70:71], v17 offset:3840
s_waitcnt lgkmcnt(11)
v_mfma_f32_32x32x16_bf16 v[76:91], a[48:51], a[16:19], v[76:91]
ds_read_b64_tr_b16 a[72:73], v17 offset:3136
ds_read_b64_tr_b16 a[74:75], v17 offset:3904
s_waitcnt lgkmcnt(11)
v_mfma_f32_32x32x16_bf16 v[92:107], a[52:55], a[16:19], v[92:107]
ds_read_b64_tr_b16 a[76:77], v17 offset:3200
ds_read_b64_tr_b16 a[78:79], v17 offset:3968
s_waitcnt vmcnt(13) lgkmcnt(10)
v_mfma_f32_32x32x16_bf16 v[60:75], a[56:59], a[20:23], v[60:75]
buffer_load_dwordx4 a[16:19], v25, s[36:39], s71 offen offset:2048 sc1
ds_read_b64_tr_b16 a[44:45], v17 offset:6144
ds_read_b64_tr_b16 a[46:47], v17 offset:6912
s_waitcnt lgkmcnt(10)
v_mfma_f32_32x32x16_bf16 v[76:91], a[60:63], a[20:23], v[76:91]
ds_read_b64_tr_b16 a[48:49], v17 offset:6208
ds_read_b64_tr_b16 a[50:51], v17 offset:6976
s_waitcnt lgkmcnt(10)
v_mfma_f32_32x32x16_bf16 v[92:107], a[64:67], a[20:23], v[92:107]
ds_read_b64_tr_b16 a[52:53], v17 offset:6272
ds_read_b64_tr_b16 a[54:55], v17 offset:7040
s_waitcnt vmcnt(13) lgkmcnt(10)
v_mfma_f32_32x32x16_bf16 v[60:75], a[68:71], a[24:27], v[60:75]
buffer_load_dwordx4 a[20:23], v25, s[36:39], s71 offen offset:3072 sc1
s_add_u32 s71, s71, 4096
s_cmp_ge_u32 s71, 10002432
s_cmov_b32 s71, 9961472
ds_read_b64_tr_b16 a[56:57], v17 offset:9216
ds_read_b64_tr_b16 a[58:59], v17 offset:9984
s_waitcnt lgkmcnt(10)
v_mfma_f32_32x32x16_bf16 v[76:91], a[72:75], a[24:27], v[76:91]
ds_read_b64_tr_b16 a[60:61], v17 offset:9280
ds_read_b64_tr_b16 a[62:63], v17 offset:10048
s_waitcnt lgkmcnt(10)
v_mfma_f32_32x32x16_bf16 v[92:107], a[76:79], a[24:27], v[92:107]
ds_read_b64_tr_b16 a[64:65], v17 offset:9344
ds_read_b64_tr_b16 a[66:67], v17 offset:10112
s_waitcnt vmcnt(13) lgkmcnt(10)
v_mfma_f32_32x32x16_bf16 v[60:75], a[44:47], a[28:31], v[60:75]
buffer_load_dwordx4 a[24:27], v25, s[36:39], s71 offen offset:0 sc1
ds_read_b64_tr_b16 a[68:69], v17 offset:12288
ds_read_b64_tr_b16 a[70:71], v17 offset:13056
s_waitcnt lgkmcnt(10)
v_mfma_f32_32x32x16_bf16 v[76:91], a[48:51], a[28:31], v[76:91]
ds_read_b64_tr_b16 a[72:73], v17 offset:12352
ds_read_b64_tr_b16 a[74:75], v17 offset:13120
s_waitcnt lgkmcnt(10)
v_mfma_f32_32x32x16_bf16 v[92:107], a[52:55], a[28:31], v[92:107]
ds_read_b64_tr_b16 a[76:77], v17 offset:12416
ds_read_b64_tr_b16 a[78:79], v17 offset:13184
s_waitcnt vmcnt(9) lgkmcnt(10)
v_mfma_f32_32x32x16_bf16 v[60:75], a[56:59], a[32:35], v[60:75]
buffer_load_dwordx4 a[28:31], v25, s[36:39], s71 offen offset:1024 sc1
ds_read_b64_tr_b16 a[44:45], v17 offset:15360
ds_read_b64_tr_b16 a[46:47], v17 offset:16128
s_waitcnt lgkmcnt(10)
v_mfma_f32_32x32x16_bf16 v[76:91], a[60:63], a[32:35], v[76:91]
ds_read_b64_tr_b16 a[48:49], v17 offset:15424
ds_read_b64_tr_b16 a[50:51], v17 offset:16192
s_waitcnt lgkmcnt(10)
v_mfma_f32_32x32x16_bf16 v[92:107], a[64:67], a[32:35], v[92:107]
ds_read_b64_tr_b16 a[52:53], v17 offset:15488
ds_read_b64_tr_b16 a[54:55], v17 offset:16256
s_waitcnt vmcnt(9) lgkmcnt(10)
v_mfma_f32_32x32x16_bf16 v[60:75], a[68:71], a[36:39], v[60:75]
buffer_load_dwordx4 a[32:35], v25, s[36:39], s71 offen offset:2048 sc1
ds_read_b64_tr_b16 a[56:57], v17 offset:18432
ds_read_b64_tr_b16 a[58:59], v17 offset:19200
s_waitcnt lgkmcnt(10)
v_mfma_f32_32x32x16_bf16 v[76:91], a[72:75], a[36:39], v[76:91]
ds_read_b64_tr_b16 a[60:61], v17 offset:18496
ds_read_b64_tr_b16 a[62:63], v17 offset:19264
s_waitcnt lgkmcnt(10)
v_mfma_f32_32x32x16_bf16 v[92:107], a[76:79], a[36:39], v[92:107]
ds_read_b64_tr_b16 a[64:65], v17 offset:18560
ds_read_b64_tr_b16 a[66:67], v17 offset:19328
s_waitcnt vmcnt(9) lgkmcnt(10)
v_mfma_f32_32x32x16_bf16 v[60:75], a[44:47], a[40:43], v[60:75]
buffer_load_dwordx4 a[36:39], v25, s[36:39], s71 offen offset:3072 sc1
s_add_u32 s71, s71, 4096
s_cmp_ge_u32 s71, 10002432
s_cmov_b32 s71, 9961472
ds_read_b64_tr_b16 a[68:69], v17 offset:21504
ds_read_b64_tr_b16 a[70:71], v17 offset:22272
s_waitcnt lgkmcnt(10)
v_mfma_f32_32x32x16_bf16 v[76:91], a[48:51], a[40:43], v[76:91]
ds_read_b64_tr_b16 a[72:73], v17 offset:21568
ds_read_b64_tr_b16 a[74:75], v17 offset:22336
s_waitcnt lgkmcnt(10)
v_mfma_f32_32x32x16_bf16 v[92:107], a[52:55], a[40:43], v[92:107]
ds_read_b64_tr_b16 a[76:77], v17 offset:21632
ds_read_b64_tr_b16 a[78:79], v17 offset:22400
v_mov_b32 v9, 17
ds_write_b32 v10, v9
v_xor_b32 v119, s53, v34
v_bitop3_b32 v119, v119, v2, v38 bitop3:0xf6
v_bitop3_b32 v119, v119, v2, v42 bitop3:0xf6
v_bitop3_b32 v119, v119, v2, v46 bitop3:0xf6
v_cmp_ne_u32 vcc, 0, v119
s_nop 0
s_cbranch_vccnz R90
B91:
s_waitcnt vmcnt(9) lgkmcnt(11)
v_mfma_f32_32x32x16_bf16 v[60:75], a[56:59], a[0:3], v[60:75]
buffer_load_dwordx4 a[40:43], v25, s[36:39], s71 offen offset:0 sc1
ds_read_b64_tr_b16 a[44:45], v17 offset:24576
ds_read_b64_tr_b16 a[46:47], v17 offset:25344
v_add_f32 v32, v32, v36
v_add_f32 v33, v33, v37
v_add_f32 v32, v32, v40
s_waitcnt lgkmcnt(11)
v_mfma_f32_32x32x16_bf16 v[76:91], a[60:63], a[0:3], v[76:91]
ds_read_b64_tr_b16 a[48:49], v17 offset:24640
ds_read_b64_tr_b16 a[50:51], v17 offset:25408
v_add_f32 v33, v33, v41
v_add_f32 v32, v32, v44
v_add_f32 v33, v33, v45
v_mov_b32 v34, v32
s_waitcnt lgkmcnt(11)
v_mfma_f32_32x32x16_bf16 v[92:107], a[64:67], a[0:3], v[92:107]
ds_read_b64_tr_b16 a[52:53], v17 offset:24704
ds_read_b64_tr_b16 a[54:55], v17 offset:25472
v_mov_b32 v35, v33
v_permlane32_swap_b32 v32, v34
s_nop 0
v_permlane32_swap_b32 v33, v35
s_waitcnt vmcnt(9) lgkmcnt(11)
v_mfma_f32_32x32x16_bf16 v[60:75], a[68:71], a[4:7], v[60:75]
buffer_load_dwordx4 a[0:3], v25, s[36:39], s71 offen offset:1024 sc1
ds_read_b64_tr_b16 a[56:57], v17 offset:27648
ds_read_b64_tr_b16 a[58:59], v17 offset:28416
v_add_f32 v32, v32, v34
v_add_f32 v33, v33, v35
v_mul_f32 v32, 0x3acccccd, v32
s_waitcnt lgkmcnt(11)
v_mfma_f32_32x32x16_bf16 v[76:91], a[72:75], a[4:7], v[76:91]
ds_read_b64_tr_b16 a[60:61], v17 offset:27712
ds_read_b64_tr_b16 a[62:63], v17 offset:28480
v_mul_f32 v33, 0x3acccccd, v33
v_fma_f32 v33, -v32, v32, v33
v_max_f32 v33, 0, v33
v_cvt_pk_bf16_f32 v112, v33, v33
s_waitcnt lgkmcnt(11)
v_mfma_f32_32x32x16_bf16 v[92:107], a[76:79], a[4:7], v[92:107]
ds_read_b64_tr_b16 a[64:65], v17 offset:27776
ds_read_b64_tr_b16 a[66:67], v17 offset:28544
v_and_b32 v112, 0xffff0000, v112
v_add_f32 v112, 0x3727c5ac, v112
v_cvt_pk_bf16_f32 v112, v112, v112
v_and_b32 v112, 0xffff0000, v112
s_waitcnt vmcnt(9) lgkmcnt(10)
v_mfma_f32_32x32x16_bf16 v[60:75], a[44:47], a[8:11], v[60:75]
buffer_load_dwordx4 a[4:7], v25, s[36:39], s71 offen offset:2048 sc1
ds_read_b64_tr_b16 a[68:69], v17 offset:30720
ds_read_b64_tr_b16 a[70:71], v17 offset:31488
v_sqrt_f32 v112, v112
s_nop 0
v_cvt_pk_bf16_f32 v112, v112, v112
s_waitcnt lgkmcnt(10)
v_mfma_f32_32x32x16_bf16 v[76:91], a[48:51], a[8:11], v[76:91]
ds_read_b64_tr_b16 a[72:73], v17 offset:30784
ds_read_b64_tr_b16 a[74:75], v17 offset:31552
v_and_b32 v112, 0xffff0000, v112
v_rcp_f32 v34, v112
v_cvt_pk_bf16_f32 v108, -v32, -v32
s_waitcnt lgkmcnt(10)
v_mfma_f32_32x32x16_bf16 v[92:107], a[52:55], a[8:11], v[92:107]
ds_read_b64_tr_b16 a[76:77], v17 offset:30848
ds_read_b64_tr_b16 a[78:79], v17 offset:31616
v_and_b32 v110, 0xffff0000, v108
v_sub_f32 v110, -v32, v110
v_cvt_pk_bf16_f32 v109, v110, 0
v_mov_b32 v110, 0
s_waitcnt vmcnt(9) lgkmcnt(10)
v_mfma_f32_32x32x16_bf16 v[60:75], a[56:59], a[12:15], v[60:75]
buffer_load_dwordx4 a[8:11], v25, s[36:39], s71 offen offset:3072 sc1
s_add_u32 s71, s71, 4096
s_cmp_ge_u32 s71, 10002432
s_cmov_b32 s71, 9961472
ds_read_b64_tr_b16 a[44:45], v17 offset:33792
ds_read_b64_tr_b16 a[46:47], v17 offset:34560
ds_read_b64 v[6:7], v3
v_mov_b32 v111, 0
v_mul_f32 v26, 0xc0135761, v34
s_waitcnt lgkmcnt(11)
v_mfma_f32_32x32x16_bf16 v[76:91], a[60:63], a[12:15], v[76:91]
ds_read_b64_tr_b16 a[48:49], v17 offset:33856
ds_read_b64_tr_b16 a[50:51], v17 offset:34624
v_mul_f32 v28, v34, v34
v_mul_f32 v28, v28, v34
v_mul_f32 v28, 0xbdd2d3e8, v28
s_waitcnt lgkmcnt(11)
v_mfma_f32_32x32x16_bf16 v[92:107], a[64:67], a[12:15], v[92:107]
ds_read_b64_tr_b16 a[52:53], v17 offset:33920
ds_read_b64_tr_b16 a[54:55], v17 offset:34688
s_waitcnt vmcnt(9) lgkmcnt(11)
v_mfma_f32_32x32x16_bf16 v[60:75], a[68:71], a[16:19], v[60:75]
buffer_load_dwordx4 a[12:15], v25, s[36:39], s71 offen offset:0 sc1
s_waitcnt lgkmcnt(4)
v_min_u32 v6, v6, v7
v_cmp_gt_u32 vcc, 25, v6
s_nop 0
s_cbranch_vccnz W93
B94:
ds_read_b64_tr_b16 a[56:57], v17 offset:36864
ds_read_b64_tr_b16 a[58:59], v17 offset:37632
v_mfma_f32_32x32x16_bf16 v[76:91], a[72:75], a[16:19], v[76:91]
ds_read_b64_tr_b16 a[60:61], v17 offset:36928
ds_read_b64_tr_b16 a[62:63], v17 offset:37696
v_mfma_f32_32x32x16_bf16 v[92:107], a[76:79], a[16:19], v[92:107]
ds_read_b64_tr_b16 a[64:65], v17 offset:36992
ds_read_b64_tr_b16 a[66:67], v17 offset:37760
s_waitcnt vmcnt(9)
v_mfma_f32_32x32x16_bf16 v[60:75], a[44:47], a[20:23], v[60:75]
buffer_load_dwordx4 a[16:19], v25, s[36:39], s71 offen offset:1024 sc1
ds_read_b64_tr_b16 a[68:69], v17 offset:39936
ds_read_b64_tr_b16 a[70:71], v17 offset:40704
s_waitcnt lgkmcnt(10)
v_mfma_f32_32x32x16_bf16 v[76:91], a[48:51], a[20:23], v[76:91]
ds_read_b64_tr_b16 a[72:73], v17 offset:40000
ds_read_b64_tr_b16 a[74:75], v17 offset:40768
s_waitcnt lgkmcnt(10)
v_mfma_f32_32x32x16_bf16 v[92:107], a[52:55], a[20:23], v[92:107]
ds_read_b64_tr_b16 a[76:77], v17 offset:40064
ds_read_b64_tr_b16 a[78:79], v17 offset:40832
s_waitcnt vmcnt(9) lgkmcnt(10)
v_mfma_f32_32x32x16_bf16 v[60:75], a[56:59], a[24:27], v[60:75]
buffer_load_dwordx4 a[20:23], v25, s[36:39], s71 offen offset:2048 sc1
ds_read_b64_tr_b16 a[44:45], v17 offset:43008
ds_read_b64_tr_b16 a[46:47], v17 offset:43776
s_waitcnt lgkmcnt(10)
v_mfma_f32_32x32x16_bf16 v[76:91], a[60:63], a[24:27], v[76:91]
ds_read_b64_tr_b16 a[48:49], v17 offset:43072
ds_read_b64_tr_b16 a[50:51], v17 offset:43840
s_waitcnt lgkmcnt(10)
v_mfma_f32_32x32x16_bf16 v[92:107], a[64:67], a[24:27], v[92:107]
ds_read_b64_tr_b16 a[52:53], v17 offset:43136
ds_read_b64_tr_b16 a[54:55], v17 offset:43904
s_waitcnt vmcnt(9) lgkmcnt(10)
v_mfma_f32_32x32x16_bf16 v[60:75], a[68:71], a[28:31], v[60:75]
buffer_load_dwordx4 a[24:27], v25, s[36:39], s71 offen offset:3072 sc1
s_add_u32 s71, s71, 4096
s_cmp_ge_u32 s71, 10002432
s_cmov_b32 s71, 9961472
ds_read_b64_tr_b16 a[56:57], v17 offset:46080
ds_read_b64_tr_b16 a[58:59], v17 offset:46848
s_waitcnt lgkmcnt(10)
v_mfma_f32_32x32x16_bf16 v[76:91], a[72:75], a[28:31], v[76:91]
ds_read_b64_tr_b16 a[60:61], v17 offset:46144
ds_read_b64_tr_b16 a[62:63], v17 offset:46912
s_waitcnt lgkmcnt(10)
v_mfma_f32_32x32x16_bf16 v[92:107], a[76:79], a[28:31], v[92:107]
ds_read_b64_tr_b16 a[64:65], v17 offset:46208
ds_read_b64_tr_b16 a[66:67], v17 offset:46976
v_mov_b32 v9, 18
ds_write_b32 v10, v9
s_waitcnt vmcnt(9) lgkmcnt(11)
v_mfma_f32_32x32x16_bf16 v[60:75], a[44:47], a[32:35], v[60:75]
ds_read_b64_tr_b16 a[68:69], v17 offset:49152
ds_read_b64_tr_b16 a[70:71], v17 offset:49920
s_waitcnt lgkmcnt(11)
v_mfma_f32_32x32x16_bf16 v[76:91], a[48:51], a[32:35], v[76:91]
ds_read_b64_tr_b16 a[72:73], v17 offset:49216
ds_read_b64_tr_b16 a[74:75], v17 offset:49984
s_waitcnt lgkmcnt(11)
v_mfma_f32_32x32x16_bf16 v[92:107], a[52:55], a[32:35], v[92:107]
ds_read_b64_tr_b16 a[76:77], v17 offset:49280
ds_read_b64_tr_b16 a[78:79], v17 offset:50048
s_waitcnt vmcnt(8) lgkmcnt(11)
v_mfma_f32_32x32x16_bf16 v[60:75], a[56:59], a[36:39], v[60:75]
ds_read_b64_tr_b16 a[44:45], v17 offset:52224
ds_read_b64_tr_b16 a[46:47], v17 offset:52992
s_waitcnt lgkmcnt(11)
v_mfma_f32_32x32x16_bf16 v[76:91], a[60:63], a[36:39], v[76:91]
ds_read_b64_tr_b16 a[48:49], v17 offset:52288
ds_read_b64_tr_b16 a[50:51], v17 offset:53056
s_waitcnt lgkmcnt(11)
v_mfma_f32_32x32x16_bf16 v[92:107], a[64:67], a[36:39], v[92:107]
ds_read_b64_tr_b16 a[52:53], v17 offset:52352
ds_read_b64_tr_b16 a[54:55], v17 offset:53120
s_waitcnt vmcnt(7) lgkmcnt(10)
v_mfma_f32_32x32x16_bf16 v[60:75], a[68:71], a[40:43], v[60:75]
ds_read_b64_tr_b16 a[56:57], v17 offset:55296
ds_read_b64_tr_b16 a[58:59], v17 offset:56064
s_waitcnt lgkmcnt(10)
v_mfma_f32_32x32x16_bf16 v[76:91], a[72:75], a[40:43], v[76:91]
ds_read_b64_tr_b16 a[60:61], v17 offset:55360
ds_read_b64_tr_b16 a[62:63], v17 offset:56128
s_waitcnt lgkmcnt(10)
v_mfma_f32_32x32x16_bf16 v[92:107], a[76:79], a[40:43], v[92:107]
ds_read_b64_tr_b16 a[64:65], v17 offset:55424
ds_read_b64_tr_b16 a[66:67], v17 offset:56192
s_waitcnt vmcnt(6) lgkmcnt(10)
v_mfma_f32_32x32x16_bf16 v[60:75], a[44:47], a[0:3], v[60:75]
ds_read_b64_tr_b16 a[68:69], v17 offset:58368
ds_read_b64_tr_b16 a[70:71], v17 offset:59136
s_waitcnt lgkmcnt(10)
v_mfma_f32_32x32x16_bf16 v[76:91], a[48:51], a[0:3], v[76:91]
ds_read_b64_tr_b16 a[72:73], v17 offset:58432
ds_read_b64_tr_b16 a[74:75], v17 offset:59200
s_waitcnt lgkmcnt(10)
v_mfma_f32_32x32x16_bf16 v[92:107], a[52:55], a[0:3], v[92:107]
ds_read_b64_tr_b16 a[76:77], v17 offset:58496
ds_read_b64_tr_b16 a[78:79], v17 offset:59264
v_mov_b32 v9, 19
ds_write_b32 v10, v9
s_waitcnt vmcnt(5) lgkmcnt(11)
v_mfma_f32_32x32x16_bf16 v[60:75], a[56:59], a[4:7], v[60:75]
ds_read_b64_tr_b16 a[44:45], v17 offset:61440
ds_read_b64_tr_b16 a[46:47], v17 offset:62208
s_waitcnt lgkmcnt(11)
v_mfma_f32_32x32x16_bf16 v[76:91], a[60:63], a[4:7], v[76:91]
ds_read_b64_tr_b16 a[48:49], v17 offset:61504
ds_read_b64_tr_b16 a[50:51], v17 offset:62272
s_waitcnt lgkmcnt(11)
v_mfma_f32_32x32x16_bf16 v[92:107], a[64:67], a[4:7], v[92:107]
ds_read_b64_tr_b16 a[52:53], v17 offset:61568
ds_read_b64_tr_b16 a[54:55], v17 offset:62336
ds_read_b32 v6, v3 offset:56
s_waitcnt lgkmcnt(0)
v_cmp_gt_u32 vcc, 2, v6
s_nop 0
s_cbranch_vccnz W95
B96:
s_waitcnt vmcnt(4)
v_mfma_f32_32x32x16_bf16 v[60:75], a[68:71], a[8:11], v[60:75]
buffer_load_dwordx4 a[28:31], v13, s[36:39], s77 offen offset:0 sc1
v_mfma_f32_32x32x16_bf16 v[76:91], a[72:75], a[8:11], v[76:91]
buffer_load_dwordx4 a[32:35], v14, s[36:39], s77 offen offset:0 sc1
v_mfma_f32_32x32x16_bf16 v[92:107], a[76:79], a[8:11], v[92:107]
buffer_load_dwordx4 a[36:39], v13, s[36:39], s77 offen offset:1024 sc1
s_waitcnt vmcnt(6)
v_mfma_f32_32x32x16_bf16 v[60:75], a[44:47], a[12:15], v[60:75]
buffer_load_dwordx4 a[40:43], v14, s[36:39], s77 offen offset:1024 sc1
ds_read_b64_tr_b16 a[56:57], v17 offset:64512
ds_read_b64_tr_b16 a[58:59], v17 offset:65280
v_mfma_f32_32x32x16_bf16 v[76:91], a[48:51], a[12:15], v[76:91]
buffer_load_dwordx4 a[0:3], v13, s[36:39], s77 offen offset:2048 sc1
ds_read_b64_tr_b16 a[60:61], v17 offset:64576
ds_read_b64_tr_b16 a[62:63], v17 offset:65344
v_mfma_f32_32x32x16_bf16 v[92:107], a[52:55], a[12:15], v[92:107]
buffer_load_dwordx4 a[4:7], v14, s[36:39], s77 offen offset:2048 sc1
ds_read_b64_tr_b16 a[64:65], v17 offset:64640
ds_read_b64_tr_b16 a[66:67], v17 offset:65408
v_mfma_f32_32x32x16_bf16 v[60:75], v[48:51], v[108:111], v[60:75]
ds_read_b64_tr_b16 a[68:69], v18 offset:2048
ds_read_b64_tr_b16 a[70:71], v18 offset:2816
v_mfma_f32_32x32x16_bf16 v[76:91], v[52:55], v[108:111], v[76:91]
ds_read_b64_tr_b16 a[72:73], v18 offset:2112
ds_read_b64_tr_b16 a[74:75], v18 offset:2880
v_mfma_f32_32x32x16_bf16 v[92:107], v[56:59], v[108:111], v[92:107]
ds_read_b64_tr_b16 a[76:77], v18 offset:2176
ds_read_b64_tr_b16 a[78:79], v18 offset:2944
s_waitcnt vmcnt(8) lgkmcnt(10)
v_mfma_f32_32x32x16_bf16 v[60:75], a[56:59], a[16:19], v[60:75]
buffer_load_dwordx4 a[8:11], v13, s[36:39], s77 offen offset:3072 sc1
ds_read_b64_tr_b16 a[44:45], v18 offset:5120
ds_read_b64_tr_b16 a[46:47], v18 offset:5888
s_waitcnt lgkmcnt(10)
v_mfma_f32_32x32x16_bf16 v[76:91], a[60:63], a[16:19], v[76:91]
buffer_load_dwordx4 a[12:15], v14, s[36:39], s77 offen offset:3072 sc1
s_add_u32 s77, s77, 4096
ds_read_b64_tr_b16 a[48:49], v18 offset:5184
ds_read_b64_tr_b16 a[50:51], v18 offset:5952
s_waitcnt lgkmcnt(10)
v_mfma_f32_32x32x16_bf16 v[92:107], a[64:67], a[16:19], v[92:107]
ds_read_b64_tr_b16 a[52:53], v18 offset:5248
ds_read_b64_tr_b16 a[54:55], v18 offset:6016
v_mov_b32 v9, 20
ds_write_b32 v10, v9
s_waitcnt vmcnt(9) lgkmcnt(11)
v_mfma_f32_32x32x16_bf16 v[60:75], a[68:71], a[20:23], v[60:75]
buffer_load_dwordx4 a[16:19], v13, s[36:39], s77 offen offset:0 sc1
s_waitcnt lgkmcnt(9)
v_mfma_f32_32x32x16_bf16 v[76:91], a[72:75], a[20:23], v[76:91]
s_waitcnt lgkmcnt(7)
v_mfma_f32_32x32x16_bf16 v[92:107], a[76:79], a[20:23], v[92:107]
s_waitcnt vmcnt(9) lgkmcnt(5)
v_mfma_f32_32x32x16_bf16 v[60:75], a[44:47], a[24:27], v[60:75]
buffer_load_dwordx4 a[20:23], v14, s[36:39], s77 offen offset:0 sc1
s_waitcnt lgkmcnt(3)
v_mfma_f32_32x32x16_bf16 v[76:91], a[48:51], a[24:27], v[76:91]
s_waitcnt lgkmcnt(1)
v_mfma_f32_32x32x16_bf16 v[92:107], a[52:55], a[24:27], v[92:107]
s_nop 6
v_pk_mul_f32 v[16:17], v[60:61], v[60:61]
v_pk_mul_f32 v[18:19], v[62:63], v[62:63]
v_pk_mul_f32 v[32:33], v[64:65], v[64:65]
v_pk_mul_f32 v[34:35], v[66:67], v[66:67]
v_pk_fma_f32 v[16:17], v[16:17], v[28:29], v[26:27] op_sel_hi:[1,0,0]
v_pk_fma_f32 v[18:19], v[18:19], v[28:29], v[26:27] op_sel_hi:[1,0,0]
v_pk_fma_f32 v[32:33], v[32:33], v[28:29], v[26:27] op_sel_hi:[1,0,0]
v_pk_fma_f32 v[34:35], v[34:35], v[28:29], v[26:27] op_sel_hi:[1,0,0]
v_pk_mul_f32 v[16:17], v[16:17], v[60:61]
v_pk_mul_f32 v[18:19], v[18:19], v[62:63]
v_pk_mul_f32 v[32:33], v[32:33], v[64:65]
v_pk_mul_f32 v[34:35], v[34:35], v[66:67]
v_exp_f32 v16, v16
v_exp_f32 v17, v17
v_exp_f32 v18, v18
v_exp_f32 v19, v19
v_exp_f32 v32, v32
v_exp_f32 v33, v33
v_exp_f32 v34, v34
v_exp_f32 v35, v35
v_pk_fma_f32 v[16:17], v[16:17], v[112:113], v[112:113] op_sel_hi:[1,0,0]
v_pk_fma_f32 v[18:19], v[18:19], v[112:113], v[112:113] op_sel_hi:[1,0,0]
v_pk_fma_f32 v[32:33], v[32:33], v[112:113], v[112:113] op_sel_hi:[1,0,0]
v_pk_fma_f32 v[34:35], v[34:35], v[112:113], v[112:113] op_sel_hi:[1,0,0]
v_rcp_f32 v16, v16
v_rcp_f32 v17, v17
v_rcp_f32 v18, v18
v_rcp_f32 v19, v19
v_rcp_f32 v32, v32
v_rcp_f32 v33, v33
v_rcp_f32 v34, v34
v_rcp_f32 v35, v35
v_pk_mul_f32 v[60:61], v[60:61], v[16:17]
v_pk_mul_f32 v[62:63], v[62:63], v[18:19]
v_pk_mul_f32 v[64:65], v[64:65], v[32:33]
v_pk_mul_f32 v[66:67], v[66:67], v[34:35]
v_cvt_pk_bf16_f32 v36, v60, v61
v_cvt_pk_bf16_f32 v38, v64, v65
v_cvt_pk_bf16_f32 v37, v62, v63
v_cvt_pk_bf16_f32 v39, v66, v67
v_permlane32_swap_b32 v36, v38
s_nop 0
v_permlane32_swap_b32 v37, v39
buffer_store_dwordx4 v[36:39], v24, s[36:39], s70 offen offset:0 sc1
v_pk_mul_f32 v[16:17], v[68:69], v[68:69]
v_pk_mul_f32 v[18:19], v[70:71], v[70:71]
v_pk_mul_f32 v[32:33], v[72:73], v[72:73]
v_pk_mul_f32 v[34:35], v[74:75], v[74:75]
v_pk_fma_f32 v[16:17], v[16:17], v[28:29], v[26:27] op_sel_hi:[1,0,0]
v_pk_fma_f32 v[18:19], v[18:19], v[28:29], v[26:27] op_sel_hi:[1,0,0]
v_pk_fma_f32 v[32:33], v[32:33], v[28:29], v[26:27] op_sel_hi:[1,0,0]
v_pk_fma_f32 v[34:35], v[34:35], v[28:29], v[26:27] op_sel_hi:[1,0,0]
v_pk_mul_f32 v[16:17], v[16:17], v[68:69]
v_pk_mul_f32 v[18:19], v[18:19], v[70:71]
v_pk_mul_f32 v[32:33], v[32:33], v[72:73]
v_pk_mul_f32 v[34:35], v[34:35], v[74:75]
v_exp_f32 v16, v16
v_exp_f32 v17, v17
v_exp_f32 v18, v18
v_exp_f32 v19, v19
v_exp_f32 v32, v32
v_exp_f32 v33, v33
v_exp_f32 v34, v34
v_exp_f32 v35, v35
v_pk_fma_f32 v[16:17], v[16:17], v[112:113], v[112:113] op_sel_hi:[1,0,0]
v_pk_fma_f32 v[18:19], v[18:19], v[112:113], v[112:113] op_sel_hi:[1,0,0]
v_pk_fma_f32 v[32:33], v[32:33], v[112:113], v[112:113] op_sel_hi:[1,0,0]
v_pk_fma_f32 v[34:35], v[34:35], v[112:113], v[112:113] op_sel_hi:[1,0,0]
v_rcp_f32 v16, v16
v_rcp_f32 v17, v17
v_rcp_f32 v18, v18
v_rcp_f32 v19, v19
v_rcp_f32 v32, v32
v_rcp_f32 v33, v33
v_rcp_f32 v34, v34
v_rcp_f32 v35, v35
v_pk_mul_f32 v[68:69], v[68:69], v[16:17]
v_pk_mul_f32 v[70:71], v[70:71], v[18:19]
v_pk_mul_f32 v[72:73], v[72:73], v[32:33]
v_pk_mul_f32 v[74:75], v[74:75], v[34:35]
v_cvt_pk_bf16_f32 v40, v68, v69
v_cvt_pk_bf16_f32 v42, v72, v73
v_cvt_pk_bf16_f32 v41, v70, v71
v_cvt_pk_bf16_f32 v43, v74, v75
v_permlane32_swap_b32 v40, v42
s_nop 0
v_permlane32_swap_b32 v41, v43
buffer_store_dwordx4 v[40:43], v24, s[36:39], s70 offen offset:512 sc1
v_pk_mul_f32 v[16:17], v[76:77], v[76:77]
v_pk_mul_f32 v[18:19], v[78:79], v[78:79]
v_pk_mul_f32 v[32:33], v[80:81], v[80:81]
v_pk_mul_f32 v[34:35], v[82:83], v[82:83]
v_pk_fma_f32 v[16:17], v[16:17], v[28:29], v[26:27] op_sel_hi:[1,0,0]
v_pk_fma_f32 v[18:19], v[18:19], v[28:29], v[26:27] op_sel_hi:[1,0,0]
v_pk_fma_f32 v[32:33], v[32:33], v[28:29], v[26:27] op_sel_hi:[1,0,0]
v_pk_fma_f32 v[34:35], v[34:35], v[28:29], v[26:27] op_sel_hi:[1,0,0]
v_pk_mul_f32 v[16:17], v[16:17], v[76:77]
v_pk_mul_f32 v[18:19], v[18:19], v[78:79]
v_pk_mul_f32 v[32:33], v[32:33], v[80:81]
v_pk_mul_f32 v[34:35], v[34:35], v[82:83]
v_exp_f32 v16, v16
v_exp_f32 v17, v17
v_exp_f32 v18, v18
v_exp_f32 v19, v19
v_exp_f32 v32, v32
v_exp_f32 v33, v33
v_exp_f32 v34, v34
v_exp_f32 v35, v35
v_pk_fma_f32 v[16:17], v[16:17], v[112:113], v[112:113] op_sel_hi:[1,0,0]
v_pk_fma_f32 v[18:19], v[18:19], v[112:113], v[112:113] op_sel_hi:[1,0,0]
v_pk_fma_f32 v[32:33], v[32:33], v[112:113], v[112:113] op_sel_hi:[1,0,0]
v_pk_fma_f32 v[34:35], v[34:35], v[112:113], v[112:113] op_sel_hi:[1,0,0]
v_rcp_f32 v16, v16
v_rcp_f32 v17, v17
v_rcp_f32 v18, v18
v_rcp_f32 v19, v19
v_rcp_f32 v32, v32
v_rcp_f32 v33, v33
v_rcp_f32 v34, v34
v_rcp_f32 v35, v35
v_pk_mul_f32 v[76:77], v[76:77], v[16:17]
v_pk_mul_f32 v[78:79], v[78:79], v[18:19]
v_pk_mul_f32 v[80:81], v[80:81], v[32:33]
v_pk_mul_f32 v[82:83], v[82:83], v[34:35]
v_cvt_pk_bf16_f32 v36, v76, v77
v_cvt_pk_bf16_f32 v38, v80, v81
v_cvt_pk_bf16_f32 v37, v78, v79
v_cvt_pk_bf16_f32 v39, v82, v83
v_permlane32_swap_b32 v36, v38
s_nop 0
v_permlane32_swap_b32 v37, v39
buffer_store_dwordx4 v[36:39], v24, s[36:39], s70 offen offset:1024 sc1
v_pk_mul_f32 v[16:17], v[84:85], v[84:85]
v_pk_mul_f32 v[18:19], v[86:87], v[86:87]
v_pk_mul_f32 v[32:33], v[88:89], v[88:89]
v_pk_mul_f32 v[34:35], v[90:91], v[90:91]
v_pk_fma_f32 v[16:17], v[16:17], v[28:29], v[26:27] op_sel_hi:[1,0,0]
v_pk_fma_f32 v[18:19], v[18:19], v[28:29], v[26:27] op_sel_hi:[1,0,0]
v_pk_fma_f32 v[32:33], v[32:33], v[28:29], v[26:27] op_sel_hi:[1,0,0]
v_pk_fma_f32 v[34:35], v[34:35], v[28:29], v[26:27] op_sel_hi:[1,0,0]
v_pk_mul_f32 v[16:17], v[16:17], v[84:85]
v_pk_mul_f32 v[18:19], v[18:19], v[86:87]
v_pk_mul_f32 v[32:33], v[32:33], v[88:89]
v_pk_mul_f32 v[34:35], v[34:35], v[90:91]
v_exp_f32 v16, v16
v_exp_f32 v17, v17
v_exp_f32 v18, v18
v_exp_f32 v19, v19
v_exp_f32 v32, v32
v_exp_f32 v33, v33
v_exp_f32 v34, v34
v_exp_f32 v35, v35
v_pk_fma_f32 v[16:17], v[16:17], v[112:113], v[112:113] op_sel_hi:[1,0,0]
v_pk_fma_f32 v[18:19], v[18:19], v[112:113], v[112:113] op_sel_hi:[1,0,0]
v_pk_fma_f32 v[32:33], v[32:33], v[112:113], v[112:113] op_sel_hi:[1,0,0]
v_pk_fma_f32 v[34:35], v[34:35], v[112:113], v[112:113] op_sel_hi:[1,0,0]
v_rcp_f32 v16, v16
v_rcp_f32 v17, v17
v_rcp_f32 v18, v18
v_rcp_f32 v19, v19
v_rcp_f32 v32, v32
v_rcp_f32 v33, v33
v_rcp_f32 v34, v34
v_rcp_f32 v35, v35
v_pk_mul_f32 v[84:85], v[84:85], v[16:17]
v_pk_mul_f32 v[86:87], v[86:87], v[18:19]
v_pk_mul_f32 v[88:89], v[88:89], v[32:33]
v_pk_mul_f32 v[90:91], v[90:91], v[34:35]
v_cvt_pk_bf16_f32 v40, v84, v85
v_cvt_pk_bf16_f32 v42, v88, v89
v_cvt_pk_bf16_f32 v41, v86, v87
v_cvt_pk_bf16_f32 v43, v90, v91
v_permlane32_swap_b32 v40, v42
s_nop 0
v_permlane32_swap_b32 v41, v43
buffer_store_dwordx4 v[40:43], v24, s[36:39], s70 offen offset:1536 sc1
v_pk_mul_f32 v[16:17], v[92:93], v[92:93]
v_pk_mul_f32 v[18:19], v[94:95], v[94:95]
v_pk_mul_f32 v[32:33], v[96:97], v[96:97]
v_pk_mul_f32 v[34:35], v[98:99], v[98:99]
v_pk_fma_f32 v[16:17], v[16:17], v[28:29], v[26:27] op_sel_hi:[1,0,0]
v_pk_fma_f32 v[18:19], v[18:19], v[28:29], v[26:27] op_sel_hi:[1,0,0]
v_pk_fma_f32 v[32:33], v[32:33], v[28:29], v[26:27] op_sel_hi:[1,0,0]
v_pk_fma_f32 v[34:35], v[34:35], v[28:29], v[26:27] op_sel_hi:[1,0,0]
v_pk_mul_f32 v[16:17], v[16:17], v[92:93]
v_pk_mul_f32 v[18:19], v[18:19], v[94:95]
v_pk_mul_f32 v[32:33], v[32:33], v[96:97]
v_pk_mul_f32 v[34:35], v[34:35], v[98:99]
v_exp_f32 v16, v16
v_exp_f32 v17, v17
v_exp_f32 v18, v18
v_exp_f32 v19, v19
v_exp_f32 v32, v32
v_exp_f32 v33, v33
v_exp_f32 v34, v34
v_exp_f32 v35, v35
v_pk_fma_f32 v[16:17], v[16:17], v[112:113], v[112:113] op_sel_hi:[1,0,0]
v_pk_fma_f32 v[18:19], v[18:19], v[112:113], v[112:113] op_sel_hi:[1,0,0]
v_pk_fma_f32 v[32:33], v[32:33], v[112:113], v[112:113] op_sel_hi:[1,0,0]
v_pk_fma_f32 v[34:35], v[34:35], v[112:113], v[112:113] op_sel_hi:[1,0,0]
v_rcp_f32 v16, v16
v_rcp_f32 v17, v17
v_rcp_f32 v18, v18
v_rcp_f32 v19, v19
v_rcp_f32 v32, v32
v_rcp_f32 v33, v33
v_rcp_f32 v34, v34
v_rcp_f32 v35, v35
v_pk_mul_f32 v[92:93], v[92:93], v[16:17]
v_pk_mul_f32 v[94:95], v[94:95], v[18:19]
v_pk_mul_f32 v[96:97], v[96:97], v[32:33]
v_pk_mul_f32 v[98:99], v[98:99], v[34:35]
v_cvt_pk_bf16_f32 v36, v92, v93
v_cvt_pk_bf16_f32 v38, v96, v97
v_cvt_pk_bf16_f32 v37, v94, v95
v_cvt_pk_bf16_f32 v39, v98, v99
v_permlane32_swap_b32 v36, v38
s_nop 0
v_permlane32_swap_b32 v37, v39
buffer_store_dwordx4 v[36:39], v24, s[36:39], s70 offen offset:2048 sc1
v_pk_mul_f32 v[16:17], v[100:101], v[100:101]
v_pk_mul_f32 v[18:19], v[102:103], v[102:103]
v_pk_mul_f32 v[32:33], v[104:105], v[104:105]
v_pk_mul_f32 v[34:35], v[106:107], v[106:107]
v_pk_fma_f32 v[16:17], v[16:17], v[28:29], v[26:27] op_sel_hi:[1,0,0]
v_pk_fma_f32 v[18:19], v[18:19], v[28:29], v[26:27] op_sel_hi:[1,0,0]
v_pk_fma_f32 v[32:33], v[32:33], v[28:29], v[26:27] op_sel_hi:[1,0,0]
v_pk_fma_f32 v[34:35], v[34:35], v[28:29], v[26:27] op_sel_hi:[1,0,0]
v_pk_mul_f32 v[16:17], v[16:17], v[100:101]
v_pk_mul_f32 v[18:19], v[18:19], v[102:103]
v_pk_mul_f32 v[32:33], v[32:33], v[104:105]
v_pk_mul_f32 v[34:35], v[34:35], v[106:107]
v_exp_f32 v16, v16
v_exp_f32 v17, v17
v_exp_f32 v18, v18
v_exp_f32 v19, v19
v_exp_f32 v32, v32
v_exp_f32 v33, v33
v_exp_f32 v34, v34
v_exp_f32 v35, v35
v_pk_fma_f32 v[16:17], v[16:17], v[112:113], v[112:113] op_sel_hi:[1,0,0]
v_pk_fma_f32 v[18:19], v[18:19], v[112:113], v[112:113] op_sel_hi:[1,0,0]
v_pk_fma_f32 v[32:33], v[32:33], v[112:113], v[112:113] op_sel_hi:[1,0,0]
v_pk_fma_f32 v[34:35], v[34:35], v[112:113], v[112:113] op_sel_hi:[1,0,0]
v_rcp_f32 v16, v16
v_rcp_f32 v17, v17
v_rcp_f32 v18, v18
v_rcp_f32 v19, v19
v_rcp_f32 v32, v32
v_rcp_f32 v33, v33
v_rcp_f32 v34, v34
v_rcp_f32 v35, v35
v_pk_mul_f32 v[100:101], v[100:101], v[16:17]
v_pk_mul_f32 v[102:103], v[102:103], v[18:19]
v_pk_mul_f32 v[104:105], v[104:105], v[32:33]
v_pk_mul_f32 v[106:107], v[106:107], v[34:35]
v_cvt_pk_bf16_f32 v40, v100, v101
v_cvt_pk_bf16_f32 v42, v104, v105
v_cvt_pk_bf16_f32 v41, v102, v103
v_cvt_pk_bf16_f32 v43, v106, v107
v_permlane32_swap_b32 v40, v42
s_nop 0
v_permlane32_swap_b32 v41, v43
buffer_store_dwordx4 v[40:43], v24, s[36:39], s70 offen offset:2560 sc1
v_mov_b32 v9, 21
ds_write_b32 v10, v9
s_and_b32 s49, s60, 3
s_mul_i32 s49, s49, 3
s_lshr_b32 s49, s49, 1
s_mul_i32 s73, s49, 4096
s_add_u32 s73, s73, 12582912
s_mov_b32 s71, s73
s_lshl_b32 s76, s57, 3
s_lshl_b32 s76, 0xff, s76
s_movk_i32 s79, 4096
s_and_b32 s48, s60, 3
s_lshl_b32 s48, s48, 3
s_lshr_b32 s80, 3765440007, s48
s_and_b32 s80, s80, 0xff
s_lshl_b32 s48, s57, 3
s_lshl_b32 s80, s80, s48
ds_read_b64 v[6:7], v3 offset:0
s_waitcnt lgkmcnt(0)
v_min_u32 v6, v6, v7
v_cmp_gt_u32 vcc, 34, v6
s_nop 0
s_cbranch_vccnz W99
B98:
ds_read_b64 v[48:49], v115 offset:0
ds_read_b64 v[50:51], v115 offset:512
ds_read_b64 v[52:53], v115 offset:1024
ds_read_b64 v[54:55], v115 offset:1536
ds_read_b64 v[56:57], v115 offset:2048
ds_read_b64 v[58:59], v115 offset:2560
ds_read_b64 v[60:61], v115 offset:3072
ds_read_b64 v[62:63], v115 offset:3584
ds_read_b64 v[64:65], v115 offset:4096
ds_read_b64 v[66:67], v115 offset:4608
ds_read_b64 v[68:69], v115 offset:5120
ds_read_b64 v[70:71], v115 offset:5632
ds_read_b64 v[72:73], v115 offset:6144
ds_read_b64 v[74:75], v115 offset:6656
ds_read_b64 v[76:77], v115 offset:7168
ds_read_b64 v[78:79], v115 offset:7680
s_waitcnt vmcnt(14) lgkmcnt(12)
v_mfma_f32_16x16x32_bf16 v[148:151], v[48:51], a[28:31], v[148:151]
buffer_load_dwordx4 a[24:27], v13, s[36:39], s77 offen offset:1024 sc1
v_mfma_f32_16x16x32_bf16 v[16:19], v[48:51], a[32:35], 0
ds_read_b64 v[80:81], v115 offset:8192
v_mfma_f32_16x16x32_bf16 v[152:155], v[52:55], a[28:31], v[152:155]
ds_read_b64 v[82:83], v115 offset:8704
v_mfma_f32_16x16x32_bf16 v[32:35], v[52:55], a[32:35], 0
ds_read_b64 v[84:85], v115 offset:9216
s_waitcnt lgkmcnt(9)
v_mfma_f32_16x16x32_bf16 v[156:159], v[56:59], a[28:31], v[156:159]
buffer_load_dwordx4 a[44:47], v14, s[36:39], s77 offen offset:1024 sc1
ds_read_b64 v[86:87], v115 offset:9728
v_mfma_f32_16x16x32_bf16 v[36:39], v[56:59], a[32:35], 0
ds_read_b64 v[88:89], v115 offset:10240
v_mfma_f32_16x16x32_bf16 v[160:163], v[60:63], a[28:31], v[160:163]
ds_read_b64 v[90:91], v115 offset:10752
v_mfma_f32_16x16x32_bf16 v[40:43], v[60:63], a[32:35], 0
ds_read_b64 v[92:93], v115 offset:11264
v_mfma_f32_16x16x32_bf16 v[164:167], v[64:67], a[28:31], v[164:167]
ds_read_b64 v[94:95], v115 offset:11776
v_mfma_f32_16x16x32_bf16 v[44:47], v[64:67], a[32:35], 0
ds_read_b64 v[96:97], v115 offset:12288
s_waitcnt vmcnt(14) lgkmcnt(11)
v_mfma_f32_16x16x32_bf16 v[148:151], v[68:71], a[36:39], v[148:151]
buffer_load_dwordx4 a[48:51], v13, s[36:39], s77 offen offset:2048 sc1
ds_read_b64 v[98:99], v115 offset:12800
v_mfma_f32_16x16x32_bf16 v[16:19], v[68:71], a[40:43], v[16:19]
ds_read_b64 v[100:101], v115 offset:13312
v_mfma_f32_16x16x32_bf16 v[152:155], v[72:75], a[36:39], v[152:155]
ds_read_b64 v[102:103], v115 offset:13824
v_mfma_f32_16x16x32_bf16 v[32:35], v[72:75], a[40:43], v[32:35]
ds_read_b64 v[104:105], v115 offset:14336
s_waitcnt lgkmcnt(9)
v_mfma_f32_16x16x32_bf16 v[156:159], v[76:79], a[36:39], v[156:159]
buffer_load_dwordx4 a[52:55], v14, s[36:39], s77 offen offset:2048 sc1
ds_read_b64 v[106:107], v115 offset:14848
v_mfma_f32_16x16x32_bf16 v[36:39], v[76:79], a[40:43], v[36:39]
ds_read_b64 v[48:49], v115 offset:15360
v_mfma_f32_16x16x32_bf16 v[160:163], v[80:83], a[36:39], v[160:163]
ds_read_b64 v[50:51], v115 offset:15872
v_mfma_f32_16x16x32_bf16 v[40:43], v[80:83], a[40:43], v[40:43]
ds_read_b64 v[52:53], v115 offset:16384
v_mfma_f32_16x16x32_bf16 v[164:167], v[84:87], a[36:39], v[164:167]
ds_read_b64 v[54:55], v115 offset:16896
v_mfma_f32_16x16x32_bf16 v[44:47], v[84:87], a[40:43], v[44:47]
ds_read_b64 v[56:57], v115 offset:17408
s_waitcnt vmcnt(14) lgkmcnt(11)
v_mfma_f32_16x16x32_bf16 v[148:151], v[88:91], a[0:3], v[148:151]
buffer_load_dwordx4 a[56:59], v13, s[36:39], s77 offen offset:3072 sc1
ds_read_b64 v[58:59], v115 offset:17920
ds_read_b64 v[6:7], v3
v_mfma_f32_16x16x32_bf16 v[16:19], v[88:91], a[4:7], v[16:19]
ds_read_b64 v[60:61], v115 offset:18432
v_mfma_f32_16x16x32_bf16 v[152:155], v[92:95], a[0:3], v[152:155]
ds_read_b64 v[62:63], v115 offset:18944
v_mfma_f32_16x16x32_bf16 v[32:35], v[92:95], a[4:7], v[32:35]
ds_read_b64 v[64:65], v115 offset:19456
s_waitcnt vmcnt(5)
buffer_atomic_or v8, v5, s[36:39], s64 offen sc1
s_waitcnt lgkmcnt(10)
v_mfma_f32_16x16x32_bf16 v[156:159], v[96:99], a[0:3], v[156:159]
buffer_load_dwordx4 a[60:63], v14, s[36:39], s77 offen offset:3072 sc1
ds_read_b64 v[66:67], v115 offset:19968
v_mov_b32 v9, 22
ds_write_b32 v10, v9
v_mfma_f32_16x16x32_bf16 v[36:39], v[96:99], a[4:7], v[36:39]
s_waitcnt lgkmcnt(5)
v_min_u32 v6, v6, v7
v_cmp_gt_u32 vcc, 37, v6
s_nop 0
s_cbranch_vccnz W100
B101:
ds_read_b64 v[68:69], v115 offset:20480
v_mfma_f32_16x16x32_bf16 v[160:163], v[100:103], a[0:3], v[160:163]
ds_read_b64 v[70:71], v115 offset:20992
v_mfma_f32_16x16x32_bf16 v[40:43], v[100:103], a[4:7], v[40:43]
ds_read_b64 v[72:73], v115 offset:21504
v_mfma_f32_16x16x32_bf16 v[164:167], v[104:107], a[0:3], v[164:167]
s_add_u32 s77, s77, 4096
ds_read_b64 v[74:75], v115 offset:22016
v_mfma_f32_16x16x32_bf16 v[44:47], v[104:107], a[4:7], v[44:47]
ds_read_b64 v[76:77], v115 offset:22528
v_mfma_f32_16x16x32_bf16 v[148:151], v[48:51], a[8:11], v[148:151]
buffer_load_dwordx4 a[64:67], v13, s[36:39], s77 offen offset:0 sc1
ds_read_b64 v[78:79], v115 offset:23040
v_mfma_f32_16x16x32_bf16 v[16:19], v[48:51], a[12:15], v[16:19]
ds_read_b64 v[80:81], v115 offset:23552
v_mfma_f32_16x16x32_bf16 v[152:155], v[52:55], a[8:11], v[152:155]
ds_read_b64 v[82:83], v115 offset:24064
v_mfma_f32_16x16x32_bf16 v[32:35], v[52:55], a[12:15], v[32:35]
ds_read_b64 v[84:85], v115 offset:24576
s_waitcnt lgkmcnt(10)
v_mfma_f32_16x16x32_bf16 v[156:159], v[56:59], a[8:11], v[156:159]
buffer_load_dwordx4 a[68:71], v14, s[36:39], s77 offen offset:0 sc1
ds_read_b64 v[86:87], v115 offset:25088
v_mfma_f32_16x16x32_bf16 v[36:39], v[56:59], a[12:15], v[36:39]
ds_read_b64 v[88:89], v115 offset:25600
v_mfma_f32_16x16x32_bf16 v[160:163], v[60:63], a[8:11], v[160:163]
ds_read_b64 v[90:91], v115 offset:26112
v_mfma_f32_16x16x32_bf16 v[40:43], v[60:63], a[12:15], v[40:43]
ds_read_b64 v[92:93], v115 offset:26624
v_mfma_f32_16x16x32_bf16 v[164:167], v[64:67], a[8:11], v[164:167]
ds_read_b64 v[94:95], v115 offset:27136
v_mfma_f32_16x16x32_bf16 v[44:47], v[64:67], a[12:15], v[44:47]
ds_read_b64 v[96:97], v115 offset:27648
s_waitcnt lgkmcnt(11)
v_mfma_f32_16x16x32_bf16 v[148:151], v[68:71], a[16:19], v[148:151]
buffer_load_dwordx4 a[72:75], v13, s[36:39], s77 offen offset:1024 sc1
ds_read_b64 v[98:99], v115 offset:28160
v_mfma_f32_16x16x32_bf16 v[16:19], v[68:71], a[20:23], v[16:19]
ds_read_b64 v[100:101], v115 offset:28672
v_mfma_f32_16x16x32_bf16 v[152:155], v[72:75], a[16:19], v[152:155]
ds_read_b64 v[102:103], v115 offset:29184
v_mfma_f32_16x16x32_bf16 v[32:35], v[72:75], a[20:23], v[32:35]
ds_read_b64 v[104:105], v115 offset:29696
s_waitcnt lgkmcnt(9)
v_mfma_f32_16x16x32_bf16 v[156:159], v[76:79], a[16:19], v[156:159]
buffer_load_dwordx4 a[76:79], v14, s[36:39], s77 offen offset:1024 sc1
ds_read_b64 v[106:107], v115 offset:30208
s_xor_b32 s72, s67, 8
s_lshl_b32 s72, s72, 7
s_add_u32 s72, s72, 45056
s_mov_b64 s[74:75], 0
s_atomic_add_x2 s[74:75], s[36:37], s72 glc
v_mfma_f32_16x16x32_bf16 v[36:39], v[76:79], a[20:23], v[36:39]
ds_read_b64 v[48:49], v115 offset:30720
v_mfma_f32_16x16x32_bf16 v[160:163], v[80:83], a[16:19], v[160:163]
ds_read_b64 v[50:51], v115 offset:31232
v_mfma_f32_16x16x32_bf16 v[40:43], v[80:83], a[20:23], v[40:43]
ds_read_b64 v[52:53], v115 offset:31744
v_mfma_f32_16x16x32_bf16 v[164:167], v[84:87], a[16:19], v[164:167]
ds_read_b64 v[54:55], v115 offset:32256
v_mfma_f32_16x16x32_bf16 v[44:47], v[84:87], a[20:23], v[44:47]
ds_read_b64 v[56:57], v115 offset:32768
s_waitcnt vmcnt(9) lgkmcnt(11)
v_mfma_f32_16x16x32_bf16 v[148:151], v[88:91], a[24:27], v[148:151]
ds_read_b64 v[58:59], v115 offset:33280
v_mfma_f32_16x16x32_bf16 v[16:19], v[88:91], a[44:47], v[16:19]
ds_read_b64 v[60:61], v115 offset:33792
v_mfma_f32_16x16x32_bf16 v[152:155], v[92:95], a[24:27], v[152:155]
ds_read_b64 v[62:63], v115 offset:34304
v_mfma_f32_16x16x32_bf16 v[32:35], v[92:95], a[44:47], v[32:35]
ds_read_b64 v[64:65], v115 offset:34816
s_waitcnt lgkmcnt(9)
v_mfma_f32_16x16x32_bf16 v[156:159], v[96:99], a[24:27], v[156:159]
ds_read_b64 v[66:67], v115 offset:35328
v_mfma_f32_16x16x32_bf16 v[36:39], v[96:99], a[44:47], v[36:39]
ds_read_b64 v[68:69], v115 offset:35840
v_mfma_f32_16x16x32_bf16 v[160:163], v[100:103], a[24:27], v[160:163]
ds_read_b64 v[70:71], v115 offset:36352
v_mfma_f32_16x16x32_bf16 v[40:43], v[100:103], a[44:47], v[40:43]
ds_read_b64 v[72:73], v115 offset:36864
v_mfma_f32_16x16x32_bf16 v[164:167], v[104:107], a[24:27], v[164:167]
ds_read_b64 v[74:75], v115 offset:37376
v_mfma_f32_16x16x32_bf16 v[44:47], v[104:107], a[44:47], v[44:47]
ds_read_b64 v[76:77], v115 offset:37888
s_waitcnt vmcnt(7) lgkmcnt(11)
v_mfma_f32_16x16x32_bf16 v[148:151], v[48:51], a[48:51], v[148:151]
ds_read_b64 v[78:79], v115 offset:38400
v_mfma_f32_16x16x32_bf16 v[16:19], v[48:51], a[52:55], v[16:19]
ds_read_b64 v[80:81], v115 offset:38912
v_mfma_f32_16x16x32_bf16 v[152:155], v[52:55], a[48:51], v[152:155]
ds_read_b64 v[82:83], v115 offset:39424
v_mfma_f32_16x16x32_bf16 v[32:35], v[52:55], a[52:55], v[32:35]
ds_read_b64 v[84:85], v115 offset:39936
s_waitcnt lgkmcnt(9)
v_mfma_f32_16x16x32_bf16 v[156:159], v[56:59], a[48:51], v[156:159]
ds_read_b64 v[86:87], v115 offset:40448
v_mov_b32 v9, 23
ds_write_b32 v10, v9
v_mfma_f32_16x16x32_bf16 v[36:39], v[56:59], a[52:55], v[36:39]
ds_read_b64 v[88:89], v115 offset:40960
v_mfma_f32_16x16x32_bf16 v[160:163], v[60:63], a[48:51], v[160:163]
ds_read_b64 v[90:91], v115 offset:41472
v_mfma_f32_16x16x32_bf16 v[40:43], v[60:63], a[52:55], v[40:43]
ds_read_b64 v[92:93], v115 offset:41984
v_mfma_f32_16x16x32_bf16 v[164:167], v[64:67], a[48:51], v[164:167]
ds_read_b64 v[94:95], v115 offset:42496
v_mfma_f32_16x16x32_bf16 v[44:47], v[64:67], a[52:55], v[44:47]
ds_read_b64 v[96:97], v115 offset:43008
s_waitcnt lgkmcnt(0)
s_cmp_lg_u32 s75, s53
s_cbranch_scc1 N102
s_andn2_b32 s74, s80, s74
s_cbranch_scc1 N102
B103:
s_mov_b64 s[74:75], 0
s_atomic_add_x2 s[74:75], s[36:37], s72 glc
s_waitcnt vmcnt(4)
v_mfma_f32_16x16x32_bf16 v[148:151], v[68:71], a[56:59], v[148:151]
ds_read_b64 v[98:99], v115 offset:43520
buffer_load_dwordx4 a[28:31], v22, s[36:39], s73 offen offset:0 sc1
v_mfma_f32_16x16x32_bf16 v[16:19], v[68:71], a[60:63], v[16:19]
ds_read_b64 v[100:101], v115 offset:44032
buffer_load_dwordx4 a[32:35], v22, s[36:39], s73 offen offset:1024 sc1
v_mfma_f32_16x16x32_bf16 v[152:155], v[72:75], a[56:59], v[152:155]
ds_read_b64 v[102:103], v115 offset:44544
buffer_load_dwordx4 a[36:39], v22, s[36:39], s73 offen offset:2048 sc1
v_mfma_f32_16x16x32_bf16 v[32:35], v[72:75], a[60:63], v[32:35]
ds_read_b64 v[104:105], v115 offset:45056
buffer_load_dwordx4 a[40:43], v22, s[36:39], s73 offen offset:3072 sc1
v_mfma_f32_16x16x32_bf16 v[156:159], v[76:79], a[56:59], v[156:159]
ds_read_b64 v[106:107], v115 offset:45568
s_add_u32 s73, s73, 4096
s_cmp_ge_u32 s73, 12607488
s_cmov_b32 s73, 12582912
buffer_load_dwordx4 a[0:3], v22, s[36:39], s73 offen offset:0 sc1
v_mfma_f32_16x16x32_bf16 v[36:39], v[76:79], a[60:63], v[36:39]
ds_read_b64 v[48:49], v115 offset:46080
buffer_load_dwordx4 a[4:7], v22, s[36:39], s73 offen offset:1024 sc1
v_mfma_f32_16x16x32_bf16 v[160:163], v[80:83], a[56:59], v[160:163]
ds_read_b64 v[50:51], v115 offset:46592
buffer_load_dwordx4 a[8:11], v22, s[36:39], s73 offen offset:2048 sc1
v_mfma_f32_16x16x32_bf16 v[40:43], v[80:83], a[60:63], v[40:43]
ds_read_b64 v[52:53], v115 offset:47104
buffer_load_dwordx4 a[12:15], v22, s[36:39], s73 offen offset:3072 sc1
v_mfma_f32_16x16x32_bf16 v[164:167], v[84:87], a[56:59], v[164:167]
ds_read_b64 v[54:55], v115 offset:47616
s_add_u32 s73, s73, 4096
s_cmp_ge_u32 s73, 12607488
s_cmov_b32 s73, 12582912
v_mfma_f32_16x16x32_bf16 v[44:47], v[84:87], a[60:63], v[44:47]
ds_read_b64 v[56:57], v115 offset:48128
s_waitcnt vmcnt(10)
v_mfma_f32_16x16x32_bf16 v[148:151], v[88:91], a[64:67], v[148:151]
ds_read_b64 v[58:59], v115 offset:48640
v_mfma_f32_16x16x32_bf16 v[16:19], v[88:91], a[68:71], v[16:19]
ds_read_b64 v[60:61], v115 offset:49152
v_mfma_f32_16x16x32_bf16 v[152:155], v[92:95], a[64:67], v[152:155]
ds_read_b64 v[62:63], v115 offset:49664
v_mfma_f32_16x16x32_bf16 v[32:35], v[92:95], a[68:71], v[32:35]
ds_read_b64 v[64:65], v115 offset:50176
s_waitcnt lgkmcnt(9)
v_mfma_f32_16x16x32_bf16 v[156:159], v[96:99], a[64:67], v[156:159]
ds_read_b64 v[66:67], v115 offset:50688
v_mfma_f32_16x16x32_bf16 v[36:39], v[96:99], a[68:71], v[36:39]
v_mfma_f32_16x16x32_bf16 v[160:163], v[100:103], a[64:67], v[160:163]
v_mfma_f32_16x16x32_bf16 v[40:43], v[100:103], a[68:71], v[40:43]
v_mfma_f32_16x16x32_bf16 v[164:167], v[104:107], a[64:67], v[164:167]
v_mfma_f32_16x16x32_bf16 v[44:47], v[104:107], a[68:71], v[44:47]
s_waitcnt vmcnt(8) lgkmcnt(6)
v_mfma_f32_16x16x32_bf16 v[148:151], v[48:51], a[72:75], v[148:151]
v_mfma_f32_16x16x32_bf16 v[16:19], v[48:51], a[76:79], v[16:19]
v_mfma_f32_16x16x32_bf16 v[152:155], v[52:55], a[72:75], v[152:155]
v_mfma_f32_16x16x32_bf16 v[32:35], v[52:55], a[76:79], v[32:35]
s_waitcnt lgkmcnt(0)
v_mfma_f32_16x16x32_bf16 v[156:159], v[56:59], a[72:75], v[156:159]
v_mfma_f32_16x16x32_bf16 v[36:39], v[56:59], a[76:79], v[36:39]
v_mfma_f32_16x16x32_bf16 v[160:163], v[60:63], a[72:75], v[160:163]
v_mfma_f32_16x16x32_bf16 v[40:43], v[60:63], a[76:79], v[40:43]
v_mfma_f32_16x16x32_bf16 v[164:167], v[64:67], a[72:75], v[164:167]
v_mfma_f32_16x16x32_bf16 v[44:47], v[64:67], a[76:79], v[44:47]
s_mul_i32 s48, s52, 5120
s_add_u32 s48, s48, 20480
v_add_u32 v26, s48, v4
s_mul_i32 s48, s69, 20480
s_add_u32 s48, s48, s65
v_add_u32 v21, 0, v1
v_mul_u32_u24 v21, 6554, v21
v_lshrrev_b32 v21, 16, v21
v_mul_u32_u24 v21, 1120, v21
v_add3_u32 v115, v21, v4, s48
v_add_u32 v21, 64, v1
v_mul_u32_u24 v21, 6554, v21
v_lshrrev_b32 v21, 16, v21
v_mul_u32_u24 v21, 1120, v21
v_add3_u32 v116, v21, v4, s48
v_add_u32 v21, 128, v1
v_mul_u32_u24 v21, 6554, v21
v_lshrrev_b32 v21, 16, v21
v_mul_u32_u24 v21, 1120, v21
v_add3_u32 v117, v21, v4, s48
v_sub_u32 v25, v26, v4
v_mul_u32_u24 v21, 160, v11
v_lshrrev_b32 v30, 4, v1
v_lshl_add_u32 v21, v30, 3, v21
v_add_u32 v25, v25, v21
s_lshl_b32 s51, 1, s52
v_mov_b32 v8, s51
ds_read_b128 v[48:51], v31 offset:16384
ds_read_b128 v[52:55], v31 offset:17408
ds_read_b128 v[56:59], v31 offset:18432
ds_read_b128 v[60:63], v31 offset:19456
ds_read_b128 v[64:67], v31 offset:20480
ds_read_b128 v[68:71], v31 offset:21504
ds_read_b128 v[72:75], v31 offset:22528
ds_read_b128 v[76:79], v31 offset:23552
ds_read_b128 v[80:83], v31 offset:24576
ds_read_b128 v[84:87], v31 offset:25600
ds_read_b128 v[88:91], v31 offset:26624
ds_read_b128 v[92:95], v31 offset:27648
ds_read_b128 v[96:99], v31 offset:28672
ds_read_b128 v[100:103], v31 offset:29696
s_cmp_lg_u32 s75, s53
s_cbranch_scc1 N104
s_andn2_b32 s74, s76, s74
s_cbranch_scc1 N104
B105:
s_xor_b32 s72, s72, 1024
s_mov_b64 s[74:75], 0
s_atomic_add_x2 s[74:75], s[36:37], s72 glc
buffer_load_dwordx4 a[16:19], v22, s[36:39], s73 offen offset:0 sc1
buffer_load_dwordx4 a[20:23], v22, s[36:39], s73 offen offset:1024 sc1
buffer_load_dwordx4 a[24:27], v22, s[36:39], s73 offen offset:2048 sc1
buffer_load_dwordx4 a[44:47], v22, s[36:39], s73 offen offset:3072 sc1
s_add_u32 s73, s73, 4096
s_cmp_ge_u32 s73, 12607488
s_cmov_b32 s73, 12582912
buffer_load_dwordx4 a[48:51], v22, s[36:39], s73 offen offset:0 sc1
buffer_load_dwordx4 a[52:55], v22, s[36:39], s73 offen offset:1024 sc1
s_waitcnt vmcnt(13) lgkmcnt(9)
v_mfma_f32_16x16x32_bf16 v[16:19], v[48:51], a[28:31], v[16:19]
ds_read_b128 v[104:107], v31 offset:30720
v_mfma_f32_16x16x32_bf16 v[32:35], v[52:55], a[28:31], v[32:35]
buffer_load_dwordx4 a[56:59], v22, s[36:39], s73 offen offset:2048 sc1
ds_read_b128 v[108:111], v31 offset:31744
v_mfma_f32_16x16x32_bf16 v[36:39], v[56:59], a[28:31], v[36:39]
ds_read_b128 v[120:123], v31 offset:32768
v_mfma_f32_16x16x32_bf16 v[40:43], v[60:63], a[28:31], v[40:43]
ds_read_b128 v[124:127], v31 offset:33792
v_mfma_f32_16x16x32_bf16 v[44:47], v[64:67], a[28:31], v[44:47]
ds_read_b128 v[128:131], v31 offset:34816
s_waitcnt vmcnt(13) lgkmcnt(9)
v_mfma_f32_16x16x32_bf16 v[16:19], v[68:71], a[32:35], v[16:19]
ds_read_b128 v[132:135], v31 offset:35840
v_mfma_f32_16x16x32_bf16 v[32:35], v[72:75], a[32:35], v[32:35]
buffer_load_dwordx4 a[60:63], v22, s[36:39], s73 offen offset:3072 sc1
s_add_u32 s73, s73, 4096
s_cmp_ge_u32 s73, 12607488
s_cmov_b32 s73, 12582912
ds_read_b128 v[48:51], v31 offset:36864
v_mfma_f32_16x16x32_bf16 v[36:39], v[76:79], a[32:35], v[36:39]
ds_read_b128 v[52:55], v31 offset:37888
v_mfma_f32_16x16x32_bf16 v[40:43], v[80:83], a[32:35], v[40:43]
ds_read_b128 v[56:59], v31 offset:38912
v_mfma_f32_16x16x32_bf16 v[44:47], v[84:87], a[32:35], v[44:47]
ds_read_b128 v[60:63], v31 offset:39936
s_waitcnt vmcnt(13) lgkmcnt(9)
v_mfma_f32_16x16x32_bf16 v[16:19], v[88:91], a[36:39], v[16:19]
ds_read_b128 v[64:67], v31 offset:40960
v_mfma_f32_16x16x32_bf16 v[32:35], v[92:95], a[36:39], v[32:35]
buffer_load_dwordx4 a[64:67], v22, s[36:39], s73 offen offset:0 sc1
ds_read_b128 v[68:71], v31 offset:41984
v_mfma_f32_16x16x32_bf16 v[36:39], v[96:99], a[36:39], v[36:39]
ds_read_b128 v[72:75], v31 offset:43008
v_mfma_f32_16x16x32_bf16 v[40:43], v[100:103], a[36:39], v[40:43]
ds_read_b128 v[76:79], v31 offset:44032
v_mfma_f32_16x16x32_bf16 v[44:47], v[104:107], a[36:39], v[44:47]
ds_read_b128 v[80:83], v31 offset:45056
s_waitcnt vmcnt(13) lgkmcnt(9)
v_mfma_f32_16x16x32_bf16 v[16:19], v[108:111], a[40:43], v[16:19]
ds_read_b128 v[84:87], v31 offset:46080
v_mfma_f32_16x16x32_bf16 v[32:35], v[120:123], a[40:43], v[32:35]
buffer_load_dwordx4 a[68:71], v22, s[36:39], s73 offen offset:1024 sc1
ds_read_b128 v[88:91], v31 offset:47104
v_mfma_f32_16x16x32_bf16 v[36:39], v[124:127], a[40:43], v[36:39]
ds_read_b128 v[92:95], v31 offset:48128
v_mfma_f32_16x16x32_bf16 v[40:43], v[128:131], a[40:43], v[40:43]
ds_read_b128 v[96:99], v31 offset:49152
v_mfma_f32_16x16x32_bf16 v[44:47], v[132:135], a[40:43], v[44:47]
ds_read_b128 v[100:103], v31 offset:50176
s_waitcnt vmcnt(13) lgkmcnt(9)
v_mfma_f32_16x16x32_bf16 v[16:19], v[48:51], a[0:3], v[16:19]
ds_read_b128 v[104:107], v31 offset:51200
v_mfma_f32_16x16x32_bf16 v[32:35], v[52:55], a[0:3], v[32:35]
buffer_load_dwordx4 a[72:75], v22, s[36:39], s73 offen offset:2048 sc1
ds_read_b128 v[108:111], v31 offset:52224
v_mfma_f32_16x16x32_bf16 v[36:39], v[56:59], a[0:3], v[36:39]
ds_read_b128 v[120:123], v31 offset:53248
v_mfma_f32_16x16x32_bf16 v[40:43], v[60:63], a[0:3], v[40:43]
ds_read_b128 v[124:127], v31 offset:54272
v_mfma_f32_16x16x32_bf16 v[44:47], v[64:67], a[0:3], v[44:47]
ds_read_b128 v[128:131], v31 offset:55296
s_waitcnt vmcnt(13) lgkmcnt(9)
v_mfma_f32_16x16x32_bf16 v[16:19], v[68:71], a[4:7], v[16:19]
ds_read_b128 v[132:135], v31 offset:56320
v_mfma_f32_16x16x32_bf16 v[32:35], v[72:75], a[4:7], v[32:35]
buffer_load_dwordx4 a[76:79], v22, s[36:39], s73 offen offset:3072 sc1
s_add_u32 s73, s73, 4096
s_cmp_ge_u32 s73, 12607488
s_cmov_b32 s73, 12582912
ds_read_b128 v[48:51], v31 offset:57344
v_mfma_f32_16x16x32_bf16 v[36:39], v[76:79], a[4:7], v[36:39]
ds_read_b128 v[52:55], v31 offset:58368
v_mfma_f32_16x16x32_bf16 v[40:43], v[80:83], a[4:7], v[40:43]
ds_read_b128 v[56:59], v31 offset:59392
v_mfma_f32_16x16x32_bf16 v[44:47], v[84:87], a[4:7], v[44:47]
ds_read_b128 v[60:63], v31 offset:60416
s_waitcnt vmcnt(13) lgkmcnt(9)
v_mfma_f32_16x16x32_bf16 v[16:19], v[88:91], a[8:11], v[16:19]
ds_read_b128 v[64:67], v31 offset:61440
v_mfma_f32_16x16x32_bf16 v[32:35], v[92:95], a[8:11], v[32:35]
buffer_load_dwordx4 a[28:31], v22, s[36:39], s73 offen offset:0 sc1
ds_read_b128 v[68:71], v31 offset:62464
v_mfma_f32_16x16x32_bf16 v[36:39], v[96:99], a[8:11], v[36:39]
ds_read_b128 v[72:75], v31 offset:63488
v_mfma_f32_16x16x32_bf16 v[40:43], v[100:103], a[8:11], v[40:43]
ds_read_b128 v[76:79], v31 offset:64512
v_mfma_f32_16x16x32_bf16 v[44:47], v[104:107], a[8:11], v[44:47]
ds_read_b128 v[80:83], v114 offset:0
s_waitcnt vmcnt(13) lgkmcnt(9)
v_mfma_f32_16x16x32_bf16 v[16:19], v[108:111], a[12:15], v[16:19]
ds_read_b128 v[84:87], v114 offset:1024
v_mfma_f32_16x16x32_bf16 v[32:35], v[120:123], a[12:15], v[32:35]
buffer_load_dwordx4 a[32:35], v22, s[36:39], s73 offen offset:1024 sc1
ds_read_b128 v[88:91], v114 offset:2048
v_mfma_f32_16x16x32_bf16 v[36:39], v[124:127], a[12:15], v[36:39]
ds_read_b128 v[92:95], v114 offset:3072
v_mfma_f32_16x16x32_bf16 v[40:43], v[128:131], a[12:15], v[40:43]
ds_read_b128 v[96:99], v114 offset:4096
v_mfma_f32_16x16x32_bf16 v[44:47], v[132:135], a[12:15], v[44:47]
ds_read_b128 v[100:103], v114 offset:5120
s_waitcnt vmcnt(13) lgkmcnt(9)
v_mfma_f32_16x16x32_bf16 v[16:19], v[48:51], a[16:19], v[16:19]
ds_read_b128 v[104:107], v114 offset:6144
v_mfma_f32_16x16x32_bf16 v[32:35], v[52:55], a[16:19], v[32:35]
buffer_load_dwordx4 a[36:39], v22, s[36:39], s73 offen offset:2048 sc1
ds_read_b128 v[108:111], v114 offset:7168
v_mfma_f32_16x16x32_bf16 v[36:39], v[56:59], a[16:19], v[36:39]
ds_read_b128 v[120:123], v114 offset:8192
v_mfma_f32_16x16x32_bf16 v[40:43], v[60:63], a[16:19], v[40:43]
ds_read_b128 v[124:127], v114 offset:9216
v_mfma_f32_16x16x32_bf16 v[44:47], v[64:67], a[16:19], v[44:47]
ds_read_b128 v[128:131], v114 offset:10240
s_waitcnt vmcnt(13) lgkmcnt(9)
v_mfma_f32_16x16x32_bf16 v[16:19], v[68:71], a[20:23], v[16:19]
ds_read_b128 v[132:135], v114 offset:11264
v_mfma_f32_16x16x32_bf16 v[32:35], v[72:75], a[20:23], v[32:35]
buffer_load_dwordx4 a[40:43], v22, s[36:39], s73 offen offset:3072 sc1
s_add_u32 s73, s73, 4096
s_cmp_ge_u32 s73, 12607488
s_cmov_b32 s73, 12582912
ds_read_b128 v[48:51], v114 offset:12288
v_mfma_f32_16x16x32_bf16 v[36:39], v[76:79], a[20:23], v[36:39]
ds_read_b128 v[52:55], v114 offset:13312
v_mfma_f32_16x16x32_bf16 v[40:43], v[80:83], a[20:23], v[40:43]
ds_read_b128 v[56:59], v114 offset:14336
v_mfma_f32_16x16x32_bf16 v[44:47], v[84:87], a[20:23], v[44:47]
ds_read_b128 v[60:63], v114 offset:15360
s_waitcnt vmcnt(13) lgkmcnt(9)
v_mfma_f32_16x16x32_bf16 v[16:19], v[88:91], a[24:27], v[16:19]
ds_read_b128 v[64:67], v114 offset:16384
v_mfma_f32_16x16x32_bf16 v[32:35], v[92:95], a[24:27], v[32:35]
s_waitcnt lgkmcnt(0)
s_cmp_lg_u32 s75, s53
s_cbranch_scc1 N106
s_andn2_b32 s74, s76, s74
s_cbranch_scc1 N106
B107:
buffer_load_dwordx4 a[0:3], v15, s[36:39], s71 offen offset:0 sc1
ds_read_b128 v[68:71], v114 offset:17408
ds_read_b64 v[6:7], v3
v_mfma_f32_16x16x32_bf16 v[36:39], v[96:99], a[24:27], v[36:39]
ds_read_b128 v[72:75], v114 offset:18432
v_mfma_f32_16x16x32_bf16 v[40:43], v[100:103], a[24:27], v[40:43]
ds_read_b128 v[76:79], v114 offset:19456
v_mfma_f32_16x16x32_bf16 v[44:47], v[104:107], a[24:27], v[44:47]
ds_read_b128 v[80:83], v114 offset:20480
s_waitcnt vmcnt(13)
v_mfma_f32_16x16x32_bf16 v[16:19], v[108:111], a[44:47], v[16:19]
ds_read_b128 v[84:87], v114 offset:21504
v_mfma_f32_16x16x32_bf16 v[32:35], v[120:123], a[44:47], v[32:35]
buffer_load_dwordx4 a[4:7], v15, s[36:39], s71 offen offset:1024 sc1
s_waitcnt lgkmcnt(4)
v_min_u32 v6, v6, v7
v_cmp_gt_u32 vcc, 40, v6
s_nop 0
s_cbranch_vccnz W108
B109:
ds_read_b128 v[88:91], v23 offset:51200
v_mfma_f32_16x16x32_bf16 v[36:39], v[124:127], a[44:47], v[36:39]
ds_read_b128 v[92:95], v23 offset:52224
v_mfma_f32_16x16x32_bf16 v[40:43], v[128:131], a[44:47], v[40:43]
ds_read_b128 v[96:99], v23 offset:53248
v_mfma_f32_16x16x32_bf16 v[44:47], v[132:135], a[44:47], v[44:47]
ds_read_b128 v[100:103], v23 offset:54272
s_waitcnt vmcnt(13)
v_mfma_f32_16x16x32_bf16 v[16:19], v[48:51], a[48:51], v[16:19]
ds_read_b128 v[104:107], v23 offset:55296
v_mfma_f32_16x16x32_bf16 v[32:35], v[52:55], a[48:51], v[32:35]
buffer_load_dwordx4 a[8:11], v15, s[36:39], s71 offen offset:2048 sc1
ds_read_b128 v[108:111], v23 offset:56320
v_mfma_f32_16x16x32_bf16 v[36:39], v[56:59], a[48:51], v[36:39]
ds_read_b128 v[120:123], v23 offset:57344
v_mfma_f32_16x16x32_bf16 v[40:43], v[60:63], a[48:51], v[40:43]
ds_read_b128 v[124:127], v23 offset:58368
v_mfma_f32_16x16x32_bf16 v[44:47], v[64:67], a[48:51], v[44:47]
ds_read_b128 v[128:131], v23 offset:59392
s_waitcnt vmcnt(13) lgkmcnt(9)
v_mfma_f32_16x16x32_bf16 v[16:19], v[68:71], a[52:55], v[16:19]
ds_read_b128 v[132:135], v23 offset:60416
v_mfma_f32_16x16x32_bf16 v[32:35], v[72:75], a[52:55], v[32:35]
buffer_load_dwordx4 a[12:15], v15, s[36:39], s71 offen offset:3072 sc1
s_add_u32 s71, s71, 4096
s_cmp_ge_u32 s71, 12607488
s_cmov_b32 s71, 12582912
ds_read_b128 v[48:51], v23 offset:61440
v_mfma_f32_16x16x32_bf16 v[36:39], v[76:79], a[52:55], v[36:39]
ds_read_b128 v[52:55], v23 offset:62464
v_mfma_f32_16x16x32_bf16 v[40:43], v[80:83], a[52:55], v[40:43]
ds_read_b128 v[56:59], v23 offset:63488
v_mfma_f32_16x16x32_bf16 v[44:47], v[84:87], a[52:55], v[44:47]
ds_read_b128 v[60:63], v23 offset:64512
s_waitcnt vmcnt(13) lgkmcnt(9)
v_mfma_f32_16x16x32_bf16 v[16:19], v[88:91], a[56:59], v[16:19]
ds_read_b128 v[64:67], v31 offset:0
v_mfma_f32_16x16x32_bf16 v[32:35], v[92:95], a[56:59], v[32:35]
buffer_load_dwordx4 a[16:19], v15, s[36:39], s71 offen offset:0 sc1
ds_read_b128 v[68:71], v31 offset:1024
v_mfma_f32_16x16x32_bf16 v[36:39], v[96:99], a[56:59], v[36:39]
ds_read_b128 v[72:75], v31 offset:2048
v_mfma_f32_16x16x32_bf16 v[40:43], v[100:103], a[56:59], v[40:43]
ds_read_b128 v[76:79], v31 offset:3072
v_mfma_f32_16x16x32_bf16 v[44:47], v[104:107], a[56:59], v[44:47]
ds_read_b128 v[80:83], v31 offset:4096
s_waitcnt vmcnt(13) lgkmcnt(9)
v_mfma_f32_16x16x32_bf16 v[16:19], v[108:111], a[60:63], v[16:19]
ds_read_b128 v[84:87], v31 offset:5120
v_mfma_f32_16x16x32_bf16 v[32:35], v[120:123], a[60:63], v[32:35]
buffer_load_dwordx4 a[20:23], v15, s[36:39], s71 offen offset:1024 sc1
ds_read_b128 v[88:91], v31 offset:6144
v_mfma_f32_16x16x32_bf16 v[36:39], v[124:127], a[60:63], v[36:39]
ds_read_b128 v[92:95], v31 offset:7168
v_mfma_f32_16x16x32_bf16 v[40:43], v[128:131], a[60:63], v[40:43]
ds_read_b128 v[96:99], v31 offset:8192
v_mfma_f32_16x16x32_bf16 v[44:47], v[132:135], a[60:63], v[44:47]
ds_read_b128 v[100:103], v31 offset:9216
s_waitcnt vmcnt(13) lgkmcnt(9)
v_mfma_f32_16x16x32_bf16 v[16:19], v[48:51], a[64:67], v[16:19]
ds_read_b128 v[104:107], v31 offset:10240
v_mfma_f32_16x16x32_bf16 v[32:35], v[52:55], a[64:67], v[32:35]
buffer_load_dwordx4 a[24:27], v15, s[36:39], s71 offen offset:2048 sc1
ds_read_b128 v[108:111], v31 offset:11264
ds_read_b64 v[6:7], v3
v_mfma_f32_16x16x32_bf16 v[36:39], v[56:59], a[64:67], v[36:39]
ds_read_b128 v[120:123], v31 offset:12288
v_mfma_f32_16x16x32_bf16 v[40:43], v[60:63], a[64:67], v[40:43]
ds_read_b128 v[124:127], v31 offset:13312
v_mfma_f32_16x16x32_bf16 v[44:47], v[64:67], a[64:67], v[44:47]
ds_read_b128 v[128:131], v31 offset:14336
s_waitcnt vmcnt(13) lgkmcnt(10)
v_mfma_f32_16x16x32_bf16 v[16:19], v[68:71], a[68:71], v[16:19]
ds_read_b128 v[132:135], v31 offset:15360
v_mfma_f32_16x16x32_bf16 v[32:35], v[72:75], a[68:71], v[32:35]
buffer_load_dwordx4 a[44:47], v15, s[36:39], s71 offen offset:3072 sc1
s_add_u32 s71, s71, 4096
s_cmp_ge_u32 s71, 12607488
s_cmov_b32 s71, 12582912
s_waitcnt lgkmcnt(4)
v_min_u32 v6, v6, v7
v_cmp_gt_u32 vcc, 42, v6
s_nop 0
s_cbranch_vccnz W110
B111:
ds_read_b128 v[48:51], v23 offset:0
v_mfma_f32_16x16x32_bf16 v[36:39], v[76:79], a[68:71], v[36:39]
ds_read_b128 v[52:55], v23 offset:1024
v_mfma_f32_16x16x32_bf16 v[40:43], v[80:83], a[68:71], v[40:43]
ds_read_b128 v[56:59], v23 offset:2048
v_mfma_f32_16x16x32_bf16 v[44:47], v[84:87], a[68:71], v[44:47]
ds_read_b128 v[60:63], v23 offset:3072
s_waitcnt vmcnt(13)
v_mfma_f32_16x16x32_bf16 v[16:19], v[88:91], a[72:75], v[16:19]
ds_read_b128 v[64:67], v23 offset:4096
v_mfma_f32_16x16x32_bf16 v[32:35], v[92:95], a[72:75], v[32:35]
buffer_load_dwordx4 a[48:51], v15, s[36:39], s71 offen offset:0 sc1
ds_read_b128 v[68:71], v23 offset:5120
v_mfma_f32_16x16x32_bf16 v[36:39], v[96:99], a[72:75], v[36:39]
ds_read_b128 v[72:75], v23 offset:6144
v_mfma_f32_16x16x32_bf16 v[40:43], v[100:103], a[72:75], v[40:43]
ds_read_b128 v[76:79], v23 offset:7168
v_mfma_f32_16x16x32_bf16 v[44:47], v[104:107], a[72:75], v[44:47]
ds_read_b128 v[80:83], v23 offset:8192
s_waitcnt vmcnt(13) lgkmcnt(9)
v_mfma_f32_16x16x32_bf16 v[16:19], v[108:111], a[76:79], v[16:19]
ds_read_b128 v[84:87], v23 offset:9216
v_mfma_f32_16x16x32_bf16 v[32:35], v[120:123], a[76:79], v[32:35]
buffer_load_dwordx4 a[52:55], v15, s[36:39], s71 offen offset:1024 sc1
ds_read_b128 v[88:91], v23 offset:10240
v_mfma_f32_16x16x32_bf16 v[36:39], v[124:127], a[76:79], v[36:39]
ds_read_b128 v[92:95], v23 offset:11264
v_mfma_f32_16x16x32_bf16 v[40:43], v[128:131], a[76:79], v[40:43]
ds_read_b128 v[96:99], v23 offset:12288
v_mfma_f32_16x16x32_bf16 v[44:47], v[132:135], a[76:79], v[44:47]
ds_read_b128 v[100:103], v23 offset:13312
s_waitcnt vmcnt(13) lgkmcnt(9)
v_mfma_f32_16x16x32_bf16 v[16:19], v[48:51], a[28:31], v[16:19]
ds_read_b128 v[104:107], v23 offset:14336
v_mfma_f32_16x16x32_bf16 v[32:35], v[52:55], a[28:31], v[32:35]
buffer_load_dwordx4 a[56:59], v15, s[36:39], s71 offen offset:2048 sc1
ds_read_b128 v[108:111], v23 offset:15360
v_mfma_f32_16x16x32_bf16 v[36:39], v[56:59], a[28:31], v[36:39]
ds_read_b128 v[120:123], v23 offset:16384
v_mfma_f32_16x16x32_bf16 v[40:43], v[60:63], a[28:31], v[40:43]
ds_read_b128 v[124:127], v23 offset:17408
v_mfma_f32_16x16x32_bf16 v[44:47], v[64:67], a[28:31], v[44:47]
ds_read_b128 v[128:131], v23 offset:18432
s_waitcnt vmcnt(13) lgkmcnt(9)
v_mfma_f32_16x16x32_bf16 v[16:19], v[68:71], a[32:35], v[16:19]
ds_read_b128 v[132:135], v23 offset:19456
v_mfma_f32_16x16x32_bf16 v[32:35], v[72:75], a[32:35], v[32:35]
buffer_load_dwordx4 a[60:63], v15, s[36:39], s71 offen offset:3072 sc1
s_add_u32 s71, s71, 4096
s_cmp_ge_u32 s71, 12607488
s_cmov_b32 s71, 12582912
ds_read_b128 v[48:51], v31 offset:16384
v_mfma_f32_16x16x32_bf16 v[36:39], v[76:79], a[32:35], v[36:39]
ds_read_b128 v[52:55], v31 offset:17408
v_mfma_f32_16x16x32_bf16 v[40:43], v[80:83], a[32:35], v[40:43]
ds_read_b128 v[56:59], v31 offset:18432
v_mfma_f32_16x16x32_bf16 v[44:47], v[84:87], a[32:35], v[44:47]
ds_read_b128 v[60:63], v31 offset:19456
s_waitcnt vmcnt(13) lgkmcnt(9)
v_mfma_f32_16x16x32_bf16 v[16:19], v[88:91], a[36:39], v[16:19]
ds_read_b128 v[64:67], v31 offset:20480
v_mfma_f32_16x16x32_bf16 v[32:35], v[92:95], a[36:39], v[32:35]
buffer_load_dwordx4 a[64:67], v15, s[36:39], s71 offen offset:0 sc1
ds_read_b128 v[68:71], v31 offset:21504
v_mfma_f32_16x16x32_bf16 v[36:39], v[96:99], a[36:39], v[36:39]
ds_read_b128 v[72:75], v31 offset:22528
v_mfma_f32_16x16x32_bf16 v[40:43], v[100:103], a[36:39], v[40:43]
ds_read_b128 v[76:79], v31 offset:23552
v_mfma_f32_16x16x32_bf16 v[44:47], v[104:107], a[36:39], v[44:47]
ds_read_b128 v[80:83], v31 offset:24576
s_waitcnt vmcnt(13) lgkmcnt(9)
v_mfma_f32_16x16x32_bf16 v[16:19], v[108:111], a[40:43], v[16:19]
ds_read_b128 v[84:87], v31 offset:25600
v_mfma_f32_16x16x32_bf16 v[32:35], v[120:123], a[40:43], v[32:35]
buffer_load_dwordx4 a[68:71], v15, s[36:39], s71 offen offset:1024 sc1
ds_read_b128 v[88:91], v31 offset:26624
v_mfma_f32_16x16x32_bf16 v[36:39], v[124:127], a[40:43], v[36:39]
ds_read_b128 v[92:95], v31 offset:27648
v_mfma_f32_16x16x32_bf16 v[40:43], v[128:131], a[40:43], v[40:43]
ds_read_b128 v[96:99], v31 offset:28672
v_mfma_f32_16x16x32_bf16 v[44:47], v[132:135], a[40:43], v[44:47]
ds_read_b128 v[100:103], v31 offset:29696
s_waitcnt vmcnt(13) lgkmcnt(9)
v_mfma_f32_16x16x32_bf16 v[148:151], v[48:51], a[0:3], v[148:151]
ds_read_b128 v[104:107], v31 offset:30720
v_mfma_f32_16x16x32_bf16 v[152:155], v[52:55], a[0:3], v[152:155]
buffer_load_dwordx4 a[72:75], v15, s[36:39], s71 offen offset:2048 sc1
ds_read_b128 v[108:111], v31 offset:31744
v_mfma_f32_16x16x32_bf16 v[156:159], v[56:59], a[0:3], v[156:159]
ds_read_b128 v[120:123], v31 offset:32768
v_mfma_f32_16x16x32_bf16 v[160:163], v[60:63], a[0:3], v[160:163]
v_cvt_pk_bf16_f32 v16, v16, v17
v_cvt_pk_bf16_f32 v17, v18, v19
ds_read_b128 v[124:127], v31 offset:33792
v_mfma_f32_16x16x32_bf16 v[164:167], v[64:67], a[0:3], v[164:167]
v_cvt_pk_bf16_f32 v18, v32, v33
v_cvt_pk_bf16_f32 v19, v34, v35
buffer_store_dwordx4 v[16:19], v118, s[36:39], 0 offen offset:0 sc1
ds_read_b128 v[128:131], v31 offset:34816
s_waitcnt vmcnt(14) lgkmcnt(9)
v_mfma_f32_16x16x32_bf16 v[148:151], v[68:71], a[4:7], v[148:151]
v_cvt_pk_bf16_f32 v36, v36, v37
v_cvt_pk_bf16_f32 v37, v38, v39
ds_read_b128 v[132:135], v31 offset:35840
v_mfma_f32_16x16x32_bf16 v[152:155], v[72:75], a[4:7], v[152:155]
buffer_load_dwordx4 a[76:79], v15, s[36:39], s71 offen offset:3072 sc1
s_add_u32 s71, s71, 4096
s_cmp_ge_u32 s71, 12607488
s_cmov_b32 s71, 12582912
v_cvt_pk_bf16_f32 v38, v40, v41
v_cvt_pk_bf16_f32 v39, v42, v43
buffer_store_dwordx4 v[36:39], v118, s[36:39], 0 offen offset:1024 sc1
ds_read_b128 v[48:51], v31 offset:36864
v_mfma_f32_16x16x32_bf16 v[156:159], v[76:79], a[4:7], v[156:159]
v_cvt_pk_bf16_f32 v44, v44, v45
v_cvt_pk_bf16_f32 v45, v46, v47
buffer_store_dwordx4 v[44:47], v118, s[36:39], 0 offen offset:2048 sc1
ds_read_b128 v[52:55], v31 offset:37888
v_mfma_f32_16x16x32_bf16 v[160:163], v[80:83], a[4:7], v[160:163]
ds_read_b128 v[56:59], v31 offset:38912
v_mfma_f32_16x16x32_bf16 v[164:167], v[84:87], a[4:7], v[164:167]
ds_read_b128 v[60:63], v31 offset:39936
s_waitcnt vmcnt(16) lgkmcnt(9)
v_mfma_f32_16x16x32_bf16 v[148:151], v[88:91], a[8:11], v[148:151]
ds_read_b128 v[64:67], v31 offset:40960
v_mov_b32 v9, 24
ds_write_b32 v10, v9
v_mfma_f32_16x16x32_bf16 v[152:155], v[92:95], a[8:11], v[152:155]
buffer_load_dwordx4 a[28:31], v15, s[36:39], s71 offen offset:0 sc1
ds_read_b128 v[68:71], v31 offset:41984
v_mfma_f32_16x16x32_bf16 v[156:159], v[96:99], a[8:11], v[156:159]
ds_read_b128 v[72:75], v31 offset:43008
v_mfma_f32_16x16x32_bf16 v[160:163], v[100:103], a[8:11], v[160:163]
ds_read_b128 v[76:79], v31 offset:44032
v_mfma_f32_16x16x32_bf16 v[164:167], v[104:107], a[8:11], v[164:167]
ds_read_b128 v[80:83], v31 offset:45056
s_waitcnt vmcnt(16) lgkmcnt(10)
v_mfma_f32_16x16x32_bf16 v[148:151], v[108:111], a[12:15], v[148:151]
ds_read_b128 v[84:87], v31 offset:46080
v_mfma_f32_16x16x32_bf16 v[152:155], v[120:123], a[12:15], v[152:155]
buffer_load_dwordx4 a[32:35], v15, s[36:39], s71 offen offset:1024 sc1
ds_read_b128 v[88:91], v31 offset:47104
v_mfma_f32_16x16x32_bf16 v[156:159], v[124:127], a[12:15], v[156:159]
ds_read_b128 v[92:95], v31 offset:48128
v_mfma_f32_16x16x32_bf16 v[160:163], v[128:131], a[12:15], v[160:163]
ds_read_b128 v[96:99], v31 offset:49152
v_mfma_f32_16x16x32_bf16 v[164:167], v[132:135], a[12:15], v[164:167]
ds_read_b128 v[100:103], v31 offset:50176
s_waitcnt vmcnt(16) lgkmcnt(10)
v_mfma_f32_16x16x32_bf16 v[148:151], v[48:51], a[16:19], v[148:151]
ds_read_b128 v[104:107], v31 offset:51200
v_mfma_f32_16x16x32_bf16 v[152:155], v[52:55], a[16:19], v[152:155]
buffer_load_dwordx4 a[36:39], v15, s[36:39], s71 offen offset:2048 sc1
ds_read_b128 v[108:111], v31 offset:52224
v_mfma_f32_16x16x32_bf16 v[156:159], v[56:59], a[16:19], v[156:159]
ds_read_b128 v[120:123], v31 offset:53248
v_mfma_f32_16x16x32_bf16 v[160:163], v[60:63], a[16:19], v[160:163]
ds_read_b128 v[124:127], v31 offset:54272
v_mfma_f32_16x16x32_bf16 v[164:167], v[64:67], a[16:19], v[164:167]
ds_read_b128 v[128:131], v31 offset:55296
s_waitcnt vmcnt(16) lgkmcnt(9)
v_mfma_f32_16x16x32_bf16 v[148:151], v[68:71], a[20:23], v[148:151]
ds_read_b128 v[132:135], v31 offset:56320
v_mfma_f32_16x16x32_bf16 v[152:155], v[72:75], a[20:23], v[152:155]
buffer_load_dwordx4 a[40:43], v15, s[36:39], s71 offen offset:3072 sc1
s_add_u32 s71, s71, 4096
s_cmp_ge_u32 s71, 12607488
s_cmov_b32 s71, 12582912
ds_read_b128 v[48:51], v31 offset:57344
v_mfma_f32_16x16x32_bf16 v[156:159], v[76:79], a[20:23], v[156:159]
ds_read_b128 v[52:55], v31 offset:58368
v_mfma_f32_16x16x32_bf16 v[160:163], v[80:83], a[20:23], v[160:163]
ds_read_b128 v[56:59], v31 offset:59392
v_mfma_f32_16x16x32_bf16 v[164:167], v[84:87], a[20:23], v[164:167]
ds_read_b128 v[60:63], v31 offset:60416
s_waitcnt vmcnt(16) lgkmcnt(9)
v_mfma_f32_16x16x32_bf16 v[148:151], v[88:91], a[24:27], v[148:151]
ds_read_b128 v[64:67], v31 offset:61440
v_mfma_f32_16x16x32_bf16 v[152:155], v[92:95], a[24:27], v[152:155]
buffer_load_dwordx4 a[0:3], v15, s[36:39], s71 offen offset:0 sc1
ds_read_b128 v[68:71], v31 offset:62464
v_mfma_f32_16x16x32_bf16 v[156:159], v[96:99], a[24:27], v[156:159]
ds_read_b128 v[72:75], v31 offset:63488
v_mfma_f32_16x16x32_bf16 v[160:163], v[100:103], a[24:27], v[160:163]
ds_read_b128 v[76:79], v31 offset:64512
v_mfma_f32_16x16x32_bf16 v[164:167], v[104:107], a[24:27], v[164:167]
ds_read_b128 v[80:83], v114 offset:0
s_waitcnt vmcnt(16) lgkmcnt(9)
v_mfma_f32_16x16x32_bf16 v[148:151], v[108:111], a[44:47], v[148:151]
ds_read_b128 v[84:87], v114 offset:1024
v_mfma_f32_16x16x32_bf16 v[152:155], v[120:123], a[44:47], v[152:155]
buffer_load_dwordx4 a[4:7], v15, s[36:39], s71 offen offset:1024 sc1
ds_read_b128 v[88:91], v114 offset:2048
v_mfma_f32_16x16x32_bf16 v[156:159], v[124:127], a[44:47], v[156:159]
ds_read_b128 v[92:95], v114 offset:3072
v_mfma_f32_16x16x32_bf16 v[160:163], v[128:131], a[44:47], v[160:163]
ds_read_b128 v[96:99], v114 offset:4096
v_mfma_f32_16x16x32_bf16 v[164:167], v[132:135], a[44:47], v[164:167]
ds_read_b128 v[100:103], v114 offset:5120
s_waitcnt vmcnt(6)
buffer_atomic_or v8, v5, s[36:39], s78 offen sc1
s_waitcnt lgkmcnt(9)
v_mfma_f32_16x16x32_bf16 v[148:151], v[48:51], a[48:51], v[148:151]
ds_read_b128 v[104:107], v114 offset:6144
v_mfma_f32_16x16x32_bf16 v[152:155], v[52:55], a[48:51], v[152:155]
buffer_load_dwordx4 a[8:11], v15, s[36:39], s71 offen offset:2048 sc1
ds_read_b128 v[108:111], v114 offset:7168
v_mfma_f32_16x16x32_bf16 v[156:159], v[56:59], a[48:51], v[156:159]
ds_read_b128 v[120:123], v114 offset:8192
v_mfma_f32_16x16x32_bf16 v[160:163], v[60:63], a[48:51], v[160:163]
ds_read_b128 v[124:127], v114 offset:9216
v_mfma_f32_16x16x32_bf16 v[164:167], v[64:67], a[48:51], v[164:167]
ds_read_b128 v[128:131], v114 offset:10240
s_waitcnt lgkmcnt(9)
v_mfma_f32_16x16x32_bf16 v[148:151], v[68:71], a[52:55], v[148:151]
ds_read_b128 v[132:135], v114 offset:11264
v_mfma_f32_16x16x32_bf16 v[152:155], v[72:75], a[52:55], v[152:155]
buffer_load_dwordx4 a[12:15], v15, s[36:39], s71 offen offset:3072 sc1
s_add_u32 s71, s71, 4096
s_cmp_ge_u32 s71, 12607488
s_cmov_b32 s71, 12582912
ds_read_b128 v[48:51], v114 offset:12288
v_mfma_f32_16x16x32_bf16 v[156:159], v[76:79], a[52:55], v[156:159]
ds_read_b128 v[52:55], v114 offset:13312
v_mfma_f32_16x16x32_bf16 v[160:163], v[80:83], a[52:55], v[160:163]
ds_read_b128 v[56:59], v114 offset:14336
v_mfma_f32_16x16x32_bf16 v[164:167], v[84:87], a[52:55], v[164:167]
ds_read_b128 v[60:63], v114 offset:15360
s_waitcnt lgkmcnt(9)
v_mfma_f32_16x16x32_bf16 v[148:151], v[88:91], a[56:59], v[148:151]
ds_read_b128 v[64:67], v114 offset:16384
v_mfma_f32_16x16x32_bf16 v[152:155], v[92:95], a[56:59], v[152:155]
ds_read_b128 v[68:71], v114 offset:17408
v_mfma_f32_16x16x32_bf16 v[156:159], v[96:99], a[56:59], v[156:159]
ds_read_b128 v[72:75], v114 offset:18432
v_mfma_f32_16x16x32_bf16 v[160:163], v[100:103], a[56:59], v[160:163]
ds_read_b128 v[76:79], v114 offset:19456
v_mfma_f32_16x16x32_bf16 v[164:167], v[104:107], a[56:59], v[164:167]
ds_read_b128 v[80:83], v114 offset:20480
s_waitcnt lgkmcnt(9)
v_mfma_f32_16x16x32_bf16 v[148:151], v[108:111], a[60:63], v[148:151]
ds_read_b128 v[84:87], v114 offset:21504
v_mfma_f32_16x16x32_bf16 v[152:155], v[120:123], a[60:63], v[152:155]
ds_read_b128 v[88:91], v23 offset:51200
v_mfma_f32_16x16x32_bf16 v[156:159], v[124:127], a[60:63], v[156:159]
ds_read_b128 v[92:95], v23 offset:52224
v_mfma_f32_16x16x32_bf16 v[160:163], v[128:131], a[60:63], v[160:163]
ds_read_b128 v[96:99], v23 offset:53248
v_mfma_f32_16x16x32_bf16 v[164:167], v[132:135], a[60:63], v[164:167]
ds_read_b128 v[100:103], v23 offset:54272
s_waitcnt lgkmcnt(9)
v_mfma_f32_16x16x32_bf16 v[148:151], v[48:51], a[64:67], v[148:151]
ds_read_b128 v[104:107], v23 offset:55296
v_mfma_f32_16x16x32_bf16 v[152:155], v[52:55], a[64:67], v[152:155]
ds_read_b128 v[108:111], v23 offset:56320
v_mfma_f32_16x16x32_bf16 v[156:159], v[56:59], a[64:67], v[156:159]
ds_read_b128 v[120:123], v23 offset:57344
v_mfma_f32_16x16x32_bf16 v[160:163], v[60:63], a[64:67], v[160:163]
ds_read_b128 v[124:127], v23 offset:58368
v_mfma_f32_16x16x32_bf16 v[164:167], v[64:67], a[64:67], v[164:167]
ds_read_b128 v[128:131], v23 offset:59392
s_waitcnt lgkmcnt(9)
v_mfma_f32_16x16x32_bf16 v[148:151], v[68:71], a[68:71], v[148:151]
ds_read_b128 v[132:135], v23 offset:60416
v_mfma_f32_16x16x32_bf16 v[152:155], v[72:75], a[68:71], v[152:155]
ds_read_b128 v[48:51], v23 offset:61440
v_mfma_f32_16x16x32_bf16 v[156:159], v[76:79], a[68:71], v[156:159]
ds_read_b128 v[52:55], v23 offset:62464
v_mfma_f32_16x16x32_bf16 v[160:163], v[80:83], a[68:71], v[160:163]
ds_read_b128 v[56:59], v23 offset:63488
v_mfma_f32_16x16x32_bf16 v[164:167], v[84:87], a[68:71], v[164:167]
ds_read_b128 v[60:63], v23 offset:64512
s_waitcnt lgkmcnt(9)
v_mfma_f32_16x16x32_bf16 v[148:151], v[88:91], a[72:75], v[148:151]
ds_read_b128 v[64:67], v31 offset:0
v_mfma_f32_16x16x32_bf16 v[152:155], v[92:95], a[72:75], v[152:155]
ds_read_b128 v[68:71], v31 offset:1024
v_mfma_f32_16x16x32_bf16 v[156:159], v[96:99], a[72:75], v[156:159]
ds_read_b128 v[72:75], v31 offset:2048
v_mfma_f32_16x16x32_bf16 v[160:163], v[100:103], a[72:75], v[160:163]
ds_read_b128 v[76:79], v31 offset:3072
v_mfma_f32_16x16x32_bf16 v[164:167], v[104:107], a[72:75], v[164:167]
ds_read_b128 v[80:83], v31 offset:4096
s_waitcnt lgkmcnt(9)
v_mfma_f32_16x16x32_bf16 v[148:151], v[108:111], a[76:79], v[148:151]
ds_read_b128 v[84:87], v31 offset:5120
v_mfma_f32_16x16x32_bf16 v[152:155], v[120:123], a[76:79], v[152:155]
ds_read_b128 v[88:91], v31 offset:6144
v_mfma_f32_16x16x32_bf16 v[156:159], v[124:127], a[76:79], v[156:159]
ds_read_b128 v[92:95], v31 offset:7168
v_mfma_f32_16x16x32_bf16 v[160:163], v[128:131], a[76:79], v[160:163]
ds_read_b128 v[96:99], v31 offset:8192
v_mfma_f32_16x16x32_bf16 v[164:167], v[132:135], a[76:79], v[164:167]
ds_read_b128 v[100:103], v31 offset:9216
s_waitcnt vmcnt(8) lgkmcnt(9)
v_mfma_f32_16x16x32_bf16 v[148:151], v[48:51], a[28:31], v[148:151]
ds_read_b128 v[104:107], v31 offset:10240
v_mfma_f32_16x16x32_bf16 v[152:155], v[52:55], a[28:31], v[152:155]
ds_read_b128 v[108:111], v31 offset:11264
v_mfma_f32_16x16x32_bf16 v[156:159], v[56:59], a[28:31], v[156:159]
ds_read_b128 v[120:123], v31 offset:12288
v_mfma_f32_16x16x32_bf16 v[160:163], v[60:63], a[28:31], v[160:163]
ds_read_b128 v[124:127], v31 offset:13312
v_mfma_f32_16x16x32_bf16 v[164:167], v[64:67], a[28:31], v[164:167]
ds_read_b128 v[128:131], v31 offset:14336
s_waitcnt vmcnt(7) lgkmcnt(9)
v_mfma_f32_16x16x32_bf16 v[148:151], v[68:71], a[32:35], v[148:151]
ds_read_b128 v[132:135], v31 offset:15360
v_mfma_f32_16x16x32_bf16 v[152:155], v[72:75], a[32:35], v[152:155]
ds_read_b128 v[48:51], v23 offset:0
v_mfma_f32_16x16x32_bf16 v[156:159], v[76:79], a[32:35], v[156:159]
ds_read_b128 v[52:55], v23 offset:1024
v_mfma_f32_16x16x32_bf16 v[160:163], v[80:83], a[32:35], v[160:163]
ds_read_b128 v[56:59], v23 offset:2048
v_mfma_f32_16x16x32_bf16 v[164:167], v[84:87], a[32:35], v[164:167]
ds_read_b128 v[60:63], v23 offset:3072
s_waitcnt vmcnt(6) lgkmcnt(9)
v_mfma_f32_16x16x32_bf16 v[148:151], v[88:91], a[36:39], v[148:151]
ds_read_b128 v[64:67], v23 offset:4096
v_mfma_f32_16x16x32_bf16 v[152:155], v[92:95], a[36:39], v[152:155]
ds_read_b128 v[68:71], v23 offset:5120
v_mfma_f32_16x16x32_bf16 v[156:159], v[96:99], a[36:39], v[156:159]
ds_read_b128 v[72:75], v23 offset:6144
v_mfma_f32_16x16x32_bf16 v[160:163], v[100:103], a[36:39], v[160:163]
ds_read_b128 v[76:79], v23 offset:7168
v_mfma_f32_16x16x32_bf16 v[164:167], v[104:107], a[36:39], v[164:167]
ds_read_b128 v[80:83], v23 offset:8192
s_waitcnt vmcnt(5) lgkmcnt(9)
v_mfma_f32_16x16x32_bf16 v[148:151], v[108:111], a[40:43], v[148:151]
ds_read_b128 v[84:87], v23 offset:9216
v_mfma_f32_16x16x32_bf16 v[152:155], v[120:123], a[40:43], v[152:155]
ds_read_b128 v[88:91], v23 offset:10240
v_mfma_f32_16x16x32_bf16 v[156:159], v[124:127], a[40:43], v[156:159]
ds_read_b128 v[92:95], v23 offset:11264
v_mfma_f32_16x16x32_bf16 v[160:163], v[128:131], a[40:43], v[160:163]
ds_read_b128 v[96:99], v23 offset:12288
v_mfma_f32_16x16x32_bf16 v[164:167], v[132:135], a[40:43], v[164:167]
ds_read_b128 v[100:103], v23 offset:13312
s_waitcnt vmcnt(4) lgkmcnt(9)
v_mfma_f32_16x16x32_bf16 v[148:151], v[48:51], a[0:3], v[148:151]
ds_read_b128 v[104:107], v23 offset:14336
v_mfma_f32_16x16x32_bf16 v[152:155], v[52:55], a[0:3], v[152:155]
ds_read_b128 v[108:111], v23 offset:15360
v_mfma_f32_16x16x32_bf16 v[156:159], v[56:59], a[0:3], v[156:159]
ds_read_b128 v[120:123], v23 offset:16384
v_mfma_f32_16x16x32_bf16 v[160:163], v[60:63], a[0:3], v[160:163]
ds_read_b128 v[124:127], v23 offset:17408
v_mfma_f32_16x16x32_bf16 v[164:167], v[64:67], a[0:3], v[164:167]
ds_read_b128 v[128:131], v23 offset:18432
s_waitcnt vmcnt(3) lgkmcnt(9)
v_mfma_f32_16x16x32_bf16 v[148:151], v[68:71], a[4:7], v[148:151]
ds_read_b128 v[132:135], v23 offset:19456
v_mfma_f32_16x16x32_bf16 v[152:155], v[72:75], a[4:7], v[152:155]
v_mfma_f32_16x16x32_bf16 v[156:159], v[76:79], a[4:7], v[156:159]
v_mfma_f32_16x16x32_bf16 v[160:163], v[80:83], a[4:7], v[160:163]
v_mfma_f32_16x16x32_bf16 v[164:167], v[84:87], a[4:7], v[164:167]
s_waitcnt vmcnt(1) lgkmcnt(5)
v_mfma_f32_16x16x32_bf16 v[148:151], v[88:91], a[8:11], v[148:151]
v_mfma_f32_16x16x32_bf16 v[152:155], v[92:95], a[8:11], v[152:155]
v_mfma_f32_16x16x32_bf16 v[156:159], v[96:99], a[8:11], v[156:159]
v_mfma_f32_16x16x32_bf16 v[160:163], v[100:103], a[8:11], v[160:163]
v_mfma_f32_16x16x32_bf16 v[164:167], v[104:107], a[8:11], v[164:167]
s_waitcnt vmcnt(0) lgkmcnt(0)
v_mfma_f32_16x16x32_bf16 v[148:151], v[108:111], a[12:15], v[148:151]
v_mfma_f32_16x16x32_bf16 v[152:155], v[120:123], a[12:15], v[152:155]
v_mfma_f32_16x16x32_bf16 v[156:159], v[124:127], a[12:15], v[156:159]
v_mfma_f32_16x16x32_bf16 v[160:163], v[128:131], a[12:15], v[160:163]
v_mfma_f32_16x16x32_bf16 v[164:167], v[132:135], a[12:15], v[164:167]
ds_read_b64 v[6:7], v3 offset:0
s_waitcnt lgkmcnt(0)
v_min_u32 v6, v6, v7
v_cmp_gt_u32 vcc, 43, v6
s_nop 0
s_cbranch_vccnz W112
B113:
ds_read_b128 v[88:91], v26 offset:0
ds_read_b128 v[92:95], v26 offset:1024
ds_read_b128 v[96:99], v26 offset:2048
s_waitcnt lgkmcnt(2)
v_lshlrev_b32 v48, 16, v88
v_and_b32 v49, 0xffff0000, v88
v_lshlrev_b32 v50, 16, v89
v_and_b32 v51, 0xffff0000, v89
v_lshlrev_b32 v52, 16, v90
v_and_b32 v53, 0xffff0000, v90
v_lshlrev_b32 v54, 16, v91
v_and_b32 v55, 0xffff0000, v91
s_waitcnt lgkmcnt(1)
v_lshlrev_b32 v56, 16, v92
v_and_b32 v57, 0xffff0000, v92
v_lshlrev_b32 v58, 16, v93
v_and_b32 v59, 0xffff0000, v93
v_lshlrev_b32 v60, 16, v94
v_and_b32 v61, 0xffff0000, v94
v_lshlrev_b32 v62, 16, v95
v_and_b32 v63, 0xffff0000, v95
s_waitcnt lgkmcnt(0)
v_lshlrev_b32 v64, 16, v96
v_and_b32 v65, 0xffff0000, v96
v_lshlrev_b32 v66, 16, v97
v_and_b32 v67, 0xffff0000, v97
v_pk_add_f32 v[148:149], v[148:149], v[48:49]
v_cvt_pk_bf16_f32 v136, v148, v149
v_pk_add_f32 v[150:151], v[150:151], v[50:51]
v_cvt_pk_bf16_f32 v137, v150, v151
ds_write_b64 v25, v[136:137] offset:0
v_pk_add_f32 v[152:153], v[152:153], v[52:53]
v_cvt_pk_bf16_f32 v138, v152, v153
v_pk_add_f32 v[154:155], v[154:155], v[54:55]
v_cvt_pk_bf16_f32 v139, v154, v155
ds_write_b64 v25, v[138:139] offset:32
v_pk_add_f32 v[156:157], v[156:157], v[56:57]
v_cvt_pk_bf16_f32 v140, v156, v157
v_pk_add_f32 v[158:159], v[158:159], v[58:59]
v_cvt_pk_bf16_f32 v141, v158, v159
ds_write_b64 v25, v[140:141] offset:64
v_pk_add_f32 v[160:161], v[160:161], v[60:61]
v_cvt_pk_bf16_f32 v142, v160, v161
v_pk_add_f32 v[162:163], v[162:163], v[62:63]
v_cvt_pk_bf16_f32 v143, v162, v163
ds_write_b64 v25, v[142:143] offset:96
v_pk_add_f32 v[164:165], v[164:165], v[64:65]
v_cvt_pk_bf16_f32 v144, v164, v165
v_pk_add_f32 v[166:167], v[166:167], v[66:67]
v_cvt_pk_bf16_f32 v145, v166, v167
ds_write_b64 v25, v[144:145] offset:128
ds_read_b128 v[68:71], v26 offset:0
ds_read_b128 v[72:75], v26 offset:1024
ds_read_b128 v[76:79], v26 offset:2048
s_waitcnt lgkmcnt(2)
buffer_store_dwordx4 v[68:71], v115, s[32:35], 0 offen offset:0 nt
s_waitcnt lgkmcnt(1)
buffer_store_dwordx4 v[72:75], v116, s[32:35], 0 offen offset:1024 nt
s_mov_b32 exec_hi, 0
s_waitcnt lgkmcnt(0)
buffer_store_dwordx4 v[76:79], v117, s[32:35], 0 offen offset:2048 nt
s_mov_b32 exec_hi, -1
v_or_b32 v21, s2, v0
v_cmp_eq_u32 vcc, 0, v21
v_mov_b32 v30, 1073741824
s_nop 0
v_cndmask_b32 v21, v30, v21, vcc
buffer_store_dword v2, v21, s[36:39], 0 offen
L_fin:
L_end:
s_endpgm
s_waitcnt vmcnt(0) lgkmcnt(0)
W1:
ds_read_b64 v[6:7], v3 offset:0
s_sub_u32 s54, s54, 1
s_cmp_lt_i32 s54, 0
s_cbranch_scc1 B2
s_waitcnt lgkmcnt(0)
v_min_u32 v6, v6, v7
v_cmp_gt_u32 vcc, 1, v6
s_nop 0
s_cbranch_vccnz W1
s_branch B2
W3:
ds_read_b64 v[6:7], v3 offset:0
s_sub_u32 s54, s54, 1
s_cmp_lt_i32 s54, 0
s_cbranch_scc1 B4
s_waitcnt lgkmcnt(0)
v_min_u32 v6, v6, v7
v_cmp_gt_u32 vcc, 2, v6
s_nop 0
s_cbranch_vccnz W3
s_branch B4
W5:
ds_read_b64 v[6:7], v3 offset:0
s_sub_u32 s54, s54, 1
s_cmp_lt_i32 s54, 0
s_cbranch_scc1 B6
s_waitcnt lgkmcnt(0)
v_min_u32 v6, v6, v7
v_cmp_gt_u32 vcc, 3, v6
s_nop 0
s_cbranch_vccnz W5
s_branch B6
W7:
ds_read_b64 v[6:7], v3 offset:0
s_sub_u32 s54, s54, 1
s_cmp_lt_i32 s54, 0
s_cbranch_scc1 B8
s_waitcnt lgkmcnt(0)
v_min_u32 v6, v6, v7
v_cmp_gt_u32 vcc, 4, v6
s_nop 0
s_cbranch_vccnz W7
s_branch B8
W9:
ds_read_b64 v[6:7], v3 offset:0
s_sub_u32 s54, s54, 1
s_cmp_lt_i32 s54, 0
s_cbranch_scc1 B10
s_waitcnt lgkmcnt(0)
v_min_u32 v6, v6, v7
v_cmp_gt_u32 vcc, 5, v6
s_nop 0
s_cbranch_vccnz W9
s_branch B10
W11:
ds_read_b64 v[6:7], v3 offset:0
s_sub_u32 s54, s54, 1
s_cmp_lt_i32 s54, 0
s_cbranch_scc1 B12
s_waitcnt lgkmcnt(0)
v_min_u32 v6, v6, v7
v_cmp_gt_u32 vcc, 6, v6
s_nop 0
s_cbranch_vccnz W11
s_branch B12
W13:
ds_read_b64 v[6:7], v3 offset:0
s_sub_u32 s54, s54, 1
s_cmp_lt_i32 s54, 0
s_cbranch_scc1 B14
s_waitcnt lgkmcnt(0)
v_min_u32 v6, v6, v7
v_cmp_gt_u32 vcc, 7, v6
s_nop 0
s_cbranch_vccnz W13
s_branch B14
W15:
ds_read_b64 v[6:7], v3 offset:0
s_sub_u32 s54, s54, 1
s_cmp_lt_i32 s54, 0
s_cbranch_scc1 B16
s_waitcnt lgkmcnt(0)
v_min_u32 v6, v6, v7
v_cmp_gt_u32 vcc, 8, v6
s_nop 0
s_cbranch_vccnz W15
s_branch B16
W17:
ds_read_b32 v6, v3 offset:36
s_sub_u32 s54, s54, 1
s_cmp_lt_i32 s54, 0
s_cbranch_scc1 B18
s_waitcnt lgkmcnt(0)
v_cmp_gt_u32 vcc, 1, v6
s_nop 0
s_cbranch_vccnz W17
s_branch B18
W19:
ds_read_b64 v[6:7], v3 offset:0
s_sub_u32 s54, s54, 1
s_cmp_lt_i32 s54, 0
s_cbranch_scc1 B20
s_waitcnt lgkmcnt(0)
v_min_u32 v6, v6, v7
v_cmp_gt_u32 vcc, 9, v6
s_nop 0
s_cbranch_vccnz W19
s_branch B20
W21:
ds_read_b64 v[6:7], v3 offset:0
s_sub_u32 s54, s54, 1
s_cmp_lt_i32 s54, 0
s_cbranch_scc1 B22
s_waitcnt lgkmcnt(0)
v_min_u32 v6, v6, v7
v_cmp_gt_u32 vcc, 10, v6
s_nop 0
s_cbranch_vccnz W21
s_branch B22
W23:
ds_read_b64 v[6:7], v3 offset:0
s_sub_u32 s54, s54, 1
s_cmp_lt_i32 s54, 0
s_cbranch_scc1 B24
s_waitcnt lgkmcnt(0)
v_min_u32 v6, v6, v7
v_cmp_gt_u32 vcc, 1, v6
s_nop 0
s_cbranch_vccnz W23
s_branch B24
W25:
ds_read_b64 v[6:7], v3 offset:0
s_sub_u32 s54, s54, 1
s_cmp_lt_i32 s54, 0
s_cbranch_scc1 B26
s_waitcnt lgkmcnt(0)
v_min_u32 v6, v6, v7
v_cmp_gt_u32 vcc, 2, v6
s_nop 0
s_cbranch_vccnz W25
s_branch B26
W27:
ds_read_b64 v[6:7], v3 offset:0
s_sub_u32 s54, s54, 1
s_cmp_lt_i32 s54, 0
s_cbranch_scc1 B28
s_waitcnt lgkmcnt(0)
v_min_u32 v6, v6, v7
v_cmp_gt_u32 vcc, 3, v6
s_nop 0
s_cbranch_vccnz W27
s_branch B28
W29:
ds_read_b64 v[6:7], v3 offset:0
s_sub_u32 s54, s54, 1
s_cmp_lt_i32 s54, 0
s_cbranch_scc1 B30
s_waitcnt lgkmcnt(0)
v_min_u32 v6, v6, v7
v_cmp_gt_u32 vcc, 4, v6
s_nop 0
s_cbranch_vccnz W29
s_branch B30
W31:
ds_read_b64 v[6:7], v3 offset:0
s_sub_u32 s54, s54, 1
s_cmp_lt_i32 s54, 0
s_cbranch_scc1 B32
s_waitcnt lgkmcnt(0)
v_min_u32 v6, v6, v7
v_cmp_gt_u32 vcc, 5, v6
s_nop 0
s_cbranch_vccnz W31
s_branch B32
W33:
ds_read_b64 v[6:7], v3 offset:0
s_sub_u32 s54, s54, 1
s_cmp_lt_i32 s54, 0
s_cbranch_scc1 B34
s_waitcnt lgkmcnt(0)
v_min_u32 v6, v6, v7
v_cmp_gt_u32 vcc, 6, v6
s_nop 0
s_cbranch_vccnz W33
s_branch B34
W35:
ds_read_b64 v[6:7], v3 offset:0
s_sub_u32 s54, s54, 1
s_cmp_lt_i32 s54, 0
s_cbranch_scc1 B36
s_waitcnt lgkmcnt(0)
v_min_u32 v6, v6, v7
v_cmp_gt_u32 vcc, 7, v6
s_nop 0
s_cbranch_vccnz W35
s_branch B36
W37:
ds_read_b64 v[6:7], v3 offset:0
s_sub_u32 s54, s54, 1
s_cmp_lt_i32 s54, 0
s_cbranch_scc1 B38
s_waitcnt lgkmcnt(0)
v_min_u32 v6, v6, v7
v_cmp_gt_u32 vcc, 8, v6
s_nop 0
s_cbranch_vccnz W37
s_branch B38
W39:
ds_read_b32 v6, v3 offset:36
s_sub_u32 s54, s54, 1
s_cmp_lt_i32 s54, 0
s_cbranch_scc1 B40
s_waitcnt lgkmcnt(0)
v_cmp_gt_u32 vcc, 1, v6
s_nop 0
s_cbranch_vccnz W39
s_branch B40
W41:
ds_read_b64 v[6:7], v3 offset:0
s_sub_u32 s54, s54, 1
s_cmp_lt_i32 s54, 0
s_cbranch_scc1 B42
s_waitcnt lgkmcnt(0)
v_min_u32 v6, v6, v7
v_cmp_gt_u32 vcc, 9, v6
s_nop 0
s_cbranch_vccnz W41
s_branch B42
W43:
ds_read_b64 v[6:7], v3 offset:0
s_sub_u32 s54, s54, 1
s_cmp_lt_i32 s54, 0
s_cbranch_scc1 B44
s_waitcnt lgkmcnt(0)
v_min_u32 v6, v6, v7
v_cmp_gt_u32 vcc, 10, v6
s_nop 0
s_cbranch_vccnz W43
s_branch B44
W45:
ds_read_b64 v[6:7], v3 offset:0
s_sub_u32 s54, s54, 1
s_cmp_lt_i32 s54, 0
s_cbranch_scc1 B46
s_waitcnt lgkmcnt(0)
v_min_u32 v6, v6, v7
v_cmp_gt_u32 vcc, 1, v6
s_nop 0
s_cbranch_vccnz W45
s_branch B46
W47:
ds_read_b64 v[6:7], v3 offset:0
s_sub_u32 s54, s54, 1
s_cmp_lt_i32 s54, 0
s_cbranch_scc1 B48
s_waitcnt lgkmcnt(0)
v_min_u32 v6, v6, v7
v_cmp_gt_u32 vcc, 2, v6
s_nop 0
s_cbranch_vccnz W47
s_branch B48
W49:
ds_read_b64 v[6:7], v3 offset:0
s_sub_u32 s54, s54, 1
s_cmp_lt_i32 s54, 0
s_cbranch_scc1 B50
s_waitcnt lgkmcnt(0)
v_min_u32 v6, v6, v7
v_cmp_gt_u32 vcc, 3, v6
s_nop 0
s_cbranch_vccnz W49
s_branch B50
W51:
ds_read_b64 v[6:7], v3 offset:0
s_sub_u32 s54, s54, 1
s_cmp_lt_i32 s54, 0
s_cbranch_scc1 B52
s_waitcnt lgkmcnt(0)
v_min_u32 v6, v6, v7
v_cmp_gt_u32 vcc, 4, v6
s_nop 0
s_cbranch_vccnz W51
s_branch B52
W53:
ds_read_b64 v[6:7], v3 offset:0
s_sub_u32 s54, s54, 1
s_cmp_lt_i32 s54, 0
s_cbranch_scc1 B54
s_waitcnt lgkmcnt(0)
v_min_u32 v6, v6, v7
v_cmp_gt_u32 vcc, 5, v6
s_nop 0
s_cbranch_vccnz W53
s_branch B54
W55:
ds_read_b64 v[6:7], v3 offset:0
s_sub_u32 s54, s54, 1
s_cmp_lt_i32 s54, 0
s_cbranch_scc1 B56
s_waitcnt lgkmcnt(0)
v_min_u32 v6, v6, v7
v_cmp_gt_u32 vcc, 6, v6
s_nop 0
s_cbranch_vccnz W55
s_branch B56
W57:
ds_read_b64 v[6:7], v3 offset:0
s_sub_u32 s54, s54, 1
s_cmp_lt_i32 s54, 0
s_cbranch_scc1 B58
s_waitcnt lgkmcnt(0)
v_min_u32 v6, v6, v7
v_cmp_gt_u32 vcc, 7, v6
s_nop 0
s_cbranch_vccnz W57
s_branch B58
W59:
ds_read_b64 v[6:7], v3 offset:0
s_sub_u32 s54, s54, 1
s_cmp_lt_i32 s54, 0
s_cbranch_scc1 B60
s_waitcnt lgkmcnt(0)
v_min_u32 v6, v6, v7
v_cmp_gt_u32 vcc, 8, v6
s_nop 0
s_cbranch_vccnz W59
s_branch B60
W61:
ds_read_b32 v6, v3 offset:36
s_sub_u32 s54, s54, 1
s_cmp_lt_i32 s54, 0
s_cbranch_scc1 B62
s_waitcnt lgkmcnt(0)
v_cmp_gt_u32 vcc, 1, v6
s_nop 0
s_cbranch_vccnz W61
s_branch B62
W63:
ds_read_b64 v[6:7], v3 offset:0
s_sub_u32 s54, s54, 1
s_cmp_lt_i32 s54, 0
s_cbranch_scc1 B64
s_waitcnt lgkmcnt(0)
v_min_u32 v6, v6, v7
v_cmp_gt_u32 vcc, 9, v6
s_nop 0
s_cbranch_vccnz W63
s_branch B64
W65:
ds_read_b64 v[6:7], v3 offset:0
s_sub_u32 s54, s54, 1
s_cmp_lt_i32 s54, 0
s_cbranch_scc1 B66
s_waitcnt lgkmcnt(0)
v_min_u32 v6, v6, v7
v_cmp_gt_u32 vcc, 10, v6
s_nop 0
s_cbranch_vccnz W65
s_branch B66
W76:
ds_read_b64 v[6:7], v3 offset:0
s_sub_u32 s54, s54, 1
s_cmp_lt_i32 s54, 0
s_cbranch_scc1 B77
s_waitcnt lgkmcnt(0)
v_min_u32 v6, v6, v7
v_cmp_gt_u32 vcc, 15, v6
s_nop 0
s_cbranch_vccnz W76
s_branch B77
W80:
ds_read_b64 v[6:7], v3 offset:0
s_sub_u32 s54, s54, 1
s_cmp_lt_i32 s54, 0
s_cbranch_scc1 B81
s_waitcnt lgkmcnt(0)
v_min_u32 v6, v6, v7
v_cmp_gt_u32 vcc, 19, v6
s_nop 0
s_cbranch_vccnz W80
s_branch B81
N82:
s_mov_b64 s[74:75], 0
s_atomic_add_x2 s[74:75], s[36:37], s72 glc
s_sub_u32 s54, s54, 1
s_cmp_lt_i32 s54, 0
s_cbranch_scc1 B83
s_waitcnt lgkmcnt(0)
s_cmp_lg_u32 s75, s53
s_cbranch_scc1 N82
s_andn2_b32 s74, s73, s74
s_cbranch_scc1 N82
s_branch B83
N84:
s_mov_b64 s[74:75], 0
s_atomic_add_x2 s[74:75], s[36:37], s72 glc
s_sub_u32 s54, s54, 1
s_cmp_lt_i32 s54, 0
s_cbranch_scc1 B85
s_waitcnt lgkmcnt(0)
s_cmp_lg_u32 s75, s53
s_cbranch_scc1 N84
s_andn2_b32 s74, s76, s74
s_cbranch_scc1 N84
s_branch B85
N86:
s_mov_b64 s[74:75], 0
s_atomic_add_x2 s[74:75], s[36:37], s72 glc
s_sub_u32 s54, s54, 1
s_cmp_lt_i32 s54, 0
s_cbranch_scc1 B87
s_waitcnt lgkmcnt(0)
s_cmp_lg_u32 s75, s53
s_cbranch_scc1 N86
s_andn2_b32 s74, 65535, s74
s_cbranch_scc1 N86
s_branch B87
W88:
ds_read_b64 v[6:7], v3 offset:0
s_sub_u32 s54, s54, 1
s_cmp_lt_i32 s54, 0
s_cbranch_scc1 B89
s_waitcnt lgkmcnt(0)
v_min_u32 v6, v6, v7
v_cmp_gt_u32 vcc, 22, v6
s_nop 0
s_cbranch_vccnz W88
s_branch B89
R90:
s_waitcnt vmcnt(0) lgkmcnt(0)
R92:
s_sleep 4
buffer_load_dwordx4 v[32:35], v16, s[36:39], 0 offen offset:0 sc1
buffer_load_dwordx4 v[36:39], v16, s[36:39], 0 offen offset:512 sc1
buffer_load_dwordx4 v[40:43], v16, s[36:39], 0 offen offset:1024 sc1
buffer_load_dwordx4 v[44:47], v16, s[36:39], 0 offen offset:1536 sc1
s_waitcnt vmcnt(0)
s_sub_u32 s54, s54, 1
s_cmp_lt_i32 s54, 0
s_cbranch_scc1 B91
v_xor_b32 v119, s53, v34
v_bitop3_b32 v119, v119, v2, v38 bitop3:0xf6
v_bitop3_b32 v119, v119, v2, v42 bitop3:0xf6
v_bitop3_b32 v119, v119, v2, v46 bitop3:0xf6
v_cmp_ne_u32 vcc, 0, v119
s_nop 0
s_cbranch_vccnz R92
s_nop 4
s_branch B91
W93:
ds_read_b64 v[6:7], v3 offset:0
s_sub_u32 s54, s54, 1
s_cmp_lt_i32 s54, 0
s_cbranch_scc1 B94
s_waitcnt lgkmcnt(0)
v_min_u32 v6, v6, v7
v_cmp_gt_u32 vcc, 25, v6
s_nop 0
s_cbranch_vccnz W93
s_branch B94
W95:
ds_read_b32 v6, v3 offset:56
s_sub_u32 s54, s54, 1
s_cmp_lt_i32 s54, 0
s_cbranch_scc1 B96
s_waitcnt lgkmcnt(0)
v_cmp_gt_u32 vcc, 2, v6
s_nop 0
s_cbranch_vccnz W95
s_branch B96
W99:
s_waitcnt vmcnt(0)
buffer_atomic_or v8, v5, s[36:39], s64 offen sc1
W97:
ds_read_b64 v[6:7], v3 offset:0
s_sub_u32 s54, s54, 1
s_cmp_lt_i32 s54, 0
s_cbranch_scc1 B98
s_waitcnt lgkmcnt(0)
v_min_u32 v6, v6, v7
v_cmp_gt_u32 vcc, 34, v6
s_nop 0
s_cbranch_vccnz W97
s_branch B98
W100:
ds_read_b64 v[6:7], v3 offset:0
s_sub_u32 s54, s54, 1
s_cmp_lt_i32 s54, 0
s_cbranch_scc1 B101
s_waitcnt lgkmcnt(0)
v_min_u32 v6, v6, v7
v_cmp_gt_u32 vcc, 37, v6
s_nop 0
s_cbranch_vccnz W100
s_branch B101
N102:
s_mov_b64 s[74:75], 0
s_atomic_add_x2 s[74:75], s[36:37], s72 glc
s_sub_u32 s54, s54, 1
s_cmp_lt_i32 s54, 0
s_cbranch_scc1 B103
s_waitcnt lgkmcnt(0)
s_cmp_lg_u32 s75, s53
s_cbranch_scc1 N102
s_andn2_b32 s74, s80, s74
s_cbranch_scc1 N102
s_branch B103
N104:
s_mov_b64 s[74:75], 0
s_atomic_add_x2 s[74:75], s[36:37], s72 glc
s_sub_u32 s54, s54, 1
s_cmp_lt_i32 s54, 0
s_cbranch_scc1 B105
s_waitcnt lgkmcnt(0)
s_cmp_lg_u32 s75, s53
s_cbranch_scc1 N104
s_andn2_b32 s74, s76, s74
s_cbranch_scc1 N104
s_branch B105
N106:
s_mov_b64 s[74:75], 0
s_atomic_add_x2 s[74:75], s[36:37], s72 glc
s_sub_u32 s54, s54, 1
s_cmp_lt_i32 s54, 0
s_cbranch_scc1 B107
s_waitcnt lgkmcnt(0)
s_cmp_lg_u32 s75, s53
s_cbranch_scc1 N106
s_andn2_b32 s74, s76, s74
s_cbranch_scc1 N106
s_branch B107
W108:
ds_read_b64 v[6:7], v3 offset:0
s_sub_u32 s54, s54, 1
s_cmp_lt_i32 s54, 0
s_cbranch_scc1 B109
s_waitcnt lgkmcnt(0)
v_min_u32 v6, v6, v7
v_cmp_gt_u32 vcc, 40, v6
s_nop 0
s_cbranch_vccnz W108
s_branch B109
W110:
ds_read_b64 v[6:7], v3 offset:0
s_sub_u32 s54, s54, 1
s_cmp_lt_i32 s54, 0
s_cbranch_scc1 B111
s_waitcnt lgkmcnt(0)
v_min_u32 v6, v6, v7
v_cmp_gt_u32 vcc, 42, v6
s_nop 0
s_cbranch_vccnz W110
s_branch B111
W112:
ds_read_b64 v[6:7], v3 offset:0
s_sub_u32 s54, s54, 1
s_cmp_lt_i32 s54, 0
s_cbranch_scc1 B113
s_waitcnt lgkmcnt(0)
v_min_u32 v6, v6, v7
v_cmp_gt_u32 vcc, 43, v6
s_nop 0
s_cbranch_vccnz W112
s_branch B113
W116:
s_waitcnt vmcnt(0)
v_mov_b32 v9, 3
ds_max_u32 v10, v9
W114:
ds_read_b32 v6, v3 offset:8
s_sleep 1
s_sub_u32 s54, s54, 1
s_cmp_lt_i32 s54, 0
s_cbranch_scc1 B115
s_waitcnt lgkmcnt(0)
v_cmp_gt_u32 vcc, 1, v6
s_nop 0
s_cbranch_vccnz W114
s_branch B115
S117:
s_waitcnt vmcnt(0)
v_mov_b32 v9, 4
ds_max_u32 v10, v9
ds_read_b128 v[12:15], v3 offset:16
s_waitcnt lgkmcnt(0)
v_min3_u32 v12, v12, v13, v14
v_min_u32 v12, v12, v15
v_cmp_gt_u32 vcc, 1, v12
s_nop 0
s_cbranch_vccz B118
S119:
s_sleep 1
s_sub_u32 s54, s54, 1
s_cmp_lt_i32 s54, 0
s_cbranch_scc1 B118
ds_read_b128 v[12:15], v3 offset:16
s_waitcnt lgkmcnt(0)
v_min3_u32 v12, v12, v13, v14
v_min_u32 v12, v12, v15
v_cmp_gt_u32 vcc, 1, v12
s_nop 0
s_cbranch_vccnz S119
s_branch B118
S120:
s_waitcnt vmcnt(0)
v_mov_b32 v9, 5
ds_max_u32 v10, v9
ds_read_b128 v[12:15], v3 offset:16
s_waitcnt lgkmcnt(0)
v_min3_u32 v12, v12, v13, v14
v_min_u32 v12, v12, v15
v_cmp_gt_u32 vcc, 2, v12
s_nop 0
s_cbranch_vccz B121
S122:
s_sleep 1
s_sub_u32 s54, s54, 1
s_cmp_lt_i32 s54, 0
s_cbranch_scc1 B121
ds_read_b128 v[12:15], v3 offset:16
s_waitcnt lgkmcnt(0)
v_min3_u32 v12, v12, v13, v14
v_min_u32 v12, v12, v15
v_cmp_gt_u32 vcc, 2, v12
s_nop 0
s_cbranch_vccnz S122
s_branch B121
S123:
s_waitcnt vmcnt(0)
v_mov_b32 v9, 6
ds_max_u32 v10, v9
ds_read_b128 v[12:15], v3 offset:16
s_waitcnt lgkmcnt(0)
v_min3_u32 v12, v12, v13, v14
v_min_u32 v12, v12, v15
v_cmp_gt_u32 vcc, 3, v12
s_nop 0
s_cbranch_vccz B124
S125:
s_sleep 1
s_sub_u32 s54, s54, 1
s_cmp_lt_i32 s54, 0
s_cbranch_scc1 B124
ds_read_b128 v[12:15], v3 offset:16
s_waitcnt lgkmcnt(0)
v_min3_u32 v12, v12, v13, v14
v_min_u32 v12, v12, v15
v_cmp_gt_u32 vcc, 3, v12
s_nop 0
s_cbranch_vccnz S125
s_branch B124
S126:
s_waitcnt vmcnt(0)
v_mov_b32 v9, 7
ds_max_u32 v10, v9
ds_read_b128 v[12:15], v3 offset:16
s_waitcnt lgkmcnt(0)
v_min3_u32 v12, v12, v13, v14
v_min_u32 v12, v12, v15
v_cmp_gt_u32 vcc, 4, v12
s_nop 0
s_cbranch_vccz B127
S128:
s_sleep 1
s_sub_u32 s54, s54, 1
s_cmp_lt_i32 s54, 0
s_cbranch_scc1 B127
ds_read_b128 v[12:15], v3 offset:16
s_waitcnt lgkmcnt(0)
v_min3_u32 v12, v12, v13, v14
v_min_u32 v12, v12, v15
v_cmp_gt_u32 vcc, 4, v12
s_nop 0
s_cbranch_vccnz S128
s_branch B127
S129:
s_waitcnt vmcnt(0)
v_mov_b32 v9, 8
ds_max_u32 v10, v9
ds_read_b128 v[12:15], v3 offset:16
s_waitcnt lgkmcnt(0)
v_min3_u32 v12, v12, v13, v14
v_min_u32 v12, v12, v15
v_cmp_gt_u32 vcc, 5, v12
s_nop 0
s_cbranch_vccz B130
S131:
s_sleep 1
s_sub_u32 s54, s54, 1
s_cmp_lt_i32 s54, 0
s_cbranch_scc1 B130
ds_read_b128 v[12:15], v3 offset:16
s_waitcnt lgkmcnt(0)
v_min3_u32 v12, v12, v13, v14
v_min_u32 v12, v12, v15
v_cmp_gt_u32 vcc, 5, v12
s_nop 0
s_cbranch_vccnz S131
s_branch B130
S132:
s_waitcnt vmcnt(0)
v_mov_b32 v9, 9
ds_max_u32 v10, v9
ds_read_b128 v[12:15], v3 offset:16
s_waitcnt lgkmcnt(0)
v_min3_u32 v12, v12, v13, v14
v_min_u32 v12, v12, v15
v_cmp_gt_u32 vcc, 6, v12
s_nop 0
s_cbranch_vccz B133
S134:
s_sleep 1
s_sub_u32 s54, s54, 1
s_cmp_lt_i32 s54, 0
s_cbranch_scc1 B133
ds_read_b128 v[12:15], v3 offset:16
s_waitcnt lgkmcnt(0)
v_min3_u32 v12, v12, v13, v14
v_min_u32 v12, v12, v15
v_cmp_gt_u32 vcc, 6, v12
s_nop 0
s_cbranch_vccnz S134
s_branch B133
W137:
s_waitcnt vmcnt(0)
v_mov_b32 v9, 3
ds_max_u32 v10, v9
W135:
ds_read_b32 v6, v3 offset:8
s_sleep 1
s_sub_u32 s54, s54, 1
s_cmp_lt_i32 s54, 0
s_cbranch_scc1 B136
s_waitcnt lgkmcnt(0)
v_cmp_gt_u32 vcc, 1, v6
s_nop 0
s_cbranch_vccnz W135
s_branch B136
S138:
s_waitcnt vmcnt(0)
v_mov_b32 v9, 4
ds_max_u32 v10, v9
ds_read_b128 v[12:15], v3 offset:16
s_waitcnt lgkmcnt(0)
v_min3_u32 v12, v12, v13, v14
v_min_u32 v12, v12, v15
v_cmp_gt_u32 vcc, 1, v12
s_nop 0
s_cbranch_vccz B139
S140:
s_sleep 1
s_sub_u32 s54, s54, 1
s_cmp_lt_i32 s54, 0
s_cbranch_scc1 B139
ds_read_b128 v[12:15], v3 offset:16
s_waitcnt lgkmcnt(0)
v_min3_u32 v12, v12, v13, v14
v_min_u32 v12, v12, v15
v_cmp_gt_u32 vcc, 1, v12
s_nop 0
s_cbranch_vccnz S140
s_branch B139
S141:
s_waitcnt vmcnt(0)
v_mov_b32 v9, 5
ds_max_u32 v10, v9
ds_read_b128 v[12:15], v3 offset:16
s_waitcnt lgkmcnt(0)
v_min3_u32 v12, v12, v13, v14
v_min_u32 v12, v12, v15
v_cmp_gt_u32 vcc, 2, v12
s_nop 0
s_cbranch_vccz B142
S143:
s_sleep 1
s_sub_u32 s54, s54, 1
s_cmp_lt_i32 s54, 0
s_cbranch_scc1 B142
ds_read_b128 v[12:15], v3 offset:16
s_waitcnt lgkmcnt(0)
v_min3_u32 v12, v12, v13, v14
v_min_u32 v12, v12, v15
v_cmp_gt_u32 vcc, 2, v12
s_nop 0
s_cbranch_vccnz S143
s_branch B142
S144:
s_waitcnt vmcnt(0)
v_mov_b32 v9, 6
ds_max_u32 v10, v9
ds_read_b128 v[12:15], v3 offset:16
s_waitcnt lgkmcnt(0)
v_min3_u32 v12, v12, v13, v14
v_min_u32 v12, v12, v15
v_cmp_gt_u32 vcc, 3, v12
s_nop 0
s_cbranch_vccz B145
S146:
s_sleep 1
s_sub_u32 s54, s54, 1
s_cmp_lt_i32 s54, 0
s_cbranch_scc1 B145
ds_read_b128 v[12:15], v3 offset:16
s_waitcnt lgkmcnt(0)
v_min3_u32 v12, v12, v13, v14
v_min_u32 v12, v12, v15
v_cmp_gt_u32 vcc, 3, v12
s_nop 0
s_cbranch_vccnz S146
s_branch B145
S147:
s_waitcnt vmcnt(0)
v_mov_b32 v9, 7
ds_max_u32 v10, v9
ds_read_b128 v[12:15], v3 offset:16
s_waitcnt lgkmcnt(0)
v_min3_u32 v12, v12, v13, v14
v_min_u32 v12, v12, v15
v_cmp_gt_u32 vcc, 4, v12
s_nop 0
s_cbranch_vccz B148
S149:
s_sleep 1
s_sub_u32 s54, s54, 1
s_cmp_lt_i32 s54, 0
s_cbranch_scc1 B148
ds_read_b128 v[12:15], v3 offset:16
s_waitcnt lgkmcnt(0)
v_min3_u32 v12, v12, v13, v14
v_min_u32 v12, v12, v15
v_cmp_gt_u32 vcc, 4, v12
s_nop 0
s_cbranch_vccnz S149
s_branch B148
S150:
s_waitcnt vmcnt(0)
v_mov_b32 v9, 8
ds_max_u32 v10, v9
ds_read_b128 v[12:15], v3 offset:16
s_waitcnt lgkmcnt(0)
v_min3_u32 v12, v12, v13, v14
v_min_u32 v12, v12, v15
v_cmp_gt_u32 vcc, 5, v12
s_nop 0
s_cbranch_vccz B151
S152:
s_sleep 1
s_sub_u32 s54, s54, 1
s_cmp_lt_i32 s54, 0
s_cbranch_scc1 B151
ds_read_b128 v[12:15], v3 offset:16
s_waitcnt lgkmcnt(0)
v_min3_u32 v12, v12, v13, v14
v_min_u32 v12, v12, v15
v_cmp_gt_u32 vcc, 5, v12
s_nop 0
s_cbranch_vccnz S152
s_branch B151
S153:
s_waitcnt vmcnt(0)
v_mov_b32 v9, 9
ds_max_u32 v10, v9
ds_read_b128 v[12:15], v3 offset:16
s_waitcnt lgkmcnt(0)
v_min3_u32 v12, v12, v13, v14
v_min_u32 v12, v12, v15
v_cmp_gt_u32 vcc, 6, v12
s_nop 0
s_cbranch_vccz B154
S155:
s_sleep 1
s_sub_u32 s54, s54, 1
s_cmp_lt_i32 s54, 0
s_cbranch_scc1 B154
ds_read_b128 v[12:15], v3 offset:16
s_waitcnt lgkmcnt(0)
v_min3_u32 v12, v12, v13, v14
v_min_u32 v12, v12, v15
v_cmp_gt_u32 vcc, 6, v12
s_nop 0
s_cbranch_vccnz S155
s_branch B154
W158:
s_waitcnt vmcnt(0)
v_mov_b32 v9, 10
ds_max_u32 v10, v9
W156:
ds_read_b32 v6, v3 offset:32
s_sleep 1
s_sub_u32 s54, s54, 1
s_cmp_lt_i32 s54, 0
s_cbranch_scc1 B157
s_waitcnt lgkmcnt(0)
v_cmp_gt_u32 vcc, 1, v6
s_nop 0
s_cbranch_vccnz W156
s_branch B157
S159:
s_waitcnt vmcnt(0)
v_mov_b32 v9, 10
ds_max_u32 v10, v9
ds_read_b128 v[12:15], v3 offset:16
s_waitcnt lgkmcnt(0)
v_min3_u32 v12, v12, v13, v14
v_min_u32 v12, v12, v15
v_cmp_gt_u32 vcc, 7, v12
s_nop 0
s_cbranch_vccz B160
S161:
s_sleep 1
s_sub_u32 s54, s54, 1
s_cmp_lt_i32 s54, 0
s_cbranch_scc1 B160
ds_read_b128 v[12:15], v3 offset:16
s_waitcnt lgkmcnt(0)
v_min3_u32 v12, v12, v13, v14
v_min_u32 v12, v12, v15
v_cmp_gt_u32 vcc, 7, v12
s_nop 0
s_cbranch_vccnz S161
s_branch B160
S162:
s_waitcnt vmcnt(0)
v_mov_b32 v9, 11
ds_max_u32 v10, v9
ds_read_b128 v[12:15], v3 offset:16
s_waitcnt lgkmcnt(0)
v_min3_u32 v12, v12, v13, v14
v_min_u32 v12, v12, v15
v_cmp_gt_u32 vcc, 8, v12
s_nop 0
s_cbranch_vccz B163
S164:
s_sleep 1
s_sub_u32 s54, s54, 1
s_cmp_lt_i32 s54, 0
s_cbranch_scc1 B163
ds_read_b128 v[12:15], v3 offset:16
s_waitcnt lgkmcnt(0)
v_min3_u32 v12, v12, v13, v14
v_min_u32 v12, v12, v15
v_cmp_gt_u32 vcc, 8, v12
s_nop 0
s_cbranch_vccnz S164
s_branch B163
S165:
s_waitcnt vmcnt(0)
v_mov_b32 v9, 12
ds_max_u32 v10, v9
ds_read_b128 v[12:15], v3 offset:16
s_waitcnt lgkmcnt(0)
v_min3_u32 v12, v12, v13, v14
v_min_u32 v12, v12, v15
v_cmp_gt_u32 vcc, 9, v12
s_nop 0
s_cbranch_vccz B166
S167:
s_sleep 1
s_sub_u32 s54, s54, 1
s_cmp_lt_i32 s54, 0
s_cbranch_scc1 B166
ds_read_b128 v[12:15], v3 offset:16
s_waitcnt lgkmcnt(0)
v_min3_u32 v12, v12, v13, v14
v_min_u32 v12, v12, v15
v_cmp_gt_u32 vcc, 9, v12
s_nop 0
s_cbranch_vccnz S167
s_branch B166
S168:
s_waitcnt vmcnt(0)
v_mov_b32 v9, 14
ds_max_u32 v10, v9
ds_read_b128 v[12:15], v3 offset:16
s_waitcnt lgkmcnt(0)
v_min3_u32 v12, v12, v13, v14
v_min_u32 v12, v12, v15
v_cmp_gt_u32 vcc, 10, v12
s_nop 0
s_cbranch_vccz B169
S170:
s_sleep 1
s_sub_u32 s54, s54, 1
s_cmp_lt_i32 s54, 0
s_cbranch_scc1 B169
ds_read_b128 v[12:15], v3 offset:16
s_waitcnt lgkmcnt(0)
v_min3_u32 v12, v12, v13, v14
v_min_u32 v12, v12, v15
v_cmp_gt_u32 vcc, 10, v12
s_nop 0
s_cbranch_vccnz S170
s_branch B169
S171:
s_waitcnt vmcnt(6)
v_mov_b32 v9, 16
ds_max_u32 v10, v9
ds_read_b128 v[12:15], v3 offset:16
s_waitcnt lgkmcnt(0)
v_min3_u32 v12, v12, v13, v14
v_min_u32 v12, v12, v15
v_cmp_gt_u32 vcc, 11, v12
s_nop 0
s_cbranch_vccz B172
s_waitcnt vmcnt(0)
v_mov_b32 v9, 17
ds_max_u32 v10, v9
ds_read_b128 v[12:15], v3 offset:16
s_waitcnt lgkmcnt(0)
v_min3_u32 v12, v12, v13, v14
v_min_u32 v12, v12, v15
v_cmp_gt_u32 vcc, 11, v12
s_nop 0
s_cbranch_vccz B172
S173:
s_sleep 1
s_sub_u32 s54, s54, 1
s_cmp_lt_i32 s54, 0
s_cbranch_scc1 B172
ds_read_b128 v[12:15], v3 offset:16
s_waitcnt lgkmcnt(0)
v_min3_u32 v12, v12, v13, v14
v_min_u32 v12, v12, v15
v_cmp_gt_u32 vcc, 11, v12
s_nop 0
s_cbranch_vccnz S173
s_branch B172
W176:
s_waitcnt vmcnt(6)
v_mov_b32 v9, 17
ds_max_u32 v10, v9
s_waitcnt vmcnt(0)
v_mov_b32 v9, 18
ds_max_u32 v10, v9
W174:
ds_read_b64 v[6:7], v3 offset:40
s_sleep 1
s_sub_u32 s54, s54, 1
s_cmp_lt_i32 s54, 0
s_cbranch_scc1 B175
s_waitcnt lgkmcnt(0)
v_min_u32 v6, v6, v7
v_cmp_gt_u32 vcc, 1, v6
s_nop 0
s_cbranch_vccnz W174
s_branch B175
S177:
s_waitcnt vmcnt(6)
v_mov_b32 v9, 18
ds_max_u32 v10, v9
ds_read_b128 v[12:15], v3 offset:16
s_waitcnt lgkmcnt(0)
v_min3_u32 v12, v12, v13, v14
v_min_u32 v12, v12, v15
v_cmp_gt_u32 vcc, 12, v12
s_nop 0
s_cbranch_vccz B178
s_waitcnt vmcnt(0)
v_mov_b32 v9, 19
ds_max_u32 v10, v9
ds_read_b128 v[12:15], v3 offset:16
s_waitcnt lgkmcnt(0)
v_min3_u32 v12, v12, v13, v14
v_min_u32 v12, v12, v15
v_cmp_gt_u32 vcc, 12, v12
s_nop 0
s_cbranch_vccz B178
S179:
s_sleep 1
s_sub_u32 s54, s54, 1
s_cmp_lt_i32 s54, 0
s_cbranch_scc1 B178
ds_read_b128 v[12:15], v3 offset:16
s_waitcnt lgkmcnt(0)
v_min3_u32 v12, v12, v13, v14
v_min_u32 v12, v12, v15
v_cmp_gt_u32 vcc, 12, v12
s_nop 0
s_cbranch_vccnz S179
s_branch B178
S180:
s_waitcnt vmcnt(6)
v_mov_b32 v9, 22
ds_max_u32 v10, v9
ds_read_b128 v[12:15], v3 offset:16
s_waitcnt lgkmcnt(0)
v_min3_u32 v12, v12, v13, v14
v_min_u32 v12, v12, v15
v_cmp_gt_u32 vcc, 13, v12
s_nop 0
s_cbranch_vccz B181
s_waitcnt vmcnt(0)
v_mov_b32 v9, 23
ds_max_u32 v10, v9
ds_read_b128 v[12:15], v3 offset:16
s_waitcnt lgkmcnt(0)
v_min3_u32 v12, v12, v13, v14
v_min_u32 v12, v12, v15
v_cmp_gt_u32 vcc, 13, v12
s_nop 0
s_cbranch_vccz B181
S182:
s_sleep 1
s_sub_u32 s54, s54, 1
s_cmp_lt_i32 s54, 0
s_cbranch_scc1 B181
ds_read_b128 v[12:15], v3 offset:16
s_waitcnt lgkmcnt(0)
v_min3_u32 v12, v12, v13, v14
v_min_u32 v12, v12, v15
v_cmp_gt_u32 vcc, 13, v12
s_nop 0
s_cbranch_vccnz S182
s_branch B181
W185:
s_waitcnt vmcnt(6)
v_mov_b32 v9, 24
ds_max_u32 v10, v9
s_waitcnt vmcnt(0)
v_mov_b32 v9, 25
ds_max_u32 v10, v9
W183:
ds_read_b32 v6, v3 offset:32
s_sleep 1
s_sub_u32 s54, s54, 1
s_cmp_lt_i32 s54, 0
s_cbranch_scc1 B184
s_waitcnt lgkmcnt(0)
v_cmp_gt_u32 vcc, 2, v6
s_nop 0
s_cbranch_vccnz W183
s_branch B184
S186:
s_waitcnt vmcnt(6)
v_mov_b32 v9, 24
ds_max_u32 v10, v9
ds_read_b128 v[12:15], v3 offset:16
s_waitcnt lgkmcnt(0)
v_min3_u32 v12, v12, v13, v14
v_min_u32 v12, v12, v15
v_cmp_gt_u32 vcc, 14, v12
s_nop 0
s_cbranch_vccz B187
s_waitcnt vmcnt(0)
v_mov_b32 v9, 25
ds_max_u32 v10, v9
ds_read_b128 v[12:15], v3 offset:16
s_waitcnt lgkmcnt(0)
v_min3_u32 v12, v12, v13, v14
v_min_u32 v12, v12, v15
v_cmp_gt_u32 vcc, 14, v12
s_nop 0
s_cbranch_vccz B187
S188:
s_sleep 1
s_sub_u32 s54, s54, 1
s_cmp_lt_i32 s54, 0
s_cbranch_scc1 B187
ds_read_b128 v[12:15], v3 offset:16
s_waitcnt lgkmcnt(0)
v_min3_u32 v12, v12, v13, v14
v_min_u32 v12, v12, v15
v_cmp_gt_u32 vcc, 14, v12
s_nop 0
s_cbranch_vccnz S188
s_branch B187
S189:
s_waitcnt vmcnt(5)
v_mov_b32 v9, 26
ds_max_u32 v10, v9
ds_read_b128 v[12:15], v3 offset:16
s_waitcnt lgkmcnt(0)
v_min3_u32 v12, v12, v13, v14
v_min_u32 v12, v12, v15
v_cmp_gt_u32 vcc, 15, v12
s_nop 0
s_cbranch_vccz B190
s_waitcnt vmcnt(0)
v_mov_b32 v9, 27
ds_max_u32 v10, v9
ds_read_b128 v[12:15], v3 offset:16
s_waitcnt lgkmcnt(0)
v_min3_u32 v12, v12, v13, v14
v_min_u32 v12, v12, v15
v_cmp_gt_u32 vcc, 15, v12
s_nop 0
s_cbranch_vccz B190
S191:
s_sleep 1
s_sub_u32 s54, s54, 1
s_cmp_lt_i32 s54, 0
s_cbranch_scc1 B190
ds_read_b128 v[12:15], v3 offset:16
s_waitcnt lgkmcnt(0)
v_min3_u32 v12, v12, v13, v14
v_min_u32 v12, v12, v15
v_cmp_gt_u32 vcc, 15, v12
s_nop 0
s_cbranch_vccnz S191
s_branch B190
S192:
s_waitcnt vmcnt(5)
v_mov_b32 v9, 28
ds_max_u32 v10, v9
ds_read_b128 v[12:15], v3 offset:16
s_waitcnt lgkmcnt(0)
v_min3_u32 v12, v12, v13, v14
v_min_u32 v12, v12, v15
v_cmp_gt_u32 vcc, 16, v12
s_nop 0
s_cbranch_vccz B193
s_waitcnt vmcnt(0)
v_mov_b32 v9, 29
ds_max_u32 v10, v9
ds_read_b128 v[12:15], v3 offset:16
s_waitcnt lgkmcnt(0)
v_min3_u32 v12, v12, v13, v14
v_min_u32 v12, v12, v15
v_cmp_gt_u32 vcc, 16, v12
s_nop 0
s_cbranch_vccz B193
S194:
s_sleep 1
s_sub_u32 s54, s54, 1
s_cmp_lt_i32 s54, 0
s_cbranch_scc1 B193
ds_read_b128 v[12:15], v3 offset:16
s_waitcnt lgkmcnt(0)
v_min3_u32 v12, v12, v13, v14
v_min_u32 v12, v12, v15
v_cmp_gt_u32 vcc, 16, v12
s_nop 0
s_cbranch_vccnz S194
s_branch B193
S195:
s_waitcnt vmcnt(5)
v_mov_b32 v9, 31
ds_max_u32 v10, v9
ds_read_b128 v[12:15], v3 offset:16
s_waitcnt lgkmcnt(0)
v_min3_u32 v12, v12, v13, v14
v_min_u32 v12, v12, v15
v_cmp_gt_u32 vcc, 17, v12
s_nop 0
s_cbranch_vccz B196
s_waitcnt vmcnt(0)
v_mov_b32 v9, 32
ds_max_u32 v10, v9
ds_read_b128 v[12:15], v3 offset:16
s_waitcnt lgkmcnt(0)
v_min3_u32 v12, v12, v13, v14
v_min_u32 v12, v12, v15
v_cmp_gt_u32 vcc, 17, v12
s_nop 0
s_cbranch_vccz B196
S197:
s_sleep 1
s_sub_u32 s54, s54, 1
s_cmp_lt_i32 s54, 0
s_cbranch_scc1 B196
ds_read_b128 v[12:15], v3 offset:16
s_waitcnt lgkmcnt(0)
v_min3_u32 v12, v12, v13, v14
v_min_u32 v12, v12, v15
v_cmp_gt_u32 vcc, 17, v12
s_nop 0
s_cbranch_vccnz S197
s_branch B196
W200:
s_waitcnt vmcnt(5)
v_mov_b32 v9, 31
ds_max_u32 v10, v9
s_waitcnt vmcnt(0)
v_mov_b32 v9, 32
ds_max_u32 v10, v9
W198:
ds_read_b32 v6, v3 offset:56
s_sleep 1
s_sub_u32 s54, s54, 1
s_cmp_lt_i32 s54, 0
s_cbranch_scc1 B199
s_waitcnt lgkmcnt(0)
v_cmp_gt_u32 vcc, 1, v6
s_nop 0
s_cbranch_vccnz W198
s_branch B199
S201:
s_waitcnt vmcnt(10)
v_mov_b32 v9, 32
ds_max_u32 v10, v9
ds_read_b128 v[12:15], v3 offset:16
s_waitcnt lgkmcnt(0)
v_min3_u32 v12, v12, v13, v14
v_min_u32 v12, v12, v15
v_cmp_gt_u32 vcc, 18, v12
s_nop 0
s_cbranch_vccz B202
s_waitcnt vmcnt(5)
v_mov_b32 v9, 33
ds_max_u32 v10, v9
ds_read_b128 v[12:15], v3 offset:16
s_waitcnt lgkmcnt(0)
v_min3_u32 v12, v12, v13, v14
v_min_u32 v12, v12, v15
v_cmp_gt_u32 vcc, 18, v12
s_nop 0
s_cbranch_vccz B202
s_waitcnt vmcnt(0)
v_mov_b32 v9, 34
ds_max_u32 v10, v9
ds_read_b128 v[12:15], v3 offset:16
s_waitcnt lgkmcnt(0)
v_min3_u32 v12, v12, v13, v14
v_min_u32 v12, v12, v15
v_cmp_gt_u32 vcc, 18, v12
s_nop 0
s_cbranch_vccz B202
S203:
s_sleep 1
s_sub_u32 s54, s54, 1
s_cmp_lt_i32 s54, 0
s_cbranch_scc1 B202
ds_read_b128 v[12:15], v3 offset:16
s_waitcnt lgkmcnt(0)
v_min3_u32 v12, v12, v13, v14
v_min_u32 v12, v12, v15
v_cmp_gt_u32 vcc, 18, v12
s_nop 0
s_cbranch_vccnz S203
s_branch B202
S204:
s_waitcnt vmcnt(10)
v_mov_b32 v9, 34
ds_max_u32 v10, v9
ds_read_b128 v[12:15], v3 offset:16
s_waitcnt lgkmcnt(0)
v_min3_u32 v12, v12, v13, v14
v_min_u32 v12, v12, v15
v_cmp_gt_u32 vcc, 19, v12
s_nop 0
s_cbranch_vccz B205
s_waitcnt vmcnt(5)
v_mov_b32 v9, 35
ds_max_u32 v10, v9
ds_read_b128 v[12:15], v3 offset:16
s_waitcnt lgkmcnt(0)
v_min3_u32 v12, v12, v13, v14
v_min_u32 v12, v12, v15
v_cmp_gt_u32 vcc, 19, v12
s_nop 0
s_cbranch_vccz B205
s_waitcnt vmcnt(0)
v_mov_b32 v9, 36
ds_max_u32 v10, v9
ds_read_b128 v[12:15], v3 offset:16
s_waitcnt lgkmcnt(0)
v_min3_u32 v12, v12, v13, v14
v_min_u32 v12, v12, v15
v_cmp_gt_u32 vcc, 19, v12
s_nop 0
s_cbranch_vccz B205
S206:
s_sleep 1
s_sub_u32 s54, s54, 1
s_cmp_lt_i32 s54, 0
s_cbranch_scc1 B205
ds_read_b128 v[12:15], v3 offset:16
s_waitcnt lgkmcnt(0)
v_min3_u32 v12, v12, v13, v14
v_min_u32 v12, v12, v15
v_cmp_gt_u32 vcc, 19, v12
s_nop 0
s_cbranch_vccnz S206
s_branch B205
S207:
s_waitcnt vmcnt(10)
v_mov_b32 v9, 36
ds_max_u32 v10, v9
ds_read_b128 v[12:15], v3 offset:16
s_waitcnt lgkmcnt(0)
v_min3_u32 v12, v12, v13, v14
v_min_u32 v12, v12, v15
v_cmp_gt_u32 vcc, 20, v12
s_nop 0
s_cbranch_vccz B208
s_waitcnt vmcnt(5)
v_mov_b32 v9, 37
ds_max_u32 v10, v9
ds_read_b128 v[12:15], v3 offset:16
s_waitcnt lgkmcnt(0)
v_min3_u32 v12, v12, v13, v14
v_min_u32 v12, v12, v15
v_cmp_gt_u32 vcc, 20, v12
s_nop 0
s_cbranch_vccz B208
s_waitcnt vmcnt(0)
v_mov_b32 v9, 38
ds_max_u32 v10, v9
ds_read_b128 v[12:15], v3 offset:16
s_waitcnt lgkmcnt(0)
v_min3_u32 v12, v12, v13, v14
v_min_u32 v12, v12, v15
v_cmp_gt_u32 vcc, 20, v12
s_nop 0
s_cbranch_vccz B208
S209:
s_sleep 1
s_sub_u32 s54, s54, 1
s_cmp_lt_i32 s54, 0
s_cbranch_scc1 B208
ds_read_b128 v[12:15], v3 offset:16
s_waitcnt lgkmcnt(0)
v_min3_u32 v12, v12, v13, v14
v_min_u32 v12, v12, v15
v_cmp_gt_u32 vcc, 20, v12
s_nop 0
s_cbranch_vccnz S209
s_branch B208
S210:
s_waitcnt vmcnt(10)
v_mov_b32 v9, 38
ds_max_u32 v10, v9
ds_read_b128 v[12:15], v3 offset:16
s_waitcnt lgkmcnt(0)
v_min3_u32 v12, v12, v13, v14
v_min_u32 v12, v12, v15
v_cmp_gt_u32 vcc, 22, v12
s_nop 0
s_cbranch_vccz B211
s_waitcnt vmcnt(5)
v_mov_b32 v9, 39
ds_max_u32 v10, v9
ds_read_b128 v[12:15], v3 offset:16
s_waitcnt lgkmcnt(0)
v_min3_u32 v12, v12, v13, v14
v_min_u32 v12, v12, v15
v_cmp_gt_u32 vcc, 22, v12
s_nop 0
s_cbranch_vccz B211
s_waitcnt vmcnt(0)
v_mov_b32 v9, 40
ds_max_u32 v10, v9
ds_read_b128 v[12:15], v3 offset:16
s_waitcnt lgkmcnt(0)
v_min3_u32 v12, v12, v13, v14
v_min_u32 v12, v12, v15
v_cmp_gt_u32 vcc, 22, v12
s_nop 0
s_cbranch_vccz B211
S212:
s_sleep 1
s_sub_u32 s54, s54, 1
s_cmp_lt_i32 s54, 0
s_cbranch_scc1 B211
ds_read_b128 v[12:15], v3 offset:16
s_waitcnt lgkmcnt(0)
v_min3_u32 v12, v12, v13, v14
v_min_u32 v12, v12, v15
v_cmp_gt_u32 vcc, 22, v12
s_nop 0
s_cbranch_vccnz S212
s_branch B211
S213:
s_waitcnt vmcnt(10)
v_mov_b32 v9, 40
ds_max_u32 v10, v9
ds_read_b128 v[12:15], v3 offset:16
s_waitcnt lgkmcnt(0)
v_min3_u32 v12, v12, v13, v14
v_min_u32 v12, v12, v15
v_cmp_gt_u32 vcc, 23, v12
s_nop 0
s_cbranch_vccz B214
s_waitcnt vmcnt(5)
v_mov_b32 v9, 41
ds_max_u32 v10, v9
ds_read_b128 v[12:15], v3 offset:16
s_waitcnt lgkmcnt(0)
v_min3_u32 v12, v12, v13, v14
v_min_u32 v12, v12, v15
v_cmp_gt_u32 vcc, 23, v12
s_nop 0
s_cbranch_vccz B214
s_waitcnt vmcnt(0)
v_mov_b32 v9, 42
ds_max_u32 v10, v9
ds_read_b128 v[12:15], v3 offset:16
s_waitcnt lgkmcnt(0)
v_min3_u32 v12, v12, v13, v14
v_min_u32 v12, v12, v15
v_cmp_gt_u32 vcc, 23, v12
s_nop 0
s_cbranch_vccz B214
S215:
s_sleep 1
s_sub_u32 s54, s54, 1
s_cmp_lt_i32 s54, 0
s_cbranch_scc1 B214
ds_read_b128 v[12:15], v3 offset:16
s_waitcnt lgkmcnt(0)
v_min3_u32 v12, v12, v13, v14
v_min_u32 v12, v12, v15
v_cmp_gt_u32 vcc, 23, v12
s_nop 0
s_cbranch_vccnz S215
s_branch B214
N218:
s_mov_b64 s[80:81], 0
s_atomic_add_x2 s[80:81], s[36:37], s50 glc
s_sub_u32 s54, s54, 1
s_cmp_lt_i32 s54, 0
s_cbranch_scc1 B219
s_waitcnt lgkmcnt(0)
s_cmp_lg_u32 s81, s53
s_cbranch_scc1 N218
s_andn2_b32 s51, 4, s80
s_cbranch_scc1 N218
s_branch B219
N220:
s_mov_b64 s[80:81], 0
s_atomic_add_x2 s[80:81], s[36:37], s50 glc
s_sub_u32 s54, s54, 1
s_cmp_lt_i32 s54, 0
s_cbranch_scc1 B221
s_waitcnt lgkmcnt(0)
s_cmp_lg_u32 s81, s53
s_cbranch_scc1 N220
s_andn2_b32 s51, 8, s80
s_cbranch_scc1 N220
s_branch B221
W224:
s_waitcnt vmcnt(0)
v_mov_b32 v9, 3
ds_max_u32 v10, v9
W222:
ds_read_b32 v6, v3 offset:8
s_sleep 1
s_sub_u32 s54, s54, 1
s_cmp_lt_i32 s54, 0
s_cbranch_scc1 B223
s_waitcnt lgkmcnt(0)
v_cmp_gt_u32 vcc, 1, v6
s_nop 0
s_cbranch_vccnz W222
s_branch B223
S225:
s_waitcnt vmcnt(0)
v_mov_b32 v9, 4
ds_max_u32 v10, v9
ds_read_b128 v[12:15], v3 offset:16
s_waitcnt lgkmcnt(0)
v_min3_u32 v12, v12, v13, v14
v_min_u32 v12, v12, v15
v_cmp_gt_u32 vcc, 1, v12
s_nop 0
s_cbranch_vccz B226
S227:
s_sleep 1
s_sub_u32 s54, s54, 1
s_cmp_lt_i32 s54, 0
s_cbranch_scc1 B226
ds_read_b128 v[12:15], v3 offset:16
s_waitcnt lgkmcnt(0)
v_min3_u32 v12, v12, v13, v14
v_min_u32 v12, v12, v15
v_cmp_gt_u32 vcc, 1, v12
s_nop 0
s_cbranch_vccnz S227
s_branch B226
S228:
s_waitcnt vmcnt(0)
v_mov_b32 v9, 5
ds_max_u32 v10, v9
ds_read_b128 v[12:15], v3 offset:16
s_waitcnt lgkmcnt(0)
v_min3_u32 v12, v12, v13, v14
v_min_u32 v12, v12, v15
v_cmp_gt_u32 vcc, 2, v12
s_nop 0
s_cbranch_vccz B229
S230:
s_sleep 1
s_sub_u32 s54, s54, 1
s_cmp_lt_i32 s54, 0
s_cbranch_scc1 B229
ds_read_b128 v[12:15], v3 offset:16
s_waitcnt lgkmcnt(0)
v_min3_u32 v12, v12, v13, v14
v_min_u32 v12, v12, v15
v_cmp_gt_u32 vcc, 2, v12
s_nop 0
s_cbranch_vccnz S230
s_branch B229
S231:
s_waitcnt vmcnt(0)
v_mov_b32 v9, 6
ds_max_u32 v10, v9
ds_read_b128 v[12:15], v3 offset:16
s_waitcnt lgkmcnt(0)
v_min3_u32 v12, v12, v13, v14
v_min_u32 v12, v12, v15
v_cmp_gt_u32 vcc, 3, v12
s_nop 0
s_cbranch_vccz B232
S233:
s_sleep 1
s_sub_u32 s54, s54, 1
s_cmp_lt_i32 s54, 0
s_cbranch_scc1 B232
ds_read_b128 v[12:15], v3 offset:16
s_waitcnt lgkmcnt(0)
v_min3_u32 v12, v12, v13, v14
v_min_u32 v12, v12, v15
v_cmp_gt_u32 vcc, 3, v12
s_nop 0
s_cbranch_vccnz S233
s_branch B232
S234:
s_waitcnt vmcnt(0)
v_mov_b32 v9, 7
ds_max_u32 v10, v9
ds_read_b128 v[12:15], v3 offset:16
s_waitcnt lgkmcnt(0)
v_min3_u32 v12, v12, v13, v14
v_min_u32 v12, v12, v15
v_cmp_gt_u32 vcc, 4, v12
s_nop 0
s_cbranch_vccz B235
S236:
s_sleep 1
s_sub_u32 s54, s54, 1
s_cmp_lt_i32 s54, 0
s_cbranch_scc1 B235
ds_read_b128 v[12:15], v3 offset:16
s_waitcnt lgkmcnt(0)
v_min3_u32 v12, v12, v13, v14
v_min_u32 v12, v12, v15
v_cmp_gt_u32 vcc, 4, v12
s_nop 0
s_cbranch_vccnz S236
s_branch B235
S237:
s_waitcnt vmcnt(0)
v_mov_b32 v9, 8
ds_max_u32 v10, v9
ds_read_b128 v[12:15], v3 offset:16
s_waitcnt lgkmcnt(0)
v_min3_u32 v12, v12, v13, v14
v_min_u32 v12, v12, v15
v_cmp_gt_u32 vcc, 5, v12
s_nop 0
s_cbranch_vccz B238
S239:
s_sleep 1
s_sub_u32 s54, s54, 1
s_cmp_lt_i32 s54, 0
s_cbranch_scc1 B238
ds_read_b128 v[12:15], v3 offset:16
s_waitcnt lgkmcnt(0)
v_min3_u32 v12, v12, v13, v14
v_min_u32 v12, v12, v15
v_cmp_gt_u32 vcc, 5, v12
s_nop 0
s_cbranch_vccnz S239
s_branch B238
W242:
s_waitcnt vmcnt(0)
v_mov_b32 v9, 9
ds_max_u32 v10, v9
W240:
ds_read_b32 v6, v3 offset:36
s_sleep 1
s_sub_u32 s54, s54, 1
s_cmp_lt_i32 s54, 0
s_cbranch_scc1 B241
s_waitcnt lgkmcnt(0)
v_cmp_gt_u32 vcc, 1, v6
s_nop 0
s_cbranch_vccnz W240
s_branch B241
S243:
s_waitcnt vmcnt(1)
v_mov_b32 v9, 9
ds_max_u32 v10, v9
ds_read_b128 v[12:15], v3 offset:16
s_waitcnt lgkmcnt(0)
v_min3_u32 v12, v12, v13, v14
v_min_u32 v12, v12, v15
v_cmp_gt_u32 vcc, 6, v12
s_nop 0
s_cbranch_vccz B244
S245:
s_sleep 1
s_sub_u32 s54, s54, 1
s_cmp_lt_i32 s54, 0
s_cbranch_scc1 B244
ds_read_b128 v[12:15], v3 offset:16
s_waitcnt lgkmcnt(0)
v_min3_u32 v12, v12, v13, v14
v_min_u32 v12, v12, v15
v_cmp_gt_u32 vcc, 6, v12
s_nop 0
s_cbranch_vccnz S245
s_branch B244
R246:
s_waitcnt vmcnt(0)
v_mov_b32 v9, 10
ds_max_u32 v10, v9
s_waitcnt vmcnt(0) lgkmcnt(0)
R248:
s_sleep 8
v_mov_b32 v20, v2
s_mov_b32 exec_lo, 0xfffff
s_mov_b32 exec_hi, 0xfffff
v_mov_b32 v20, 0
buffer_atomic_add v20, v22, s[36:39], 0 offen sc0 sc1
s_mov_b64 exec, -1
s_waitcnt vmcnt(0)
s_sub_u32 s54, s54, 1
s_cmp_lt_i32 s54, 0
s_cbranch_scc1 B247
v_cmp_ne_u32 vcc, s53, v20
s_nop 0
s_cbranch_vccnz R248
s_nop 4
s_branch B247
S249:
s_waitcnt vmcnt(0)
v_mov_b32 v9, 10
ds_max_u32 v10, v9
ds_read_b128 v[12:15], v3 offset:16
s_waitcnt lgkmcnt(0)
v_min3_u32 v12, v12, v13, v14
v_min_u32 v12, v12, v15
v_cmp_gt_u32 vcc, 7, v12
s_nop 0
s_cbranch_vccz B250
S251:
s_sleep 1
s_sub_u32 s54, s54, 1
s_cmp_lt_i32 s54, 0
s_cbranch_scc1 B250
ds_read_b128 v[12:15], v3 offset:16
s_waitcnt lgkmcnt(0)
v_min3_u32 v12, v12, v13, v14
v_min_u32 v12, v12, v15
v_cmp_gt_u32 vcc, 7, v12
s_nop 0
s_cbranch_vccnz S251
s_branch B250
S252:
s_waitcnt vmcnt(0)
v_mov_b32 v9, 11
ds_max_u32 v10, v9
ds_read_b128 v[12:15], v3 offset:16
s_waitcnt lgkmcnt(0)
v_min3_u32 v12, v12, v13, v14
v_min_u32 v12, v12, v15
v_cmp_gt_u32 vcc, 8, v12
s_nop 0
s_cbranch_vccz B253
S254:
s_sleep 1
s_sub_u32 s54, s54, 1
s_cmp_lt_i32 s54, 0
s_cbranch_scc1 B253
ds_read_b128 v[12:15], v3 offset:16
s_waitcnt lgkmcnt(0)
v_min3_u32 v12, v12, v13, v14
v_min_u32 v12, v12, v15
v_cmp_gt_u32 vcc, 8, v12
s_nop 0
s_cbranch_vccnz S254
s_branch B253
S255:
s_waitcnt vmcnt(0)
v_mov_b32 v9, 12
ds_max_u32 v10, v9
ds_read_b128 v[12:15], v3 offset:16
s_waitcnt lgkmcnt(0)
v_min3_u32 v12, v12, v13, v14
v_min_u32 v12, v12, v15
v_cmp_gt_u32 vcc, 9, v12
s_nop 0
s_cbranch_vccz B256
S257:
s_sleep 1
s_sub_u32 s54, s54, 1
s_cmp_lt_i32 s54, 0
s_cbranch_scc1 B256
ds_read_b128 v[12:15], v3 offset:16
s_waitcnt lgkmcnt(0)
v_min3_u32 v12, v12, v13, v14
v_min_u32 v12, v12, v15
v_cmp_gt_u32 vcc, 9, v12
s_nop 0
s_cbranch_vccnz S257
s_branch B256
S258:
s_waitcnt vmcnt(0)
v_mov_b32 v9, 14
ds_max_u32 v10, v9
ds_read_b128 v[12:15], v3 offset:16
s_waitcnt lgkmcnt(0)
v_min3_u32 v12, v12, v13, v14
v_min_u32 v12, v12, v15
v_cmp_gt_u32 vcc, 10, v12
s_nop 0
s_cbranch_vccz B259
S260:
s_sleep 1
s_sub_u32 s54, s54, 1
s_cmp_lt_i32 s54, 0
s_cbranch_scc1 B259
ds_read_b128 v[12:15], v3 offset:16
s_waitcnt lgkmcnt(0)
v_min3_u32 v12, v12, v13, v14
v_min_u32 v12, v12, v15
v_cmp_gt_u32 vcc, 10, v12
s_nop 0
s_cbranch_vccnz S260
s_branch B259
S261:
s_waitcnt vmcnt(6)
v_mov_b32 v9, 16
ds_max_u32 v10, v9
ds_read_b128 v[12:15], v3 offset:16
s_waitcnt lgkmcnt(0)
v_min3_u32 v12, v12, v13, v14
v_min_u32 v12, v12, v15
v_cmp_gt_u32 vcc, 11, v12
s_nop 0
s_cbranch_vccz B262
s_waitcnt vmcnt(0)
v_mov_b32 v9, 17
ds_max_u32 v10, v9
ds_read_b128 v[12:15], v3 offset:16
s_waitcnt lgkmcnt(0)
v_min3_u32 v12, v12, v13, v14
v_min_u32 v12, v12, v15
v_cmp_gt_u32 vcc, 11, v12
s_nop 0
s_cbranch_vccz B262
S263:
s_sleep 1
s_sub_u32 s54, s54, 1
s_cmp_lt_i32 s54, 0
s_cbranch_scc1 B262
ds_read_b128 v[12:15], v3 offset:16
s_waitcnt lgkmcnt(0)
v_min3_u32 v12, v12, v13, v14
v_min_u32 v12, v12, v15
v_cmp_gt_u32 vcc, 11, v12
s_nop 0
s_cbranch_vccnz S263
s_branch B262
W266:
s_waitcnt vmcnt(6)
v_mov_b32 v9, 17
ds_max_u32 v10, v9
s_waitcnt vmcnt(0)
v_mov_b32 v9, 18
ds_max_u32 v10, v9
W264:
ds_read_b64 v[6:7], v3 offset:40
s_sleep 1
s_sub_u32 s54, s54, 1
s_cmp_lt_i32 s54, 0
s_cbranch_scc1 B265
s_waitcnt lgkmcnt(0)
v_min_u32 v6, v6, v7
v_cmp_gt_u32 vcc, 1, v6
s_nop 0
s_cbranch_vccnz W264
s_branch B265
S267:
s_waitcnt vmcnt(6)
v_mov_b32 v9, 18
ds_max_u32 v10, v9
ds_read_b128 v[12:15], v3 offset:16
s_waitcnt lgkmcnt(0)
v_min3_u32 v12, v12, v13, v14
v_min_u32 v12, v12, v15
v_cmp_gt_u32 vcc, 12, v12
s_nop 0
s_cbranch_vccz B268
s_waitcnt vmcnt(0)
v_mov_b32 v9, 19
ds_max_u32 v10, v9
ds_read_b128 v[12:15], v3 offset:16
s_waitcnt lgkmcnt(0)
v_min3_u32 v12, v12, v13, v14
v_min_u32 v12, v12, v15
v_cmp_gt_u32 vcc, 12, v12
s_nop 0
s_cbranch_vccz B268
S269:
s_sleep 1
s_sub_u32 s54, s54, 1
s_cmp_lt_i32 s54, 0
s_cbranch_scc1 B268
ds_read_b128 v[12:15], v3 offset:16
s_waitcnt lgkmcnt(0)
v_min3_u32 v12, v12, v13, v14
v_min_u32 v12, v12, v15
v_cmp_gt_u32 vcc, 12, v12
s_nop 0
s_cbranch_vccnz S269
s_branch B268
S270:
s_waitcnt vmcnt(6)
v_mov_b32 v9, 22
ds_max_u32 v10, v9
ds_read_b128 v[12:15], v3 offset:16
s_waitcnt lgkmcnt(0)
v_min3_u32 v12, v12, v13, v14
v_min_u32 v12, v12, v15
v_cmp_gt_u32 vcc, 13, v12
s_nop 0
s_cbranch_vccz B271
s_waitcnt vmcnt(0)
v_mov_b32 v9, 23
ds_max_u32 v10, v9
ds_read_b128 v[12:15], v3 offset:16
s_waitcnt lgkmcnt(0)
v_min3_u32 v12, v12, v13, v14
v_min_u32 v12, v12, v15
v_cmp_gt_u32 vcc, 13, v12
s_nop 0
s_cbranch_vccz B271
S272:
s_sleep 1
s_sub_u32 s54, s54, 1
s_cmp_lt_i32 s54, 0
s_cbranch_scc1 B271
ds_read_b128 v[12:15], v3 offset:16
s_waitcnt lgkmcnt(0)
v_min3_u32 v12, v12, v13, v14
v_min_u32 v12, v12, v15
v_cmp_gt_u32 vcc, 13, v12
s_nop 0
s_cbranch_vccnz S272
s_branch B271
R273:
s_waitcnt vmcnt(6)
v_mov_b32 v9, 24
ds_max_u32 v10, v9
s_waitcnt vmcnt(0)
v_mov_b32 v9, 25
ds_max_u32 v10, v9
s_waitcnt vmcnt(0) lgkmcnt(0)
R275:
s_sleep 8
v_mov_b32 v20, v2
v_mov_b32 v21, v2
s_mov_b32 exec_lo, 0xffffff
s_mov_b32 exec_hi, 0xffffff
v_mov_b32 v20, 0
v_mov_b32 v21, 0
buffer_atomic_add_x2 v[20:21], v23, s[36:39], 0 offen sc0 sc1
s_mov_b64 exec, -1
s_waitcnt vmcnt(0)
s_sub_u32 s54, s54, 1
s_cmp_lt_i32 s54, 0
s_cbranch_scc1 B274
v_xor_b32 v40, s53, v20
v_bitop3_b32 v40, v40, v2, v21 bitop3:0xf6
v_cmp_ne_u32 vcc, 0, v40
s_nop 0
s_cbranch_vccnz R275
s_nop 4
s_branch B274
S276:
s_waitcnt vmcnt(6)
v_mov_b32 v9, 24
ds_max_u32 v10, v9
ds_read_b128 v[12:15], v3 offset:16
s_waitcnt lgkmcnt(0)
v_min3_u32 v12, v12, v13, v14
v_min_u32 v12, v12, v15
v_cmp_gt_u32 vcc, 14, v12
s_nop 0
s_cbranch_vccz B277
s_waitcnt vmcnt(0)
v_mov_b32 v9, 25
ds_max_u32 v10, v9
ds_read_b128 v[12:15], v3 offset:16
s_waitcnt lgkmcnt(0)
v_min3_u32 v12, v12, v13, v14
v_min_u32 v12, v12, v15
v_cmp_gt_u32 vcc, 14, v12
s_nop 0
s_cbranch_vccz B277
S278:
s_sleep 1
s_sub_u32 s54, s54, 1
s_cmp_lt_i32 s54, 0
s_cbranch_scc1 B277
ds_read_b128 v[12:15], v3 offset:16
s_waitcnt lgkmcnt(0)
v_min3_u32 v12, v12, v13, v14
v_min_u32 v12, v12, v15
v_cmp_gt_u32 vcc, 14, v12
s_nop 0
s_cbranch_vccnz S278
s_branch B277
S279:
s_waitcnt vmcnt(5)
v_mov_b32 v9, 26
ds_max_u32 v10, v9
ds_read_b128 v[12:15], v3 offset:16
s_waitcnt lgkmcnt(0)
v_min3_u32 v12, v12, v13, v14
v_min_u32 v12, v12, v15
v_cmp_gt_u32 vcc, 15, v12
s_nop 0
s_cbranch_vccz B280
s_waitcnt vmcnt(0)
v_mov_b32 v9, 27
ds_max_u32 v10, v9
ds_read_b128 v[12:15], v3 offset:16
s_waitcnt lgkmcnt(0)
v_min3_u32 v12, v12, v13, v14
v_min_u32 v12, v12, v15
v_cmp_gt_u32 vcc, 15, v12
s_nop 0
s_cbranch_vccz B280
S281:
s_sleep 1
s_sub_u32 s54, s54, 1
s_cmp_lt_i32 s54, 0
s_cbranch_scc1 B280
ds_read_b128 v[12:15], v3 offset:16
s_waitcnt lgkmcnt(0)
v_min3_u32 v12, v12, v13, v14
v_min_u32 v12, v12, v15
v_cmp_gt_u32 vcc, 15, v12
s_nop 0
s_cbranch_vccnz S281
s_branch B280
S282:
s_waitcnt vmcnt(5)
v_mov_b32 v9, 28
ds_max_u32 v10, v9
ds_read_b128 v[12:15], v3 offset:16
s_waitcnt lgkmcnt(0)
v_min3_u32 v12, v12, v13, v14
v_min_u32 v12, v12, v15
v_cmp_gt_u32 vcc, 16, v12
s_nop 0
s_cbranch_vccz B283
s_waitcnt vmcnt(0)
v_mov_b32 v9, 29
ds_max_u32 v10, v9
ds_read_b128 v[12:15], v3 offset:16
s_waitcnt lgkmcnt(0)
v_min3_u32 v12, v12, v13, v14
v_min_u32 v12, v12, v15
v_cmp_gt_u32 vcc, 16, v12
s_nop 0
s_cbranch_vccz B283
S284:
s_sleep 1
s_sub_u32 s54, s54, 1
s_cmp_lt_i32 s54, 0
s_cbranch_scc1 B283
ds_read_b128 v[12:15], v3 offset:16
s_waitcnt lgkmcnt(0)
v_min3_u32 v12, v12, v13, v14
v_min_u32 v12, v12, v15
v_cmp_gt_u32 vcc, 16, v12
s_nop 0
s_cbranch_vccnz S284
s_branch B283
S285:
s_waitcnt vmcnt(5)
v_mov_b32 v9, 31
ds_max_u32 v10, v9
ds_read_b128 v[12:15], v3 offset:16
s_waitcnt lgkmcnt(0)
v_min3_u32 v12, v12, v13, v14
v_min_u32 v12, v12, v15
v_cmp_gt_u32 vcc, 17, v12
s_nop 0
s_cbranch_vccz B286
s_waitcnt vmcnt(0)
v_mov_b32 v9, 32
ds_max_u32 v10, v9
ds_read_b128 v[12:15], v3 offset:16
s_waitcnt lgkmcnt(0)
v_min3_u32 v12, v12, v13, v14
v_min_u32 v12, v12, v15
v_cmp_gt_u32 vcc, 17, v12
s_nop 0
s_cbranch_vccz B286
S287:
s_sleep 1
s_sub_u32 s54, s54, 1
s_cmp_lt_i32 s54, 0
s_cbranch_scc1 B286
ds_read_b128 v[12:15], v3 offset:16
s_waitcnt lgkmcnt(0)
v_min3_u32 v12, v12, v13, v14
v_min_u32 v12, v12, v15
v_cmp_gt_u32 vcc, 17, v12
s_nop 0
s_cbranch_vccnz S287
s_branch B286
W290:
s_waitcnt vmcnt(5)
v_mov_b32 v9, 31
ds_max_u32 v10, v9
s_waitcnt vmcnt(0)
v_mov_b32 v9, 32
ds_max_u32 v10, v9
W288:
ds_read_b32 v6, v3 offset:56
s_sleep 1
s_sub_u32 s54, s54, 1
s_cmp_lt_i32 s54, 0
s_cbranch_scc1 B289
s_waitcnt lgkmcnt(0)
v_cmp_gt_u32 vcc, 1, v6
s_nop 0
s_cbranch_vccnz W288
s_branch B289
S291:
s_waitcnt vmcnt(10)
v_mov_b32 v9, 32
ds_max_u32 v10, v9
ds_read_b128 v[12:15], v3 offset:16
s_waitcnt lgkmcnt(0)
v_min3_u32 v12, v12, v13, v14
v_min_u32 v12, v12, v15
v_cmp_gt_u32 vcc, 18, v12
s_nop 0
s_cbranch_vccz B292
s_waitcnt vmcnt(5)
v_mov_b32 v9, 33
ds_max_u32 v10, v9
ds_read_b128 v[12:15], v3 offset:16
s_waitcnt lgkmcnt(0)
v_min3_u32 v12, v12, v13, v14
v_min_u32 v12, v12, v15
v_cmp_gt_u32 vcc, 18, v12
s_nop 0
s_cbranch_vccz B292
s_waitcnt vmcnt(0)
v_mov_b32 v9, 34
ds_max_u32 v10, v9
ds_read_b128 v[12:15], v3 offset:16
s_waitcnt lgkmcnt(0)
v_min3_u32 v12, v12, v13, v14
v_min_u32 v12, v12, v15
v_cmp_gt_u32 vcc, 18, v12
s_nop 0
s_cbranch_vccz B292
S293:
s_sleep 1
s_sub_u32 s54, s54, 1
s_cmp_lt_i32 s54, 0
s_cbranch_scc1 B292
ds_read_b128 v[12:15], v3 offset:16
s_waitcnt lgkmcnt(0)
v_min3_u32 v12, v12, v13, v14
v_min_u32 v12, v12, v15
v_cmp_gt_u32 vcc, 18, v12
s_nop 0
s_cbranch_vccnz S293
s_branch B292
S294:
s_waitcnt vmcnt(10)
v_mov_b32 v9, 34
ds_max_u32 v10, v9
ds_read_b128 v[12:15], v3 offset:16
s_waitcnt lgkmcnt(0)
v_min3_u32 v12, v12, v13, v14
v_min_u32 v12, v12, v15
v_cmp_gt_u32 vcc, 19, v12
s_nop 0
s_cbranch_vccz B295
s_waitcnt vmcnt(5)
v_mov_b32 v9, 35
ds_max_u32 v10, v9
ds_read_b128 v[12:15], v3 offset:16
s_waitcnt lgkmcnt(0)
v_min3_u32 v12, v12, v13, v14
v_min_u32 v12, v12, v15
v_cmp_gt_u32 vcc, 19, v12
s_nop 0
s_cbranch_vccz B295
s_waitcnt vmcnt(0)
v_mov_b32 v9, 36
ds_max_u32 v10, v9
ds_read_b128 v[12:15], v3 offset:16
s_waitcnt lgkmcnt(0)
v_min3_u32 v12, v12, v13, v14
v_min_u32 v12, v12, v15
v_cmp_gt_u32 vcc, 19, v12
s_nop 0
s_cbranch_vccz B295
S296:
s_sleep 1
s_sub_u32 s54, s54, 1
s_cmp_lt_i32 s54, 0
s_cbranch_scc1 B295
ds_read_b128 v[12:15], v3 offset:16
s_waitcnt lgkmcnt(0)
v_min3_u32 v12, v12, v13, v14
v_min_u32 v12, v12, v15
v_cmp_gt_u32 vcc, 19, v12
s_nop 0
s_cbranch_vccnz S296
s_branch B295
S297:
s_waitcnt vmcnt(10)
v_mov_b32 v9, 36
ds_max_u32 v10, v9
ds_read_b128 v[12:15], v3 offset:16
s_waitcnt lgkmcnt(0)
v_min3_u32 v12, v12, v13, v14
v_min_u32 v12, v12, v15
v_cmp_gt_u32 vcc, 20, v12
s_nop 0
s_cbranch_vccz B298
s_waitcnt vmcnt(5)
v_mov_b32 v9, 37
ds_max_u32 v10, v9
ds_read_b128 v[12:15], v3 offset:16
s_waitcnt lgkmcnt(0)
v_min3_u32 v12, v12, v13, v14
v_min_u32 v12, v12, v15
v_cmp_gt_u32 vcc, 20, v12
s_nop 0
s_cbranch_vccz B298
s_waitcnt vmcnt(0)
v_mov_b32 v9, 38
ds_max_u32 v10, v9
ds_read_b128 v[12:15], v3 offset:16
s_waitcnt lgkmcnt(0)
v_min3_u32 v12, v12, v13, v14
v_min_u32 v12, v12, v15
v_cmp_gt_u32 vcc, 20, v12
s_nop 0
s_cbranch_vccz B298
S299:
s_sleep 1
s_sub_u32 s54, s54, 1
s_cmp_lt_i32 s54, 0
s_cbranch_scc1 B298
ds_read_b128 v[12:15], v3 offset:16
s_waitcnt lgkmcnt(0)
v_min3_u32 v12, v12, v13, v14
v_min_u32 v12, v12, v15
v_cmp_gt_u32 vcc, 20, v12
s_nop 0
s_cbranch_vccnz S299
s_branch B298
S300:
s_waitcnt vmcnt(10)
v_mov_b32 v9, 38
ds_max_u32 v10, v9
ds_read_b128 v[12:15], v3 offset:16
s_waitcnt lgkmcnt(0)
v_min3_u32 v12, v12, v13, v14
v_min_u32 v12, v12, v15
v_cmp_gt_u32 vcc, 22, v12
s_nop 0
s_cbranch_vccz B301
s_waitcnt vmcnt(5)
v_mov_b32 v9, 39
ds_max_u32 v10, v9
ds_read_b128 v[12:15], v3 offset:16
s_waitcnt lgkmcnt(0)
v_min3_u32 v12, v12, v13, v14
v_min_u32 v12, v12, v15
v_cmp_gt_u32 vcc, 22, v12
s_nop 0
s_cbranch_vccz B301
s_waitcnt vmcnt(0)
v_mov_b32 v9, 40
ds_max_u32 v10, v9
ds_read_b128 v[12:15], v3 offset:16
s_waitcnt lgkmcnt(0)
v_min3_u32 v12, v12, v13, v14
v_min_u32 v12, v12, v15
v_cmp_gt_u32 vcc, 22, v12
s_nop 0
s_cbranch_vccz B301
S302:
s_sleep 1
s_sub_u32 s54, s54, 1
s_cmp_lt_i32 s54, 0
s_cbranch_scc1 B301
ds_read_b128 v[12:15], v3 offset:16
s_waitcnt lgkmcnt(0)
v_min3_u32 v12, v12, v13, v14
v_min_u32 v12, v12, v15
v_cmp_gt_u32 vcc, 22, v12
s_nop 0
s_cbranch_vccnz S302
s_branch B301
S303:
s_waitcnt vmcnt(10)
v_mov_b32 v9, 40
ds_max_u32 v10, v9
ds_read_b128 v[12:15], v3 offset:16
s_waitcnt lgkmcnt(0)
v_min3_u32 v12, v12, v13, v14
v_min_u32 v12, v12, v15
v_cmp_gt_u32 vcc, 23, v12
s_nop 0
s_cbranch_vccz B304
s_waitcnt vmcnt(5)
v_mov_b32 v9, 41
ds_max_u32 v10, v9
ds_read_b128 v[12:15], v3 offset:16
s_waitcnt lgkmcnt(0)
v_min3_u32 v12, v12, v13, v14
v_min_u32 v12, v12, v15
v_cmp_gt_u32 vcc, 23, v12
s_nop 0
s_cbranch_vccz B304
s_waitcnt vmcnt(0)
v_mov_b32 v9, 42
ds_max_u32 v10, v9
ds_read_b128 v[12:15], v3 offset:16
s_waitcnt lgkmcnt(0)
v_min3_u32 v12, v12, v13, v14
v_min_u32 v12, v12, v15
v_cmp_gt_u32 vcc, 23, v12
s_nop 0
s_cbranch_vccz B304
S305:
s_sleep 1
s_sub_u32 s54, s54, 1
s_cmp_lt_i32 s54, 0
s_cbranch_scc1 B304
ds_read_b128 v[12:15], v3 offset:16
s_waitcnt lgkmcnt(0)
v_min3_u32 v12, v12, v13, v14
v_min_u32 v12, v12, v15
v_cmp_gt_u32 vcc, 23, v12
s_nop 0
s_cbranch_vccnz S305
s_branch B304
N308:
s_mov_b64 s[76:77], 0
s_atomic_add_x2 s[76:77], s[36:37], s50 glc
s_sub_u32 s54, s54, 1
s_cmp_lt_i32 s54, 0
s_cbranch_scc1 B309
s_waitcnt lgkmcnt(0)
s_cmp_lg_u32 s77, s53
s_cbranch_scc1 N308
s_andn2_b32 s51, 1, s76
s_cbranch_scc1 N308
s_branch B309
N310:
s_mov_b64 s[76:77], 0
s_atomic_add_x2 s[76:77], s[36:37], s50 glc
s_sub_u32 s54, s54, 1
s_cmp_lt_i32 s54, 0
s_cbranch_scc1 B311
s_waitcnt lgkmcnt(0)
s_cmp_lg_u32 s77, s53
s_cbranch_scc1 N310
s_andn2_b32 s51, 2, s76
s_cbranch_scc1 N310
s_branch B311
W313:
ds_read_b32 v6, v3 offset:12
s_sleep 2
s_sub_u32 s54, s54, 1
s_cmp_lt_i32 s54, 0
s_cbranch_scc1 B314
s_waitcnt lgkmcnt(0)
v_cmp_gt_u32 vcc, 1, v6
s_nop 0
s_cbranch_vccnz W313
s_branch B314
W315:
ds_read_b64 v[6:7], v3 offset:0
s_sleep 4
s_sub_u32 s54, s54, 1
s_cmp_lt_i32 s54, 0
s_cbranch_scc1 B316
s_waitcnt lgkmcnt(0)
v_min_u32 v6, v6, v7
v_cmp_gt_u32 vcc, 4, v6
s_nop 0
s_cbranch_vccnz W315
s_branch B316
R317:
s_waitcnt vmcnt(0) lgkmcnt(0)
R319:
s_sleep 8
buffer_load_dwordx4 v[40:43], v4, s[36:39], s66 offen offset:0 sc1
buffer_load_dwordx4 v[44:47], v4, s[36:39], s66 offen offset:1024 sc1
buffer_load_dwordx4 v[48:51], v4, s[36:39], s67 offen sc1
buffer_load_dwordx2 v[38:39], v13, s[36:39], s69 offen sc1
buffer_load_dwordx2 v[52:53], v13, s[36:39], s70 offen sc1
buffer_load_dwordx2 v[54:55], v13, s[36:39], s71 offen sc1
buffer_load_dwordx2 v[56:57], v13, s[36:39], s72 offen sc1
buffer_load_dwordx2 v[58:59], v14, s[36:39], s69 offen sc1
buffer_load_dwordx2 v[60:61], v14, s[36:39], s70 offen sc1
buffer_load_dwordx2 v[62:63], v14, s[36:39], s71 offen sc1
buffer_load_dwordx2 v[64:65], v14, s[36:39], s72 offen sc1
buffer_load_dwordx2 v[66:67], v15, s[36:39], s69 offen sc1
buffer_load_dwordx2 v[68:69], v15, s[36:39], s70 offen sc1
buffer_load_dwordx2 v[70:71], v15, s[36:39], s71 offen sc1
buffer_load_dwordx2 v[72:73], v15, s[36:39], s72 offen sc1
buffer_load_dwordx2 v[74:75], v36, s[36:39], s69 offen sc1
buffer_load_dwordx2 v[76:77], v36, s[36:39], s70 offen sc1
buffer_load_dwordx2 v[78:79], v36, s[36:39], s71 offen sc1
buffer_load_dwordx2 v[80:81], v36, s[36:39], s72 offen sc1
s_waitcnt vmcnt(0)
s_sub_u32 s54, s54, 1
s_cmp_lt_i32 s54, 0
s_cbranch_scc1 B318
v_xor_b32 v82, s53, v43
v_bitop3_b32 v82, v82, v2, v47 bitop3:0xf6
v_bitop3_b32 v82, v82, v2, v51 bitop3:0xf6
v_bitop3_b32 v82, v82, v2, v39 bitop3:0xf6
v_bitop3_b32 v82, v82, v2, v53 bitop3:0xf6
v_bitop3_b32 v82, v82, v2, v55 bitop3:0xf6
v_bitop3_b32 v82, v82, v2, v57 bitop3:0xf6
v_bitop3_b32 v82, v82, v2, v59 bitop3:0xf6
v_bitop3_b32 v82, v82, v2, v61 bitop3:0xf6
v_bitop3_b32 v82, v82, v2, v63 bitop3:0xf6
v_bitop3_b32 v82, v82, v2, v65 bitop3:0xf6
v_bitop3_b32 v82, v82, v2, v67 bitop3:0xf6
v_bitop3_b32 v82, v82, v2, v69 bitop3:0xf6
v_bitop3_b32 v82, v82, v2, v71 bitop3:0xf6
v_bitop3_b32 v82, v82, v2, v73 bitop3:0xf6
v_bitop3_b32 v82, v82, v2, v75 bitop3:0xf6
v_bitop3_b32 v82, v82, v2, v77 bitop3:0xf6
v_bitop3_b32 v82, v82, v2, v79 bitop3:0xf6
v_bitop3_b32 v82, v82, v2, v81 bitop3:0xf6
v_cmp_ne_u32 vcc, 0, v82
s_nop 0
s_cbranch_vccnz R319
s_nop 4
s_branch B318
W332:
ds_read_b64 v[6:7], v3 offset:0
s_sleep 8
s_sub_u32 s54, s54, 1
s_cmp_lt_i32 s54, 0
s_cbranch_scc1 B333
s_waitcnt lgkmcnt(0)
v_min_u32 v6, v6, v7
v_cmp_gt_u32 vcc, 8, v6
s_nop 0
s_cbranch_vccnz W332
s_branch B333
N336:
s_sleep 2
s_mov_b64 s[70:71], 0
s_atomic_add_x2 s[70:71], s[36:37], s65 glc
s_sub_u32 s54, s54, 1
s_cmp_lt_i32 s54, 0
s_cbranch_scc1 B337
s_waitcnt lgkmcnt(0)
s_cmp_lg_u32 s71, s53
s_cbranch_scc1 N336
s_andn2_b32 s51, 15, s70
s_cbranch_scc1 N336
s_branch B337
N338:
s_sleep 2
s_mov_b64 s[70:71], 0
s_atomic_add_x2 s[70:71], s[36:37], s65 glc
s_sub_u32 s54, s54, 1
s_cmp_lt_i32 s54, 0
s_cbranch_scc1 B339
s_waitcnt lgkmcnt(0)
s_cmp_lg_u32 s71, s53
s_cbranch_scc1 N338
s_andn2_b32 s51, 240, s70
s_cbranch_scc1 N338
s_branch B339
N340:
s_sleep 2
s_mov_b64 s[70:71], 0
s_atomic_add_x2 s[70:71], s[36:37], s65 glc
s_sub_u32 s54, s54, 1
s_cmp_lt_i32 s54, 0
s_cbranch_scc1 B341
s_waitcnt lgkmcnt(0)
s_cmp_lg_u32 s71, s53
s_cbranch_scc1 N340
s_andn2_b32 s51, 3840, s70
s_cbranch_scc1 N340
s_branch B341
N342:
s_sleep 2
s_mov_b64 s[70:71], 0
s_atomic_add_x2 s[70:71], s[36:37], s65 glc
s_sub_u32 s54, s54, 1
s_cmp_lt_i32 s54, 0
s_cbranch_scc1 B343
s_waitcnt lgkmcnt(0)
s_cmp_lg_u32 s71, s53
s_cbranch_scc1 N342
s_andn2_b32 s51, 61440, s70
s_cbranch_scc1 N342
s_branch B343
s_endpgm
.p2align 8
L_codeend:
.section .rodata,"a"
.p2align 6
.amdhsa_kernel parallel_sum__linear_attn_block__mixer_s_mlp__prompt_kernel
  .amdhsa_next_free_vgpr 256
  .amdhsa_next_free_sgpr 102
  .amdhsa_accum_offset 176
  .amdhsa_group_segment_fixed_size 0
  .amdhsa_kernarg_size 88
  .amdhsa_user_sgpr_count 2
  .amdhsa_user_sgpr_kernarg_segment_ptr 1
  .amdhsa_system_sgpr_workgroup_id_x 1
.end_amdhsa_kernel
```
